```python
import torch

def _softmax(x, axis=-1):
    return torch.softmax(x, dim=axis)

def _gelu(x):
    return torch.nn.functional.gelu(x, approximate='tanh')

def _silu(x):
    return torch.nn.functional.silu(x)

def _sigmoid(x):
    return torch.sigmoid(x)

def _layernorm(x, axis=-1, eps=1e-05):
    m = x.mean(dim=axis, keepdim=True)
    v = x.var(dim=axis, keepdim=True, unbiased=False)
    return (x - m) / torch.sqrt(v + eps)

def _scatter_add(tgt, idx, src, axis=0):
    return tgt.clone().index_add_(axis, idx, src)

def _segment_sum(src, seg, n):
    out = torch.zeros((n,) + src.shape[1:], dtype=src.dtype)
    return out.index_add_(0, seg, src)

def _pad(x, pw):
    flat = tuple((v for pair in reversed(pw) for v in pair))
    return torch.nn.functional.pad(x, flat)
kernel_name = 'sequential_preLN__linear_kernel_hedgehog__mixer_gmlp__prompt'

def setup_inputs():

    _w = lambda a: (lambda t: t.to(torch.bfloat16) if t.is_floating_point() else t)(torch.as_tensor(a))

    def _A_setup():
        B, S, D, H = (1, 2048, 576, 32)
        Dh = D // H
        return {'x': _w((lambda *s: torch.randn(*s, dtype=torch.bfloat16) * 0.05)(B, S, D)), 'wqkv': _w((lambda *s: torch.randn(*s, dtype=torch.bfloat16) * 0.2)(D, 3 * D)), 'w_phi': _w((lambda *s: torch.randn(*s, dtype=torch.bfloat16) * 0.2)(H, Dh, Dh) * Dh ** (-0.5)), 'wo': _w((lambda *s: torch.randn(*s, dtype=torch.bfloat16) * 0.05)(D, D))}
    _A_in = _A_setup()

    def _B_setup():
        B, S, D, F = (1, 2048, 576, 4608)
        Fh = F // 2
        return {'x': _w((lambda *s: torch.randn(*s, dtype=torch.bfloat16) * 0.05)(B, S, D)), 'w_in': _w((lambda *s: torch.randn(*s, dtype=torch.bfloat16) * 0.4)(D, 2 * Fh)), 'w_sp': _w(0.01 * (lambda *s: torch.randn(*s, dtype=torch.bfloat16) * 0.4)(S, S)), 'b_sp': _w(1.0 + 0.01 * (lambda *s: torch.randn(*s, dtype=torch.bfloat16) * 0.05)(S)), 'w_out': _w((lambda *s: torch.randn(*s, dtype=torch.bfloat16) * 0.05)(Fh, D))}
    _B_in = _B_setup()
    return {'A_x': _A_in['x'], 'A_wqkv': _A_in['wqkv'], 'A_w_phi': _A_in['w_phi'], 'A_wo': _A_in['wo'], 'B_x': _B_in['x'], 'B_w_in': _B_in['w_in'], 'B_w_sp': _B_in['w_sp'], 'B_b_sp': _B_in['b_sp'], 'B_w_out': _B_in['w_out']}

def reference(A_x, A_wqkv, A_w_phi, A_wo, B_x, B_w_in, B_w_sp, B_b_sp, B_w_out):

    def _A_ref(x, wqkv, w_phi, wo):
        B, S, D = x.shape
        H = 32
        Dh = D // H
        qkv = (lambda x, *d: x.permute(*d))((x @ wqkv).reshape(B, S, 3, H, Dh), 2, 0, 3, 1, 4)
        q, k, v = (qkv[0], qkv[1], qkv[2])
        pq = torch.einsum('bhsd,hdf->bhsf', q, w_phi)
        pk = torch.einsum('bhsd,hdf->bhsf', k, w_phi)
        phi_q = torch.concatenate([_softmax(pq, axis=-1), _softmax(-pq, axis=-1)], axis=-1)
        phi_k = torch.concatenate([_softmax(pk, axis=-1), _softmax(-pk, axis=-1)], axis=-1)
        kv = torch.einsum('bhsf,bhsd->bhfd', phi_k, v)
        z = torch.einsum('bhsf->bhf', phi_k)
        num = torch.einsum('bhqf,bhfd->bhqd', phi_q, kv)
        den = torch.einsum('bhqf,bhf->bhq', phi_q, z)[..., None] + 1e-06
        o = num / den
        return (lambda x, *d: x.permute(*d))(o, 0, 2, 1, 3).reshape(B, S, D) @ wo

    def _B_ref(x, w_in, w_sp, b_sp, w_out):
        B, S, D = x.shape
        F = w_in.shape[-1]
        Fh = F // 2
        z = _gelu(torch.einsum('bsd,df->bsf', x, w_in))
        z1 = z[..., :Fh].clone()
        z2 = _layernorm(z[..., Fh:], axis=-1)
        g = torch.einsum('ts,bsf->btf', w_sp, z2) + b_sp[None, :, None]
        return torch.einsum('bsf,fd->bsd', z1 * g, w_out)
    x = A_x
    h = x + _A_ref(_layernorm(x, axis=-1), A_wqkv, A_w_phi, A_wo)
    h2 = h + _B_ref(_layernorm(h, axis=-1), B_w_in, B_w_sp, B_b_sp, B_w_out)
    return h2
```

```asm
; @launch kernel=k1_kernel grid=(256,1,1) block=(512,1,1) lds=139520
; @launch kernel=k2_kernel grid=(256,1,1) block=(512,1,1) lds=111104
; @launch kernel=k3_kernel grid=(256,1,1) block=(512,1,1) lds=157696
; @launch kernel=kn_kernel grid=(256,1,1) block=(256,1,1) lds=0
; @launch kernel=k4_kernel grid=(256,1,1) block=(512,1,1) lds=139264
; @launch kernel=k5_kernel grid=(256,1,1) block=(512,1,1) lds=73728
.amdgcn_target "amdgcn-amd-amdhsa--gfx950"
.text
.globl k1_kernel
.p2align 8
.type k1_kernel,@function
k1_kernel:
    s_cmp_ge_u32 s2, 256
    s_cbranch_scc1 k1_kernel_end
    s_load_dwordx16 s[4:19], s[0:1], 0
    s_load_dwordx8 s[20:27], s[0:1], 64
    v_and_b32 v1, 63, v0
    v_lshrrev_b32 v2, 6, v0
    s_nop 0
    v_readfirstlane_b32 s72, v2
    s_and_b32 s52, s72, 3
    s_lshr_b32 s72, s72, 2
    s_and_b32 s66, s2, 7
    s_lshr_b32 s65, s2, 3
    s_lshl_b32 s57, s66, 8
    s_waitcnt lgkmcnt(0)
    s_mov_b32 s28, s4
    s_and_b32 s29, s5, 0xffff
    s_mov_b32 s30, 2359296
    s_mov_b32 s31, 0x00020000
    s_mov_b32 s32, s6
    s_and_b32 s33, s7, 0xffff
    s_mov_b32 s34, 1990656
    s_mov_b32 s35, 0x00020000
    s_mov_b32 s36, s8
    s_and_b32 s37, s9, 0xffff
    s_mov_b32 s38, 20736
    s_mov_b32 s39, 0x00020000
    s_mov_b32 s40, s26
    s_and_b32 s41, s27, 0xffff
    s_mov_b32 s42, 4719104
    s_mov_b32 s43, 0x00020000
    s_add_u32 s44, s26, 9437184
    s_addc_u32 s45, s27, 0
    s_and_b32 s45, s45, 0xffff
    s_mov_b32 s46, 1572864
    s_mov_b32 s47, 0x00020000
    s_add_u32 s48, s26, 12582912
    s_addc_u32 s49, s27, 0
    s_and_b32 s49, s49, 0xffff
    s_mov_b32 s50, 98304
    s_mov_b32 s51, 0x00020000
    s_lshl_b32 s63, s52, 6
    s_add_u32 s63, s63, s57
    s_mul_i32 s64, s65, 36
    s_mul_i32 s53, s52, 2560
    s_add_u32 s53, s53, 108800
    s_lshl_b32 s60, s52, 4
    v_add_u32 v2, 0, v1
    v_mul_u32_u24 v3, 6554, v2
    v_lshrrev_b32 v3, 16, v3
    v_mul_u32_u24 v4, 10, v3
    v_sub_u32 v2, v2, v4
    v_and_b32 v4, 3, v3
    v_and_b32 v5, 4, v3
    v_lshl_or_b32 v4, v5, 1, v4
    v_and_b32 v5, 8, v3
    v_lshrrev_b32 v5, 1, v5
    v_or_b32 v4, v4, v5
    v_add_u32 v4, s60, v4
    s_mov_b32 s61, 3456
    v_mul_lo_u32 v4, v4, s61
    v_cmp_eq_u32 vcc, 9, v2
    s_nop 1
    v_cndmask_b32 v2, v2, 0, vcc
    v_mul_u32_u24 v3, 21846, v2
    v_lshrrev_b32 v3, 16, v3
    v_mul_u32_u24 v5, 3, v3
    v_sub_u32 v2, v2, v5
    v_lshlrev_b32 v2, 4, v2
    v_mul_u32_u24 v3, 1152, v3
    v_add_u32 v2, v2, v3
    v_add_u32 v144, v4, v2
    v_add_u32 v144, s64, v144
    v_add_u32 v2, 64, v1
    v_mul_u32_u24 v3, 6554, v2
    v_lshrrev_b32 v3, 16, v3
    v_mul_u32_u24 v4, 10, v3
    v_sub_u32 v2, v2, v4
    v_and_b32 v4, 3, v3
    v_and_b32 v5, 4, v3
    v_lshl_or_b32 v4, v5, 1, v4
    v_and_b32 v5, 8, v3
    v_lshrrev_b32 v5, 1, v5
    v_or_b32 v4, v4, v5
    v_add_u32 v4, s60, v4
    s_mov_b32 s61, 3456
    v_mul_lo_u32 v4, v4, s61
    v_cmp_eq_u32 vcc, 9, v2
    s_nop 1
    v_cndmask_b32 v2, v2, 0, vcc
    v_mul_u32_u24 v3, 21846, v2
    v_lshrrev_b32 v3, 16, v3
    v_mul_u32_u24 v5, 3, v3
    v_sub_u32 v2, v2, v5
    v_lshlrev_b32 v2, 4, v2
    v_mul_u32_u24 v3, 1152, v3
    v_add_u32 v2, v2, v3
    v_add_u32 v145, v4, v2
    v_add_u32 v145, s64, v145
    v_add_u32 v2, 128, v1
    v_mul_u32_u24 v3, 6554, v2
    v_lshrrev_b32 v3, 16, v3
    v_mul_u32_u24 v4, 10, v3
    v_sub_u32 v2, v2, v4
    v_and_b32 v4, 3, v3
    v_and_b32 v5, 4, v3
    v_lshl_or_b32 v4, v5, 1, v4
    v_and_b32 v5, 8, v3
    v_lshrrev_b32 v5, 1, v5
    v_or_b32 v4, v4, v5
    v_add_u32 v4, s60, v4
    s_mov_b32 s61, 3456
    v_mul_lo_u32 v4, v4, s61
    v_cmp_eq_u32 vcc, 9, v2
    s_nop 1
    v_cndmask_b32 v2, v2, 0, vcc
    v_mul_u32_u24 v3, 21846, v2
    v_lshrrev_b32 v3, 16, v3
    v_mul_u32_u24 v5, 3, v3
    v_sub_u32 v2, v2, v5
    v_lshlrev_b32 v2, 4, v2
    v_mul_u32_u24 v3, 1152, v3
    v_add_u32 v2, v2, v3
    v_add_u32 v146, v4, v2
    v_add_u32 v146, s64, v146
    v_lshrrev_b32 v2, 5, v1
    v_lshlrev_b32 v2, 4, v2
    v_bfe_u32 v3, v1, 4, 1
    v_lshl_or_b32 v2, v3, 2, v2
    v_bfe_u32 v3, v1, 2, 2
    v_add_u32 v2, v2, v3
    v_mul_u32_u24 v2, 160, v2
    v_and_b32 v3, 3, v1
    v_lshl_add_u32 v2, v3, 3, v2
    v_add_u32 v147, 108800, v2
    v_add_u32 v148, 119040, v2
    v_add_u32 v149, 129280, v2
    s_mul_i32 s59, s52, 8192
    s_add_u32 s59, s59, 10496
    v_lshrrev_b32 v2, 3, v1
    v_and_b32 v3, 7, v1
    v_xor_b32 v3, v3, v2
    v_add_u32 v2, s63, v2
    s_mov_b32 s60, 1152
    v_mul_lo_u32 v2, v2, s60
    v_lshl_add_u32 v2, v3, 4, v2
    v_add_u32 v150, 0, v2
    v_add_u32 v151, 9216, v2
    v_add_u32 v152, 18432, v2
    v_add_u32 v153, 27648, v2
    v_add_u32 v154, 36864, v2
    v_add_u32 v155, 46080, v2
    v_add_u32 v156, 55296, v2
    v_add_u32 v157, 64512, v2
    v_and_b32 v2, 15, v1
    v_lshrrev_b32 v3, 4, v1
    v_and_b32 v4, 7, v1
    v_xor_b32 v3, v3, v4
    v_lshlrev_b32 v3, 4, v3
    v_lshl_add_u32 v2, v2, 7, v3
    v_add_u32 v158, s59, v2
    v_xor_b32 v159, 64, v158
    v_add_u32 v160, 32768, v158
    v_add_u32 v161, 32768, v159
    v_add_u32 v162, 65536, v158
    v_add_u32 v163, 65536, v159
    s_cmp_eq_u32 s72, 0
    s_cbranch_scc1 k1_kernel_comp
    s_mov_b32 s55, 0
    s_mov_b32 s54, 0
    s_add_u32 m0, s59, 0
    s_nop 0
    buffer_load_dwordx4 v150, s[28:31], s55 offen lds
    s_add_u32 m0, s59, 1024
    s_nop 0
    buffer_load_dwordx4 v151, s[28:31], s55 offen lds
    s_add_u32 m0, s59, 2048
    s_nop 0
    buffer_load_dwordx4 v152, s[28:31], s55 offen lds
    s_add_u32 m0, s59, 3072
    s_nop 0
    buffer_load_dwordx4 v153, s[28:31], s55 offen lds
    s_add_u32 m0, s59, 4096
    s_nop 0
    buffer_load_dwordx4 v154, s[28:31], s55 offen lds
    s_add_u32 m0, s59, 5120
    s_nop 0
    buffer_load_dwordx4 v155, s[28:31], s55 offen lds
    s_add_u32 m0, s59, 6144
    s_nop 0
    buffer_load_dwordx4 v156, s[28:31], s55 offen lds
    s_add_u32 m0, s59, 7168
    s_nop 0
    buffer_load_dwordx4 v157, s[28:31], s55 offen lds
    s_add_u32 m0, s53, 0
    s_nop 0
    buffer_load_dwordx4 v144, s[32:35], s54 offen lds
    s_add_u32 m0, s53, 1024
    s_nop 0
    buffer_load_dwordx4 v145, s[32:35], s54 offen lds
    s_add_u32 m0, s53, 2048
    s_nop 0
    s_mov_b32 exec_hi, 0
    buffer_load_dwordx4 v146, s[32:35], s54 offen lds
    s_mov_b32 exec_hi, -1
    s_mov_b32 s55, 128
    s_mov_b32 s54, 221184
    s_add_u32 m0, s59, 32768
    s_nop 0
    buffer_load_dwordx4 v150, s[28:31], s55 offen lds
    s_add_u32 m0, s59, 33792
    s_nop 0
    buffer_load_dwordx4 v151, s[28:31], s55 offen lds
    s_add_u32 m0, s59, 34816
    s_nop 0
    buffer_load_dwordx4 v152, s[28:31], s55 offen lds
    s_add_u32 m0, s59, 35840
    s_nop 0
    buffer_load_dwordx4 v153, s[28:31], s55 offen lds
    s_add_u32 m0, s59, 36864
    s_nop 0
    buffer_load_dwordx4 v154, s[28:31], s55 offen lds
    s_add_u32 m0, s59, 37888
    s_nop 0
    buffer_load_dwordx4 v155, s[28:31], s55 offen lds
    s_add_u32 m0, s59, 38912
    s_nop 0
    buffer_load_dwordx4 v156, s[28:31], s55 offen lds
    s_add_u32 m0, s59, 39936
    s_nop 0
    buffer_load_dwordx4 v157, s[28:31], s55 offen lds
    s_add_u32 m0, s53, 10240
    s_nop 0
    buffer_load_dwordx4 v144, s[32:35], s54 offen lds
    s_add_u32 m0, s53, 11264
    s_nop 0
    buffer_load_dwordx4 v145, s[32:35], s54 offen lds
    s_add_u32 m0, s53, 12288
    s_nop 0
    s_mov_b32 exec_hi, 0
    buffer_load_dwordx4 v146, s[32:35], s54 offen lds
    s_mov_b32 exec_hi, -1
    s_mov_b32 s55, 256
    s_mov_b32 s54, 442368
    s_add_u32 m0, s59, 65536
    s_nop 0
    buffer_load_dwordx4 v150, s[28:31], s55 offen lds
    s_add_u32 m0, s59, 66560
    s_nop 0
    buffer_load_dwordx4 v151, s[28:31], s55 offen lds
    s_add_u32 m0, s59, 67584
    s_nop 0
    buffer_load_dwordx4 v152, s[28:31], s55 offen lds
    s_add_u32 m0, s59, 68608
    s_nop 0
    buffer_load_dwordx4 v153, s[28:31], s55 offen lds
    s_add_u32 m0, s59, 69632
    s_nop 0
    buffer_load_dwordx4 v154, s[28:31], s55 offen lds
    s_add_u32 m0, s59, 70656
    s_nop 0
    buffer_load_dwordx4 v155, s[28:31], s55 offen lds
    s_add_u32 m0, s59, 71680
    s_nop 0
    buffer_load_dwordx4 v156, s[28:31], s55 offen lds
    s_add_u32 m0, s59, 72704
    s_nop 0
    buffer_load_dwordx4 v157, s[28:31], s55 offen lds
    s_add_u32 m0, s53, 20480
    s_nop 0
    buffer_load_dwordx4 v144, s[32:35], s54 offen lds
    s_add_u32 m0, s53, 21504
    s_nop 0
    buffer_load_dwordx4 v145, s[32:35], s54 offen lds
    s_add_u32 m0, s53, 22528
    s_nop 0
    s_mov_b32 exec_hi, 0
    buffer_load_dwordx4 v146, s[32:35], s54 offen lds
    s_mov_b32 exec_hi, -1
    s_waitcnt vmcnt(22)
    s_barrier
    s_waitcnt vmcnt(11)
    s_barrier
    s_mov_b32 s55, 384
    s_mov_b32 s54, 663552
    s_add_u32 m0, s59, 0
    s_nop 0
    buffer_load_dwordx4 v150, s[28:31], s55 offen lds
    s_add_u32 m0, s59, 1024
    s_nop 0
    buffer_load_dwordx4 v151, s[28:31], s55 offen lds
    s_add_u32 m0, s59, 2048
    s_nop 0
    buffer_load_dwordx4 v152, s[28:31], s55 offen lds
    s_add_u32 m0, s59, 3072
    s_nop 0
    buffer_load_dwordx4 v153, s[28:31], s55 offen lds
    s_add_u32 m0, s59, 4096
    s_nop 0
    buffer_load_dwordx4 v154, s[28:31], s55 offen lds
    s_add_u32 m0, s59, 5120
    s_nop 0
    buffer_load_dwordx4 v155, s[28:31], s55 offen lds
    s_add_u32 m0, s59, 6144
    s_nop 0
    buffer_load_dwordx4 v156, s[28:31], s55 offen lds
    s_add_u32 m0, s59, 7168
    s_nop 0
    buffer_load_dwordx4 v157, s[28:31], s55 offen lds
    s_add_u32 m0, s53, 0
    s_nop 0
    buffer_load_dwordx4 v144, s[32:35], s54 offen lds
    s_add_u32 m0, s53, 1024
    s_nop 0
    buffer_load_dwordx4 v145, s[32:35], s54 offen lds
    s_add_u32 m0, s53, 2048
    s_nop 0
    s_mov_b32 exec_hi, 0
    buffer_load_dwordx4 v146, s[32:35], s54 offen lds
    s_mov_b32 exec_hi, -1
    s_waitcnt vmcnt(11)
    s_barrier
    s_mov_b32 s55, 512
    s_mov_b32 s54, 884736
    s_add_u32 m0, s59, 32768
    s_nop 0
    buffer_load_dwordx4 v150, s[28:31], s55 offen lds
    s_add_u32 m0, s59, 33792
    s_nop 0
    buffer_load_dwordx4 v151, s[28:31], s55 offen lds
    s_add_u32 m0, s59, 34816
    s_nop 0
    buffer_load_dwordx4 v152, s[28:31], s55 offen lds
    s_add_u32 m0, s59, 35840
    s_nop 0
    buffer_load_dwordx4 v153, s[28:31], s55 offen lds
    s_add_u32 m0, s59, 36864
    s_nop 0
    buffer_load_dwordx4 v154, s[28:31], s55 offen lds
    s_add_u32 m0, s59, 37888
    s_nop 0
    buffer_load_dwordx4 v155, s[28:31], s55 offen lds
    s_add_u32 m0, s59, 38912
    s_nop 0
    buffer_load_dwordx4 v156, s[28:31], s55 offen lds
    s_add_u32 m0, s59, 39936
    s_nop 0
    buffer_load_dwordx4 v157, s[28:31], s55 offen lds
    s_add_u32 m0, s53, 10240
    s_nop 0
    buffer_load_dwordx4 v144, s[32:35], s54 offen lds
    s_add_u32 m0, s53, 11264
    s_nop 0
    buffer_load_dwordx4 v145, s[32:35], s54 offen lds
    s_add_u32 m0, s53, 12288
    s_nop 0
    s_mov_b32 exec_hi, 0
    buffer_load_dwordx4 v146, s[32:35], s54 offen lds
    s_mov_b32 exec_hi, -1
    s_waitcnt vmcnt(11)
    s_barrier
    s_mov_b32 s55, 640
    s_mov_b32 s54, 1105920
    s_add_u32 m0, s59, 65536
    s_nop 0
    buffer_load_dwordx4 v150, s[28:31], s55 offen lds
    s_add_u32 m0, s59, 66560
    s_nop 0
    buffer_load_dwordx4 v151, s[28:31], s55 offen lds
    s_add_u32 m0, s59, 67584
    s_nop 0
    buffer_load_dwordx4 v152, s[28:31], s55 offen lds
    s_add_u32 m0, s59, 68608
    s_nop 0
    buffer_load_dwordx4 v153, s[28:31], s55 offen lds
    s_add_u32 m0, s59, 69632
    s_nop 0
    buffer_load_dwordx4 v154, s[28:31], s55 offen lds
    s_add_u32 m0, s59, 70656
    s_nop 0
    buffer_load_dwordx4 v155, s[28:31], s55 offen lds
    s_add_u32 m0, s59, 71680
    s_nop 0
    buffer_load_dwordx4 v156, s[28:31], s55 offen lds
    s_add_u32 m0, s59, 72704
    s_nop 0
    buffer_load_dwordx4 v157, s[28:31], s55 offen lds
    s_add_u32 m0, s53, 20480
    s_nop 0
    buffer_load_dwordx4 v144, s[32:35], s54 offen lds
    s_add_u32 m0, s53, 21504
    s_nop 0
    buffer_load_dwordx4 v145, s[32:35], s54 offen lds
    s_add_u32 m0, s53, 22528
    s_nop 0
    s_mov_b32 exec_hi, 0
    buffer_load_dwordx4 v146, s[32:35], s54 offen lds
    s_mov_b32 exec_hi, -1
    s_waitcnt vmcnt(11)
    s_barrier
    s_mov_b32 s55, 768
    s_mov_b32 s54, 1327104
    s_add_u32 m0, s59, 0
    s_nop 0
    buffer_load_dwordx4 v150, s[28:31], s55 offen lds
    s_add_u32 m0, s59, 1024
    s_nop 0
    buffer_load_dwordx4 v151, s[28:31], s55 offen lds
    s_add_u32 m0, s59, 2048
    s_nop 0
    buffer_load_dwordx4 v152, s[28:31], s55 offen lds
    s_add_u32 m0, s59, 3072
    s_nop 0
    buffer_load_dwordx4 v153, s[28:31], s55 offen lds
    s_add_u32 m0, s59, 4096
    s_nop 0
    buffer_load_dwordx4 v154, s[28:31], s55 offen lds
    s_add_u32 m0, s59, 5120
    s_nop 0
    buffer_load_dwordx4 v155, s[28:31], s55 offen lds
    s_add_u32 m0, s59, 6144
    s_nop 0
    buffer_load_dwordx4 v156, s[28:31], s55 offen lds
    s_add_u32 m0, s59, 7168
    s_nop 0
    buffer_load_dwordx4 v157, s[28:31], s55 offen lds
    s_add_u32 m0, s53, 0
    s_nop 0
    buffer_load_dwordx4 v144, s[32:35], s54 offen lds
    s_add_u32 m0, s53, 1024
    s_nop 0
    buffer_load_dwordx4 v145, s[32:35], s54 offen lds
    s_add_u32 m0, s53, 2048
    s_nop 0
    s_mov_b32 exec_hi, 0
    buffer_load_dwordx4 v146, s[32:35], s54 offen lds
    s_mov_b32 exec_hi, -1
    s_waitcnt vmcnt(11)
    s_barrier
    s_mov_b32 s55, 896
    s_mov_b32 s54, 1548288
    s_add_u32 m0, s59, 32768
    s_nop 0
    buffer_load_dwordx4 v150, s[28:31], s55 offen lds
    s_add_u32 m0, s59, 33792
    s_nop 0
    buffer_load_dwordx4 v151, s[28:31], s55 offen lds
    s_add_u32 m0, s59, 34816
    s_nop 0
    buffer_load_dwordx4 v152, s[28:31], s55 offen lds
    s_add_u32 m0, s59, 35840
    s_nop 0
    buffer_load_dwordx4 v153, s[28:31], s55 offen lds
    s_add_u32 m0, s59, 36864
    s_nop 0
    buffer_load_dwordx4 v154, s[28:31], s55 offen lds
    s_add_u32 m0, s59, 37888
    s_nop 0
    buffer_load_dwordx4 v155, s[28:31], s55 offen lds
    s_add_u32 m0, s59, 38912
    s_nop 0
    buffer_load_dwordx4 v156, s[28:31], s55 offen lds
    s_add_u32 m0, s59, 39936
    s_nop 0
    buffer_load_dwordx4 v157, s[28:31], s55 offen lds
    s_add_u32 m0, s53, 10240
    s_nop 0
    buffer_load_dwordx4 v144, s[32:35], s54 offen lds
    s_add_u32 m0, s53, 11264
    s_nop 0
    buffer_load_dwordx4 v145, s[32:35], s54 offen lds
    s_add_u32 m0, s53, 12288
    s_nop 0
    s_mov_b32 exec_hi, 0
    buffer_load_dwordx4 v146, s[32:35], s54 offen lds
    s_mov_b32 exec_hi, -1
    s_waitcnt vmcnt(11)
    s_barrier
    s_mov_b32 s55, 1024
    s_mov_b32 s54, 1769472
    s_add_u32 m0, s59, 65536
    s_nop 0
    buffer_load_dwordx4 v150, s[28:31], s55 offen lds
    s_add_u32 m0, s59, 66560
    s_nop 0
    buffer_load_dwordx4 v151, s[28:31], s55 offen lds
    s_add_u32 m0, s59, 67584
    s_nop 0
    buffer_load_dwordx4 v152, s[28:31], s55 offen lds
    s_add_u32 m0, s59, 68608
    s_nop 0
    buffer_load_dwordx4 v153, s[28:31], s55 offen lds
    s_add_u32 m0, s59, 69632
    s_nop 0
    buffer_load_dwordx4 v154, s[28:31], s55 offen lds
    s_add_u32 m0, s59, 70656
    s_nop 0
    buffer_load_dwordx4 v155, s[28:31], s55 offen lds
    s_add_u32 m0, s59, 71680
    s_nop 0
    buffer_load_dwordx4 v156, s[28:31], s55 offen lds
    s_add_u32 m0, s59, 72704
    s_nop 0
    buffer_load_dwordx4 v157, s[28:31], s55 offen lds
    s_add_u32 m0, s53, 20480
    s_nop 0
    buffer_load_dwordx4 v144, s[32:35], s54 offen lds
    s_add_u32 m0, s53, 21504
    s_nop 0
    buffer_load_dwordx4 v145, s[32:35], s54 offen lds
    s_add_u32 m0, s53, 22528
    s_nop 0
    s_mov_b32 exec_hi, 0
    buffer_load_dwordx4 v146, s[32:35], s54 offen lds
    s_mov_b32 exec_hi, -1
    s_waitcnt vmcnt(11)
    s_barrier
    s_waitcnt vmcnt(0)
    s_barrier
    s_waitcnt vmcnt(0)
    s_barrier
    s_barrier
    v_and_b32 v7, 255, v0
    s_cmp_eq_u32 s52, 3
    s_cbranch_scc1 k1_kernel_cs
    s_mul_i32 s60, s2, 192
    v_add_u32 v2, s60, v7
    s_mov_b32 s32, s10
    s_and_b32 s33, s11, 0xffff
    s_mov_b32 s34, 663552
    s_mov_b32 s35, 0x00020000
    s_add_u32 s36, s26, 70254592
    s_addc_u32 s37, s27, 0
    s_and_b32 s37, s37, 0xffff
    s_mov_b32 s38, 663552
    s_mov_b32 s39, 0x00020000
    v_add_u32 v28, 0, v2
    v_lshlrev_b32 v6, 4, v28
    buffer_load_dwordx4 v[48:51], v6, s[32:35], 0 offen
    s_mov_b32 s76, s14
    s_and_b32 s77, s15, 0xffff
    s_mov_b32 s78, 5308416
    s_mov_b32 s79, 0x00020000
    s_add_u32 s80, s26, 71303168
    s_addc_u32 s81, s27, 0
    s_and_b32 s81, s81, 0xffff
    s_mov_b32 s82, 5308416
    s_mov_b32 s83, 0x00020000
    v_add_u32 v29, 0, v2
    v_lshlrev_b32 v6, 4, v29
    buffer_load_dwordx4 v[52:55], v6, s[76:79], 0 offen
    v_add_u32 v30, 49152, v2
    v_lshlrev_b32 v6, 4, v30
    buffer_load_dwordx4 v[56:59], v6, s[76:79], 0 offen
    v_add_u32 v31, 98304, v2
    v_lshlrev_b32 v6, 4, v31
    buffer_load_dwordx4 v[60:63], v6, s[76:79], 0 offen
    v_add_u32 v32, 147456, v2
    v_lshlrev_b32 v6, 4, v32
    buffer_load_dwordx4 v[64:67], v6, s[76:79], 0 offen
    v_add_u32 v33, 196608, v2
    v_lshlrev_b32 v6, 4, v33
    buffer_load_dwordx4 v[68:71], v6, s[76:79], 0 offen
    v_add_u32 v34, 245760, v2
    v_lshlrev_b32 v6, 4, v34
    buffer_load_dwordx4 v[72:75], v6, s[76:79], 0 offen
    v_add_u32 v35, 294912, v2
    v_lshlrev_b32 v6, 4, v35
    buffer_load_dwordx4 v[76:79], v6, s[76:79], 0 offen
    s_mov_b32 s84, s20
    s_and_b32 s85, s21, 0xffff
    s_mov_b32 s86, 2654208
    s_mov_b32 s87, 0x00020000
    s_add_u32 s88, s26, 77594624
    s_addc_u32 s89, s27, 0
    s_and_b32 s89, s89, 0xffff
    s_mov_b32 s90, 2949120
    s_mov_b32 s91, 0x00020000
    v_add_u32 v36, 0, v2
    v_lshlrev_b32 v6, 4, v36
    buffer_load_dwordx4 v[80:83], v6, s[84:87], 0 offen
    v_add_u32 v37, 49152, v2
    v_lshlrev_b32 v6, 4, v37
    buffer_load_dwordx4 v[84:87], v6, s[84:87], 0 offen
    v_add_u32 v38, 98304, v2
    v_lshlrev_b32 v6, 4, v38
    buffer_load_dwordx4 v[88:91], v6, s[84:87], 0 offen
    v_add_u32 v39, 147456, v2
    v_lshlrev_b32 v6, 4, v39
    buffer_load_dwordx4 v[92:95], v6, s[84:87], 0 offen
    s_mov_b32 s60, 59652324
    v_mul_hi_u32 v5, v28, s60
    v_mul_u32_u24 v7, 72, v5
    v_sub_u32 v7, v28, v7
    s_mov_b32 s60, 238609295
    v_mul_hi_u32 v6, v7, s60
    v_mul_u32_u24 v24, 18, v6
    v_sub_u32 v24, v7, v24
    s_mov_b32 s60, 165888
    v_mul_lo_u32 v6, v6, s60
    v_mul_u32_u24 v5, 288, v5
    v_add_u32 v6, v6, v5
    v_lshl_add_u32 v6, v24, 4, v6
    v_cmp_gt_u32 vcc, 41472, v28
    v_mov_b32 v7, 0x40000000
    s_nop 0
    v_cndmask_b32 v6, v7, v6, vcc
    v_mov_b32 v28, v6
    s_mov_b32 s60, 7456541
    v_mul_hi_u32 v5, v29, s60
    v_mul_u32_u24 v7, 576, v5
    v_sub_u32 v7, v29, v7
    s_mov_b32 s60, 238609295
    v_mul_hi_u32 v6, v7, s60
    v_mul_u32_u24 v24, 18, v6
    v_sub_u32 v24, v7, v24
    s_mov_b32 s60, 165888
    v_mul_lo_u32 v6, v6, s60
    v_mul_u32_u24 v5, 288, v5
    v_add_u32 v6, v6, v5
    v_lshl_add_u32 v6, v24, 4, v6
    v_mov_b32 v29, v6
    s_mov_b32 s60, 7456541
    v_mul_hi_u32 v5, v30, s60
    v_mul_u32_u24 v7, 576, v5
    v_sub_u32 v7, v30, v7
    s_mov_b32 s60, 238609295
    v_mul_hi_u32 v6, v7, s60
    v_mul_u32_u24 v24, 18, v6
    v_sub_u32 v24, v7, v24
    s_mov_b32 s60, 165888
    v_mul_lo_u32 v6, v6, s60
    v_mul_u32_u24 v5, 288, v5
    v_add_u32 v6, v6, v5
    v_lshl_add_u32 v6, v24, 4, v6
    v_mov_b32 v30, v6
    s_mov_b32 s60, 7456541
    v_mul_hi_u32 v5, v31, s60
    v_mul_u32_u24 v7, 576, v5
    v_sub_u32 v7, v31, v7
    s_mov_b32 s60, 238609295
    v_mul_hi_u32 v6, v7, s60
    v_mul_u32_u24 v24, 18, v6
    v_sub_u32 v24, v7, v24
    s_mov_b32 s60, 165888
    v_mul_lo_u32 v6, v6, s60
    v_mul_u32_u24 v5, 288, v5
    v_add_u32 v6, v6, v5
    v_lshl_add_u32 v6, v24, 4, v6
    v_mov_b32 v31, v6
    s_mov_b32 s60, 7456541
    v_mul_hi_u32 v5, v32, s60
    v_mul_u32_u24 v7, 576, v5
    v_sub_u32 v7, v32, v7
    s_mov_b32 s60, 238609295
    v_mul_hi_u32 v6, v7, s60
    v_mul_u32_u24 v24, 18, v6
    v_sub_u32 v24, v7, v24
    s_mov_b32 s60, 165888
    v_mul_lo_u32 v6, v6, s60
    v_mul_u32_u24 v5, 288, v5
    v_add_u32 v6, v6, v5
    v_lshl_add_u32 v6, v24, 4, v6
    v_mov_b32 v32, v6
    s_mov_b32 s60, 7456541
    v_mul_hi_u32 v5, v33, s60
    v_mul_u32_u24 v7, 576, v5
    v_sub_u32 v7, v33, v7
    s_mov_b32 s60, 238609295
    v_mul_hi_u32 v6, v7, s60
    v_mul_u32_u24 v24, 18, v6
    v_sub_u32 v24, v7, v24
    s_mov_b32 s60, 165888
    v_mul_lo_u32 v6, v6, s60
    v_mul_u32_u24 v5, 288, v5
    v_add_u32 v6, v6, v5
    v_lshl_add_u32 v6, v24, 4, v6
    v_mov_b32 v33, v6
    s_mov_b32 s60, 7456541
    v_mul_hi_u32 v5, v34, s60
    v_mul_u32_u24 v7, 576, v5
    v_sub_u32 v7, v34, v7
    s_mov_b32 s60, 238609295
    v_mul_hi_u32 v6, v7, s60
    v_mul_u32_u24 v24, 18, v6
    v_sub_u32 v24, v7, v24
    s_mov_b32 s60, 165888
    v_mul_lo_u32 v6, v6, s60
    v_mul_u32_u24 v5, 288, v5
    v_add_u32 v6, v6, v5
    v_lshl_add_u32 v6, v24, 4, v6
    v_mov_b32 v34, v6
    s_mov_b32 s60, 7456541
    v_mul_hi_u32 v5, v35, s60
    v_mul_u32_u24 v7, 576, v5
    v_sub_u32 v7, v35, v7
    s_mov_b32 s60, 238609295
    v_mul_hi_u32 v6, v7, s60
    v_mul_u32_u24 v24, 18, v6
    v_sub_u32 v24, v7, v24
    s_mov_b32 s60, 165888
    v_mul_lo_u32 v6, v6, s60
    v_mul_u32_u24 v5, 288, v5
    v_add_u32 v6, v6, v5
    v_lshl_add_u32 v6, v24, 4, v6
    v_cmp_gt_u32 vcc, 331776, v35
    v_mov_b32 v7, 0x40000000
    s_nop 0
    v_cndmask_b32 v6, v7, v6, vcc
    v_mov_b32 v35, v6
    s_mov_b32 s60, 59652324
    v_mul_hi_u32 v5, v36, s60
    v_mul_u32_u24 v7, 72, v5
    v_sub_u32 v7, v36, v7
    s_mov_b32 s60, 477218589
    v_mul_hi_u32 v6, v7, s60
    v_mul_u32_u24 v24, 9, v6
    v_sub_u32 v24, v7, v24
    s_mov_b32 s60, 368640
    v_mul_lo_u32 v6, v6, s60
    v_mul_u32_u24 v5, 160, v5
    v_add_u32 v6, v6, v5
    v_lshl_add_u32 v6, v24, 4, v6
    v_mov_b32 v36, v6
    s_mov_b32 s60, 59652324
    v_mul_hi_u32 v5, v37, s60
    v_mul_u32_u24 v7, 72, v5
    v_sub_u32 v7, v37, v7
    s_mov_b32 s60, 477218589
    v_mul_hi_u32 v6, v7, s60
    v_mul_u32_u24 v24, 9, v6
    v_sub_u32 v24, v7, v24
    s_mov_b32 s60, 368640
    v_mul_lo_u32 v6, v6, s60
    v_mul_u32_u24 v5, 160, v5
    v_add_u32 v6, v6, v5
    v_lshl_add_u32 v6, v24, 4, v6
    v_mov_b32 v37, v6
    s_mov_b32 s60, 59652324
    v_mul_hi_u32 v5, v38, s60
    v_mul_u32_u24 v7, 72, v5
    v_sub_u32 v7, v38, v7
    s_mov_b32 s60, 477218589
    v_mul_hi_u32 v6, v7, s60
    v_mul_u32_u24 v24, 9, v6
    v_sub_u32 v24, v7, v24
    s_mov_b32 s60, 368640
    v_mul_lo_u32 v6, v6, s60
    v_mul_u32_u24 v5, 160, v5
    v_add_u32 v6, v6, v5
    v_lshl_add_u32 v6, v24, 4, v6
    v_mov_b32 v38, v6
    s_mov_b32 s60, 59652324
    v_mul_hi_u32 v5, v39, s60
    v_mul_u32_u24 v7, 72, v5
    v_sub_u32 v7, v39, v7
    s_mov_b32 s60, 477218589
    v_mul_hi_u32 v6, v7, s60
    v_mul_u32_u24 v24, 9, v6
    v_sub_u32 v24, v7, v24
    s_mov_b32 s60, 368640
    v_mul_lo_u32 v6, v6, s60
    v_mul_u32_u24 v5, 160, v5
    v_add_u32 v6, v6, v5
    v_lshl_add_u32 v6, v24, 4, v6
    v_cmp_gt_u32 vcc, 165888, v39
    v_mov_b32 v7, 0x40000000
    s_nop 0
    v_cndmask_b32 v6, v7, v6, vcc
    v_mov_b32 v39, v6
    s_waitcnt vmcnt(11)
    buffer_store_dwordx4 v[48:51], v28, s[36:39], 0 offen sc1
    s_waitcnt vmcnt(11)
    buffer_store_dwordx4 v[52:55], v29, s[80:83], 0 offen sc1
    s_waitcnt vmcnt(11)
    buffer_store_dwordx4 v[56:59], v30, s[80:83], 0 offen sc1
    s_waitcnt vmcnt(11)
    buffer_store_dwordx4 v[60:63], v31, s[80:83], 0 offen sc1
    s_waitcnt vmcnt(11)
    buffer_store_dwordx4 v[64:67], v32, s[80:83], 0 offen sc1
    s_waitcnt vmcnt(11)
    buffer_store_dwordx4 v[68:71], v33, s[80:83], 0 offen sc1
    s_waitcnt vmcnt(11)
    buffer_store_dwordx4 v[72:75], v34, s[80:83], 0 offen sc1
    s_waitcnt vmcnt(11)
    buffer_store_dwordx4 v[76:79], v35, s[80:83], 0 offen sc1
    s_waitcnt vmcnt(11)
    buffer_store_dwordx4 v[80:83], v36, s[88:91], 0 offen sc1
    s_waitcnt vmcnt(11)
    buffer_store_dwordx4 v[84:87], v37, s[88:91], 0 offen sc1
    s_waitcnt vmcnt(11)
    buffer_store_dwordx4 v[88:91], v38, s[88:91], 0 offen sc1
    s_waitcnt vmcnt(11)
    buffer_store_dwordx4 v[92:95], v39, s[88:91], 0 offen sc1
    s_add_u32 s28, s26, 48234496
    s_addc_u32 s29, s27, 0
    s_and_b32 s29, s29, 0xffff
    s_mov_b32 s30, 16384
    s_mov_b32 s31, 0x00020000
    v_mov_b32 v8, 0
    v_mov_b32 v9, 0
    v_mov_b32 v10, 0
    v_mov_b32 v11, 0
    v_lshlrev_b32 v6, 4, v2
    buffer_store_dwordx4 v[8:11], v6, s[28:31], 0 offen sc1
    s_branch k1_kernel_end
k1_kernel_cs:
    s_sub_u32 s60, s2, 0
    s_cmp_ge_u32 s60, 144
    s_cbranch_scc1 k1_kernel_end
    s_mov_b32 s28, s14
    s_and_b32 s29, s15, 0xffff
    s_mov_b32 s30, 5308416
    s_mov_b32 s31, 0x00020000
    s_add_u32 s32, s26, 61865984
    s_addc_u32 s33, s27, 0
    s_and_b32 s33, s33, 0xffff
    s_mov_b32 s34, 18432
    s_mov_b32 s35, 0x00020000
    s_lshl_b32 s60, s60, 6
    v_lshrrev_b32 v2, 2, v1
    v_mul_u32_u24 v2, 9216, v2
    v_and_b32 v3, 3, v1
    v_lshl_add_u32 v2, v3, 4, v2
    v_add_u32 v2, s60, v2
    v_mov_b32 v8, 0
    v_mov_b32 v9, 0
    v_mov_b32 v10, 0
    v_mov_b32 v11, 0
    v_mov_b32 v12, 0
    v_mov_b32 v13, 0
    v_mov_b32 v14, 0
    v_mov_b32 v15, 0
    s_mov_b32 s61, 0
    buffer_load_dwordx4 v[16:19], v2, s[28:31], s61 offen
    s_mov_b32 s61, 147456
    buffer_load_dwordx4 v[20:23], v2, s[28:31], s61 offen
    s_mov_b32 s61, 294912
    buffer_load_dwordx4 v[24:27], v2, s[28:31], s61 offen
    s_mov_b32 s61, 442368
    buffer_load_dwordx4 v[28:31], v2, s[28:31], s61 offen
    s_mov_b32 s61, 589824
    buffer_load_dwordx4 v[32:35], v2, s[28:31], s61 offen
    s_mov_b32 s61, 737280
    buffer_load_dwordx4 v[36:39], v2, s[28:31], s61 offen
    s_mov_b32 s61, 884736
    buffer_load_dwordx4 v[40:43], v2, s[28:31], s61 offen
    s_mov_b32 s61, 1032192
    buffer_load_dwordx4 v[44:47], v2, s[28:31], s61 offen
    s_mov_b32 s61, 1179648
    buffer_load_dwordx4 v[48:51], v2, s[28:31], s61 offen
    s_mov_b32 s61, 1327104
    buffer_load_dwordx4 v[52:55], v2, s[28:31], s61 offen
    s_mov_b32 s61, 1474560
    buffer_load_dwordx4 v[56:59], v2, s[28:31], s61 offen
    s_mov_b32 s61, 1622016
    buffer_load_dwordx4 v[60:63], v2, s[28:31], s61 offen
    s_mov_b32 s61, 1769472
    buffer_load_dwordx4 v[64:67], v2, s[28:31], s61 offen
    s_mov_b32 s61, 1916928
    buffer_load_dwordx4 v[68:71], v2, s[28:31], s61 offen
    s_mov_b32 s61, 2064384
    buffer_load_dwordx4 v[72:75], v2, s[28:31], s61 offen
    s_mov_b32 s61, 2211840
    buffer_load_dwordx4 v[76:79], v2, s[28:31], s61 offen
    s_mov_b32 s61, 2359296
    buffer_load_dwordx4 v[80:83], v2, s[28:31], s61 offen
    s_mov_b32 s61, 2506752
    buffer_load_dwordx4 v[84:87], v2, s[28:31], s61 offen
    s_mov_b32 s61, 2654208
    buffer_load_dwordx4 v[88:91], v2, s[28:31], s61 offen
    s_mov_b32 s61, 2801664
    buffer_load_dwordx4 v[92:95], v2, s[28:31], s61 offen
    s_mov_b32 s61, 2949120
    buffer_load_dwordx4 v[96:99], v2, s[28:31], s61 offen
    s_mov_b32 s61, 3096576
    buffer_load_dwordx4 v[100:103], v2, s[28:31], s61 offen
    s_mov_b32 s61, 3244032
    buffer_load_dwordx4 v[104:107], v2, s[28:31], s61 offen
    s_mov_b32 s61, 3391488
    buffer_load_dwordx4 v[108:111], v2, s[28:31], s61 offen
    s_mov_b32 s61, 3538944
    buffer_load_dwordx4 v[112:115], v2, s[28:31], s61 offen
    s_mov_b32 s61, 3686400
    buffer_load_dwordx4 v[116:119], v2, s[28:31], s61 offen
    s_mov_b32 s61, 3833856
    buffer_load_dwordx4 v[120:123], v2, s[28:31], s61 offen
    s_mov_b32 s61, 3981312
    buffer_load_dwordx4 v[124:127], v2, s[28:31], s61 offen
    s_mov_b32 s61, 4128768
    buffer_load_dwordx4 v[128:131], v2, s[28:31], s61 offen
    s_mov_b32 s61, 4276224
    buffer_load_dwordx4 v[132:135], v2, s[28:31], s61 offen
    s_mov_b32 s61, 4423680
    buffer_load_dwordx4 v[136:139], v2, s[28:31], s61 offen
    s_mov_b32 s61, 4571136
    buffer_load_dwordx4 v[140:143], v2, s[28:31], s61 offen
    s_mov_b32 s61, 4718592
    buffer_load_dwordx4 v[144:147], v2, s[28:31], s61 offen
    s_mov_b32 s61, 4866048
    buffer_load_dwordx4 v[148:151], v2, s[28:31], s61 offen
    s_mov_b32 s61, 5013504
    buffer_load_dwordx4 v[152:155], v2, s[28:31], s61 offen
    s_mov_b32 s61, 5160960
    buffer_load_dwordx4 v[156:159], v2, s[28:31], s61 offen
    s_waitcnt vmcnt(35)
    v_lshlrev_b32 v4, 16, v16
    v_and_b32 v5, 0xffff0000, v16
    v_add_f32 v8, v8, v4
    v_add_f32 v9, v9, v5
    v_lshlrev_b32 v4, 16, v17
    v_and_b32 v5, 0xffff0000, v17
    v_add_f32 v10, v10, v4
    v_add_f32 v11, v11, v5
    v_lshlrev_b32 v4, 16, v18
    v_and_b32 v5, 0xffff0000, v18
    v_add_f32 v12, v12, v4
    v_add_f32 v13, v13, v5
    v_lshlrev_b32 v4, 16, v19
    v_and_b32 v5, 0xffff0000, v19
    v_add_f32 v14, v14, v4
    v_add_f32 v15, v15, v5
    s_waitcnt vmcnt(34)
    v_lshlrev_b32 v4, 16, v20
    v_and_b32 v5, 0xffff0000, v20
    v_add_f32 v8, v8, v4
    v_add_f32 v9, v9, v5
    v_lshlrev_b32 v4, 16, v21
    v_and_b32 v5, 0xffff0000, v21
    v_add_f32 v10, v10, v4
    v_add_f32 v11, v11, v5
    v_lshlrev_b32 v4, 16, v22
    v_and_b32 v5, 0xffff0000, v22
    v_add_f32 v12, v12, v4
    v_add_f32 v13, v13, v5
    v_lshlrev_b32 v4, 16, v23
    v_and_b32 v5, 0xffff0000, v23
    v_add_f32 v14, v14, v4
    v_add_f32 v15, v15, v5
    s_waitcnt vmcnt(33)
    v_lshlrev_b32 v4, 16, v24
    v_and_b32 v5, 0xffff0000, v24
    v_add_f32 v8, v8, v4
    v_add_f32 v9, v9, v5
    v_lshlrev_b32 v4, 16, v25
    v_and_b32 v5, 0xffff0000, v25
    v_add_f32 v10, v10, v4
    v_add_f32 v11, v11, v5
    v_lshlrev_b32 v4, 16, v26
    v_and_b32 v5, 0xffff0000, v26
    v_add_f32 v12, v12, v4
    v_add_f32 v13, v13, v5
    v_lshlrev_b32 v4, 16, v27
    v_and_b32 v5, 0xffff0000, v27
    v_add_f32 v14, v14, v4
    v_add_f32 v15, v15, v5
    s_waitcnt vmcnt(32)
    v_lshlrev_b32 v4, 16, v28
    v_and_b32 v5, 0xffff0000, v28
    v_add_f32 v8, v8, v4
    v_add_f32 v9, v9, v5
    v_lshlrev_b32 v4, 16, v29
    v_and_b32 v5, 0xffff0000, v29
    v_add_f32 v10, v10, v4
    v_add_f32 v11, v11, v5
    v_lshlrev_b32 v4, 16, v30
    v_and_b32 v5, 0xffff0000, v30
    v_add_f32 v12, v12, v4
    v_add_f32 v13, v13, v5
    v_lshlrev_b32 v4, 16, v31
    v_and_b32 v5, 0xffff0000, v31
    v_add_f32 v14, v14, v4
    v_add_f32 v15, v15, v5
    s_waitcnt vmcnt(31)
    v_lshlrev_b32 v4, 16, v32
    v_and_b32 v5, 0xffff0000, v32
    v_add_f32 v8, v8, v4
    v_add_f32 v9, v9, v5
    v_lshlrev_b32 v4, 16, v33
    v_and_b32 v5, 0xffff0000, v33
    v_add_f32 v10, v10, v4
    v_add_f32 v11, v11, v5
    v_lshlrev_b32 v4, 16, v34
    v_and_b32 v5, 0xffff0000, v34
    v_add_f32 v12, v12, v4
    v_add_f32 v13, v13, v5
    v_lshlrev_b32 v4, 16, v35
    v_and_b32 v5, 0xffff0000, v35
    v_add_f32 v14, v14, v4
    v_add_f32 v15, v15, v5
    s_waitcnt vmcnt(30)
    v_lshlrev_b32 v4, 16, v36
    v_and_b32 v5, 0xffff0000, v36
    v_add_f32 v8, v8, v4
    v_add_f32 v9, v9, v5
    v_lshlrev_b32 v4, 16, v37
    v_and_b32 v5, 0xffff0000, v37
    v_add_f32 v10, v10, v4
    v_add_f32 v11, v11, v5
    v_lshlrev_b32 v4, 16, v38
    v_and_b32 v5, 0xffff0000, v38
    v_add_f32 v12, v12, v4
    v_add_f32 v13, v13, v5
    v_lshlrev_b32 v4, 16, v39
    v_and_b32 v5, 0xffff0000, v39
    v_add_f32 v14, v14, v4
    v_add_f32 v15, v15, v5
    s_waitcnt vmcnt(29)
    v_lshlrev_b32 v4, 16, v40
    v_and_b32 v5, 0xffff0000, v40
    v_add_f32 v8, v8, v4
    v_add_f32 v9, v9, v5
    v_lshlrev_b32 v4, 16, v41
    v_and_b32 v5, 0xffff0000, v41
    v_add_f32 v10, v10, v4
    v_add_f32 v11, v11, v5
    v_lshlrev_b32 v4, 16, v42
    v_and_b32 v5, 0xffff0000, v42
    v_add_f32 v12, v12, v4
    v_add_f32 v13, v13, v5
    v_lshlrev_b32 v4, 16, v43
    v_and_b32 v5, 0xffff0000, v43
    v_add_f32 v14, v14, v4
    v_add_f32 v15, v15, v5
    s_waitcnt vmcnt(28)
    v_lshlrev_b32 v4, 16, v44
    v_and_b32 v5, 0xffff0000, v44
    v_add_f32 v8, v8, v4
    v_add_f32 v9, v9, v5
    v_lshlrev_b32 v4, 16, v45
    v_and_b32 v5, 0xffff0000, v45
    v_add_f32 v10, v10, v4
    v_add_f32 v11, v11, v5
    v_lshlrev_b32 v4, 16, v46
    v_and_b32 v5, 0xffff0000, v46
    v_add_f32 v12, v12, v4
    v_add_f32 v13, v13, v5
    v_lshlrev_b32 v4, 16, v47
    v_and_b32 v5, 0xffff0000, v47
    v_add_f32 v14, v14, v4
    v_add_f32 v15, v15, v5
    s_waitcnt vmcnt(27)
    v_lshlrev_b32 v4, 16, v48
    v_and_b32 v5, 0xffff0000, v48
    v_add_f32 v8, v8, v4
    v_add_f32 v9, v9, v5
    v_lshlrev_b32 v4, 16, v49
    v_and_b32 v5, 0xffff0000, v49
    v_add_f32 v10, v10, v4
    v_add_f32 v11, v11, v5
    v_lshlrev_b32 v4, 16, v50
    v_and_b32 v5, 0xffff0000, v50
    v_add_f32 v12, v12, v4
    v_add_f32 v13, v13, v5
    v_lshlrev_b32 v4, 16, v51
    v_and_b32 v5, 0xffff0000, v51
    v_add_f32 v14, v14, v4
    v_add_f32 v15, v15, v5
    s_waitcnt vmcnt(26)
    v_lshlrev_b32 v4, 16, v52
    v_and_b32 v5, 0xffff0000, v52
    v_add_f32 v8, v8, v4
    v_add_f32 v9, v9, v5
    v_lshlrev_b32 v4, 16, v53
    v_and_b32 v5, 0xffff0000, v53
    v_add_f32 v10, v10, v4
    v_add_f32 v11, v11, v5
    v_lshlrev_b32 v4, 16, v54
    v_and_b32 v5, 0xffff0000, v54
    v_add_f32 v12, v12, v4
    v_add_f32 v13, v13, v5
    v_lshlrev_b32 v4, 16, v55
    v_and_b32 v5, 0xffff0000, v55
    v_add_f32 v14, v14, v4
    v_add_f32 v15, v15, v5
    s_waitcnt vmcnt(25)
    v_lshlrev_b32 v4, 16, v56
    v_and_b32 v5, 0xffff0000, v56
    v_add_f32 v8, v8, v4
    v_add_f32 v9, v9, v5
    v_lshlrev_b32 v4, 16, v57
    v_and_b32 v5, 0xffff0000, v57
    v_add_f32 v10, v10, v4
    v_add_f32 v11, v11, v5
    v_lshlrev_b32 v4, 16, v58
    v_and_b32 v5, 0xffff0000, v58
    v_add_f32 v12, v12, v4
    v_add_f32 v13, v13, v5
    v_lshlrev_b32 v4, 16, v59
    v_and_b32 v5, 0xffff0000, v59
    v_add_f32 v14, v14, v4
    v_add_f32 v15, v15, v5
    s_waitcnt vmcnt(24)
    v_lshlrev_b32 v4, 16, v60
    v_and_b32 v5, 0xffff0000, v60
    v_add_f32 v8, v8, v4
    v_add_f32 v9, v9, v5
    v_lshlrev_b32 v4, 16, v61
    v_and_b32 v5, 0xffff0000, v61
    v_add_f32 v10, v10, v4
    v_add_f32 v11, v11, v5
    v_lshlrev_b32 v4, 16, v62
    v_and_b32 v5, 0xffff0000, v62
    v_add_f32 v12, v12, v4
    v_add_f32 v13, v13, v5
    v_lshlrev_b32 v4, 16, v63
    v_and_b32 v5, 0xffff0000, v63
    v_add_f32 v14, v14, v4
    v_add_f32 v15, v15, v5
    s_waitcnt vmcnt(23)
    v_lshlrev_b32 v4, 16, v64
    v_and_b32 v5, 0xffff0000, v64
    v_add_f32 v8, v8, v4
    v_add_f32 v9, v9, v5
    v_lshlrev_b32 v4, 16, v65
    v_and_b32 v5, 0xffff0000, v65
    v_add_f32 v10, v10, v4
    v_add_f32 v11, v11, v5
    v_lshlrev_b32 v4, 16, v66
    v_and_b32 v5, 0xffff0000, v66
    v_add_f32 v12, v12, v4
    v_add_f32 v13, v13, v5
    v_lshlrev_b32 v4, 16, v67
    v_and_b32 v5, 0xffff0000, v67
    v_add_f32 v14, v14, v4
    v_add_f32 v15, v15, v5
    s_waitcnt vmcnt(22)
    v_lshlrev_b32 v4, 16, v68
    v_and_b32 v5, 0xffff0000, v68
    v_add_f32 v8, v8, v4
    v_add_f32 v9, v9, v5
    v_lshlrev_b32 v4, 16, v69
    v_and_b32 v5, 0xffff0000, v69
    v_add_f32 v10, v10, v4
    v_add_f32 v11, v11, v5
    v_lshlrev_b32 v4, 16, v70
    v_and_b32 v5, 0xffff0000, v70
    v_add_f32 v12, v12, v4
    v_add_f32 v13, v13, v5
    v_lshlrev_b32 v4, 16, v71
    v_and_b32 v5, 0xffff0000, v71
    v_add_f32 v14, v14, v4
    v_add_f32 v15, v15, v5
    s_waitcnt vmcnt(21)
    v_lshlrev_b32 v4, 16, v72
    v_and_b32 v5, 0xffff0000, v72
    v_add_f32 v8, v8, v4
    v_add_f32 v9, v9, v5
    v_lshlrev_b32 v4, 16, v73
    v_and_b32 v5, 0xffff0000, v73
    v_add_f32 v10, v10, v4
    v_add_f32 v11, v11, v5
    v_lshlrev_b32 v4, 16, v74
    v_and_b32 v5, 0xffff0000, v74
    v_add_f32 v12, v12, v4
    v_add_f32 v13, v13, v5
    v_lshlrev_b32 v4, 16, v75
    v_and_b32 v5, 0xffff0000, v75
    v_add_f32 v14, v14, v4
    v_add_f32 v15, v15, v5
    s_waitcnt vmcnt(20)
    v_lshlrev_b32 v4, 16, v76
    v_and_b32 v5, 0xffff0000, v76
    v_add_f32 v8, v8, v4
    v_add_f32 v9, v9, v5
    v_lshlrev_b32 v4, 16, v77
    v_and_b32 v5, 0xffff0000, v77
    v_add_f32 v10, v10, v4
    v_add_f32 v11, v11, v5
    v_lshlrev_b32 v4, 16, v78
    v_and_b32 v5, 0xffff0000, v78
    v_add_f32 v12, v12, v4
    v_add_f32 v13, v13, v5
    v_lshlrev_b32 v4, 16, v79
    v_and_b32 v5, 0xffff0000, v79
    v_add_f32 v14, v14, v4
    v_add_f32 v15, v15, v5
    s_waitcnt vmcnt(19)
    v_lshlrev_b32 v4, 16, v80
    v_and_b32 v5, 0xffff0000, v80
    v_add_f32 v8, v8, v4
    v_add_f32 v9, v9, v5
    v_lshlrev_b32 v4, 16, v81
    v_and_b32 v5, 0xffff0000, v81
    v_add_f32 v10, v10, v4
    v_add_f32 v11, v11, v5
    v_lshlrev_b32 v4, 16, v82
    v_and_b32 v5, 0xffff0000, v82
    v_add_f32 v12, v12, v4
    v_add_f32 v13, v13, v5
    v_lshlrev_b32 v4, 16, v83
    v_and_b32 v5, 0xffff0000, v83
    v_add_f32 v14, v14, v4
    v_add_f32 v15, v15, v5
    s_waitcnt vmcnt(18)
    v_lshlrev_b32 v4, 16, v84
    v_and_b32 v5, 0xffff0000, v84
    v_add_f32 v8, v8, v4
    v_add_f32 v9, v9, v5
    v_lshlrev_b32 v4, 16, v85
    v_and_b32 v5, 0xffff0000, v85
    v_add_f32 v10, v10, v4
    v_add_f32 v11, v11, v5
    v_lshlrev_b32 v4, 16, v86
    v_and_b32 v5, 0xffff0000, v86
    v_add_f32 v12, v12, v4
    v_add_f32 v13, v13, v5
    v_lshlrev_b32 v4, 16, v87
    v_and_b32 v5, 0xffff0000, v87
    v_add_f32 v14, v14, v4
    v_add_f32 v15, v15, v5
    s_waitcnt vmcnt(17)
    v_lshlrev_b32 v4, 16, v88
    v_and_b32 v5, 0xffff0000, v88
    v_add_f32 v8, v8, v4
    v_add_f32 v9, v9, v5
    v_lshlrev_b32 v4, 16, v89
    v_and_b32 v5, 0xffff0000, v89
    v_add_f32 v10, v10, v4
    v_add_f32 v11, v11, v5
    v_lshlrev_b32 v4, 16, v90
    v_and_b32 v5, 0xffff0000, v90
    v_add_f32 v12, v12, v4
    v_add_f32 v13, v13, v5
    v_lshlrev_b32 v4, 16, v91
    v_and_b32 v5, 0xffff0000, v91
    v_add_f32 v14, v14, v4
    v_add_f32 v15, v15, v5
    s_waitcnt vmcnt(16)
    v_lshlrev_b32 v4, 16, v92
    v_and_b32 v5, 0xffff0000, v92
    v_add_f32 v8, v8, v4
    v_add_f32 v9, v9, v5
    v_lshlrev_b32 v4, 16, v93
    v_and_b32 v5, 0xffff0000, v93
    v_add_f32 v10, v10, v4
    v_add_f32 v11, v11, v5
    v_lshlrev_b32 v4, 16, v94
    v_and_b32 v5, 0xffff0000, v94
    v_add_f32 v12, v12, v4
    v_add_f32 v13, v13, v5
    v_lshlrev_b32 v4, 16, v95
    v_and_b32 v5, 0xffff0000, v95
    v_add_f32 v14, v14, v4
    v_add_f32 v15, v15, v5
    s_waitcnt vmcnt(15)
    v_lshlrev_b32 v4, 16, v96
    v_and_b32 v5, 0xffff0000, v96
    v_add_f32 v8, v8, v4
    v_add_f32 v9, v9, v5
    v_lshlrev_b32 v4, 16, v97
    v_and_b32 v5, 0xffff0000, v97
    v_add_f32 v10, v10, v4
    v_add_f32 v11, v11, v5
    v_lshlrev_b32 v4, 16, v98
    v_and_b32 v5, 0xffff0000, v98
    v_add_f32 v12, v12, v4
    v_add_f32 v13, v13, v5
    v_lshlrev_b32 v4, 16, v99
    v_and_b32 v5, 0xffff0000, v99
    v_add_f32 v14, v14, v4
    v_add_f32 v15, v15, v5
    s_waitcnt vmcnt(14)
    v_lshlrev_b32 v4, 16, v100
    v_and_b32 v5, 0xffff0000, v100
    v_add_f32 v8, v8, v4
    v_add_f32 v9, v9, v5
    v_lshlrev_b32 v4, 16, v101
    v_and_b32 v5, 0xffff0000, v101
    v_add_f32 v10, v10, v4
    v_add_f32 v11, v11, v5
    v_lshlrev_b32 v4, 16, v102
    v_and_b32 v5, 0xffff0000, v102
    v_add_f32 v12, v12, v4
    v_add_f32 v13, v13, v5
    v_lshlrev_b32 v4, 16, v103
    v_and_b32 v5, 0xffff0000, v103
    v_add_f32 v14, v14, v4
    v_add_f32 v15, v15, v5
    s_waitcnt vmcnt(13)
    v_lshlrev_b32 v4, 16, v104
    v_and_b32 v5, 0xffff0000, v104
    v_add_f32 v8, v8, v4
    v_add_f32 v9, v9, v5
    v_lshlrev_b32 v4, 16, v105
    v_and_b32 v5, 0xffff0000, v105
    v_add_f32 v10, v10, v4
    v_add_f32 v11, v11, v5
    v_lshlrev_b32 v4, 16, v106
    v_and_b32 v5, 0xffff0000, v106
    v_add_f32 v12, v12, v4
    v_add_f32 v13, v13, v5
    v_lshlrev_b32 v4, 16, v107
    v_and_b32 v5, 0xffff0000, v107
    v_add_f32 v14, v14, v4
    v_add_f32 v15, v15, v5
    s_waitcnt vmcnt(12)
    v_lshlrev_b32 v4, 16, v108
    v_and_b32 v5, 0xffff0000, v108
    v_add_f32 v8, v8, v4
    v_add_f32 v9, v9, v5
    v_lshlrev_b32 v4, 16, v109
    v_and_b32 v5, 0xffff0000, v109
    v_add_f32 v10, v10, v4
    v_add_f32 v11, v11, v5
    v_lshlrev_b32 v4, 16, v110
    v_and_b32 v5, 0xffff0000, v110
    v_add_f32 v12, v12, v4
    v_add_f32 v13, v13, v5
    v_lshlrev_b32 v4, 16, v111
    v_and_b32 v5, 0xffff0000, v111
    v_add_f32 v14, v14, v4
    v_add_f32 v15, v15, v5
    s_waitcnt vmcnt(11)
    v_lshlrev_b32 v4, 16, v112
    v_and_b32 v5, 0xffff0000, v112
    v_add_f32 v8, v8, v4
    v_add_f32 v9, v9, v5
    v_lshlrev_b32 v4, 16, v113
    v_and_b32 v5, 0xffff0000, v113
    v_add_f32 v10, v10, v4
    v_add_f32 v11, v11, v5
    v_lshlrev_b32 v4, 16, v114
    v_and_b32 v5, 0xffff0000, v114
    v_add_f32 v12, v12, v4
    v_add_f32 v13, v13, v5
    v_lshlrev_b32 v4, 16, v115
    v_and_b32 v5, 0xffff0000, v115
    v_add_f32 v14, v14, v4
    v_add_f32 v15, v15, v5
    s_waitcnt vmcnt(10)
    v_lshlrev_b32 v4, 16, v116
    v_and_b32 v5, 0xffff0000, v116
    v_add_f32 v8, v8, v4
    v_add_f32 v9, v9, v5
    v_lshlrev_b32 v4, 16, v117
    v_and_b32 v5, 0xffff0000, v117
    v_add_f32 v10, v10, v4
    v_add_f32 v11, v11, v5
    v_lshlrev_b32 v4, 16, v118
    v_and_b32 v5, 0xffff0000, v118
    v_add_f32 v12, v12, v4
    v_add_f32 v13, v13, v5
    v_lshlrev_b32 v4, 16, v119
    v_and_b32 v5, 0xffff0000, v119
    v_add_f32 v14, v14, v4
    v_add_f32 v15, v15, v5
    s_waitcnt vmcnt(9)
    v_lshlrev_b32 v4, 16, v120
    v_and_b32 v5, 0xffff0000, v120
    v_add_f32 v8, v8, v4
    v_add_f32 v9, v9, v5
    v_lshlrev_b32 v4, 16, v121
    v_and_b32 v5, 0xffff0000, v121
    v_add_f32 v10, v10, v4
    v_add_f32 v11, v11, v5
    v_lshlrev_b32 v4, 16, v122
    v_and_b32 v5, 0xffff0000, v122
    v_add_f32 v12, v12, v4
    v_add_f32 v13, v13, v5
    v_lshlrev_b32 v4, 16, v123
    v_and_b32 v5, 0xffff0000, v123
    v_add_f32 v14, v14, v4
    v_add_f32 v15, v15, v5
    s_waitcnt vmcnt(8)
    v_lshlrev_b32 v4, 16, v124
    v_and_b32 v5, 0xffff0000, v124
    v_add_f32 v8, v8, v4
    v_add_f32 v9, v9, v5
    v_lshlrev_b32 v4, 16, v125
    v_and_b32 v5, 0xffff0000, v125
    v_add_f32 v10, v10, v4
    v_add_f32 v11, v11, v5
    v_lshlrev_b32 v4, 16, v126
    v_and_b32 v5, 0xffff0000, v126
    v_add_f32 v12, v12, v4
    v_add_f32 v13, v13, v5
    v_lshlrev_b32 v4, 16, v127
    v_and_b32 v5, 0xffff0000, v127
    v_add_f32 v14, v14, v4
    v_add_f32 v15, v15, v5
    s_waitcnt vmcnt(7)
    v_lshlrev_b32 v4, 16, v128
    v_and_b32 v5, 0xffff0000, v128
    v_add_f32 v8, v8, v4
    v_add_f32 v9, v9, v5
    v_lshlrev_b32 v4, 16, v129
    v_and_b32 v5, 0xffff0000, v129
    v_add_f32 v10, v10, v4
    v_add_f32 v11, v11, v5
    v_lshlrev_b32 v4, 16, v130
    v_and_b32 v5, 0xffff0000, v130
    v_add_f32 v12, v12, v4
    v_add_f32 v13, v13, v5
    v_lshlrev_b32 v4, 16, v131
    v_and_b32 v5, 0xffff0000, v131
    v_add_f32 v14, v14, v4
    v_add_f32 v15, v15, v5
    s_waitcnt vmcnt(6)
    v_lshlrev_b32 v4, 16, v132
    v_and_b32 v5, 0xffff0000, v132
    v_add_f32 v8, v8, v4
    v_add_f32 v9, v9, v5
    v_lshlrev_b32 v4, 16, v133
    v_and_b32 v5, 0xffff0000, v133
    v_add_f32 v10, v10, v4
    v_add_f32 v11, v11, v5
    v_lshlrev_b32 v4, 16, v134
    v_and_b32 v5, 0xffff0000, v134
    v_add_f32 v12, v12, v4
    v_add_f32 v13, v13, v5
    v_lshlrev_b32 v4, 16, v135
    v_and_b32 v5, 0xffff0000, v135
    v_add_f32 v14, v14, v4
    v_add_f32 v15, v15, v5
    s_waitcnt vmcnt(5)
    v_lshlrev_b32 v4, 16, v136
    v_and_b32 v5, 0xffff0000, v136
    v_add_f32 v8, v8, v4
    v_add_f32 v9, v9, v5
    v_lshlrev_b32 v4, 16, v137
    v_and_b32 v5, 0xffff0000, v137
    v_add_f32 v10, v10, v4
    v_add_f32 v11, v11, v5
    v_lshlrev_b32 v4, 16, v138
    v_and_b32 v5, 0xffff0000, v138
    v_add_f32 v12, v12, v4
    v_add_f32 v13, v13, v5
    v_lshlrev_b32 v4, 16, v139
    v_and_b32 v5, 0xffff0000, v139
    v_add_f32 v14, v14, v4
    v_add_f32 v15, v15, v5
    s_waitcnt vmcnt(4)
    v_lshlrev_b32 v4, 16, v140
    v_and_b32 v5, 0xffff0000, v140
    v_add_f32 v8, v8, v4
    v_add_f32 v9, v9, v5
    v_lshlrev_b32 v4, 16, v141
    v_and_b32 v5, 0xffff0000, v141
    v_add_f32 v10, v10, v4
    v_add_f32 v11, v11, v5
    v_lshlrev_b32 v4, 16, v142
    v_and_b32 v5, 0xffff0000, v142
    v_add_f32 v12, v12, v4
    v_add_f32 v13, v13, v5
    v_lshlrev_b32 v4, 16, v143
    v_and_b32 v5, 0xffff0000, v143
    v_add_f32 v14, v14, v4
    v_add_f32 v15, v15, v5
    s_waitcnt vmcnt(3)
    v_lshlrev_b32 v4, 16, v144
    v_and_b32 v5, 0xffff0000, v144
    v_add_f32 v8, v8, v4
    v_add_f32 v9, v9, v5
    v_lshlrev_b32 v4, 16, v145
    v_and_b32 v5, 0xffff0000, v145
    v_add_f32 v10, v10, v4
    v_add_f32 v11, v11, v5
    v_lshlrev_b32 v4, 16, v146
    v_and_b32 v5, 0xffff0000, v146
    v_add_f32 v12, v12, v4
    v_add_f32 v13, v13, v5
    v_lshlrev_b32 v4, 16, v147
    v_and_b32 v5, 0xffff0000, v147
    v_add_f32 v14, v14, v4
    v_add_f32 v15, v15, v5
    s_waitcnt vmcnt(2)
    v_lshlrev_b32 v4, 16, v148
    v_and_b32 v5, 0xffff0000, v148
    v_add_f32 v8, v8, v4
    v_add_f32 v9, v9, v5
    v_lshlrev_b32 v4, 16, v149
    v_and_b32 v5, 0xffff0000, v149
    v_add_f32 v10, v10, v4
    v_add_f32 v11, v11, v5
    v_lshlrev_b32 v4, 16, v150
    v_and_b32 v5, 0xffff0000, v150
    v_add_f32 v12, v12, v4
    v_add_f32 v13, v13, v5
    v_lshlrev_b32 v4, 16, v151
    v_and_b32 v5, 0xffff0000, v151
    v_add_f32 v14, v14, v4
    v_add_f32 v15, v15, v5
    s_waitcnt vmcnt(1)
    v_lshlrev_b32 v4, 16, v152
    v_and_b32 v5, 0xffff0000, v152
    v_add_f32 v8, v8, v4
    v_add_f32 v9, v9, v5
    v_lshlrev_b32 v4, 16, v153
    v_and_b32 v5, 0xffff0000, v153
    v_add_f32 v10, v10, v4
    v_add_f32 v11, v11, v5
    v_lshlrev_b32 v4, 16, v154
    v_and_b32 v5, 0xffff0000, v154
    v_add_f32 v12, v12, v4
    v_add_f32 v13, v13, v5
    v_lshlrev_b32 v4, 16, v155
    v_and_b32 v5, 0xffff0000, v155
    v_add_f32 v14, v14, v4
    v_add_f32 v15, v15, v5
    s_waitcnt vmcnt(0)
    v_lshlrev_b32 v4, 16, v156
    v_and_b32 v5, 0xffff0000, v156
    v_add_f32 v8, v8, v4
    v_add_f32 v9, v9, v5
    v_lshlrev_b32 v4, 16, v157
    v_and_b32 v5, 0xffff0000, v157
    v_add_f32 v10, v10, v4
    v_add_f32 v11, v11, v5
    v_lshlrev_b32 v4, 16, v158
    v_and_b32 v5, 0xffff0000, v158
    v_add_f32 v12, v12, v4
    v_add_f32 v13, v13, v5
    v_lshlrev_b32 v4, 16, v159
    v_and_b32 v5, 0xffff0000, v159
    v_add_f32 v14, v14, v4
    v_add_f32 v15, v15, v5
    v_xor_b32 v4, 4, v1
    v_lshlrev_b32 v4, 2, v4
    ds_bpermute_b32 v16, v4, v8
    ds_bpermute_b32 v17, v4, v9
    ds_bpermute_b32 v18, v4, v10
    ds_bpermute_b32 v19, v4, v11
    ds_bpermute_b32 v20, v4, v12
    ds_bpermute_b32 v21, v4, v13
    ds_bpermute_b32 v22, v4, v14
    ds_bpermute_b32 v23, v4, v15
    s_waitcnt lgkmcnt(0)
    v_add_f32 v8, v8, v16
    v_add_f32 v9, v9, v17
    v_add_f32 v10, v10, v18
    v_add_f32 v11, v11, v19
    v_add_f32 v12, v12, v20
    v_add_f32 v13, v13, v21
    v_add_f32 v14, v14, v22
    v_add_f32 v15, v15, v23
    v_xor_b32 v4, 8, v1
    v_lshlrev_b32 v4, 2, v4
    ds_bpermute_b32 v16, v4, v8
    ds_bpermute_b32 v17, v4, v9
    ds_bpermute_b32 v18, v4, v10
    ds_bpermute_b32 v19, v4, v11
    ds_bpermute_b32 v20, v4, v12
    ds_bpermute_b32 v21, v4, v13
    ds_bpermute_b32 v22, v4, v14
    ds_bpermute_b32 v23, v4, v15
    s_waitcnt lgkmcnt(0)
    v_add_f32 v8, v8, v16
    v_add_f32 v9, v9, v17
    v_add_f32 v10, v10, v18
    v_add_f32 v11, v11, v19
    v_add_f32 v12, v12, v20
    v_add_f32 v13, v13, v21
    v_add_f32 v14, v14, v22
    v_add_f32 v15, v15, v23
    v_xor_b32 v4, 16, v1
    v_lshlrev_b32 v4, 2, v4
    ds_bpermute_b32 v16, v4, v8
    ds_bpermute_b32 v17, v4, v9
    ds_bpermute_b32 v18, v4, v10
    ds_bpermute_b32 v19, v4, v11
    ds_bpermute_b32 v20, v4, v12
    ds_bpermute_b32 v21, v4, v13
    ds_bpermute_b32 v22, v4, v14
    ds_bpermute_b32 v23, v4, v15
    s_waitcnt lgkmcnt(0)
    v_add_f32 v8, v8, v16
    v_add_f32 v9, v9, v17
    v_add_f32 v10, v10, v18
    v_add_f32 v11, v11, v19
    v_add_f32 v12, v12, v20
    v_add_f32 v13, v13, v21
    v_add_f32 v14, v14, v22
    v_add_f32 v15, v15, v23
    v_xor_b32 v4, 32, v1
    v_lshlrev_b32 v4, 2, v4
    ds_bpermute_b32 v16, v4, v8
    ds_bpermute_b32 v17, v4, v9
    ds_bpermute_b32 v18, v4, v10
    ds_bpermute_b32 v19, v4, v11
    ds_bpermute_b32 v20, v4, v12
    ds_bpermute_b32 v21, v4, v13
    ds_bpermute_b32 v22, v4, v14
    ds_bpermute_b32 v23, v4, v15
    s_waitcnt lgkmcnt(0)
    v_add_f32 v8, v8, v16
    v_add_f32 v9, v9, v17
    v_add_f32 v10, v10, v18
    v_add_f32 v11, v11, v19
    v_add_f32 v12, v12, v20
    v_add_f32 v13, v13, v21
    v_add_f32 v14, v14, v22
    v_add_f32 v15, v15, v23
    s_lshl_b32 s60, s60, 1
    v_lshlrev_b32 v4, 5, v1
    v_add_u32 v4, s60, v4
    s_mov_b64 exec, 0xf
    buffer_store_dwordx4 v[8:11], v4, s[32:35], 0 offen sc1
    buffer_store_dwordx4 v[12:15], v4, s[32:35], 0 offen offset:16 sc1
    s_mov_b64 exec, -1
    s_branch k1_kernel_end
k1_kernel_comp:
    s_cmp_lg_u32 s52, 0
    s_cbranch_scc1 k1_kernel_now
    s_mul_i32 s61, s65, 648
    v_and_b32 v2, 15, v1
    v_lshrrev_b32 v3, 4, v1
    v_lshlrev_b32 v3, 2, v3
    v_mov_b32 v7, 0x40000000
    v_add_u32 v4, 0, v3
    v_add_u32 v5, 0, v2
    v_mul_u32_u24 v6, 18, v4
    v_add_u32 v6, v6, v5
    v_lshlrev_b32 v6, 1, v6
    v_cmp_gt_u32 vcc, 18, v4
    v_cmp_gt_u32 s[68:69], 18, v5
    s_and_b64 vcc, vcc, s[68:69]
    v_cndmask_b32 v6, v7, v6, vcc
    buffer_load_ushort v8, v6, s[36:39], s61 offen
    v_add_u32 v4, 1, v3
    v_add_u32 v5, 0, v2
    v_mul_u32_u24 v6, 18, v4
    v_add_u32 v6, v6, v5
    v_lshlrev_b32 v6, 1, v6
    v_cmp_gt_u32 vcc, 18, v4
    v_cmp_gt_u32 s[68:69], 18, v5
    s_and_b64 vcc, vcc, s[68:69]
    v_cndmask_b32 v6, v7, v6, vcc
    buffer_load_ushort v9, v6, s[36:39], s61 offen
    v_add_u32 v4, 2, v3
    v_add_u32 v5, 0, v2
    v_mul_u32_u24 v6, 18, v4
    v_add_u32 v6, v6, v5
    v_lshlrev_b32 v6, 1, v6
    v_cmp_gt_u32 vcc, 18, v4
    v_cmp_gt_u32 s[68:69], 18, v5
    s_and_b64 vcc, vcc, s[68:69]
    v_cndmask_b32 v6, v7, v6, vcc
    buffer_load_ushort v10, v6, s[36:39], s61 offen
    v_add_u32 v4, 3, v3
    v_add_u32 v5, 0, v2
    v_mul_u32_u24 v6, 18, v4
    v_add_u32 v6, v6, v5
    v_lshlrev_b32 v6, 1, v6
    v_cmp_gt_u32 vcc, 18, v4
    v_cmp_gt_u32 s[68:69], 18, v5
    s_and_b64 vcc, vcc, s[68:69]
    v_cndmask_b32 v6, v7, v6, vcc
    buffer_load_ushort v11, v6, s[36:39], s61 offen
    v_add_u32 v4, 0, v3
    v_add_u32 v5, 16, v2
    v_mul_u32_u24 v6, 18, v4
    v_add_u32 v6, v6, v5
    v_lshlrev_b32 v6, 1, v6
    v_cmp_gt_u32 vcc, 18, v4
    v_cmp_gt_u32 s[68:69], 18, v5
    s_and_b64 vcc, vcc, s[68:69]
    v_cndmask_b32 v6, v7, v6, vcc
    buffer_load_ushort v12, v6, s[36:39], s61 offen
    v_add_u32 v4, 1, v3
    v_add_u32 v5, 16, v2
    v_mul_u32_u24 v6, 18, v4
    v_add_u32 v6, v6, v5
    v_lshlrev_b32 v6, 1, v6
    v_cmp_gt_u32 vcc, 18, v4
    v_cmp_gt_u32 s[68:69], 18, v5
    s_and_b64 vcc, vcc, s[68:69]
    v_cndmask_b32 v6, v7, v6, vcc
    buffer_load_ushort v13, v6, s[36:39], s61 offen
    v_add_u32 v4, 2, v3
    v_add_u32 v5, 16, v2
    v_mul_u32_u24 v6, 18, v4
    v_add_u32 v6, v6, v5
    v_lshlrev_b32 v6, 1, v6
    v_cmp_gt_u32 vcc, 18, v4
    v_cmp_gt_u32 s[68:69], 18, v5
    s_and_b64 vcc, vcc, s[68:69]
    v_cndmask_b32 v6, v7, v6, vcc
    buffer_load_ushort v14, v6, s[36:39], s61 offen
    v_add_u32 v4, 3, v3
    v_add_u32 v5, 16, v2
    v_mul_u32_u24 v6, 18, v4
    v_add_u32 v6, v6, v5
    v_lshlrev_b32 v6, 1, v6
    v_cmp_gt_u32 vcc, 18, v4
    v_cmp_gt_u32 s[68:69], 18, v5
    s_and_b64 vcc, vcc, s[68:69]
    v_cndmask_b32 v6, v7, v6, vcc
    buffer_load_ushort v15, v6, s[36:39], s61 offen
    v_add_u32 v4, 16, v3
    v_add_u32 v5, 0, v2
    v_mul_u32_u24 v6, 18, v4
    v_add_u32 v6, v6, v5
    v_lshlrev_b32 v6, 1, v6
    v_cmp_gt_u32 vcc, 18, v4
    v_cmp_gt_u32 s[68:69], 18, v5
    s_and_b64 vcc, vcc, s[68:69]
    v_cndmask_b32 v6, v7, v6, vcc
    buffer_load_ushort v16, v6, s[36:39], s61 offen
    v_add_u32 v4, 17, v3
    v_add_u32 v5, 0, v2
    v_mul_u32_u24 v6, 18, v4
    v_add_u32 v6, v6, v5
    v_lshlrev_b32 v6, 1, v6
    v_cmp_gt_u32 vcc, 18, v4
    v_cmp_gt_u32 s[68:69], 18, v5
    s_and_b64 vcc, vcc, s[68:69]
    v_cndmask_b32 v6, v7, v6, vcc
    buffer_load_ushort v17, v6, s[36:39], s61 offen
    v_add_u32 v4, 18, v3
    v_add_u32 v5, 0, v2
    v_mul_u32_u24 v6, 18, v4
    v_add_u32 v6, v6, v5
    v_lshlrev_b32 v6, 1, v6
    v_cmp_gt_u32 vcc, 18, v4
    v_cmp_gt_u32 s[68:69], 18, v5
    s_and_b64 vcc, vcc, s[68:69]
    v_cndmask_b32 v6, v7, v6, vcc
    buffer_load_ushort v18, v6, s[36:39], s61 offen
    v_add_u32 v4, 19, v3
    v_add_u32 v5, 0, v2
    v_mul_u32_u24 v6, 18, v4
    v_add_u32 v6, v6, v5
    v_lshlrev_b32 v6, 1, v6
    v_cmp_gt_u32 vcc, 18, v4
    v_cmp_gt_u32 s[68:69], 18, v5
    s_and_b64 vcc, vcc, s[68:69]
    v_cndmask_b32 v6, v7, v6, vcc
    buffer_load_ushort v19, v6, s[36:39], s61 offen
    v_add_u32 v4, 16, v3
    v_add_u32 v5, 16, v2
    v_mul_u32_u24 v6, 18, v4
    v_add_u32 v6, v6, v5
    v_lshlrev_b32 v6, 1, v6
    v_cmp_gt_u32 vcc, 18, v4
    v_cmp_gt_u32 s[68:69], 18, v5
    s_and_b64 vcc, vcc, s[68:69]
    v_cndmask_b32 v6, v7, v6, vcc
    buffer_load_ushort v20, v6, s[36:39], s61 offen
    v_add_u32 v4, 17, v3
    v_add_u32 v5, 16, v2
    v_mul_u32_u24 v6, 18, v4
    v_add_u32 v6, v6, v5
    v_lshlrev_b32 v6, 1, v6
    v_cmp_gt_u32 vcc, 18, v4
    v_cmp_gt_u32 s[68:69], 18, v5
    s_and_b64 vcc, vcc, s[68:69]
    v_cndmask_b32 v6, v7, v6, vcc
    buffer_load_ushort v21, v6, s[36:39], s61 offen
    v_add_u32 v4, 18, v3
    v_add_u32 v5, 16, v2
    v_mul_u32_u24 v6, 18, v4
    v_add_u32 v6, v6, v5
    v_lshlrev_b32 v6, 1, v6
    v_cmp_gt_u32 vcc, 18, v4
    v_cmp_gt_u32 s[68:69], 18, v5
    s_and_b64 vcc, vcc, s[68:69]
    v_cndmask_b32 v6, v7, v6, vcc
    buffer_load_ushort v22, v6, s[36:39], s61 offen
    v_add_u32 v4, 19, v3
    v_add_u32 v5, 16, v2
    v_mul_u32_u24 v6, 18, v4
    v_add_u32 v6, v6, v5
    v_lshlrev_b32 v6, 1, v6
    v_cmp_gt_u32 vcc, 18, v4
    v_cmp_gt_u32 s[68:69], 18, v5
    s_and_b64 vcc, vcc, s[68:69]
    v_cndmask_b32 v6, v7, v6, vcc
    buffer_load_ushort v23, v6, s[36:39], s61 offen
    v_add_u32 v4, -8, v3
    v_add_u32 v5, 0, v2
    v_mul_u32_u24 v6, 18, v4
    v_add_u32 v6, v6, v5
    v_lshlrev_b32 v6, 1, v6
    v_cmp_gt_u32 vcc, 18, v4
    v_cmp_gt_u32 s[68:69], 18, v5
    s_and_b64 vcc, vcc, s[68:69]
    v_cndmask_b32 v6, v7, v6, vcc
    buffer_load_ushort v24, v6, s[36:39], s61 offen
    v_add_u32 v4, -7, v3
    v_add_u32 v5, 0, v2
    v_mul_u32_u24 v6, 18, v4
    v_add_u32 v6, v6, v5
    v_lshlrev_b32 v6, 1, v6
    v_cmp_gt_u32 vcc, 18, v4
    v_cmp_gt_u32 s[68:69], 18, v5
    s_and_b64 vcc, vcc, s[68:69]
    v_cndmask_b32 v6, v7, v6, vcc
    buffer_load_ushort v25, v6, s[36:39], s61 offen
    v_add_u32 v4, -6, v3
    v_add_u32 v5, 0, v2
    v_mul_u32_u24 v6, 18, v4
    v_add_u32 v6, v6, v5
    v_lshlrev_b32 v6, 1, v6
    v_cmp_gt_u32 vcc, 18, v4
    v_cmp_gt_u32 s[68:69], 18, v5
    s_and_b64 vcc, vcc, s[68:69]
    v_cndmask_b32 v6, v7, v6, vcc
    buffer_load_ushort v26, v6, s[36:39], s61 offen
    v_add_u32 v4, -5, v3
    v_add_u32 v5, 0, v2
    v_mul_u32_u24 v6, 18, v4
    v_add_u32 v6, v6, v5
    v_lshlrev_b32 v6, 1, v6
    v_cmp_gt_u32 vcc, 18, v4
    v_cmp_gt_u32 s[68:69], 18, v5
    s_and_b64 vcc, vcc, s[68:69]
    v_cndmask_b32 v6, v7, v6, vcc
    buffer_load_ushort v27, v6, s[36:39], s61 offen
    v_add_u32 v4, -8, v3
    v_add_u32 v5, 16, v2
    v_mul_u32_u24 v6, 18, v4
    v_add_u32 v6, v6, v5
    v_lshlrev_b32 v6, 1, v6
    v_cmp_gt_u32 vcc, 18, v4
    v_cmp_gt_u32 s[68:69], 18, v5
    s_and_b64 vcc, vcc, s[68:69]
    v_cndmask_b32 v6, v7, v6, vcc
    buffer_load_ushort v28, v6, s[36:39], s61 offen
    v_add_u32 v4, -7, v3
    v_add_u32 v5, 16, v2
    v_mul_u32_u24 v6, 18, v4
    v_add_u32 v6, v6, v5
    v_lshlrev_b32 v6, 1, v6
    v_cmp_gt_u32 vcc, 18, v4
    v_cmp_gt_u32 s[68:69], 18, v5
    s_and_b64 vcc, vcc, s[68:69]
    v_cndmask_b32 v6, v7, v6, vcc
    buffer_load_ushort v29, v6, s[36:39], s61 offen
    v_add_u32 v4, -6, v3
    v_add_u32 v5, 16, v2
    v_mul_u32_u24 v6, 18, v4
    v_add_u32 v6, v6, v5
    v_lshlrev_b32 v6, 1, v6
    v_cmp_gt_u32 vcc, 18, v4
    v_cmp_gt_u32 s[68:69], 18, v5
    s_and_b64 vcc, vcc, s[68:69]
    v_cndmask_b32 v6, v7, v6, vcc
    buffer_load_ushort v30, v6, s[36:39], s61 offen
    v_add_u32 v4, -5, v3
    v_add_u32 v5, 16, v2
    v_mul_u32_u24 v6, 18, v4
    v_add_u32 v6, v6, v5
    v_lshlrev_b32 v6, 1, v6
    v_cmp_gt_u32 vcc, 18, v4
    v_cmp_gt_u32 s[68:69], 18, v5
    s_and_b64 vcc, vcc, s[68:69]
    v_cndmask_b32 v6, v7, v6, vcc
    buffer_load_ushort v31, v6, s[36:39], s61 offen
    v_add_u32 v4, 8, v3
    v_add_u32 v5, 0, v2
    v_mul_u32_u24 v6, 18, v4
    v_add_u32 v6, v6, v5
    v_lshlrev_b32 v6, 1, v6
    v_cmp_gt_u32 vcc, 18, v4
    v_cmp_gt_u32 s[68:69], 18, v5
    s_and_b64 vcc, vcc, s[68:69]
    v_cndmask_b32 v6, v7, v6, vcc
    buffer_load_ushort v32, v6, s[36:39], s61 offen
    v_add_u32 v4, 9, v3
    v_add_u32 v5, 0, v2
    v_mul_u32_u24 v6, 18, v4
    v_add_u32 v6, v6, v5
    v_lshlrev_b32 v6, 1, v6
    v_cmp_gt_u32 vcc, 18, v4
    v_cmp_gt_u32 s[68:69], 18, v5
    s_and_b64 vcc, vcc, s[68:69]
    v_cndmask_b32 v6, v7, v6, vcc
    buffer_load_ushort v33, v6, s[36:39], s61 offen
    v_add_u32 v4, 10, v3
    v_add_u32 v5, 0, v2
    v_mul_u32_u24 v6, 18, v4
    v_add_u32 v6, v6, v5
    v_lshlrev_b32 v6, 1, v6
    v_cmp_gt_u32 vcc, 18, v4
    v_cmp_gt_u32 s[68:69], 18, v5
    s_and_b64 vcc, vcc, s[68:69]
    v_cndmask_b32 v6, v7, v6, vcc
    buffer_load_ushort v34, v6, s[36:39], s61 offen
    v_add_u32 v4, 11, v3
    v_add_u32 v5, 0, v2
    v_mul_u32_u24 v6, 18, v4
    v_add_u32 v6, v6, v5
    v_lshlrev_b32 v6, 1, v6
    v_cmp_gt_u32 vcc, 18, v4
    v_cmp_gt_u32 s[68:69], 18, v5
    s_and_b64 vcc, vcc, s[68:69]
    v_cndmask_b32 v6, v7, v6, vcc
    buffer_load_ushort v35, v6, s[36:39], s61 offen
    v_add_u32 v4, 8, v3
    v_add_u32 v5, 16, v2
    v_mul_u32_u24 v6, 18, v4
    v_add_u32 v6, v6, v5
    v_lshlrev_b32 v6, 1, v6
    v_cmp_gt_u32 vcc, 18, v4
    v_cmp_gt_u32 s[68:69], 18, v5
    s_and_b64 vcc, vcc, s[68:69]
    v_cndmask_b32 v6, v7, v6, vcc
    buffer_load_ushort v36, v6, s[36:39], s61 offen
    v_add_u32 v4, 9, v3
    v_add_u32 v5, 16, v2
    v_mul_u32_u24 v6, 18, v4
    v_add_u32 v6, v6, v5
    v_lshlrev_b32 v6, 1, v6
    v_cmp_gt_u32 vcc, 18, v4
    v_cmp_gt_u32 s[68:69], 18, v5
    s_and_b64 vcc, vcc, s[68:69]
    v_cndmask_b32 v6, v7, v6, vcc
    buffer_load_ushort v37, v6, s[36:39], s61 offen
    v_add_u32 v4, 10, v3
    v_add_u32 v5, 16, v2
    v_mul_u32_u24 v6, 18, v4
    v_add_u32 v6, v6, v5
    v_lshlrev_b32 v6, 1, v6
    v_cmp_gt_u32 vcc, 18, v4
    v_cmp_gt_u32 s[68:69], 18, v5
    s_and_b64 vcc, vcc, s[68:69]
    v_cndmask_b32 v6, v7, v6, vcc
    buffer_load_ushort v38, v6, s[36:39], s61 offen
    v_add_u32 v4, 11, v3
    v_add_u32 v5, 16, v2
    v_mul_u32_u24 v6, 18, v4
    v_add_u32 v6, v6, v5
    v_lshlrev_b32 v6, 1, v6
    v_cmp_gt_u32 vcc, 18, v4
    v_cmp_gt_u32 s[68:69], 18, v5
    s_and_b64 vcc, vcc, s[68:69]
    v_cndmask_b32 v6, v7, v6, vcc
    buffer_load_ushort v39, v6, s[36:39], s61 offen
    s_waitcnt vmcnt(0)
    v_lshlrev_b32 v2, 3, v1
    v_lshl_or_b32 v8, v9, 16, v8
    v_lshl_or_b32 v9, v11, 16, v10
    ds_write_b64 v2, v[8:9] offset:0
    v_lshl_or_b32 v12, v13, 16, v12
    v_lshl_or_b32 v13, v15, 16, v14
    ds_write_b64 v2, v[12:13] offset:512
    v_lshl_or_b32 v16, v17, 16, v16
    v_lshl_or_b32 v17, v19, 16, v18
    ds_write_b64 v2, v[16:17] offset:1024
    v_lshl_or_b32 v20, v21, 16, v20
    v_lshl_or_b32 v21, v23, 16, v22
    ds_write_b64 v2, v[20:21] offset:1536
    v_lshl_or_b32 v24, v25, 16, v24
    v_lshl_or_b32 v25, v27, 16, v26
    ds_write_b64 v2, v[24:25] offset:2048
    v_lshl_or_b32 v28, v29, 16, v28
    v_lshl_or_b32 v29, v31, 16, v30
    ds_write_b64 v2, v[28:29] offset:2560
    v_lshl_or_b32 v32, v33, 16, v32
    v_lshl_or_b32 v33, v35, 16, v34
    ds_write_b64 v2, v[32:33] offset:3072
    v_lshl_or_b32 v36, v37, 16, v36
    v_lshl_or_b32 v37, v39, 16, v38
    ds_write_b64 v2, v[36:37] offset:3584
    v_mov_b32 v8, 0
    v_mov_b32 v9, 0
    v_mov_b32 v10, 0
    v_mov_b32 v11, 0
    v_lshlrev_b32 v2, 4, v1
    ds_write_b128 v2, v[8:11] offset:4096
    ds_write_b128 v2, v[8:11] offset:5120
    ds_write_b128 v2, v[8:11] offset:6144
    ds_write_b128 v2, v[8:11] offset:7168
    ds_write_b128 v2, v[8:11] offset:8192
    ds_write_b128 v2, v[8:11] offset:9216
    ds_write_b128 v2, v[8:11] offset:9472
    s_waitcnt lgkmcnt(0)
k1_kernel_now:
    v_mov_b32 v8, 0
    v_mov_b32 v9, 0
    v_mov_b32 v10, 0
    v_mov_b32 v11, 0
    v_mov_b32 v12, 0
    v_mov_b32 v13, 0
    v_mov_b32 v14, 0
    v_mov_b32 v15, 0
    v_mov_b32 v16, 0
    v_mov_b32 v17, 0
    v_mov_b32 v18, 0
    v_mov_b32 v19, 0
    v_mov_b32 v20, 0
    v_mov_b32 v21, 0
    v_mov_b32 v22, 0
    v_mov_b32 v23, 0
    v_mov_b32 v24, 0
    v_mov_b32 v25, 0
    v_mov_b32 v26, 0
    v_mov_b32 v27, 0
    v_mov_b32 v28, 0
    v_mov_b32 v29, 0
    v_mov_b32 v30, 0
    v_mov_b32 v31, 0
    v_mov_b32 v32, 0
    v_mov_b32 v33, 0
    v_mov_b32 v34, 0
    v_mov_b32 v35, 0
    v_mov_b32 v36, 0
    v_mov_b32 v37, 0
    v_mov_b32 v38, 0
    v_mov_b32 v39, 0
    v_mov_b32 v40, 0
    v_mov_b32 v41, 0
    v_mov_b32 v42, 0
    v_mov_b32 v43, 0
    v_mov_b32 v44, 0
    v_mov_b32 v45, 0
    v_mov_b32 v46, 0
    v_mov_b32 v47, 0
    v_mov_b32 v48, 0
    v_mov_b32 v49, 0
    v_mov_b32 v50, 0
    v_mov_b32 v51, 0
    v_mov_b32 v52, 0
    v_mov_b32 v53, 0
    v_mov_b32 v54, 0
    v_mov_b32 v55, 0
    v_mov_b32 v56, 0
    v_mov_b32 v57, 0
    v_mov_b32 v58, 0
    v_mov_b32 v59, 0
    v_mov_b32 v60, 0
    v_mov_b32 v61, 0
    v_mov_b32 v62, 0
    v_mov_b32 v63, 0
    v_mov_b32 v64, 0
    v_mov_b32 v65, 0
    v_mov_b32 v66, 0
    v_mov_b32 v67, 0
    v_mov_b32 v68, 0
    v_mov_b32 v69, 0
    v_mov_b32 v70, 0
    v_mov_b32 v71, 0
    v_mov_b32 v72, 0
    v_mov_b32 v73, 0
    v_mov_b32 v74, 0
    v_mov_b32 v75, 0
    v_mov_b32 v76, 0
    v_mov_b32 v77, 0
    v_mov_b32 v78, 0
    v_mov_b32 v79, 0
    v_mov_b32 v80, 0
    v_mov_b32 v81, 0
    v_mov_b32 v82, 0
    v_mov_b32 v83, 0
    v_mov_b32 v84, 0
    v_mov_b32 v85, 0
    v_mov_b32 v86, 0
    v_mov_b32 v87, 0
    v_mov_b32 v88, 0
    v_mov_b32 v89, 0
    v_mov_b32 v90, 0
    v_mov_b32 v91, 0
    v_mov_b32 v92, 0
    v_mov_b32 v93, 0
    v_mov_b32 v94, 0
    v_mov_b32 v95, 0
    v_mov_b32 v96, 0
    v_mov_b32 v97, 0
    v_mov_b32 v98, 0
    v_mov_b32 v99, 0
    v_mov_b32 v100, 0
    v_mov_b32 v101, 0
    v_mov_b32 v102, 0
    v_mov_b32 v103, 0
    v_mov_b32 v104, 0
    v_mov_b32 v105, 0
    v_mov_b32 v106, 0
    v_mov_b32 v107, 0
    v_mov_b32 v108, 0
    v_mov_b32 v109, 0
    v_mov_b32 v110, 0
    v_mov_b32 v111, 0
    v_mov_b32 v112, 0
    v_mov_b32 v113, 0
    v_mov_b32 v114, 0
    v_mov_b32 v115, 0
    v_mov_b32 v116, 0
    v_mov_b32 v117, 0
    v_mov_b32 v118, 0
    v_mov_b32 v119, 0
    v_mov_b32 v120, 0
    v_mov_b32 v121, 0
    v_mov_b32 v122, 0
    v_mov_b32 v123, 0
    v_mov_b32 v124, 0
    v_mov_b32 v125, 0
    v_mov_b32 v126, 0
    v_mov_b32 v127, 0
    v_mov_b32 v128, 0
    v_mov_b32 v129, 0
    v_mov_b32 v130, 0
    v_mov_b32 v131, 0
    v_mov_b32 v132, 0
    v_mov_b32 v133, 0
    v_mov_b32 v134, 0
    v_mov_b32 v135, 0
    v_mov_b32 v136, 0
    v_mov_b32 v137, 0
    v_mov_b32 v138, 0
    v_mov_b32 v139, 0
    v_mov_b32 v140, 0x3f803f80
    v_mov_b32 v141, 0x3f803f80
    v_mov_b32 v142, 0x3f803f80
    v_mov_b32 v143, 0x3f803f80
    s_barrier
    ds_read_b128 v[204:207], v158 offset:0
    ds_read_b128 v[208:211], v158 offset:2048
    ds_read_b128 v[212:215], v158 offset:4096
    ds_read_b128 v[216:219], v158 offset:6144
    ds_read_b64_tr_b16 v[164:165], v147 offset:0
    ds_read_b64_tr_b16 v[166:167], v147 offset:1280
    ds_read_b64_tr_b16 v[168:169], v147 offset:32
    ds_read_b64_tr_b16 v[170:171], v147 offset:1312
    ds_read_b64_tr_b16 v[172:173], v147 offset:64
    ds_read_b64_tr_b16 v[174:175], v147 offset:1344
    ds_read_b64_tr_b16 v[176:177], v147 offset:96
    ds_read_b64_tr_b16 v[178:179], v147 offset:1376
    ds_read_b64_tr_b16 v[180:181], v147 offset:128
    ds_read_b64_tr_b16 v[182:183], v147 offset:1408
    s_waitcnt lgkmcnt(0)
    ds_read_b128 v[220:223], v159 offset:0
    ds_read_b128 v[224:227], v159 offset:2048
    v_mfma_f32_16x16x32_bf16 v[8:11], v[164:167], v[204:207], v[8:11]
    ds_read_b128 v[228:231], v159 offset:4096
    ds_read_b128 v[232:235], v159 offset:6144
    v_mfma_f32_16x16x32_bf16 v[28:31], v[164:167], v[208:211], v[28:31]
    ds_read_b64_tr_b16 v[184:185], v147 offset:5120
    ds_read_b64_tr_b16 v[186:187], v147 offset:6400
    v_mfma_f32_16x16x32_bf16 v[48:51], v[164:167], v[212:215], v[48:51]
    ds_read_b64_tr_b16 v[188:189], v147 offset:5152
    ds_read_b64_tr_b16 v[190:191], v147 offset:6432
    v_mfma_f32_16x16x32_bf16 v[68:71], v[164:167], v[216:219], v[68:71]
    ds_read_b64_tr_b16 v[192:193], v147 offset:5184
    ds_read_b64_tr_b16 v[194:195], v147 offset:6464
    v_mfma_f32_16x16x32_bf16 v[12:15], v[168:171], v[204:207], v[12:15]
    ds_read_b64_tr_b16 v[196:197], v147 offset:5216
    ds_read_b64_tr_b16 v[198:199], v147 offset:6496
    v_mfma_f32_16x16x32_bf16 v[32:35], v[168:171], v[208:211], v[32:35]
    ds_read_b64_tr_b16 v[200:201], v147 offset:5248
    ds_read_b64_tr_b16 v[202:203], v147 offset:6528
    v_mfma_f32_16x16x32_bf16 v[52:55], v[168:171], v[212:215], v[52:55]
    v_mfma_f32_16x16x32_bf16 v[72:75], v[168:171], v[216:219], v[72:75]
    v_mfma_f32_16x16x32_bf16 v[16:19], v[172:175], v[204:207], v[16:19]
    v_mfma_f32_16x16x32_bf16 v[36:39], v[172:175], v[208:211], v[36:39]
    v_mfma_f32_16x16x32_bf16 v[56:59], v[172:175], v[212:215], v[56:59]
    v_mfma_f32_16x16x32_bf16 v[76:79], v[172:175], v[216:219], v[76:79]
    v_mfma_f32_16x16x32_bf16 v[20:23], v[176:179], v[204:207], v[20:23]
    v_mfma_f32_16x16x32_bf16 v[40:43], v[176:179], v[208:211], v[40:43]
    v_mfma_f32_16x16x32_bf16 v[60:63], v[176:179], v[212:215], v[60:63]
    v_mfma_f32_16x16x32_bf16 v[80:83], v[176:179], v[216:219], v[80:83]
    v_mfma_f32_16x16x32_bf16 v[24:27], v[180:183], v[204:207], v[24:27]
    v_mfma_f32_16x16x32_bf16 v[44:47], v[180:183], v[208:211], v[44:47]
    v_mfma_f32_16x16x32_bf16 v[64:67], v[180:183], v[212:215], v[64:67]
    v_mfma_f32_16x16x32_bf16 v[84:87], v[180:183], v[216:219], v[84:87]
    v_mfma_f32_16x16x32_bf16 v[88:91], v[164:167], v[140:143], v[88:91]
    v_mfma_f32_16x16x32_bf16 v[92:95], v[168:171], v[140:143], v[92:95]
    v_mfma_f32_16x16x32_bf16 v[96:99], v[172:175], v[140:143], v[96:99]
    v_mfma_f32_16x16x32_bf16 v[100:103], v[176:179], v[140:143], v[100:103]
    v_mfma_f32_16x16x32_bf16 v[104:107], v[180:183], v[140:143], v[104:107]
    v_mfma_f32_16x16x32_bf16 v[108:111], v[140:143], v[204:207], v[108:111]
    v_mfma_f32_16x16x32_bf16 v[124:127], v[204:207], v[204:207], v[124:127]
    v_mfma_f32_16x16x32_bf16 v[112:115], v[140:143], v[208:211], v[112:115]
    v_mfma_f32_16x16x32_bf16 v[128:131], v[208:211], v[208:211], v[128:131]
    v_mfma_f32_16x16x32_bf16 v[116:119], v[140:143], v[212:215], v[116:119]
    v_mfma_f32_16x16x32_bf16 v[132:135], v[212:215], v[212:215], v[132:135]
    v_mfma_f32_16x16x32_bf16 v[120:123], v[140:143], v[216:219], v[120:123]
    v_mfma_f32_16x16x32_bf16 v[136:139], v[216:219], v[216:219], v[136:139]
    s_waitcnt lgkmcnt(0)
    s_barrier
    ds_read_b128 v[204:207], v160 offset:0
    ds_read_b128 v[208:211], v160 offset:2048
    v_mfma_f32_16x16x32_bf16 v[8:11], v[184:187], v[220:223], v[8:11]
    ds_read_b128 v[212:215], v160 offset:4096
    ds_read_b128 v[216:219], v160 offset:6144
    v_mfma_f32_16x16x32_bf16 v[28:31], v[184:187], v[224:227], v[28:31]
    ds_read_b64_tr_b16 v[164:165], v148 offset:0
    ds_read_b64_tr_b16 v[166:167], v148 offset:1280
    v_mfma_f32_16x16x32_bf16 v[48:51], v[184:187], v[228:231], v[48:51]
    ds_read_b64_tr_b16 v[168:169], v148 offset:32
    ds_read_b64_tr_b16 v[170:171], v148 offset:1312
    v_mfma_f32_16x16x32_bf16 v[68:71], v[184:187], v[232:235], v[68:71]
    ds_read_b64_tr_b16 v[172:173], v148 offset:64
    ds_read_b64_tr_b16 v[174:175], v148 offset:1344
    v_mfma_f32_16x16x32_bf16 v[12:15], v[188:191], v[220:223], v[12:15]
    ds_read_b64_tr_b16 v[176:177], v148 offset:96
    ds_read_b64_tr_b16 v[178:179], v148 offset:1376
    v_mfma_f32_16x16x32_bf16 v[32:35], v[188:191], v[224:227], v[32:35]
    ds_read_b64_tr_b16 v[180:181], v148 offset:128
    ds_read_b64_tr_b16 v[182:183], v148 offset:1408
    v_mfma_f32_16x16x32_bf16 v[52:55], v[188:191], v[228:231], v[52:55]
    v_mfma_f32_16x16x32_bf16 v[72:75], v[188:191], v[232:235], v[72:75]
    v_mfma_f32_16x16x32_bf16 v[16:19], v[192:195], v[220:223], v[16:19]
    v_mfma_f32_16x16x32_bf16 v[36:39], v[192:195], v[224:227], v[36:39]
    v_mfma_f32_16x16x32_bf16 v[56:59], v[192:195], v[228:231], v[56:59]
    v_mfma_f32_16x16x32_bf16 v[76:79], v[192:195], v[232:235], v[76:79]
    v_mfma_f32_16x16x32_bf16 v[20:23], v[196:199], v[220:223], v[20:23]
    v_mfma_f32_16x16x32_bf16 v[40:43], v[196:199], v[224:227], v[40:43]
    v_mfma_f32_16x16x32_bf16 v[60:63], v[196:199], v[228:231], v[60:63]
    v_mfma_f32_16x16x32_bf16 v[80:83], v[196:199], v[232:235], v[80:83]
    v_mfma_f32_16x16x32_bf16 v[24:27], v[200:203], v[220:223], v[24:27]
    v_mfma_f32_16x16x32_bf16 v[44:47], v[200:203], v[224:227], v[44:47]
    v_mfma_f32_16x16x32_bf16 v[64:67], v[200:203], v[228:231], v[64:67]
    v_mfma_f32_16x16x32_bf16 v[84:87], v[200:203], v[232:235], v[84:87]
    v_mfma_f32_16x16x32_bf16 v[88:91], v[184:187], v[140:143], v[88:91]
    v_mfma_f32_16x16x32_bf16 v[92:95], v[188:191], v[140:143], v[92:95]
    v_mfma_f32_16x16x32_bf16 v[96:99], v[192:195], v[140:143], v[96:99]
    v_mfma_f32_16x16x32_bf16 v[100:103], v[196:199], v[140:143], v[100:103]
    v_mfma_f32_16x16x32_bf16 v[104:107], v[200:203], v[140:143], v[104:107]
    v_mfma_f32_16x16x32_bf16 v[108:111], v[140:143], v[220:223], v[108:111]
    v_mfma_f32_16x16x32_bf16 v[124:127], v[220:223], v[220:223], v[124:127]
    v_mfma_f32_16x16x32_bf16 v[112:115], v[140:143], v[224:227], v[112:115]
    v_mfma_f32_16x16x32_bf16 v[128:131], v[224:227], v[224:227], v[128:131]
    v_mfma_f32_16x16x32_bf16 v[116:119], v[140:143], v[228:231], v[116:119]
    v_mfma_f32_16x16x32_bf16 v[132:135], v[228:231], v[228:231], v[132:135]
    v_mfma_f32_16x16x32_bf16 v[120:123], v[140:143], v[232:235], v[120:123]
    v_mfma_f32_16x16x32_bf16 v[136:139], v[232:235], v[232:235], v[136:139]
    s_waitcnt lgkmcnt(0)
    ds_read_b128 v[220:223], v161 offset:0
    ds_read_b128 v[224:227], v161 offset:2048
    v_mfma_f32_16x16x32_bf16 v[8:11], v[164:167], v[204:207], v[8:11]
    ds_read_b128 v[228:231], v161 offset:4096
    ds_read_b128 v[232:235], v161 offset:6144
    v_mfma_f32_16x16x32_bf16 v[28:31], v[164:167], v[208:211], v[28:31]
    ds_read_b64_tr_b16 v[184:185], v148 offset:5120
    ds_read_b64_tr_b16 v[186:187], v148 offset:6400
    v_mfma_f32_16x16x32_bf16 v[48:51], v[164:167], v[212:215], v[48:51]
    ds_read_b64_tr_b16 v[188:189], v148 offset:5152
    ds_read_b64_tr_b16 v[190:191], v148 offset:6432
    v_mfma_f32_16x16x32_bf16 v[68:71], v[164:167], v[216:219], v[68:71]
    ds_read_b64_tr_b16 v[192:193], v148 offset:5184
    ds_read_b64_tr_b16 v[194:195], v148 offset:6464
    v_mfma_f32_16x16x32_bf16 v[12:15], v[168:171], v[204:207], v[12:15]
    ds_read_b64_tr_b16 v[196:197], v148 offset:5216
    ds_read_b64_tr_b16 v[198:199], v148 offset:6496
    v_mfma_f32_16x16x32_bf16 v[32:35], v[168:171], v[208:211], v[32:35]
    ds_read_b64_tr_b16 v[200:201], v148 offset:5248
    ds_read_b64_tr_b16 v[202:203], v148 offset:6528
    v_mfma_f32_16x16x32_bf16 v[52:55], v[168:171], v[212:215], v[52:55]
    v_mfma_f32_16x16x32_bf16 v[72:75], v[168:171], v[216:219], v[72:75]
    v_mfma_f32_16x16x32_bf16 v[16:19], v[172:175], v[204:207], v[16:19]
    v_mfma_f32_16x16x32_bf16 v[36:39], v[172:175], v[208:211], v[36:39]
    v_mfma_f32_16x16x32_bf16 v[56:59], v[172:175], v[212:215], v[56:59]
    v_mfma_f32_16x16x32_bf16 v[76:79], v[172:175], v[216:219], v[76:79]
    v_mfma_f32_16x16x32_bf16 v[20:23], v[176:179], v[204:207], v[20:23]
    v_mfma_f32_16x16x32_bf16 v[40:43], v[176:179], v[208:211], v[40:43]
    v_mfma_f32_16x16x32_bf16 v[60:63], v[176:179], v[212:215], v[60:63]
    v_mfma_f32_16x16x32_bf16 v[80:83], v[176:179], v[216:219], v[80:83]
    v_mfma_f32_16x16x32_bf16 v[24:27], v[180:183], v[204:207], v[24:27]
    v_mfma_f32_16x16x32_bf16 v[44:47], v[180:183], v[208:211], v[44:47]
    v_mfma_f32_16x16x32_bf16 v[64:67], v[180:183], v[212:215], v[64:67]
    v_mfma_f32_16x16x32_bf16 v[84:87], v[180:183], v[216:219], v[84:87]
    v_mfma_f32_16x16x32_bf16 v[88:91], v[164:167], v[140:143], v[88:91]
    v_mfma_f32_16x16x32_bf16 v[92:95], v[168:171], v[140:143], v[92:95]
    v_mfma_f32_16x16x32_bf16 v[96:99], v[172:175], v[140:143], v[96:99]
    v_mfma_f32_16x16x32_bf16 v[100:103], v[176:179], v[140:143], v[100:103]
    v_mfma_f32_16x16x32_bf16 v[104:107], v[180:183], v[140:143], v[104:107]
    v_mfma_f32_16x16x32_bf16 v[108:111], v[140:143], v[204:207], v[108:111]
    v_mfma_f32_16x16x32_bf16 v[124:127], v[204:207], v[204:207], v[124:127]
    v_mfma_f32_16x16x32_bf16 v[112:115], v[140:143], v[208:211], v[112:115]
    v_mfma_f32_16x16x32_bf16 v[128:131], v[208:211], v[208:211], v[128:131]
    v_mfma_f32_16x16x32_bf16 v[116:119], v[140:143], v[212:215], v[116:119]
    v_mfma_f32_16x16x32_bf16 v[132:135], v[212:215], v[212:215], v[132:135]
    v_mfma_f32_16x16x32_bf16 v[120:123], v[140:143], v[216:219], v[120:123]
    v_mfma_f32_16x16x32_bf16 v[136:139], v[216:219], v[216:219], v[136:139]
    s_waitcnt lgkmcnt(0)
    s_barrier
    ds_read_b128 v[204:207], v162 offset:0
    ds_read_b128 v[208:211], v162 offset:2048
    v_mfma_f32_16x16x32_bf16 v[8:11], v[184:187], v[220:223], v[8:11]
    ds_read_b128 v[212:215], v162 offset:4096
    ds_read_b128 v[216:219], v162 offset:6144
    v_mfma_f32_16x16x32_bf16 v[28:31], v[184:187], v[224:227], v[28:31]
    ds_read_b64_tr_b16 v[164:165], v149 offset:0
    ds_read_b64_tr_b16 v[166:167], v149 offset:1280
    v_mfma_f32_16x16x32_bf16 v[48:51], v[184:187], v[228:231], v[48:51]
    ds_read_b64_tr_b16 v[168:169], v149 offset:32
    ds_read_b64_tr_b16 v[170:171], v149 offset:1312
    v_mfma_f32_16x16x32_bf16 v[68:71], v[184:187], v[232:235], v[68:71]
    ds_read_b64_tr_b16 v[172:173], v149 offset:64
    ds_read_b64_tr_b16 v[174:175], v149 offset:1344
    v_mfma_f32_16x16x32_bf16 v[12:15], v[188:191], v[220:223], v[12:15]
    ds_read_b64_tr_b16 v[176:177], v149 offset:96
    ds_read_b64_tr_b16 v[178:179], v149 offset:1376
    v_mfma_f32_16x16x32_bf16 v[32:35], v[188:191], v[224:227], v[32:35]
    ds_read_b64_tr_b16 v[180:181], v149 offset:128
    ds_read_b64_tr_b16 v[182:183], v149 offset:1408
    v_mfma_f32_16x16x32_bf16 v[52:55], v[188:191], v[228:231], v[52:55]
    v_mfma_f32_16x16x32_bf16 v[72:75], v[188:191], v[232:235], v[72:75]
    v_mfma_f32_16x16x32_bf16 v[16:19], v[192:195], v[220:223], v[16:19]
    v_mfma_f32_16x16x32_bf16 v[36:39], v[192:195], v[224:227], v[36:39]
    v_mfma_f32_16x16x32_bf16 v[56:59], v[192:195], v[228:231], v[56:59]
    v_mfma_f32_16x16x32_bf16 v[76:79], v[192:195], v[232:235], v[76:79]
    v_mfma_f32_16x16x32_bf16 v[20:23], v[196:199], v[220:223], v[20:23]
    v_mfma_f32_16x16x32_bf16 v[40:43], v[196:199], v[224:227], v[40:43]
    v_mfma_f32_16x16x32_bf16 v[60:63], v[196:199], v[228:231], v[60:63]
    v_mfma_f32_16x16x32_bf16 v[80:83], v[196:199], v[232:235], v[80:83]
    v_mfma_f32_16x16x32_bf16 v[24:27], v[200:203], v[220:223], v[24:27]
    v_mfma_f32_16x16x32_bf16 v[44:47], v[200:203], v[224:227], v[44:47]
    v_mfma_f32_16x16x32_bf16 v[64:67], v[200:203], v[228:231], v[64:67]
    v_mfma_f32_16x16x32_bf16 v[84:87], v[200:203], v[232:235], v[84:87]
    v_mfma_f32_16x16x32_bf16 v[88:91], v[184:187], v[140:143], v[88:91]
    v_mfma_f32_16x16x32_bf16 v[92:95], v[188:191], v[140:143], v[92:95]
    v_mfma_f32_16x16x32_bf16 v[96:99], v[192:195], v[140:143], v[96:99]
    v_mfma_f32_16x16x32_bf16 v[100:103], v[196:199], v[140:143], v[100:103]
    v_mfma_f32_16x16x32_bf16 v[104:107], v[200:203], v[140:143], v[104:107]
    v_mfma_f32_16x16x32_bf16 v[108:111], v[140:143], v[220:223], v[108:111]
    v_mfma_f32_16x16x32_bf16 v[124:127], v[220:223], v[220:223], v[124:127]
    v_mfma_f32_16x16x32_bf16 v[112:115], v[140:143], v[224:227], v[112:115]
    v_mfma_f32_16x16x32_bf16 v[128:131], v[224:227], v[224:227], v[128:131]
    v_mfma_f32_16x16x32_bf16 v[116:119], v[140:143], v[228:231], v[116:119]
    v_mfma_f32_16x16x32_bf16 v[132:135], v[228:231], v[228:231], v[132:135]
    v_mfma_f32_16x16x32_bf16 v[120:123], v[140:143], v[232:235], v[120:123]
    v_mfma_f32_16x16x32_bf16 v[136:139], v[232:235], v[232:235], v[136:139]
    s_waitcnt lgkmcnt(0)
    ds_read_b128 v[220:223], v163 offset:0
    ds_read_b128 v[224:227], v163 offset:2048
    v_mfma_f32_16x16x32_bf16 v[8:11], v[164:167], v[204:207], v[8:11]
    ds_read_b128 v[228:231], v163 offset:4096
    ds_read_b128 v[232:235], v163 offset:6144
    v_mfma_f32_16x16x32_bf16 v[28:31], v[164:167], v[208:211], v[28:31]
    ds_read_b64_tr_b16 v[184:185], v149 offset:5120
    ds_read_b64_tr_b16 v[186:187], v149 offset:6400
    v_mfma_f32_16x16x32_bf16 v[48:51], v[164:167], v[212:215], v[48:51]
    ds_read_b64_tr_b16 v[188:189], v149 offset:5152
    ds_read_b64_tr_b16 v[190:191], v149 offset:6432
    v_mfma_f32_16x16x32_bf16 v[68:71], v[164:167], v[216:219], v[68:71]
    ds_read_b64_tr_b16 v[192:193], v149 offset:5184
    ds_read_b64_tr_b16 v[194:195], v149 offset:6464
    v_mfma_f32_16x16x32_bf16 v[12:15], v[168:171], v[204:207], v[12:15]
    ds_read_b64_tr_b16 v[196:197], v149 offset:5216
    ds_read_b64_tr_b16 v[198:199], v149 offset:6496
    v_mfma_f32_16x16x32_bf16 v[32:35], v[168:171], v[208:211], v[32:35]
    ds_read_b64_tr_b16 v[200:201], v149 offset:5248
    ds_read_b64_tr_b16 v[202:203], v149 offset:6528
    v_mfma_f32_16x16x32_bf16 v[52:55], v[168:171], v[212:215], v[52:55]
    v_mfma_f32_16x16x32_bf16 v[72:75], v[168:171], v[216:219], v[72:75]
    v_mfma_f32_16x16x32_bf16 v[16:19], v[172:175], v[204:207], v[16:19]
    v_mfma_f32_16x16x32_bf16 v[36:39], v[172:175], v[208:211], v[36:39]
    v_mfma_f32_16x16x32_bf16 v[56:59], v[172:175], v[212:215], v[56:59]
    v_mfma_f32_16x16x32_bf16 v[76:79], v[172:175], v[216:219], v[76:79]
    v_mfma_f32_16x16x32_bf16 v[20:23], v[176:179], v[204:207], v[20:23]
    v_mfma_f32_16x16x32_bf16 v[40:43], v[176:179], v[208:211], v[40:43]
    v_mfma_f32_16x16x32_bf16 v[60:63], v[176:179], v[212:215], v[60:63]
    v_mfma_f32_16x16x32_bf16 v[80:83], v[176:179], v[216:219], v[80:83]
    v_mfma_f32_16x16x32_bf16 v[24:27], v[180:183], v[204:207], v[24:27]
    v_mfma_f32_16x16x32_bf16 v[44:47], v[180:183], v[208:211], v[44:47]
    v_mfma_f32_16x16x32_bf16 v[64:67], v[180:183], v[212:215], v[64:67]
    v_mfma_f32_16x16x32_bf16 v[84:87], v[180:183], v[216:219], v[84:87]
    v_mfma_f32_16x16x32_bf16 v[88:91], v[164:167], v[140:143], v[88:91]
    v_mfma_f32_16x16x32_bf16 v[92:95], v[168:171], v[140:143], v[92:95]
    v_mfma_f32_16x16x32_bf16 v[96:99], v[172:175], v[140:143], v[96:99]
    v_mfma_f32_16x16x32_bf16 v[100:103], v[176:179], v[140:143], v[100:103]
    v_mfma_f32_16x16x32_bf16 v[104:107], v[180:183], v[140:143], v[104:107]
    v_mfma_f32_16x16x32_bf16 v[108:111], v[140:143], v[204:207], v[108:111]
    v_mfma_f32_16x16x32_bf16 v[124:127], v[204:207], v[204:207], v[124:127]
    v_mfma_f32_16x16x32_bf16 v[112:115], v[140:143], v[208:211], v[112:115]
    v_mfma_f32_16x16x32_bf16 v[128:131], v[208:211], v[208:211], v[128:131]
    v_mfma_f32_16x16x32_bf16 v[116:119], v[140:143], v[212:215], v[116:119]
    v_mfma_f32_16x16x32_bf16 v[132:135], v[212:215], v[212:215], v[132:135]
    v_mfma_f32_16x16x32_bf16 v[120:123], v[140:143], v[216:219], v[120:123]
    v_mfma_f32_16x16x32_bf16 v[136:139], v[216:219], v[216:219], v[136:139]
    s_waitcnt lgkmcnt(0)
    s_barrier
    ds_read_b128 v[204:207], v158 offset:0
    ds_read_b128 v[208:211], v158 offset:2048
    v_mfma_f32_16x16x32_bf16 v[8:11], v[184:187], v[220:223], v[8:11]
    ds_read_b128 v[212:215], v158 offset:4096
    ds_read_b128 v[216:219], v158 offset:6144
    v_mfma_f32_16x16x32_bf16 v[28:31], v[184:187], v[224:227], v[28:31]
    ds_read_b64_tr_b16 v[164:165], v147 offset:0
    ds_read_b64_tr_b16 v[166:167], v147 offset:1280
    v_mfma_f32_16x16x32_bf16 v[48:51], v[184:187], v[228:231], v[48:51]
    ds_read_b64_tr_b16 v[168:169], v147 offset:32
    ds_read_b64_tr_b16 v[170:171], v147 offset:1312
    v_mfma_f32_16x16x32_bf16 v[68:71], v[184:187], v[232:235], v[68:71]
    ds_read_b64_tr_b16 v[172:173], v147 offset:64
    ds_read_b64_tr_b16 v[174:175], v147 offset:1344
    v_mfma_f32_16x16x32_bf16 v[12:15], v[188:191], v[220:223], v[12:15]
    ds_read_b64_tr_b16 v[176:177], v147 offset:96
    ds_read_b64_tr_b16 v[178:179], v147 offset:1376
    v_mfma_f32_16x16x32_bf16 v[32:35], v[188:191], v[224:227], v[32:35]
    ds_read_b64_tr_b16 v[180:181], v147 offset:128
    ds_read_b64_tr_b16 v[182:183], v147 offset:1408
    v_mfma_f32_16x16x32_bf16 v[52:55], v[188:191], v[228:231], v[52:55]
    v_mfma_f32_16x16x32_bf16 v[72:75], v[188:191], v[232:235], v[72:75]
    v_mfma_f32_16x16x32_bf16 v[16:19], v[192:195], v[220:223], v[16:19]
    v_mfma_f32_16x16x32_bf16 v[36:39], v[192:195], v[224:227], v[36:39]
    v_mfma_f32_16x16x32_bf16 v[56:59], v[192:195], v[228:231], v[56:59]
    v_mfma_f32_16x16x32_bf16 v[76:79], v[192:195], v[232:235], v[76:79]
    v_mfma_f32_16x16x32_bf16 v[20:23], v[196:199], v[220:223], v[20:23]
    v_mfma_f32_16x16x32_bf16 v[40:43], v[196:199], v[224:227], v[40:43]
    v_mfma_f32_16x16x32_bf16 v[60:63], v[196:199], v[228:231], v[60:63]
    v_mfma_f32_16x16x32_bf16 v[80:83], v[196:199], v[232:235], v[80:83]
    v_mfma_f32_16x16x32_bf16 v[24:27], v[200:203], v[220:223], v[24:27]
    v_mfma_f32_16x16x32_bf16 v[44:47], v[200:203], v[224:227], v[44:47]
    v_mfma_f32_16x16x32_bf16 v[64:67], v[200:203], v[228:231], v[64:67]
    v_mfma_f32_16x16x32_bf16 v[84:87], v[200:203], v[232:235], v[84:87]
    v_mfma_f32_16x16x32_bf16 v[88:91], v[184:187], v[140:143], v[88:91]
    v_mfma_f32_16x16x32_bf16 v[92:95], v[188:191], v[140:143], v[92:95]
    v_mfma_f32_16x16x32_bf16 v[96:99], v[192:195], v[140:143], v[96:99]
    v_mfma_f32_16x16x32_bf16 v[100:103], v[196:199], v[140:143], v[100:103]
    v_mfma_f32_16x16x32_bf16 v[104:107], v[200:203], v[140:143], v[104:107]
    v_mfma_f32_16x16x32_bf16 v[108:111], v[140:143], v[220:223], v[108:111]
    v_mfma_f32_16x16x32_bf16 v[124:127], v[220:223], v[220:223], v[124:127]
    v_mfma_f32_16x16x32_bf16 v[112:115], v[140:143], v[224:227], v[112:115]
    v_mfma_f32_16x16x32_bf16 v[128:131], v[224:227], v[224:227], v[128:131]
    v_mfma_f32_16x16x32_bf16 v[116:119], v[140:143], v[228:231], v[116:119]
    v_mfma_f32_16x16x32_bf16 v[132:135], v[228:231], v[228:231], v[132:135]
    v_mfma_f32_16x16x32_bf16 v[120:123], v[140:143], v[232:235], v[120:123]
    v_mfma_f32_16x16x32_bf16 v[136:139], v[232:235], v[232:235], v[136:139]
    s_waitcnt lgkmcnt(0)
    ds_read_b128 v[220:223], v159 offset:0
    ds_read_b128 v[224:227], v159 offset:2048
    v_mfma_f32_16x16x32_bf16 v[8:11], v[164:167], v[204:207], v[8:11]
    ds_read_b128 v[228:231], v159 offset:4096
    ds_read_b128 v[232:235], v159 offset:6144
    v_mfma_f32_16x16x32_bf16 v[28:31], v[164:167], v[208:211], v[28:31]
    ds_read_b64_tr_b16 v[184:185], v147 offset:5120
    ds_read_b64_tr_b16 v[186:187], v147 offset:6400
    v_mfma_f32_16x16x32_bf16 v[48:51], v[164:167], v[212:215], v[48:51]
    ds_read_b64_tr_b16 v[188:189], v147 offset:5152
    ds_read_b64_tr_b16 v[190:191], v147 offset:6432
    v_mfma_f32_16x16x32_bf16 v[68:71], v[164:167], v[216:219], v[68:71]
    ds_read_b64_tr_b16 v[192:193], v147 offset:5184
    ds_read_b64_tr_b16 v[194:195], v147 offset:6464
    v_mfma_f32_16x16x32_bf16 v[12:15], v[168:171], v[204:207], v[12:15]
    ds_read_b64_tr_b16 v[196:197], v147 offset:5216
    ds_read_b64_tr_b16 v[198:199], v147 offset:6496
    v_mfma_f32_16x16x32_bf16 v[32:35], v[168:171], v[208:211], v[32:35]
    ds_read_b64_tr_b16 v[200:201], v147 offset:5248
    ds_read_b64_tr_b16 v[202:203], v147 offset:6528
    v_mfma_f32_16x16x32_bf16 v[52:55], v[168:171], v[212:215], v[52:55]
    v_mfma_f32_16x16x32_bf16 v[72:75], v[168:171], v[216:219], v[72:75]
    v_mfma_f32_16x16x32_bf16 v[16:19], v[172:175], v[204:207], v[16:19]
    v_mfma_f32_16x16x32_bf16 v[36:39], v[172:175], v[208:211], v[36:39]
    v_mfma_f32_16x16x32_bf16 v[56:59], v[172:175], v[212:215], v[56:59]
    v_mfma_f32_16x16x32_bf16 v[76:79], v[172:175], v[216:219], v[76:79]
    v_mfma_f32_16x16x32_bf16 v[20:23], v[176:179], v[204:207], v[20:23]
    v_mfma_f32_16x16x32_bf16 v[40:43], v[176:179], v[208:211], v[40:43]
    v_mfma_f32_16x16x32_bf16 v[60:63], v[176:179], v[212:215], v[60:63]
    v_mfma_f32_16x16x32_bf16 v[80:83], v[176:179], v[216:219], v[80:83]
    v_mfma_f32_16x16x32_bf16 v[24:27], v[180:183], v[204:207], v[24:27]
    v_mfma_f32_16x16x32_bf16 v[44:47], v[180:183], v[208:211], v[44:47]
    v_mfma_f32_16x16x32_bf16 v[64:67], v[180:183], v[212:215], v[64:67]
    v_mfma_f32_16x16x32_bf16 v[84:87], v[180:183], v[216:219], v[84:87]
    v_mfma_f32_16x16x32_bf16 v[88:91], v[164:167], v[140:143], v[88:91]
    v_mfma_f32_16x16x32_bf16 v[92:95], v[168:171], v[140:143], v[92:95]
    v_mfma_f32_16x16x32_bf16 v[96:99], v[172:175], v[140:143], v[96:99]
    v_mfma_f32_16x16x32_bf16 v[100:103], v[176:179], v[140:143], v[100:103]
    v_mfma_f32_16x16x32_bf16 v[104:107], v[180:183], v[140:143], v[104:107]
    v_mfma_f32_16x16x32_bf16 v[108:111], v[140:143], v[204:207], v[108:111]
    v_mfma_f32_16x16x32_bf16 v[124:127], v[204:207], v[204:207], v[124:127]
    v_mfma_f32_16x16x32_bf16 v[112:115], v[140:143], v[208:211], v[112:115]
    v_mfma_f32_16x16x32_bf16 v[128:131], v[208:211], v[208:211], v[128:131]
    v_mfma_f32_16x16x32_bf16 v[116:119], v[140:143], v[212:215], v[116:119]
    v_mfma_f32_16x16x32_bf16 v[132:135], v[212:215], v[212:215], v[132:135]
    v_mfma_f32_16x16x32_bf16 v[120:123], v[140:143], v[216:219], v[120:123]
    v_mfma_f32_16x16x32_bf16 v[136:139], v[216:219], v[216:219], v[136:139]
    s_waitcnt lgkmcnt(0)
    s_barrier
    ds_read_b128 v[204:207], v160 offset:0
    ds_read_b128 v[208:211], v160 offset:2048
    v_mfma_f32_16x16x32_bf16 v[8:11], v[184:187], v[220:223], v[8:11]
    ds_read_b128 v[212:215], v160 offset:4096
    ds_read_b128 v[216:219], v160 offset:6144
    v_mfma_f32_16x16x32_bf16 v[28:31], v[184:187], v[224:227], v[28:31]
    ds_read_b64_tr_b16 v[164:165], v148 offset:0
    ds_read_b64_tr_b16 v[166:167], v148 offset:1280
    v_mfma_f32_16x16x32_bf16 v[48:51], v[184:187], v[228:231], v[48:51]
    ds_read_b64_tr_b16 v[168:169], v148 offset:32
    ds_read_b64_tr_b16 v[170:171], v148 offset:1312
    v_mfma_f32_16x16x32_bf16 v[68:71], v[184:187], v[232:235], v[68:71]
    ds_read_b64_tr_b16 v[172:173], v148 offset:64
    ds_read_b64_tr_b16 v[174:175], v148 offset:1344
    v_mfma_f32_16x16x32_bf16 v[12:15], v[188:191], v[220:223], v[12:15]
    ds_read_b64_tr_b16 v[176:177], v148 offset:96
    ds_read_b64_tr_b16 v[178:179], v148 offset:1376
    v_mfma_f32_16x16x32_bf16 v[32:35], v[188:191], v[224:227], v[32:35]
    ds_read_b64_tr_b16 v[180:181], v148 offset:128
    ds_read_b64_tr_b16 v[182:183], v148 offset:1408
    v_mfma_f32_16x16x32_bf16 v[52:55], v[188:191], v[228:231], v[52:55]
    v_mfma_f32_16x16x32_bf16 v[72:75], v[188:191], v[232:235], v[72:75]
    v_mfma_f32_16x16x32_bf16 v[16:19], v[192:195], v[220:223], v[16:19]
    v_mfma_f32_16x16x32_bf16 v[36:39], v[192:195], v[224:227], v[36:39]
    v_mfma_f32_16x16x32_bf16 v[56:59], v[192:195], v[228:231], v[56:59]
    v_mfma_f32_16x16x32_bf16 v[76:79], v[192:195], v[232:235], v[76:79]
    v_mfma_f32_16x16x32_bf16 v[20:23], v[196:199], v[220:223], v[20:23]
    v_mfma_f32_16x16x32_bf16 v[40:43], v[196:199], v[224:227], v[40:43]
    v_mfma_f32_16x16x32_bf16 v[60:63], v[196:199], v[228:231], v[60:63]
    v_mfma_f32_16x16x32_bf16 v[80:83], v[196:199], v[232:235], v[80:83]
    v_mfma_f32_16x16x32_bf16 v[24:27], v[200:203], v[220:223], v[24:27]
    v_mfma_f32_16x16x32_bf16 v[44:47], v[200:203], v[224:227], v[44:47]
    v_mfma_f32_16x16x32_bf16 v[64:67], v[200:203], v[228:231], v[64:67]
    v_mfma_f32_16x16x32_bf16 v[84:87], v[200:203], v[232:235], v[84:87]
    v_mfma_f32_16x16x32_bf16 v[88:91], v[184:187], v[140:143], v[88:91]
    v_mfma_f32_16x16x32_bf16 v[92:95], v[188:191], v[140:143], v[92:95]
    v_mfma_f32_16x16x32_bf16 v[96:99], v[192:195], v[140:143], v[96:99]
    v_mfma_f32_16x16x32_bf16 v[100:103], v[196:199], v[140:143], v[100:103]
    v_mfma_f32_16x16x32_bf16 v[104:107], v[200:203], v[140:143], v[104:107]
    v_mfma_f32_16x16x32_bf16 v[108:111], v[140:143], v[220:223], v[108:111]
    v_mfma_f32_16x16x32_bf16 v[124:127], v[220:223], v[220:223], v[124:127]
    v_mfma_f32_16x16x32_bf16 v[112:115], v[140:143], v[224:227], v[112:115]
    v_mfma_f32_16x16x32_bf16 v[128:131], v[224:227], v[224:227], v[128:131]
    v_mfma_f32_16x16x32_bf16 v[116:119], v[140:143], v[228:231], v[116:119]
    v_mfma_f32_16x16x32_bf16 v[132:135], v[228:231], v[228:231], v[132:135]
    v_mfma_f32_16x16x32_bf16 v[120:123], v[140:143], v[232:235], v[120:123]
    v_mfma_f32_16x16x32_bf16 v[136:139], v[232:235], v[232:235], v[136:139]
    s_waitcnt lgkmcnt(0)
    ds_read_b128 v[220:223], v161 offset:0
    ds_read_b128 v[224:227], v161 offset:2048
    v_mfma_f32_16x16x32_bf16 v[8:11], v[164:167], v[204:207], v[8:11]
    ds_read_b128 v[228:231], v161 offset:4096
    ds_read_b128 v[232:235], v161 offset:6144
    v_mfma_f32_16x16x32_bf16 v[28:31], v[164:167], v[208:211], v[28:31]
    ds_read_b64_tr_b16 v[184:185], v148 offset:5120
    ds_read_b64_tr_b16 v[186:187], v148 offset:6400
    v_mfma_f32_16x16x32_bf16 v[48:51], v[164:167], v[212:215], v[48:51]
    ds_read_b64_tr_b16 v[188:189], v148 offset:5152
    ds_read_b64_tr_b16 v[190:191], v148 offset:6432
    v_mfma_f32_16x16x32_bf16 v[68:71], v[164:167], v[216:219], v[68:71]
    ds_read_b64_tr_b16 v[192:193], v148 offset:5184
    ds_read_b64_tr_b16 v[194:195], v148 offset:6464
    v_mfma_f32_16x16x32_bf16 v[12:15], v[168:171], v[204:207], v[12:15]
    ds_read_b64_tr_b16 v[196:197], v148 offset:5216
    ds_read_b64_tr_b16 v[198:199], v148 offset:6496
    v_mfma_f32_16x16x32_bf16 v[32:35], v[168:171], v[208:211], v[32:35]
    ds_read_b64_tr_b16 v[200:201], v148 offset:5248
    ds_read_b64_tr_b16 v[202:203], v148 offset:6528
    v_mfma_f32_16x16x32_bf16 v[52:55], v[168:171], v[212:215], v[52:55]
    v_mfma_f32_16x16x32_bf16 v[72:75], v[168:171], v[216:219], v[72:75]
    v_mfma_f32_16x16x32_bf16 v[16:19], v[172:175], v[204:207], v[16:19]
    v_mfma_f32_16x16x32_bf16 v[36:39], v[172:175], v[208:211], v[36:39]
    v_mfma_f32_16x16x32_bf16 v[56:59], v[172:175], v[212:215], v[56:59]
    v_mfma_f32_16x16x32_bf16 v[76:79], v[172:175], v[216:219], v[76:79]
    v_mfma_f32_16x16x32_bf16 v[20:23], v[176:179], v[204:207], v[20:23]
    v_mfma_f32_16x16x32_bf16 v[40:43], v[176:179], v[208:211], v[40:43]
    v_mfma_f32_16x16x32_bf16 v[60:63], v[176:179], v[212:215], v[60:63]
    v_mfma_f32_16x16x32_bf16 v[80:83], v[176:179], v[216:219], v[80:83]
    v_mfma_f32_16x16x32_bf16 v[24:27], v[180:183], v[204:207], v[24:27]
    v_mfma_f32_16x16x32_bf16 v[44:47], v[180:183], v[208:211], v[44:47]
    v_mfma_f32_16x16x32_bf16 v[64:67], v[180:183], v[212:215], v[64:67]
    v_mfma_f32_16x16x32_bf16 v[84:87], v[180:183], v[216:219], v[84:87]
    v_mfma_f32_16x16x32_bf16 v[88:91], v[164:167], v[140:143], v[88:91]
    v_mfma_f32_16x16x32_bf16 v[92:95], v[168:171], v[140:143], v[92:95]
    v_mfma_f32_16x16x32_bf16 v[96:99], v[172:175], v[140:143], v[96:99]
    v_mfma_f32_16x16x32_bf16 v[100:103], v[176:179], v[140:143], v[100:103]
    v_mfma_f32_16x16x32_bf16 v[104:107], v[180:183], v[140:143], v[104:107]
    v_mfma_f32_16x16x32_bf16 v[108:111], v[140:143], v[204:207], v[108:111]
    v_mfma_f32_16x16x32_bf16 v[124:127], v[204:207], v[204:207], v[124:127]
    v_mfma_f32_16x16x32_bf16 v[112:115], v[140:143], v[208:211], v[112:115]
    v_mfma_f32_16x16x32_bf16 v[128:131], v[208:211], v[208:211], v[128:131]
    v_mfma_f32_16x16x32_bf16 v[116:119], v[140:143], v[212:215], v[116:119]
    v_mfma_f32_16x16x32_bf16 v[132:135], v[212:215], v[212:215], v[132:135]
    v_mfma_f32_16x16x32_bf16 v[120:123], v[140:143], v[216:219], v[120:123]
    v_mfma_f32_16x16x32_bf16 v[136:139], v[216:219], v[216:219], v[136:139]
    s_waitcnt lgkmcnt(0)
    s_barrier
    ds_read_b128 v[204:207], v162 offset:0
    ds_read_b128 v[208:211], v162 offset:2048
    v_mfma_f32_16x16x32_bf16 v[8:11], v[184:187], v[220:223], v[8:11]
    ds_read_b128 v[212:215], v162 offset:4096
    ds_read_b128 v[216:219], v162 offset:6144
    v_mfma_f32_16x16x32_bf16 v[28:31], v[184:187], v[224:227], v[28:31]
    ds_read_b64_tr_b16 v[164:165], v149 offset:0
    ds_read_b64_tr_b16 v[166:167], v149 offset:1280
    v_mfma_f32_16x16x32_bf16 v[48:51], v[184:187], v[228:231], v[48:51]
    ds_read_b64_tr_b16 v[168:169], v149 offset:32
    ds_read_b64_tr_b16 v[170:171], v149 offset:1312
    v_mfma_f32_16x16x32_bf16 v[68:71], v[184:187], v[232:235], v[68:71]
    ds_read_b64_tr_b16 v[172:173], v149 offset:64
    ds_read_b64_tr_b16 v[174:175], v149 offset:1344
    v_mfma_f32_16x16x32_bf16 v[12:15], v[188:191], v[220:223], v[12:15]
    ds_read_b64_tr_b16 v[176:177], v149 offset:96
    ds_read_b64_tr_b16 v[178:179], v149 offset:1376
    v_mfma_f32_16x16x32_bf16 v[32:35], v[188:191], v[224:227], v[32:35]
    ds_read_b64_tr_b16 v[180:181], v149 offset:128
    ds_read_b64_tr_b16 v[182:183], v149 offset:1408
    v_mfma_f32_16x16x32_bf16 v[52:55], v[188:191], v[228:231], v[52:55]
    v_mfma_f32_16x16x32_bf16 v[72:75], v[188:191], v[232:235], v[72:75]
    v_mfma_f32_16x16x32_bf16 v[16:19], v[192:195], v[220:223], v[16:19]
    v_mfma_f32_16x16x32_bf16 v[36:39], v[192:195], v[224:227], v[36:39]
    v_mfma_f32_16x16x32_bf16 v[56:59], v[192:195], v[228:231], v[56:59]
    v_mfma_f32_16x16x32_bf16 v[76:79], v[192:195], v[232:235], v[76:79]
    v_mfma_f32_16x16x32_bf16 v[20:23], v[196:199], v[220:223], v[20:23]
    v_mfma_f32_16x16x32_bf16 v[40:43], v[196:199], v[224:227], v[40:43]
    v_mfma_f32_16x16x32_bf16 v[60:63], v[196:199], v[228:231], v[60:63]
    v_mfma_f32_16x16x32_bf16 v[80:83], v[196:199], v[232:235], v[80:83]
    v_mfma_f32_16x16x32_bf16 v[24:27], v[200:203], v[220:223], v[24:27]
    v_mfma_f32_16x16x32_bf16 v[44:47], v[200:203], v[224:227], v[44:47]
    v_mfma_f32_16x16x32_bf16 v[64:67], v[200:203], v[228:231], v[64:67]
    v_mfma_f32_16x16x32_bf16 v[84:87], v[200:203], v[232:235], v[84:87]
    v_mfma_f32_16x16x32_bf16 v[88:91], v[184:187], v[140:143], v[88:91]
    v_mfma_f32_16x16x32_bf16 v[92:95], v[188:191], v[140:143], v[92:95]
    v_mfma_f32_16x16x32_bf16 v[96:99], v[192:195], v[140:143], v[96:99]
    v_mfma_f32_16x16x32_bf16 v[100:103], v[196:199], v[140:143], v[100:103]
    v_mfma_f32_16x16x32_bf16 v[104:107], v[200:203], v[140:143], v[104:107]
    v_mfma_f32_16x16x32_bf16 v[108:111], v[140:143], v[220:223], v[108:111]
    v_mfma_f32_16x16x32_bf16 v[124:127], v[220:223], v[220:223], v[124:127]
    v_mfma_f32_16x16x32_bf16 v[112:115], v[140:143], v[224:227], v[112:115]
    v_mfma_f32_16x16x32_bf16 v[128:131], v[224:227], v[224:227], v[128:131]
    v_mfma_f32_16x16x32_bf16 v[116:119], v[140:143], v[228:231], v[116:119]
    v_mfma_f32_16x16x32_bf16 v[132:135], v[228:231], v[228:231], v[132:135]
    v_mfma_f32_16x16x32_bf16 v[120:123], v[140:143], v[232:235], v[120:123]
    v_mfma_f32_16x16x32_bf16 v[136:139], v[232:235], v[232:235], v[136:139]
    s_waitcnt lgkmcnt(0)
    ds_read_b128 v[220:223], v163 offset:0
    ds_read_b128 v[224:227], v163 offset:2048
    v_mfma_f32_16x16x32_bf16 v[8:11], v[164:167], v[204:207], v[8:11]
    ds_read_b128 v[228:231], v163 offset:4096
    ds_read_b128 v[232:235], v163 offset:6144
    v_mfma_f32_16x16x32_bf16 v[28:31], v[164:167], v[208:211], v[28:31]
    ds_read_b64_tr_b16 v[184:185], v149 offset:5120
    ds_read_b64_tr_b16 v[186:187], v149 offset:6400
    v_mfma_f32_16x16x32_bf16 v[48:51], v[164:167], v[212:215], v[48:51]
    ds_read_b64_tr_b16 v[188:189], v149 offset:5152
    ds_read_b64_tr_b16 v[190:191], v149 offset:6432
    v_mfma_f32_16x16x32_bf16 v[68:71], v[164:167], v[216:219], v[68:71]
    ds_read_b64_tr_b16 v[192:193], v149 offset:5184
    ds_read_b64_tr_b16 v[194:195], v149 offset:6464
    v_mfma_f32_16x16x32_bf16 v[12:15], v[168:171], v[204:207], v[12:15]
    ds_read_b64_tr_b16 v[196:197], v149 offset:5216
    ds_read_b64_tr_b16 v[198:199], v149 offset:6496
    v_mfma_f32_16x16x32_bf16 v[32:35], v[168:171], v[208:211], v[32:35]
    ds_read_b64_tr_b16 v[200:201], v149 offset:5248
    ds_read_b64_tr_b16 v[202:203], v149 offset:6528
    v_mfma_f32_16x16x32_bf16 v[52:55], v[168:171], v[212:215], v[52:55]
    v_mfma_f32_16x16x32_bf16 v[72:75], v[168:171], v[216:219], v[72:75]
    v_mfma_f32_16x16x32_bf16 v[16:19], v[172:175], v[204:207], v[16:19]
    v_mfma_f32_16x16x32_bf16 v[36:39], v[172:175], v[208:211], v[36:39]
    v_mfma_f32_16x16x32_bf16 v[56:59], v[172:175], v[212:215], v[56:59]
    v_mfma_f32_16x16x32_bf16 v[76:79], v[172:175], v[216:219], v[76:79]
    v_mfma_f32_16x16x32_bf16 v[20:23], v[176:179], v[204:207], v[20:23]
    v_mfma_f32_16x16x32_bf16 v[40:43], v[176:179], v[208:211], v[40:43]
    v_mfma_f32_16x16x32_bf16 v[60:63], v[176:179], v[212:215], v[60:63]
    v_mfma_f32_16x16x32_bf16 v[80:83], v[176:179], v[216:219], v[80:83]
    v_mfma_f32_16x16x32_bf16 v[24:27], v[180:183], v[204:207], v[24:27]
    v_mfma_f32_16x16x32_bf16 v[44:47], v[180:183], v[208:211], v[44:47]
    v_mfma_f32_16x16x32_bf16 v[64:67], v[180:183], v[212:215], v[64:67]
    v_mfma_f32_16x16x32_bf16 v[84:87], v[180:183], v[216:219], v[84:87]
    v_mfma_f32_16x16x32_bf16 v[88:91], v[164:167], v[140:143], v[88:91]
    v_mfma_f32_16x16x32_bf16 v[92:95], v[168:171], v[140:143], v[92:95]
    v_mfma_f32_16x16x32_bf16 v[96:99], v[172:175], v[140:143], v[96:99]
    v_mfma_f32_16x16x32_bf16 v[100:103], v[176:179], v[140:143], v[100:103]
    v_mfma_f32_16x16x32_bf16 v[104:107], v[180:183], v[140:143], v[104:107]
    v_mfma_f32_16x16x32_bf16 v[108:111], v[140:143], v[204:207], v[108:111]
    v_mfma_f32_16x16x32_bf16 v[124:127], v[204:207], v[204:207], v[124:127]
    v_mfma_f32_16x16x32_bf16 v[112:115], v[140:143], v[208:211], v[112:115]
    v_mfma_f32_16x16x32_bf16 v[128:131], v[208:211], v[208:211], v[128:131]
    v_mfma_f32_16x16x32_bf16 v[116:119], v[140:143], v[212:215], v[116:119]
    v_mfma_f32_16x16x32_bf16 v[132:135], v[212:215], v[212:215], v[132:135]
    v_mfma_f32_16x16x32_bf16 v[120:123], v[140:143], v[216:219], v[120:123]
    v_mfma_f32_16x16x32_bf16 v[136:139], v[216:219], v[216:219], v[136:139]
    s_waitcnt lgkmcnt(0)
    s_barrier
    ds_read_b128 v[204:207], v158 offset:0
    ds_read_b128 v[208:211], v158 offset:2048
    v_mfma_f32_16x16x32_bf16 v[8:11], v[184:187], v[220:223], v[8:11]
    ds_read_b128 v[212:215], v158 offset:4096
    ds_read_b128 v[216:219], v158 offset:6144
    v_mfma_f32_16x16x32_bf16 v[28:31], v[184:187], v[224:227], v[28:31]
    ds_read_b64_tr_b16 v[164:165], v147 offset:0
    ds_read_b64_tr_b16 v[166:167], v147 offset:1280
    v_mfma_f32_16x16x32_bf16 v[48:51], v[184:187], v[228:231], v[48:51]
    ds_read_b64_tr_b16 v[168:169], v147 offset:32
    ds_read_b64_tr_b16 v[170:171], v147 offset:1312
    v_mfma_f32_16x16x32_bf16 v[68:71], v[184:187], v[232:235], v[68:71]
    ds_read_b64_tr_b16 v[172:173], v147 offset:64
    ds_read_b64_tr_b16 v[174:175], v147 offset:1344
    v_mfma_f32_16x16x32_bf16 v[12:15], v[188:191], v[220:223], v[12:15]
    ds_read_b64_tr_b16 v[176:177], v147 offset:96
    ds_read_b64_tr_b16 v[178:179], v147 offset:1376
    v_mfma_f32_16x16x32_bf16 v[32:35], v[188:191], v[224:227], v[32:35]
    ds_read_b64_tr_b16 v[180:181], v147 offset:128
    ds_read_b64_tr_b16 v[182:183], v147 offset:1408
    v_mfma_f32_16x16x32_bf16 v[52:55], v[188:191], v[228:231], v[52:55]
    v_mfma_f32_16x16x32_bf16 v[72:75], v[188:191], v[232:235], v[72:75]
    v_mfma_f32_16x16x32_bf16 v[16:19], v[192:195], v[220:223], v[16:19]
    v_mfma_f32_16x16x32_bf16 v[36:39], v[192:195], v[224:227], v[36:39]
    v_mfma_f32_16x16x32_bf16 v[56:59], v[192:195], v[228:231], v[56:59]
    v_mfma_f32_16x16x32_bf16 v[76:79], v[192:195], v[232:235], v[76:79]
    v_mfma_f32_16x16x32_bf16 v[20:23], v[196:199], v[220:223], v[20:23]
    v_mfma_f32_16x16x32_bf16 v[40:43], v[196:199], v[224:227], v[40:43]
    v_mfma_f32_16x16x32_bf16 v[60:63], v[196:199], v[228:231], v[60:63]
    v_mfma_f32_16x16x32_bf16 v[80:83], v[196:199], v[232:235], v[80:83]
    v_mfma_f32_16x16x32_bf16 v[24:27], v[200:203], v[220:223], v[24:27]
    v_mfma_f32_16x16x32_bf16 v[44:47], v[200:203], v[224:227], v[44:47]
    v_mfma_f32_16x16x32_bf16 v[64:67], v[200:203], v[228:231], v[64:67]
    v_mfma_f32_16x16x32_bf16 v[84:87], v[200:203], v[232:235], v[84:87]
    v_mfma_f32_16x16x32_bf16 v[88:91], v[184:187], v[140:143], v[88:91]
    v_mfma_f32_16x16x32_bf16 v[92:95], v[188:191], v[140:143], v[92:95]
    v_mfma_f32_16x16x32_bf16 v[96:99], v[192:195], v[140:143], v[96:99]
    v_mfma_f32_16x16x32_bf16 v[100:103], v[196:199], v[140:143], v[100:103]
    v_mfma_f32_16x16x32_bf16 v[104:107], v[200:203], v[140:143], v[104:107]
    v_mfma_f32_16x16x32_bf16 v[108:111], v[140:143], v[220:223], v[108:111]
    v_mfma_f32_16x16x32_bf16 v[124:127], v[220:223], v[220:223], v[124:127]
    v_mfma_f32_16x16x32_bf16 v[112:115], v[140:143], v[224:227], v[112:115]
    v_mfma_f32_16x16x32_bf16 v[128:131], v[224:227], v[224:227], v[128:131]
    v_mfma_f32_16x16x32_bf16 v[116:119], v[140:143], v[228:231], v[116:119]
    v_mfma_f32_16x16x32_bf16 v[132:135], v[228:231], v[228:231], v[132:135]
    v_mfma_f32_16x16x32_bf16 v[120:123], v[140:143], v[232:235], v[120:123]
    v_mfma_f32_16x16x32_bf16 v[136:139], v[232:235], v[232:235], v[136:139]
    s_waitcnt lgkmcnt(0)
    ds_read_b128 v[220:223], v159 offset:0
    ds_read_b128 v[224:227], v159 offset:2048
    v_mfma_f32_16x16x32_bf16 v[8:11], v[164:167], v[204:207], v[8:11]
    ds_read_b128 v[228:231], v159 offset:4096
    ds_read_b128 v[232:235], v159 offset:6144
    v_mfma_f32_16x16x32_bf16 v[28:31], v[164:167], v[208:211], v[28:31]
    ds_read_b64_tr_b16 v[184:185], v147 offset:5120
    ds_read_b64_tr_b16 v[186:187], v147 offset:6400
    v_mfma_f32_16x16x32_bf16 v[48:51], v[164:167], v[212:215], v[48:51]
    ds_read_b64_tr_b16 v[188:189], v147 offset:5152
    ds_read_b64_tr_b16 v[190:191], v147 offset:6432
    v_mfma_f32_16x16x32_bf16 v[68:71], v[164:167], v[216:219], v[68:71]
    ds_read_b64_tr_b16 v[192:193], v147 offset:5184
    ds_read_b64_tr_b16 v[194:195], v147 offset:6464
    v_mfma_f32_16x16x32_bf16 v[12:15], v[168:171], v[204:207], v[12:15]
    ds_read_b64_tr_b16 v[196:197], v147 offset:5216
    ds_read_b64_tr_b16 v[198:199], v147 offset:6496
    v_mfma_f32_16x16x32_bf16 v[32:35], v[168:171], v[208:211], v[32:35]
    ds_read_b64_tr_b16 v[200:201], v147 offset:5248
    ds_read_b64_tr_b16 v[202:203], v147 offset:6528
    v_mfma_f32_16x16x32_bf16 v[52:55], v[168:171], v[212:215], v[52:55]
    v_mfma_f32_16x16x32_bf16 v[72:75], v[168:171], v[216:219], v[72:75]
    v_mfma_f32_16x16x32_bf16 v[16:19], v[172:175], v[204:207], v[16:19]
    v_mfma_f32_16x16x32_bf16 v[36:39], v[172:175], v[208:211], v[36:39]
    v_mfma_f32_16x16x32_bf16 v[56:59], v[172:175], v[212:215], v[56:59]
    v_mfma_f32_16x16x32_bf16 v[76:79], v[172:175], v[216:219], v[76:79]
    v_mfma_f32_16x16x32_bf16 v[20:23], v[176:179], v[204:207], v[20:23]
    v_mfma_f32_16x16x32_bf16 v[40:43], v[176:179], v[208:211], v[40:43]
    v_mfma_f32_16x16x32_bf16 v[60:63], v[176:179], v[212:215], v[60:63]
    v_mfma_f32_16x16x32_bf16 v[80:83], v[176:179], v[216:219], v[80:83]
    v_mfma_f32_16x16x32_bf16 v[24:27], v[180:183], v[204:207], v[24:27]
    v_mfma_f32_16x16x32_bf16 v[44:47], v[180:183], v[208:211], v[44:47]
    v_mfma_f32_16x16x32_bf16 v[64:67], v[180:183], v[212:215], v[64:67]
    v_mfma_f32_16x16x32_bf16 v[84:87], v[180:183], v[216:219], v[84:87]
    v_mfma_f32_16x16x32_bf16 v[88:91], v[164:167], v[140:143], v[88:91]
    v_mfma_f32_16x16x32_bf16 v[92:95], v[168:171], v[140:143], v[92:95]
    v_mfma_f32_16x16x32_bf16 v[96:99], v[172:175], v[140:143], v[96:99]
    v_mfma_f32_16x16x32_bf16 v[100:103], v[176:179], v[140:143], v[100:103]
    v_mfma_f32_16x16x32_bf16 v[104:107], v[180:183], v[140:143], v[104:107]
    v_mfma_f32_16x16x32_bf16 v[108:111], v[140:143], v[204:207], v[108:111]
    v_mfma_f32_16x16x32_bf16 v[124:127], v[204:207], v[204:207], v[124:127]
    v_mfma_f32_16x16x32_bf16 v[112:115], v[140:143], v[208:211], v[112:115]
    v_mfma_f32_16x16x32_bf16 v[128:131], v[208:211], v[208:211], v[128:131]
    v_mfma_f32_16x16x32_bf16 v[116:119], v[140:143], v[212:215], v[116:119]
    v_mfma_f32_16x16x32_bf16 v[132:135], v[212:215], v[212:215], v[132:135]
    v_mfma_f32_16x16x32_bf16 v[120:123], v[140:143], v[216:219], v[120:123]
    v_mfma_f32_16x16x32_bf16 v[136:139], v[216:219], v[216:219], v[136:139]
    s_waitcnt lgkmcnt(0)
    s_barrier
    ds_read_b128 v[204:207], v160 offset:0
    ds_read_b128 v[208:211], v160 offset:2048
    v_mfma_f32_16x16x32_bf16 v[8:11], v[184:187], v[220:223], v[8:11]
    ds_read_b128 v[212:215], v160 offset:4096
    ds_read_b128 v[216:219], v160 offset:6144
    v_mfma_f32_16x16x32_bf16 v[28:31], v[184:187], v[224:227], v[28:31]
    ds_read_b64_tr_b16 v[164:165], v148 offset:0
    ds_read_b64_tr_b16 v[166:167], v148 offset:1280
    v_mfma_f32_16x16x32_bf16 v[48:51], v[184:187], v[228:231], v[48:51]
    ds_read_b64_tr_b16 v[168:169], v148 offset:32
    ds_read_b64_tr_b16 v[170:171], v148 offset:1312
    v_mfma_f32_16x16x32_bf16 v[68:71], v[184:187], v[232:235], v[68:71]
    ds_read_b64_tr_b16 v[172:173], v148 offset:64
    ds_read_b64_tr_b16 v[174:175], v148 offset:1344
    v_mfma_f32_16x16x32_bf16 v[12:15], v[188:191], v[220:223], v[12:15]
    ds_read_b64_tr_b16 v[176:177], v148 offset:96
    ds_read_b64_tr_b16 v[178:179], v148 offset:1376
    v_mfma_f32_16x16x32_bf16 v[32:35], v[188:191], v[224:227], v[32:35]
    ds_read_b64_tr_b16 v[180:181], v148 offset:128
    ds_read_b64_tr_b16 v[182:183], v148 offset:1408
    v_mfma_f32_16x16x32_bf16 v[52:55], v[188:191], v[228:231], v[52:55]
    v_mfma_f32_16x16x32_bf16 v[72:75], v[188:191], v[232:235], v[72:75]
    v_mfma_f32_16x16x32_bf16 v[16:19], v[192:195], v[220:223], v[16:19]
    v_mfma_f32_16x16x32_bf16 v[36:39], v[192:195], v[224:227], v[36:39]
    v_mfma_f32_16x16x32_bf16 v[56:59], v[192:195], v[228:231], v[56:59]
    v_mfma_f32_16x16x32_bf16 v[76:79], v[192:195], v[232:235], v[76:79]
    v_mfma_f32_16x16x32_bf16 v[20:23], v[196:199], v[220:223], v[20:23]
    v_mfma_f32_16x16x32_bf16 v[40:43], v[196:199], v[224:227], v[40:43]
    v_mfma_f32_16x16x32_bf16 v[60:63], v[196:199], v[228:231], v[60:63]
    v_mfma_f32_16x16x32_bf16 v[80:83], v[196:199], v[232:235], v[80:83]
    v_mfma_f32_16x16x32_bf16 v[24:27], v[200:203], v[220:223], v[24:27]
    v_mfma_f32_16x16x32_bf16 v[44:47], v[200:203], v[224:227], v[44:47]
    v_mfma_f32_16x16x32_bf16 v[64:67], v[200:203], v[228:231], v[64:67]
    v_mfma_f32_16x16x32_bf16 v[84:87], v[200:203], v[232:235], v[84:87]
    v_mfma_f32_16x16x32_bf16 v[88:91], v[184:187], v[140:143], v[88:91]
    v_mfma_f32_16x16x32_bf16 v[92:95], v[188:191], v[140:143], v[92:95]
    v_mfma_f32_16x16x32_bf16 v[96:99], v[192:195], v[140:143], v[96:99]
    v_mfma_f32_16x16x32_bf16 v[100:103], v[196:199], v[140:143], v[100:103]
    v_mfma_f32_16x16x32_bf16 v[104:107], v[200:203], v[140:143], v[104:107]
    v_mfma_f32_16x16x32_bf16 v[108:111], v[140:143], v[220:223], v[108:111]
    v_mfma_f32_16x16x32_bf16 v[124:127], v[220:223], v[220:223], v[124:127]
    v_mfma_f32_16x16x32_bf16 v[112:115], v[140:143], v[224:227], v[112:115]
    v_mfma_f32_16x16x32_bf16 v[128:131], v[224:227], v[224:227], v[128:131]
    v_mfma_f32_16x16x32_bf16 v[116:119], v[140:143], v[228:231], v[116:119]
    v_mfma_f32_16x16x32_bf16 v[132:135], v[228:231], v[228:231], v[132:135]
    v_mfma_f32_16x16x32_bf16 v[120:123], v[140:143], v[232:235], v[120:123]
    v_mfma_f32_16x16x32_bf16 v[136:139], v[232:235], v[232:235], v[136:139]
    s_waitcnt lgkmcnt(0)
    ds_read_b128 v[220:223], v161 offset:0
    ds_read_b128 v[224:227], v161 offset:2048
    v_mfma_f32_16x16x32_bf16 v[8:11], v[164:167], v[204:207], v[8:11]
    ds_read_b128 v[228:231], v161 offset:4096
    ds_read_b128 v[232:235], v161 offset:6144
    v_mfma_f32_16x16x32_bf16 v[28:31], v[164:167], v[208:211], v[28:31]
    ds_read_b64_tr_b16 v[184:185], v148 offset:5120
    ds_read_b64_tr_b16 v[186:187], v148 offset:6400
    v_mfma_f32_16x16x32_bf16 v[48:51], v[164:167], v[212:215], v[48:51]
    ds_read_b64_tr_b16 v[188:189], v148 offset:5152
    ds_read_b64_tr_b16 v[190:191], v148 offset:6432
    v_mfma_f32_16x16x32_bf16 v[68:71], v[164:167], v[216:219], v[68:71]
    ds_read_b64_tr_b16 v[192:193], v148 offset:5184
    ds_read_b64_tr_b16 v[194:195], v148 offset:6464
    v_mfma_f32_16x16x32_bf16 v[12:15], v[168:171], v[204:207], v[12:15]
    ds_read_b64_tr_b16 v[196:197], v148 offset:5216
    ds_read_b64_tr_b16 v[198:199], v148 offset:6496
    v_mfma_f32_16x16x32_bf16 v[32:35], v[168:171], v[208:211], v[32:35]
    ds_read_b64_tr_b16 v[200:201], v148 offset:5248
    ds_read_b64_tr_b16 v[202:203], v148 offset:6528
    v_mfma_f32_16x16x32_bf16 v[52:55], v[168:171], v[212:215], v[52:55]
    v_mfma_f32_16x16x32_bf16 v[72:75], v[168:171], v[216:219], v[72:75]
    v_mfma_f32_16x16x32_bf16 v[16:19], v[172:175], v[204:207], v[16:19]
    v_mfma_f32_16x16x32_bf16 v[36:39], v[172:175], v[208:211], v[36:39]
    v_mfma_f32_16x16x32_bf16 v[56:59], v[172:175], v[212:215], v[56:59]
    v_mfma_f32_16x16x32_bf16 v[76:79], v[172:175], v[216:219], v[76:79]
    v_mfma_f32_16x16x32_bf16 v[20:23], v[176:179], v[204:207], v[20:23]
    v_mfma_f32_16x16x32_bf16 v[40:43], v[176:179], v[208:211], v[40:43]
    v_mfma_f32_16x16x32_bf16 v[60:63], v[176:179], v[212:215], v[60:63]
    v_mfma_f32_16x16x32_bf16 v[80:83], v[176:179], v[216:219], v[80:83]
    v_mfma_f32_16x16x32_bf16 v[24:27], v[180:183], v[204:207], v[24:27]
    v_mfma_f32_16x16x32_bf16 v[44:47], v[180:183], v[208:211], v[44:47]
    v_mfma_f32_16x16x32_bf16 v[64:67], v[180:183], v[212:215], v[64:67]
    v_mfma_f32_16x16x32_bf16 v[84:87], v[180:183], v[216:219], v[84:87]
    v_mfma_f32_16x16x32_bf16 v[88:91], v[164:167], v[140:143], v[88:91]
    v_mfma_f32_16x16x32_bf16 v[92:95], v[168:171], v[140:143], v[92:95]
    v_mfma_f32_16x16x32_bf16 v[96:99], v[172:175], v[140:143], v[96:99]
    v_mfma_f32_16x16x32_bf16 v[100:103], v[176:179], v[140:143], v[100:103]
    v_mfma_f32_16x16x32_bf16 v[104:107], v[180:183], v[140:143], v[104:107]
    v_mfma_f32_16x16x32_bf16 v[108:111], v[140:143], v[204:207], v[108:111]
    v_mfma_f32_16x16x32_bf16 v[124:127], v[204:207], v[204:207], v[124:127]
    v_mfma_f32_16x16x32_bf16 v[112:115], v[140:143], v[208:211], v[112:115]
    v_mfma_f32_16x16x32_bf16 v[128:131], v[208:211], v[208:211], v[128:131]
    v_mfma_f32_16x16x32_bf16 v[116:119], v[140:143], v[212:215], v[116:119]
    v_mfma_f32_16x16x32_bf16 v[132:135], v[212:215], v[212:215], v[132:135]
    v_mfma_f32_16x16x32_bf16 v[120:123], v[140:143], v[216:219], v[120:123]
    v_mfma_f32_16x16x32_bf16 v[136:139], v[216:219], v[216:219], v[136:139]
    s_waitcnt lgkmcnt(0)
    s_barrier
    ds_read_b128 v[204:207], v162 offset:0
    ds_read_b128 v[208:211], v162 offset:2048
    v_mfma_f32_16x16x32_bf16 v[8:11], v[184:187], v[220:223], v[8:11]
    ds_read_b128 v[212:215], v162 offset:4096
    ds_read_b128 v[216:219], v162 offset:6144
    v_mfma_f32_16x16x32_bf16 v[28:31], v[184:187], v[224:227], v[28:31]
    ds_read_b64_tr_b16 v[164:165], v149 offset:0
    ds_read_b64_tr_b16 v[166:167], v149 offset:1280
    v_mfma_f32_16x16x32_bf16 v[48:51], v[184:187], v[228:231], v[48:51]
    ds_read_b64_tr_b16 v[168:169], v149 offset:32
    ds_read_b64_tr_b16 v[170:171], v149 offset:1312
    v_mfma_f32_16x16x32_bf16 v[68:71], v[184:187], v[232:235], v[68:71]
    ds_read_b64_tr_b16 v[172:173], v149 offset:64
    ds_read_b64_tr_b16 v[174:175], v149 offset:1344
    v_mfma_f32_16x16x32_bf16 v[12:15], v[188:191], v[220:223], v[12:15]
    ds_read_b64_tr_b16 v[176:177], v149 offset:96
    ds_read_b64_tr_b16 v[178:179], v149 offset:1376
    v_mfma_f32_16x16x32_bf16 v[32:35], v[188:191], v[224:227], v[32:35]
    ds_read_b64_tr_b16 v[180:181], v149 offset:128
    ds_read_b64_tr_b16 v[182:183], v149 offset:1408
    v_mfma_f32_16x16x32_bf16 v[52:55], v[188:191], v[228:231], v[52:55]
    v_mfma_f32_16x16x32_bf16 v[72:75], v[188:191], v[232:235], v[72:75]
    v_mfma_f32_16x16x32_bf16 v[16:19], v[192:195], v[220:223], v[16:19]
    v_mfma_f32_16x16x32_bf16 v[36:39], v[192:195], v[224:227], v[36:39]
    v_mfma_f32_16x16x32_bf16 v[56:59], v[192:195], v[228:231], v[56:59]
    v_mfma_f32_16x16x32_bf16 v[76:79], v[192:195], v[232:235], v[76:79]
    v_mfma_f32_16x16x32_bf16 v[20:23], v[196:199], v[220:223], v[20:23]
    v_mfma_f32_16x16x32_bf16 v[40:43], v[196:199], v[224:227], v[40:43]
    v_mfma_f32_16x16x32_bf16 v[60:63], v[196:199], v[228:231], v[60:63]
    v_mfma_f32_16x16x32_bf16 v[80:83], v[196:199], v[232:235], v[80:83]
    v_mfma_f32_16x16x32_bf16 v[24:27], v[200:203], v[220:223], v[24:27]
    v_mfma_f32_16x16x32_bf16 v[44:47], v[200:203], v[224:227], v[44:47]
    v_mfma_f32_16x16x32_bf16 v[64:67], v[200:203], v[228:231], v[64:67]
    v_mfma_f32_16x16x32_bf16 v[84:87], v[200:203], v[232:235], v[84:87]
    v_mfma_f32_16x16x32_bf16 v[88:91], v[184:187], v[140:143], v[88:91]
    v_mfma_f32_16x16x32_bf16 v[92:95], v[188:191], v[140:143], v[92:95]
    v_mfma_f32_16x16x32_bf16 v[96:99], v[192:195], v[140:143], v[96:99]
    v_mfma_f32_16x16x32_bf16 v[100:103], v[196:199], v[140:143], v[100:103]
    v_mfma_f32_16x16x32_bf16 v[104:107], v[200:203], v[140:143], v[104:107]
    v_mfma_f32_16x16x32_bf16 v[108:111], v[140:143], v[220:223], v[108:111]
    v_mfma_f32_16x16x32_bf16 v[124:127], v[220:223], v[220:223], v[124:127]
    v_mfma_f32_16x16x32_bf16 v[112:115], v[140:143], v[224:227], v[112:115]
    v_mfma_f32_16x16x32_bf16 v[128:131], v[224:227], v[224:227], v[128:131]
    v_mfma_f32_16x16x32_bf16 v[116:119], v[140:143], v[228:231], v[116:119]
    v_mfma_f32_16x16x32_bf16 v[132:135], v[228:231], v[228:231], v[132:135]
    v_mfma_f32_16x16x32_bf16 v[120:123], v[140:143], v[232:235], v[120:123]
    v_mfma_f32_16x16x32_bf16 v[136:139], v[232:235], v[232:235], v[136:139]
    s_waitcnt lgkmcnt(0)
    ds_read_b128 v[220:223], v163 offset:0
    ds_read_b128 v[224:227], v163 offset:2048
    v_mfma_f32_16x16x32_bf16 v[8:11], v[164:167], v[204:207], v[8:11]
    ds_read_b128 v[228:231], v163 offset:4096
    ds_read_b128 v[232:235], v163 offset:6144
    v_mfma_f32_16x16x32_bf16 v[28:31], v[164:167], v[208:211], v[28:31]
    ds_read_b64_tr_b16 v[184:185], v149 offset:5120
    ds_read_b64_tr_b16 v[186:187], v149 offset:6400
    v_mfma_f32_16x16x32_bf16 v[48:51], v[164:167], v[212:215], v[48:51]
    ds_read_b64_tr_b16 v[188:189], v149 offset:5152
    ds_read_b64_tr_b16 v[190:191], v149 offset:6432
    v_mfma_f32_16x16x32_bf16 v[68:71], v[164:167], v[216:219], v[68:71]
    ds_read_b64_tr_b16 v[192:193], v149 offset:5184
    ds_read_b64_tr_b16 v[194:195], v149 offset:6464
    v_mfma_f32_16x16x32_bf16 v[12:15], v[168:171], v[204:207], v[12:15]
    ds_read_b64_tr_b16 v[196:197], v149 offset:5216
    ds_read_b64_tr_b16 v[198:199], v149 offset:6496
    v_mfma_f32_16x16x32_bf16 v[32:35], v[168:171], v[208:211], v[32:35]
    ds_read_b64_tr_b16 v[200:201], v149 offset:5248
    ds_read_b64_tr_b16 v[202:203], v149 offset:6528
    v_mfma_f32_16x16x32_bf16 v[52:55], v[168:171], v[212:215], v[52:55]
    v_mfma_f32_16x16x32_bf16 v[72:75], v[168:171], v[216:219], v[72:75]
    v_mfma_f32_16x16x32_bf16 v[16:19], v[172:175], v[204:207], v[16:19]
    v_mfma_f32_16x16x32_bf16 v[36:39], v[172:175], v[208:211], v[36:39]
    v_mfma_f32_16x16x32_bf16 v[56:59], v[172:175], v[212:215], v[56:59]
    v_mfma_f32_16x16x32_bf16 v[76:79], v[172:175], v[216:219], v[76:79]
    v_mfma_f32_16x16x32_bf16 v[20:23], v[176:179], v[204:207], v[20:23]
    v_mfma_f32_16x16x32_bf16 v[40:43], v[176:179], v[208:211], v[40:43]
    v_mfma_f32_16x16x32_bf16 v[60:63], v[176:179], v[212:215], v[60:63]
    v_mfma_f32_16x16x32_bf16 v[80:83], v[176:179], v[216:219], v[80:83]
    v_mfma_f32_16x16x32_bf16 v[24:27], v[180:183], v[204:207], v[24:27]
    v_mfma_f32_16x16x32_bf16 v[44:47], v[180:183], v[208:211], v[44:47]
    v_mfma_f32_16x16x32_bf16 v[64:67], v[180:183], v[212:215], v[64:67]
    v_mfma_f32_16x16x32_bf16 v[84:87], v[180:183], v[216:219], v[84:87]
    v_mfma_f32_16x16x32_bf16 v[88:91], v[164:167], v[140:143], v[88:91]
    v_mfma_f32_16x16x32_bf16 v[92:95], v[168:171], v[140:143], v[92:95]
    v_mfma_f32_16x16x32_bf16 v[96:99], v[172:175], v[140:143], v[96:99]
    v_mfma_f32_16x16x32_bf16 v[100:103], v[176:179], v[140:143], v[100:103]
    v_mfma_f32_16x16x32_bf16 v[104:107], v[180:183], v[140:143], v[104:107]
    v_mfma_f32_16x16x32_bf16 v[108:111], v[140:143], v[204:207], v[108:111]
    v_mfma_f32_16x16x32_bf16 v[124:127], v[204:207], v[204:207], v[124:127]
    v_mfma_f32_16x16x32_bf16 v[112:115], v[140:143], v[208:211], v[112:115]
    v_mfma_f32_16x16x32_bf16 v[128:131], v[208:211], v[208:211], v[128:131]
    v_mfma_f32_16x16x32_bf16 v[116:119], v[140:143], v[212:215], v[116:119]
    v_mfma_f32_16x16x32_bf16 v[132:135], v[212:215], v[212:215], v[132:135]
    v_mfma_f32_16x16x32_bf16 v[120:123], v[140:143], v[216:219], v[120:123]
    v_mfma_f32_16x16x32_bf16 v[136:139], v[216:219], v[216:219], v[136:139]
    s_waitcnt lgkmcnt(0)
    s_barrier
    v_mfma_f32_16x16x32_bf16 v[8:11], v[184:187], v[220:223], v[8:11]
    v_mfma_f32_16x16x32_bf16 v[28:31], v[184:187], v[224:227], v[28:31]
    v_mfma_f32_16x16x32_bf16 v[48:51], v[184:187], v[228:231], v[48:51]
    v_mfma_f32_16x16x32_bf16 v[68:71], v[184:187], v[232:235], v[68:71]
    v_mfma_f32_16x16x32_bf16 v[12:15], v[188:191], v[220:223], v[12:15]
    v_mfma_f32_16x16x32_bf16 v[32:35], v[188:191], v[224:227], v[32:35]
    v_mfma_f32_16x16x32_bf16 v[52:55], v[188:191], v[228:231], v[52:55]
    v_mfma_f32_16x16x32_bf16 v[72:75], v[188:191], v[232:235], v[72:75]
    v_mfma_f32_16x16x32_bf16 v[16:19], v[192:195], v[220:223], v[16:19]
    v_mfma_f32_16x16x32_bf16 v[36:39], v[192:195], v[224:227], v[36:39]
    v_mfma_f32_16x16x32_bf16 v[56:59], v[192:195], v[228:231], v[56:59]
    v_mfma_f32_16x16x32_bf16 v[76:79], v[192:195], v[232:235], v[76:79]
    v_mfma_f32_16x16x32_bf16 v[20:23], v[196:199], v[220:223], v[20:23]
    v_mfma_f32_16x16x32_bf16 v[40:43], v[196:199], v[224:227], v[40:43]
    v_mfma_f32_16x16x32_bf16 v[60:63], v[196:199], v[228:231], v[60:63]
    v_mfma_f32_16x16x32_bf16 v[80:83], v[196:199], v[232:235], v[80:83]
    v_mfma_f32_16x16x32_bf16 v[24:27], v[200:203], v[220:223], v[24:27]
    v_mfma_f32_16x16x32_bf16 v[44:47], v[200:203], v[224:227], v[44:47]
    v_mfma_f32_16x16x32_bf16 v[64:67], v[200:203], v[228:231], v[64:67]
    v_mfma_f32_16x16x32_bf16 v[84:87], v[200:203], v[232:235], v[84:87]
    v_mfma_f32_16x16x32_bf16 v[88:91], v[184:187], v[140:143], v[88:91]
    v_mfma_f32_16x16x32_bf16 v[92:95], v[188:191], v[140:143], v[92:95]
    v_mfma_f32_16x16x32_bf16 v[96:99], v[192:195], v[140:143], v[96:99]
    v_mfma_f32_16x16x32_bf16 v[100:103], v[196:199], v[140:143], v[100:103]
    v_mfma_f32_16x16x32_bf16 v[104:107], v[200:203], v[140:143], v[104:107]
    v_mfma_f32_16x16x32_bf16 v[108:111], v[140:143], v[220:223], v[108:111]
    v_mfma_f32_16x16x32_bf16 v[124:127], v[220:223], v[220:223], v[124:127]
    v_mfma_f32_16x16x32_bf16 v[112:115], v[140:143], v[224:227], v[112:115]
    v_mfma_f32_16x16x32_bf16 v[128:131], v[224:227], v[224:227], v[128:131]
    v_mfma_f32_16x16x32_bf16 v[116:119], v[140:143], v[228:231], v[116:119]
    v_mfma_f32_16x16x32_bf16 v[132:135], v[228:231], v[228:231], v[132:135]
    v_mfma_f32_16x16x32_bf16 v[120:123], v[140:143], v[232:235], v[120:123]
    v_mfma_f32_16x16x32_bf16 v[136:139], v[232:235], v[232:235], v[136:139]
    s_barrier
    v_and_b32 v2, 15, v1
    v_lshrrev_b32 v3, 2, v2
    v_lshl_add_u32 v3, v3, 4, v2
    v_lshlrev_b32 v3, 2, v3
    v_and_b32 v4, 3, v1
    s_nop 4
    v_cmp_eq_u32 vcc, 1, v4
    s_nop 1
    v_cndmask_b32 v164, v124, v125, vcc
    v_cmp_eq_u32 vcc, 2, v4
    s_nop 1
    v_cndmask_b32 v164, v164, v126, vcc
    v_cmp_eq_u32 vcc, 3, v4
    s_nop 1
    v_cndmask_b32 v164, v164, v127, vcc
    v_cmp_eq_u32 vcc, 1, v4
    s_nop 1
    v_cndmask_b32 v165, v128, v129, vcc
    v_cmp_eq_u32 vcc, 2, v4
    s_nop 1
    v_cndmask_b32 v165, v165, v130, vcc
    v_cmp_eq_u32 vcc, 3, v4
    s_nop 1
    v_cndmask_b32 v165, v165, v131, vcc
    v_cmp_eq_u32 vcc, 1, v4
    s_nop 1
    v_cndmask_b32 v166, v132, v133, vcc
    v_cmp_eq_u32 vcc, 2, v4
    s_nop 1
    v_cndmask_b32 v166, v166, v134, vcc
    v_cmp_eq_u32 vcc, 3, v4
    s_nop 1
    v_cndmask_b32 v166, v166, v135, vcc
    v_cmp_eq_u32 vcc, 1, v4
    s_nop 1
    v_cndmask_b32 v167, v136, v137, vcc
    v_cmp_eq_u32 vcc, 2, v4
    s_nop 1
    v_cndmask_b32 v167, v167, v138, vcc
    v_cmp_eq_u32 vcc, 3, v4
    s_nop 1
    v_cndmask_b32 v167, v167, v139, vcc
    ds_bpermute_b32 v168, v3, v164
    ds_bpermute_b32 v169, v3, v165
    ds_bpermute_b32 v170, v3, v166
    ds_bpermute_b32 v171, v3, v167
    s_waitcnt lgkmcnt(0)
    v_mul_f32 v172, 0.001736111111111111, v108
    v_mul_f32 v173, 0.001736111111111111, v168
    v_fma_f32 v173, -v172, v172, v173
    v_max_f32 v173, 0, v173
    v_cvt_pk_bf16_f32 v5, v172, v172
    v_lshlrev_b32 v172, 16, v5
    v_cvt_pk_bf16_f32 v5, v173, v173
    v_lshlrev_b32 v173, 16, v5
    v_add_f32 v173, 0x3727c5ac, v173
    v_cvt_pk_bf16_f32 v5, v173, v173
    v_lshlrev_b32 v173, 16, v5
    v_sqrt_f32 v173, v173
    s_nop 0
    v_cvt_pk_bf16_f32 v5, v173, v173
    v_lshlrev_b32 v173, 16, v5
    v_rcp_f32 v173, v173
    s_nop 0
    v_sub_f32 v172, 0, v172
    v_mul_f32 v174, 0.001736111111111111, v112
    v_mul_f32 v175, 0.001736111111111111, v169
    v_fma_f32 v175, -v174, v174, v175
    v_max_f32 v175, 0, v175
    v_cvt_pk_bf16_f32 v5, v174, v174
    v_lshlrev_b32 v174, 16, v5
    v_cvt_pk_bf16_f32 v5, v175, v175
    v_lshlrev_b32 v175, 16, v5
    v_add_f32 v175, 0x3727c5ac, v175
    v_cvt_pk_bf16_f32 v5, v175, v175
    v_lshlrev_b32 v175, 16, v5
    v_sqrt_f32 v175, v175
    s_nop 0
    v_cvt_pk_bf16_f32 v5, v175, v175
    v_lshlrev_b32 v175, 16, v5
    v_rcp_f32 v175, v175
    s_nop 0
    v_sub_f32 v174, 0, v174
    v_mul_f32 v176, 0.001736111111111111, v116
    v_mul_f32 v177, 0.001736111111111111, v170
    v_fma_f32 v177, -v176, v176, v177
    v_max_f32 v177, 0, v177
    v_cvt_pk_bf16_f32 v5, v176, v176
    v_lshlrev_b32 v176, 16, v5
    v_cvt_pk_bf16_f32 v5, v177, v177
    v_lshlrev_b32 v177, 16, v5
    v_add_f32 v177, 0x3727c5ac, v177
    v_cvt_pk_bf16_f32 v5, v177, v177
    v_lshlrev_b32 v177, 16, v5
    v_sqrt_f32 v177, v177
    s_nop 0
    v_cvt_pk_bf16_f32 v5, v177, v177
    v_lshlrev_b32 v177, 16, v5
    v_rcp_f32 v177, v177
    s_nop 0
    v_sub_f32 v176, 0, v176
    v_mul_f32 v178, 0.001736111111111111, v120
    v_mul_f32 v179, 0.001736111111111111, v171
    v_fma_f32 v179, -v178, v178, v179
    v_max_f32 v179, 0, v179
    v_cvt_pk_bf16_f32 v5, v178, v178
    v_lshlrev_b32 v178, 16, v5
    v_cvt_pk_bf16_f32 v5, v179, v179
    v_lshlrev_b32 v179, 16, v5
    v_add_f32 v179, 0x3727c5ac, v179
    v_cvt_pk_bf16_f32 v5, v179, v179
    v_lshlrev_b32 v179, 16, v5
    v_sqrt_f32 v179, v179
    s_nop 0
    v_cvt_pk_bf16_f32 v5, v179, v179
    v_lshlrev_b32 v179, 16, v5
    v_rcp_f32 v179, v179
    s_nop 0
    v_sub_f32 v178, 0, v178
    v_pk_fma_f32 v[8:9], v[88:89], v[172:173], v[8:9] op_sel:[0,0,0] op_sel_hi:[1,0,1]
    v_pk_fma_f32 v[10:11], v[90:91], v[172:173], v[10:11] op_sel:[0,0,0] op_sel_hi:[1,0,1]
    v_pk_mul_f32 v[8:9], v[8:9], v[172:173] op_sel:[0,1] op_sel_hi:[1,1]
    v_pk_mul_f32 v[10:11], v[10:11], v[172:173] op_sel:[0,1] op_sel_hi:[1,1]
    v_cvt_pk_bf16_f32 v8, v8, v9
    v_cvt_pk_bf16_f32 v9, v10, v11
    v_pk_fma_f32 v[12:13], v[92:93], v[172:173], v[12:13] op_sel:[0,0,0] op_sel_hi:[1,0,1]
    v_pk_fma_f32 v[14:15], v[94:95], v[172:173], v[14:15] op_sel:[0,0,0] op_sel_hi:[1,0,1]
    v_pk_mul_f32 v[12:13], v[12:13], v[172:173] op_sel:[0,1] op_sel_hi:[1,1]
    v_pk_mul_f32 v[14:15], v[14:15], v[172:173] op_sel:[0,1] op_sel_hi:[1,1]
    v_cvt_pk_bf16_f32 v12, v12, v13
    v_cvt_pk_bf16_f32 v13, v14, v15
    v_pk_fma_f32 v[16:17], v[96:97], v[172:173], v[16:17] op_sel:[0,0,0] op_sel_hi:[1,0,1]
    v_pk_fma_f32 v[18:19], v[98:99], v[172:173], v[18:19] op_sel:[0,0,0] op_sel_hi:[1,0,1]
    v_pk_mul_f32 v[16:17], v[16:17], v[172:173] op_sel:[0,1] op_sel_hi:[1,1]
    v_pk_mul_f32 v[18:19], v[18:19], v[172:173] op_sel:[0,1] op_sel_hi:[1,1]
    v_cvt_pk_bf16_f32 v16, v16, v17
    v_cvt_pk_bf16_f32 v17, v18, v19
    v_pk_fma_f32 v[20:21], v[100:101], v[172:173], v[20:21] op_sel:[0,0,0] op_sel_hi:[1,0,1]
    v_pk_fma_f32 v[22:23], v[102:103], v[172:173], v[22:23] op_sel:[0,0,0] op_sel_hi:[1,0,1]
    v_pk_mul_f32 v[20:21], v[20:21], v[172:173] op_sel:[0,1] op_sel_hi:[1,1]
    v_pk_mul_f32 v[22:23], v[22:23], v[172:173] op_sel:[0,1] op_sel_hi:[1,1]
    v_cvt_pk_bf16_f32 v20, v20, v21
    v_cvt_pk_bf16_f32 v21, v22, v23
    v_pk_fma_f32 v[24:25], v[104:105], v[172:173], v[24:25] op_sel:[0,0,0] op_sel_hi:[1,0,1]
    v_pk_fma_f32 v[26:27], v[106:107], v[172:173], v[26:27] op_sel:[0,0,0] op_sel_hi:[1,0,1]
    v_pk_mul_f32 v[24:25], v[24:25], v[172:173] op_sel:[0,1] op_sel_hi:[1,1]
    v_pk_mul_f32 v[26:27], v[26:27], v[172:173] op_sel:[0,1] op_sel_hi:[1,1]
    v_cvt_pk_bf16_f32 v24, v24, v25
    v_cvt_pk_bf16_f32 v25, v26, v27
    v_pk_fma_f32 v[28:29], v[88:89], v[174:175], v[28:29] op_sel:[0,0,0] op_sel_hi:[1,0,1]
    v_pk_fma_f32 v[30:31], v[90:91], v[174:175], v[30:31] op_sel:[0,0,0] op_sel_hi:[1,0,1]
    v_pk_mul_f32 v[28:29], v[28:29], v[174:175] op_sel:[0,1] op_sel_hi:[1,1]
    v_pk_mul_f32 v[30:31], v[30:31], v[174:175] op_sel:[0,1] op_sel_hi:[1,1]
    v_cvt_pk_bf16_f32 v28, v28, v29
    v_cvt_pk_bf16_f32 v29, v30, v31
    v_pk_fma_f32 v[32:33], v[92:93], v[174:175], v[32:33] op_sel:[0,0,0] op_sel_hi:[1,0,1]
    v_pk_fma_f32 v[34:35], v[94:95], v[174:175], v[34:35] op_sel:[0,0,0] op_sel_hi:[1,0,1]
    v_pk_mul_f32 v[32:33], v[32:33], v[174:175] op_sel:[0,1] op_sel_hi:[1,1]
    v_pk_mul_f32 v[34:35], v[34:35], v[174:175] op_sel:[0,1] op_sel_hi:[1,1]
    v_cvt_pk_bf16_f32 v32, v32, v33
    v_cvt_pk_bf16_f32 v33, v34, v35
    v_pk_fma_f32 v[36:37], v[96:97], v[174:175], v[36:37] op_sel:[0,0,0] op_sel_hi:[1,0,1]
    v_pk_fma_f32 v[38:39], v[98:99], v[174:175], v[38:39] op_sel:[0,0,0] op_sel_hi:[1,0,1]
    v_pk_mul_f32 v[36:37], v[36:37], v[174:175] op_sel:[0,1] op_sel_hi:[1,1]
    v_pk_mul_f32 v[38:39], v[38:39], v[174:175] op_sel:[0,1] op_sel_hi:[1,1]
    v_cvt_pk_bf16_f32 v36, v36, v37
    v_cvt_pk_bf16_f32 v37, v38, v39
    v_pk_fma_f32 v[40:41], v[100:101], v[174:175], v[40:41] op_sel:[0,0,0] op_sel_hi:[1,0,1]
    v_pk_fma_f32 v[42:43], v[102:103], v[174:175], v[42:43] op_sel:[0,0,0] op_sel_hi:[1,0,1]
    v_pk_mul_f32 v[40:41], v[40:41], v[174:175] op_sel:[0,1] op_sel_hi:[1,1]
    v_pk_mul_f32 v[42:43], v[42:43], v[174:175] op_sel:[0,1] op_sel_hi:[1,1]
    v_cvt_pk_bf16_f32 v40, v40, v41
    v_cvt_pk_bf16_f32 v41, v42, v43
    v_pk_fma_f32 v[44:45], v[104:105], v[174:175], v[44:45] op_sel:[0,0,0] op_sel_hi:[1,0,1]
    v_pk_fma_f32 v[46:47], v[106:107], v[174:175], v[46:47] op_sel:[0,0,0] op_sel_hi:[1,0,1]
    v_pk_mul_f32 v[44:45], v[44:45], v[174:175] op_sel:[0,1] op_sel_hi:[1,1]
    v_pk_mul_f32 v[46:47], v[46:47], v[174:175] op_sel:[0,1] op_sel_hi:[1,1]
    v_cvt_pk_bf16_f32 v44, v44, v45
    v_cvt_pk_bf16_f32 v45, v46, v47
    v_pk_fma_f32 v[48:49], v[88:89], v[176:177], v[48:49] op_sel:[0,0,0] op_sel_hi:[1,0,1]
    v_pk_fma_f32 v[50:51], v[90:91], v[176:177], v[50:51] op_sel:[0,0,0] op_sel_hi:[1,0,1]
    v_pk_mul_f32 v[48:49], v[48:49], v[176:177] op_sel:[0,1] op_sel_hi:[1,1]
    v_pk_mul_f32 v[50:51], v[50:51], v[176:177] op_sel:[0,1] op_sel_hi:[1,1]
    v_cvt_pk_bf16_f32 v48, v48, v49
    v_cvt_pk_bf16_f32 v49, v50, v51
    v_pk_fma_f32 v[52:53], v[92:93], v[176:177], v[52:53] op_sel:[0,0,0] op_sel_hi:[1,0,1]
    v_pk_fma_f32 v[54:55], v[94:95], v[176:177], v[54:55] op_sel:[0,0,0] op_sel_hi:[1,0,1]
    v_pk_mul_f32 v[52:53], v[52:53], v[176:177] op_sel:[0,1] op_sel_hi:[1,1]
    v_pk_mul_f32 v[54:55], v[54:55], v[176:177] op_sel:[0,1] op_sel_hi:[1,1]
    v_cvt_pk_bf16_f32 v52, v52, v53
    v_cvt_pk_bf16_f32 v53, v54, v55
    v_pk_fma_f32 v[56:57], v[96:97], v[176:177], v[56:57] op_sel:[0,0,0] op_sel_hi:[1,0,1]
    v_pk_fma_f32 v[58:59], v[98:99], v[176:177], v[58:59] op_sel:[0,0,0] op_sel_hi:[1,0,1]
    v_pk_mul_f32 v[56:57], v[56:57], v[176:177] op_sel:[0,1] op_sel_hi:[1,1]
    v_pk_mul_f32 v[58:59], v[58:59], v[176:177] op_sel:[0,1] op_sel_hi:[1,1]
    v_cvt_pk_bf16_f32 v56, v56, v57
    v_cvt_pk_bf16_f32 v57, v58, v59
    v_pk_fma_f32 v[60:61], v[100:101], v[176:177], v[60:61] op_sel:[0,0,0] op_sel_hi:[1,0,1]
    v_pk_fma_f32 v[62:63], v[102:103], v[176:177], v[62:63] op_sel:[0,0,0] op_sel_hi:[1,0,1]
    v_pk_mul_f32 v[60:61], v[60:61], v[176:177] op_sel:[0,1] op_sel_hi:[1,1]
    v_pk_mul_f32 v[62:63], v[62:63], v[176:177] op_sel:[0,1] op_sel_hi:[1,1]
    v_cvt_pk_bf16_f32 v60, v60, v61
    v_cvt_pk_bf16_f32 v61, v62, v63
    v_pk_fma_f32 v[64:65], v[104:105], v[176:177], v[64:65] op_sel:[0,0,0] op_sel_hi:[1,0,1]
    v_pk_fma_f32 v[66:67], v[106:107], v[176:177], v[66:67] op_sel:[0,0,0] op_sel_hi:[1,0,1]
    v_pk_mul_f32 v[64:65], v[64:65], v[176:177] op_sel:[0,1] op_sel_hi:[1,1]
    v_pk_mul_f32 v[66:67], v[66:67], v[176:177] op_sel:[0,1] op_sel_hi:[1,1]
    v_cvt_pk_bf16_f32 v64, v64, v65
    v_cvt_pk_bf16_f32 v65, v66, v67
    v_pk_fma_f32 v[68:69], v[88:89], v[178:179], v[68:69] op_sel:[0,0,0] op_sel_hi:[1,0,1]
    v_pk_fma_f32 v[70:71], v[90:91], v[178:179], v[70:71] op_sel:[0,0,0] op_sel_hi:[1,0,1]
    v_pk_mul_f32 v[68:69], v[68:69], v[178:179] op_sel:[0,1] op_sel_hi:[1,1]
    v_pk_mul_f32 v[70:71], v[70:71], v[178:179] op_sel:[0,1] op_sel_hi:[1,1]
    v_cvt_pk_bf16_f32 v68, v68, v69
    v_cvt_pk_bf16_f32 v69, v70, v71
    v_pk_fma_f32 v[72:73], v[92:93], v[178:179], v[72:73] op_sel:[0,0,0] op_sel_hi:[1,0,1]
    v_pk_fma_f32 v[74:75], v[94:95], v[178:179], v[74:75] op_sel:[0,0,0] op_sel_hi:[1,0,1]
    v_pk_mul_f32 v[72:73], v[72:73], v[178:179] op_sel:[0,1] op_sel_hi:[1,1]
    v_pk_mul_f32 v[74:75], v[74:75], v[178:179] op_sel:[0,1] op_sel_hi:[1,1]
    v_cvt_pk_bf16_f32 v72, v72, v73
    v_cvt_pk_bf16_f32 v73, v74, v75
    v_pk_fma_f32 v[76:77], v[96:97], v[178:179], v[76:77] op_sel:[0,0,0] op_sel_hi:[1,0,1]
    v_pk_fma_f32 v[78:79], v[98:99], v[178:179], v[78:79] op_sel:[0,0,0] op_sel_hi:[1,0,1]
    v_pk_mul_f32 v[76:77], v[76:77], v[178:179] op_sel:[0,1] op_sel_hi:[1,1]
    v_pk_mul_f32 v[78:79], v[78:79], v[178:179] op_sel:[0,1] op_sel_hi:[1,1]
    v_cvt_pk_bf16_f32 v76, v76, v77
    v_cvt_pk_bf16_f32 v77, v78, v79
    v_pk_fma_f32 v[80:81], v[100:101], v[178:179], v[80:81] op_sel:[0,0,0] op_sel_hi:[1,0,1]
    v_pk_fma_f32 v[82:83], v[102:103], v[178:179], v[82:83] op_sel:[0,0,0] op_sel_hi:[1,0,1]
    v_pk_mul_f32 v[80:81], v[80:81], v[178:179] op_sel:[0,1] op_sel_hi:[1,1]
    v_pk_mul_f32 v[82:83], v[82:83], v[178:179] op_sel:[0,1] op_sel_hi:[1,1]
    v_cvt_pk_bf16_f32 v80, v80, v81
    v_cvt_pk_bf16_f32 v81, v82, v83
    v_pk_fma_f32 v[84:85], v[104:105], v[178:179], v[84:85] op_sel:[0,0,0] op_sel_hi:[1,0,1]
    v_pk_fma_f32 v[86:87], v[106:107], v[178:179], v[86:87] op_sel:[0,0,0] op_sel_hi:[1,0,1]
    v_pk_mul_f32 v[84:85], v[84:85], v[178:179] op_sel:[0,1] op_sel_hi:[1,1]
    v_pk_mul_f32 v[86:87], v[86:87], v[178:179] op_sel:[0,1] op_sel_hi:[1,1]
    v_cvt_pk_bf16_f32 v84, v84, v85
    v_cvt_pk_bf16_f32 v85, v86, v87
    v_lshlrev_b32 v2, 3, v1
    ds_read_b64 v[88:89], v2 offset:0
    ds_read_b64 v[90:91], v2 offset:512
    ds_read_b64 v[92:93], v2 offset:1024
    ds_read_b64 v[94:95], v2 offset:1536
    ds_read_b64 v[96:97], v2 offset:2048
    ds_read_b64 v[98:99], v2 offset:2560
    ds_read_b64 v[100:101], v2 offset:3072
    ds_read_b64 v[102:103], v2 offset:3584
    s_mul_i32 s62, s52, 10240
    s_add_u32 s62, s62, 47360
    v_mov_b32 v108, 0
    v_mov_b32 v109, 0
    v_mov_b32 v110, 0
    v_mov_b32 v111, 0
    v_lshlrev_b32 v3, 4, v1
    v_add_u32 v3, s62, v3
    ds_write_b128 v3, v[108:111] offset:0
    ds_write_b128 v3, v[108:111] offset:1024
    ds_write_b128 v3, v[108:111] offset:2048
    ds_write_b128 v3, v[108:111] offset:3072
    ds_write_b128 v3, v[108:111] offset:4096
    ds_write_b128 v3, v[108:111] offset:5120
    ds_write_b128 v3, v[108:111] offset:6144
    ds_write_b128 v3, v[108:111] offset:7168
    ds_write_b128 v3, v[108:111] offset:8192
    ds_write_b128 v3, v[108:111] offset:9216
    s_waitcnt lgkmcnt(0)
    v_mfma_f32_16x16x16_bf16 v[144:147], v[88:89], v[8:9], 0
    v_mfma_f32_16x16x16_bf16 v[144:147], v[92:93], v[12:13], v[144:147]
    v_mfma_f32_16x16x16_bf16 v[148:151], v[90:91], v[8:9], 0
    v_mfma_f32_16x16x16_bf16 v[148:151], v[94:95], v[12:13], v[148:151]
    v_mfma_f32_16x16x16_bf16 v[152:155], v[96:97], v[12:13], 0
    v_mfma_f32_16x16x16_bf16 v[152:155], v[100:101], v[16:17], v[152:155]
    v_mfma_f32_16x16x16_bf16 v[156:159], v[98:99], v[12:13], 0
    v_mfma_f32_16x16x16_bf16 v[156:159], v[102:103], v[16:17], v[156:159]
    v_mfma_f32_16x16x16_bf16 v[160:163], v[88:89], v[28:29], 0
    v_mfma_f32_16x16x16_bf16 v[160:163], v[92:93], v[32:33], v[160:163]
    v_mfma_f32_16x16x16_bf16 v[164:167], v[90:91], v[28:29], 0
    v_mfma_f32_16x16x16_bf16 v[164:167], v[94:95], v[32:33], v[164:167]
    v_mfma_f32_16x16x16_bf16 v[168:171], v[96:97], v[32:33], 0
    v_mfma_f32_16x16x16_bf16 v[168:171], v[100:101], v[36:37], v[168:171]
    v_mfma_f32_16x16x16_bf16 v[172:175], v[98:99], v[32:33], 0
    v_mfma_f32_16x16x16_bf16 v[172:175], v[102:103], v[36:37], v[172:175]
    v_mfma_f32_16x16x16_bf16 v[176:179], v[88:89], v[48:49], 0
    v_mfma_f32_16x16x16_bf16 v[176:179], v[92:93], v[52:53], v[176:179]
    v_mfma_f32_16x16x16_bf16 v[180:183], v[90:91], v[48:49], 0
    v_mfma_f32_16x16x16_bf16 v[180:183], v[94:95], v[52:53], v[180:183]
    v_mfma_f32_16x16x16_bf16 v[184:187], v[96:97], v[52:53], 0
    v_mfma_f32_16x16x16_bf16 v[184:187], v[100:101], v[56:57], v[184:187]
    v_mfma_f32_16x16x16_bf16 v[188:191], v[98:99], v[52:53], 0
    v_mfma_f32_16x16x16_bf16 v[188:191], v[102:103], v[56:57], v[188:191]
    v_mfma_f32_16x16x16_bf16 v[192:195], v[88:89], v[68:69], 0
    v_mfma_f32_16x16x16_bf16 v[192:195], v[92:93], v[72:73], v[192:195]
    v_mfma_f32_16x16x16_bf16 v[196:199], v[90:91], v[68:69], 0
    v_mfma_f32_16x16x16_bf16 v[196:199], v[94:95], v[72:73], v[196:199]
    v_mfma_f32_16x16x16_bf16 v[200:203], v[96:97], v[72:73], 0
    v_mfma_f32_16x16x16_bf16 v[200:203], v[100:101], v[76:77], v[200:203]
    v_mfma_f32_16x16x16_bf16 v[204:207], v[98:99], v[72:73], 0
    v_mfma_f32_16x16x16_bf16 v[204:207], v[102:103], v[76:77], v[204:207]
    v_mov_b32 v240, 0x3fb8aa3b
    v_cmp_gt_u32 vcc, 16, v1
    s_nop 1
    v_cndmask_b32 v241, 0, 1.0, vcc
    v_xor_b32 v242, 16, v1
    v_lshlrev_b32 v242, 2, v242
    v_xor_b32 v243, 32, v1
    v_lshlrev_b32 v243, 2, v243
    s_nop 4
    v_cvt_pk_bf16_f32 v224, v144, v145
    v_lshlrev_b32 v144, 16, v224
    v_and_b32 v145, 0xffff0000, v224
    v_cvt_pk_bf16_f32 v224, v146, v147
    v_lshlrev_b32 v146, 16, v224
    v_and_b32 v147, 0xffff0000, v224
    v_cvt_pk_bf16_f32 v224, v148, v149
    v_lshlrev_b32 v148, 16, v224
    v_and_b32 v149, 0xffff0000, v224
    v_cndmask_b32 v148, v144, v148, vcc
    v_cndmask_b32 v149, v144, v149, vcc
    v_max3_f32 v208, v144, v145, v146
    v_max3_f32 v208, v208, v147, v148
    v_max_f32 v208, v208, v149
    v_min3_f32 v209, v144, v145, v146
    v_min3_f32 v209, v209, v147, v148
    v_min_f32 v209, v209, v149
    v_cvt_pk_bf16_f32 v224, v152, v153
    v_lshlrev_b32 v152, 16, v224
    v_and_b32 v153, 0xffff0000, v224
    v_cvt_pk_bf16_f32 v224, v154, v155
    v_lshlrev_b32 v154, 16, v224
    v_and_b32 v155, 0xffff0000, v224
    v_cvt_pk_bf16_f32 v224, v156, v157
    v_lshlrev_b32 v156, 16, v224
    v_and_b32 v157, 0xffff0000, v224
    v_cndmask_b32 v156, v152, v156, vcc
    v_cndmask_b32 v157, v152, v157, vcc
    v_max3_f32 v210, v152, v153, v154
    v_max3_f32 v210, v210, v155, v156
    v_max_f32 v210, v210, v157
    v_min3_f32 v211, v152, v153, v154
    v_min3_f32 v211, v211, v155, v156
    v_min_f32 v211, v211, v157
    v_cvt_pk_bf16_f32 v224, v160, v161
    v_lshlrev_b32 v160, 16, v224
    v_and_b32 v161, 0xffff0000, v224
    v_cvt_pk_bf16_f32 v224, v162, v163
    v_lshlrev_b32 v162, 16, v224
    v_and_b32 v163, 0xffff0000, v224
    v_cvt_pk_bf16_f32 v224, v164, v165
    v_lshlrev_b32 v164, 16, v224
    v_and_b32 v165, 0xffff0000, v224
    v_cndmask_b32 v164, v160, v164, vcc
    v_cndmask_b32 v165, v160, v165, vcc
    v_max3_f32 v212, v160, v161, v162
    v_max3_f32 v212, v212, v163, v164
    v_max_f32 v212, v212, v165
    v_min3_f32 v213, v160, v161, v162
    v_min3_f32 v213, v213, v163, v164
    v_min_f32 v213, v213, v165
    v_cvt_pk_bf16_f32 v224, v168, v169
    v_lshlrev_b32 v168, 16, v224
    v_and_b32 v169, 0xffff0000, v224
    v_cvt_pk_bf16_f32 v224, v170, v171
    v_lshlrev_b32 v170, 16, v224
    v_and_b32 v171, 0xffff0000, v224
    v_cvt_pk_bf16_f32 v224, v172, v173
    v_lshlrev_b32 v172, 16, v224
    v_and_b32 v173, 0xffff0000, v224
    v_cndmask_b32 v172, v168, v172, vcc
    v_cndmask_b32 v173, v168, v173, vcc
    v_max3_f32 v214, v168, v169, v170
    v_max3_f32 v214, v214, v171, v172
    v_max_f32 v214, v214, v173
    v_min3_f32 v215, v168, v169, v170
    v_min3_f32 v215, v215, v171, v172
    v_min_f32 v215, v215, v173
    v_cvt_pk_bf16_f32 v224, v176, v177
    v_lshlrev_b32 v176, 16, v224
    v_and_b32 v177, 0xffff0000, v224
    v_cvt_pk_bf16_f32 v224, v178, v179
    v_lshlrev_b32 v178, 16, v224
    v_and_b32 v179, 0xffff0000, v224
    v_cvt_pk_bf16_f32 v224, v180, v181
    v_lshlrev_b32 v180, 16, v224
    v_and_b32 v181, 0xffff0000, v224
    v_cndmask_b32 v180, v176, v180, vcc
    v_cndmask_b32 v181, v176, v181, vcc
    v_max3_f32 v216, v176, v177, v178
    v_max3_f32 v216, v216, v179, v180
    v_max_f32 v216, v216, v181
    v_min3_f32 v217, v176, v177, v178
    v_min3_f32 v217, v217, v179, v180
    v_min_f32 v217, v217, v181
    v_cvt_pk_bf16_f32 v224, v184, v185
    v_lshlrev_b32 v184, 16, v224
    v_and_b32 v185, 0xffff0000, v224
    v_cvt_pk_bf16_f32 v224, v186, v187
    v_lshlrev_b32 v186, 16, v224
    v_and_b32 v187, 0xffff0000, v224
    v_cvt_pk_bf16_f32 v224, v188, v189
    v_lshlrev_b32 v188, 16, v224
    v_and_b32 v189, 0xffff0000, v224
    v_cndmask_b32 v188, v184, v188, vcc
    v_cndmask_b32 v189, v184, v189, vcc
    v_max3_f32 v218, v184, v185, v186
    v_max3_f32 v218, v218, v187, v188
    v_max_f32 v218, v218, v189
    v_min3_f32 v219, v184, v185, v186
    v_min3_f32 v219, v219, v187, v188
    v_min_f32 v219, v219, v189
    v_cvt_pk_bf16_f32 v224, v192, v193
    v_lshlrev_b32 v192, 16, v224
    v_and_b32 v193, 0xffff0000, v224
    v_cvt_pk_bf16_f32 v224, v194, v195
    v_lshlrev_b32 v194, 16, v224
    v_and_b32 v195, 0xffff0000, v224
    v_cvt_pk_bf16_f32 v224, v196, v197
    v_lshlrev_b32 v196, 16, v224
    v_and_b32 v197, 0xffff0000, v224
    v_cndmask_b32 v196, v192, v196, vcc
    v_cndmask_b32 v197, v192, v197, vcc
    v_max3_f32 v220, v192, v193, v194
    v_max3_f32 v220, v220, v195, v196
    v_max_f32 v220, v220, v197
    v_min3_f32 v221, v192, v193, v194
    v_min3_f32 v221, v221, v195, v196
    v_min_f32 v221, v221, v197
    v_cvt_pk_bf16_f32 v224, v200, v201
    v_lshlrev_b32 v200, 16, v224
    v_and_b32 v201, 0xffff0000, v224
    v_cvt_pk_bf16_f32 v224, v202, v203
    v_lshlrev_b32 v202, 16, v224
    v_and_b32 v203, 0xffff0000, v224
    v_cvt_pk_bf16_f32 v224, v204, v205
    v_lshlrev_b32 v204, 16, v224
    v_and_b32 v205, 0xffff0000, v224
    v_cndmask_b32 v204, v200, v204, vcc
    v_cndmask_b32 v205, v200, v205, vcc
    v_max3_f32 v222, v200, v201, v202
    v_max3_f32 v222, v222, v203, v204
    v_max_f32 v222, v222, v205
    v_min3_f32 v223, v200, v201, v202
    v_min3_f32 v223, v223, v203, v204
    v_min_f32 v223, v223, v205
    ds_bpermute_b32 v224, v242, v208
    ds_bpermute_b32 v225, v242, v209
    ds_bpermute_b32 v226, v242, v210
    ds_bpermute_b32 v227, v242, v211
    ds_bpermute_b32 v228, v242, v212
    ds_bpermute_b32 v229, v242, v213
    ds_bpermute_b32 v230, v242, v214
    ds_bpermute_b32 v231, v242, v215
    ds_bpermute_b32 v232, v242, v216
    ds_bpermute_b32 v233, v242, v217
    ds_bpermute_b32 v234, v242, v218
    ds_bpermute_b32 v235, v242, v219
    ds_bpermute_b32 v236, v242, v220
    ds_bpermute_b32 v237, v242, v221
    ds_bpermute_b32 v238, v242, v222
    ds_bpermute_b32 v239, v242, v223
    s_waitcnt lgkmcnt(0)
    v_max_f32 v208, v208, v224
    v_min_f32 v209, v209, v225
    v_max_f32 v210, v210, v226
    v_min_f32 v211, v211, v227
    v_max_f32 v212, v212, v228
    v_min_f32 v213, v213, v229
    v_max_f32 v214, v214, v230
    v_min_f32 v215, v215, v231
    v_max_f32 v216, v216, v232
    v_min_f32 v217, v217, v233
    v_max_f32 v218, v218, v234
    v_min_f32 v219, v219, v235
    v_max_f32 v220, v220, v236
    v_min_f32 v221, v221, v237
    v_max_f32 v222, v222, v238
    v_min_f32 v223, v223, v239
    ds_bpermute_b32 v224, v243, v208
    ds_bpermute_b32 v225, v243, v209
    ds_bpermute_b32 v226, v243, v210
    ds_bpermute_b32 v227, v243, v211
    ds_bpermute_b32 v228, v243, v212
    ds_bpermute_b32 v229, v243, v213
    ds_bpermute_b32 v230, v243, v214
    ds_bpermute_b32 v231, v243, v215
    ds_bpermute_b32 v232, v243, v216
    ds_bpermute_b32 v233, v243, v217
    ds_bpermute_b32 v234, v243, v218
    ds_bpermute_b32 v235, v243, v219
    ds_bpermute_b32 v236, v243, v220
    ds_bpermute_b32 v237, v243, v221
    ds_bpermute_b32 v238, v243, v222
    ds_bpermute_b32 v239, v243, v223
    s_waitcnt lgkmcnt(0)
    v_max_f32 v208, v208, v224
    v_min_f32 v209, v209, v225
    v_max_f32 v210, v210, v226
    v_min_f32 v211, v211, v227
    v_max_f32 v212, v212, v228
    v_min_f32 v213, v213, v229
    v_max_f32 v214, v214, v230
    v_min_f32 v215, v215, v231
    v_max_f32 v216, v216, v232
    v_min_f32 v217, v217, v233
    v_max_f32 v218, v218, v234
    v_min_f32 v219, v219, v235
    v_max_f32 v220, v220, v236
    v_min_f32 v221, v221, v237
    v_max_f32 v222, v222, v238
    v_min_f32 v223, v223, v239
    v_mul_f32 v208, v208, v240
    v_mul_f32 v209, v209, v240
    v_fma_f32 v10, -v144, v240, v209
    v_fma_f32 v144, v144, v240, -v208
    v_fma_f32 v11, -v145, v240, v209
    v_fma_f32 v145, v145, v240, -v208
    v_fma_f32 v14, -v146, v240, v209
    v_fma_f32 v146, v146, v240, -v208
    v_fma_f32 v15, -v147, v240, v209
    v_fma_f32 v147, v147, v240, -v208
    v_fma_f32 v18, -v148, v240, v209
    v_fma_f32 v148, v148, v240, -v208
    v_fma_f32 v19, -v149, v240, v209
    v_fma_f32 v149, v149, v240, -v208
    v_exp_f32 v10, v10
    v_exp_f32 v144, v144
    v_exp_f32 v11, v11
    v_exp_f32 v145, v145
    v_exp_f32 v14, v14
    v_exp_f32 v146, v146
    v_exp_f32 v15, v15
    v_exp_f32 v147, v147
    v_exp_f32 v18, v18
    v_exp_f32 v148, v148
    v_exp_f32 v19, v19
    v_exp_f32 v149, v149
    v_mul_f32 v210, v210, v240
    v_mul_f32 v211, v211, v240
    v_fma_f32 v22, -v152, v240, v211
    v_fma_f32 v152, v152, v240, -v210
    v_fma_f32 v23, -v153, v240, v211
    v_fma_f32 v153, v153, v240, -v210
    v_fma_f32 v26, -v154, v240, v211
    v_fma_f32 v154, v154, v240, -v210
    v_fma_f32 v27, -v155, v240, v211
    v_fma_f32 v155, v155, v240, -v210
    v_fma_f32 v30, -v156, v240, v211
    v_fma_f32 v156, v156, v240, -v210
    v_fma_f32 v31, -v157, v240, v211
    v_fma_f32 v157, v157, v240, -v210
    v_exp_f32 v22, v22
    v_exp_f32 v152, v152
    v_exp_f32 v23, v23
    v_exp_f32 v153, v153
    v_exp_f32 v26, v26
    v_exp_f32 v154, v154
    v_exp_f32 v27, v27
    v_exp_f32 v155, v155
    v_exp_f32 v30, v30
    v_exp_f32 v156, v156
    v_exp_f32 v31, v31
    v_exp_f32 v157, v157
    v_mul_f32 v212, v212, v240
    v_mul_f32 v213, v213, v240
    v_fma_f32 v34, -v160, v240, v213
    v_fma_f32 v160, v160, v240, -v212
    v_fma_f32 v35, -v161, v240, v213
    v_fma_f32 v161, v161, v240, -v212
    v_fma_f32 v38, -v162, v240, v213
    v_fma_f32 v162, v162, v240, -v212
    v_fma_f32 v39, -v163, v240, v213
    v_fma_f32 v163, v163, v240, -v212
    v_fma_f32 v42, -v164, v240, v213
    v_fma_f32 v164, v164, v240, -v212
    v_fma_f32 v43, -v165, v240, v213
    v_fma_f32 v165, v165, v240, -v212
    v_exp_f32 v34, v34
    v_exp_f32 v160, v160
    v_exp_f32 v35, v35
    v_exp_f32 v161, v161
    v_exp_f32 v38, v38
    v_exp_f32 v162, v162
    v_exp_f32 v39, v39
    v_exp_f32 v163, v163
    v_exp_f32 v42, v42
    v_exp_f32 v164, v164
    v_exp_f32 v43, v43
    v_exp_f32 v165, v165
    v_mul_f32 v214, v214, v240
    v_mul_f32 v215, v215, v240
    v_fma_f32 v46, -v168, v240, v215
    v_fma_f32 v168, v168, v240, -v214
    v_fma_f32 v47, -v169, v240, v215
    v_fma_f32 v169, v169, v240, -v214
    v_fma_f32 v50, -v170, v240, v215
    v_fma_f32 v170, v170, v240, -v214
    v_fma_f32 v51, -v171, v240, v215
    v_fma_f32 v171, v171, v240, -v214
    v_fma_f32 v54, -v172, v240, v215
    v_fma_f32 v172, v172, v240, -v214
    v_fma_f32 v55, -v173, v240, v215
    v_fma_f32 v173, v173, v240, -v214
    v_exp_f32 v46, v46
    v_exp_f32 v168, v168
    v_exp_f32 v47, v47
    v_exp_f32 v169, v169
    v_exp_f32 v50, v50
    v_exp_f32 v170, v170
    v_exp_f32 v51, v51
    v_exp_f32 v171, v171
    v_exp_f32 v54, v54
    v_exp_f32 v172, v172
    v_exp_f32 v55, v55
    v_exp_f32 v173, v173
    v_mul_f32 v216, v216, v240
    v_mul_f32 v217, v217, v240
    v_fma_f32 v58, -v176, v240, v217
    v_fma_f32 v176, v176, v240, -v216
    v_fma_f32 v59, -v177, v240, v217
    v_fma_f32 v177, v177, v240, -v216
    v_fma_f32 v62, -v178, v240, v217
    v_fma_f32 v178, v178, v240, -v216
    v_fma_f32 v63, -v179, v240, v217
    v_fma_f32 v179, v179, v240, -v216
    v_fma_f32 v66, -v180, v240, v217
    v_fma_f32 v180, v180, v240, -v216
    v_fma_f32 v67, -v181, v240, v217
    v_fma_f32 v181, v181, v240, -v216
    v_exp_f32 v58, v58
    v_exp_f32 v176, v176
    v_exp_f32 v59, v59
    v_exp_f32 v177, v177
    v_exp_f32 v62, v62
    v_exp_f32 v178, v178
    v_exp_f32 v63, v63
    v_exp_f32 v179, v179
    v_exp_f32 v66, v66
    v_exp_f32 v180, v180
    v_exp_f32 v67, v67
    v_exp_f32 v181, v181
    v_mul_f32 v218, v218, v240
    v_mul_f32 v219, v219, v240
    v_fma_f32 v70, -v184, v240, v219
    v_fma_f32 v184, v184, v240, -v218
    v_fma_f32 v71, -v185, v240, v219
    v_fma_f32 v185, v185, v240, -v218
    v_fma_f32 v74, -v186, v240, v219
    v_fma_f32 v186, v186, v240, -v218
    v_fma_f32 v75, -v187, v240, v219
    v_fma_f32 v187, v187, v240, -v218
    v_fma_f32 v78, -v188, v240, v219
    v_fma_f32 v188, v188, v240, -v218
    v_fma_f32 v79, -v189, v240, v219
    v_fma_f32 v189, v189, v240, -v218
    v_exp_f32 v70, v70
    v_exp_f32 v184, v184
    v_exp_f32 v71, v71
    v_exp_f32 v185, v185
    v_exp_f32 v74, v74
    v_exp_f32 v186, v186
    v_exp_f32 v75, v75
    v_exp_f32 v187, v187
    v_exp_f32 v78, v78
    v_exp_f32 v188, v188
    v_exp_f32 v79, v79
    v_exp_f32 v189, v189
    v_mul_f32 v220, v220, v240
    v_mul_f32 v221, v221, v240
    v_fma_f32 v82, -v192, v240, v221
    v_fma_f32 v192, v192, v240, -v220
    v_fma_f32 v83, -v193, v240, v221
    v_fma_f32 v193, v193, v240, -v220
    v_fma_f32 v86, -v194, v240, v221
    v_fma_f32 v194, v194, v240, -v220
    v_fma_f32 v87, -v195, v240, v221
    v_fma_f32 v195, v195, v240, -v220
    v_fma_f32 v112, -v196, v240, v221
    v_fma_f32 v196, v196, v240, -v220
    v_fma_f32 v113, -v197, v240, v221
    v_fma_f32 v197, v197, v240, -v220
    v_exp_f32 v82, v82
    v_exp_f32 v192, v192
    v_exp_f32 v83, v83
    v_exp_f32 v193, v193
    v_exp_f32 v86, v86
    v_exp_f32 v194, v194
    v_exp_f32 v87, v87
    v_exp_f32 v195, v195
    v_exp_f32 v112, v112
    v_exp_f32 v196, v196
    v_exp_f32 v113, v113
    v_exp_f32 v197, v197
    v_mul_f32 v222, v222, v240
    v_mul_f32 v223, v223, v240
    v_fma_f32 v114, -v200, v240, v223
    v_fma_f32 v200, v200, v240, -v222
    v_fma_f32 v115, -v201, v240, v223
    v_fma_f32 v201, v201, v240, -v222
    v_fma_f32 v116, -v202, v240, v223
    v_fma_f32 v202, v202, v240, -v222
    v_fma_f32 v117, -v203, v240, v223
    v_fma_f32 v203, v203, v240, -v222
    v_fma_f32 v118, -v204, v240, v223
    v_fma_f32 v204, v204, v240, -v222
    v_fma_f32 v119, -v205, v240, v223
    v_fma_f32 v205, v205, v240, -v222
    v_exp_f32 v114, v114
    v_exp_f32 v200, v200
    v_exp_f32 v115, v115
    v_exp_f32 v201, v201
    v_exp_f32 v116, v116
    v_exp_f32 v202, v202
    v_exp_f32 v117, v117
    v_exp_f32 v203, v203
    v_exp_f32 v118, v118
    v_exp_f32 v204, v204
    v_exp_f32 v119, v119
    v_exp_f32 v205, v205
    s_nop 0
    v_add_f32 v208, v148, v149
    v_mul_f32 v208, v208, v241
    v_add_f32 v208, v208, v144
    v_add_f32 v208, v208, v145
    v_add_f32 v208, v208, v146
    v_add_f32 v208, v208, v147
    v_add_f32 v209, v18, v19
    v_mul_f32 v209, v209, v241
    v_add_f32 v209, v209, v10
    v_add_f32 v209, v209, v11
    v_add_f32 v209, v209, v14
    v_add_f32 v209, v209, v15
    v_add_f32 v210, v156, v157
    v_mul_f32 v210, v210, v241
    v_add_f32 v210, v210, v152
    v_add_f32 v210, v210, v153
    v_add_f32 v210, v210, v154
    v_add_f32 v210, v210, v155
    v_add_f32 v211, v30, v31
    v_mul_f32 v211, v211, v241
    v_add_f32 v211, v211, v22
    v_add_f32 v211, v211, v23
    v_add_f32 v211, v211, v26
    v_add_f32 v211, v211, v27
    v_add_f32 v212, v164, v165
    v_mul_f32 v212, v212, v241
    v_add_f32 v212, v212, v160
    v_add_f32 v212, v212, v161
    v_add_f32 v212, v212, v162
    v_add_f32 v212, v212, v163
    v_add_f32 v213, v42, v43
    v_mul_f32 v213, v213, v241
    v_add_f32 v213, v213, v34
    v_add_f32 v213, v213, v35
    v_add_f32 v213, v213, v38
    v_add_f32 v213, v213, v39
    v_add_f32 v214, v172, v173
    v_mul_f32 v214, v214, v241
    v_add_f32 v214, v214, v168
    v_add_f32 v214, v214, v169
    v_add_f32 v214, v214, v170
    v_add_f32 v214, v214, v171
    v_add_f32 v215, v54, v55
    v_mul_f32 v215, v215, v241
    v_add_f32 v215, v215, v46
    v_add_f32 v215, v215, v47
    v_add_f32 v215, v215, v50
    v_add_f32 v215, v215, v51
    v_add_f32 v216, v180, v181
    v_mul_f32 v216, v216, v241
    v_add_f32 v216, v216, v176
    v_add_f32 v216, v216, v177
    v_add_f32 v216, v216, v178
    v_add_f32 v216, v216, v179
    v_add_f32 v217, v66, v67
    v_mul_f32 v217, v217, v241
    v_add_f32 v217, v217, v58
    v_add_f32 v217, v217, v59
    v_add_f32 v217, v217, v62
    v_add_f32 v217, v217, v63
    v_add_f32 v218, v188, v189
    v_mul_f32 v218, v218, v241
    v_add_f32 v218, v218, v184
    v_add_f32 v218, v218, v185
    v_add_f32 v218, v218, v186
    v_add_f32 v218, v218, v187
    v_add_f32 v219, v78, v79
    v_mul_f32 v219, v219, v241
    v_add_f32 v219, v219, v70
    v_add_f32 v219, v219, v71
    v_add_f32 v219, v219, v74
    v_add_f32 v219, v219, v75
    v_add_f32 v220, v196, v197
    v_mul_f32 v220, v220, v241
    v_add_f32 v220, v220, v192
    v_add_f32 v220, v220, v193
    v_add_f32 v220, v220, v194
    v_add_f32 v220, v220, v195
    v_add_f32 v221, v112, v113
    v_mul_f32 v221, v221, v241
    v_add_f32 v221, v221, v82
    v_add_f32 v221, v221, v83
    v_add_f32 v221, v221, v86
    v_add_f32 v221, v221, v87
    v_add_f32 v222, v204, v205
    v_mul_f32 v222, v222, v241
    v_add_f32 v222, v222, v200
    v_add_f32 v222, v222, v201
    v_add_f32 v222, v222, v202
    v_add_f32 v222, v222, v203
    v_add_f32 v223, v118, v119
    v_mul_f32 v223, v223, v241
    v_add_f32 v223, v223, v114
    v_add_f32 v223, v223, v115
    v_add_f32 v223, v223, v116
    v_add_f32 v223, v223, v117
    ds_bpermute_b32 v224, v242, v208
    ds_bpermute_b32 v225, v242, v209
    ds_bpermute_b32 v226, v242, v210
    ds_bpermute_b32 v227, v242, v211
    ds_bpermute_b32 v228, v242, v212
    ds_bpermute_b32 v229, v242, v213
    ds_bpermute_b32 v230, v242, v214
    ds_bpermute_b32 v231, v242, v215
    ds_bpermute_b32 v232, v242, v216
    ds_bpermute_b32 v233, v242, v217
    ds_bpermute_b32 v234, v242, v218
    ds_bpermute_b32 v235, v242, v219
    ds_bpermute_b32 v236, v242, v220
    ds_bpermute_b32 v237, v242, v221
    ds_bpermute_b32 v238, v242, v222
    ds_bpermute_b32 v239, v242, v223
    s_waitcnt lgkmcnt(0)
    v_add_f32 v208, v208, v224
    v_add_f32 v209, v209, v225
    v_add_f32 v210, v210, v226
    v_add_f32 v211, v211, v227
    v_add_f32 v212, v212, v228
    v_add_f32 v213, v213, v229
    v_add_f32 v214, v214, v230
    v_add_f32 v215, v215, v231
    v_add_f32 v216, v216, v232
    v_add_f32 v217, v217, v233
    v_add_f32 v218, v218, v234
    v_add_f32 v219, v219, v235
    v_add_f32 v220, v220, v236
    v_add_f32 v221, v221, v237
    v_add_f32 v222, v222, v238
    v_add_f32 v223, v223, v239
    ds_bpermute_b32 v224, v243, v208
    ds_bpermute_b32 v225, v243, v209
    ds_bpermute_b32 v226, v243, v210
    ds_bpermute_b32 v227, v243, v211
    ds_bpermute_b32 v228, v243, v212
    ds_bpermute_b32 v229, v243, v213
    ds_bpermute_b32 v230, v243, v214
    ds_bpermute_b32 v231, v243, v215
    ds_bpermute_b32 v232, v243, v216
    ds_bpermute_b32 v233, v243, v217
    ds_bpermute_b32 v234, v243, v218
    ds_bpermute_b32 v235, v243, v219
    ds_bpermute_b32 v236, v243, v220
    ds_bpermute_b32 v237, v243, v221
    ds_bpermute_b32 v238, v243, v222
    ds_bpermute_b32 v239, v243, v223
    s_waitcnt lgkmcnt(0)
    v_add_f32 v208, v208, v224
    v_add_f32 v209, v209, v225
    v_add_f32 v210, v210, v226
    v_add_f32 v211, v211, v227
    v_add_f32 v212, v212, v228
    v_add_f32 v213, v213, v229
    v_add_f32 v214, v214, v230
    v_add_f32 v215, v215, v231
    v_add_f32 v216, v216, v232
    v_add_f32 v217, v217, v233
    v_add_f32 v218, v218, v234
    v_add_f32 v219, v219, v235
    v_add_f32 v220, v220, v236
    v_add_f32 v221, v221, v237
    v_add_f32 v222, v222, v238
    v_add_f32 v223, v223, v239
    v_rcp_f32 v208, v208
    v_rcp_f32 v209, v209
    v_rcp_f32 v210, v210
    v_rcp_f32 v211, v211
    v_rcp_f32 v212, v212
    v_rcp_f32 v213, v213
    v_rcp_f32 v214, v214
    v_rcp_f32 v215, v215
    v_rcp_f32 v216, v216
    v_rcp_f32 v217, v217
    v_rcp_f32 v218, v218
    v_rcp_f32 v219, v219
    v_rcp_f32 v220, v220
    v_rcp_f32 v221, v221
    v_rcp_f32 v222, v222
    v_rcp_f32 v223, v223
    s_nop 0
    v_lshlrev_b32 v4, 4, v1
    v_and_b32 v5, 15, v1
    v_lshlrev_b32 v5, 3, v5
    s_lshl_b32 s60, s66, 4
    s_lshl_b32 s61, s52, 2
    s_add_u32 s60, s60, s61
    s_lshl_b32 s60, s60, 5
    s_add_u32 s60, s60, s65
    s_mul_i32 s60, s60, 1152
    v_and_b32 v6, 15, v1
    v_mul_u32_u24 v6, 160, v6
    v_lshrrev_b32 v7, 4, v1
    v_lshl_add_u32 v6, v7, 3, v6
    v_add_u32 v6, s62, v6
    v_mov_b32 v240, 0x3f80
    v_mul_f32 v144, v144, v208
    v_mul_f32 v10, v10, v209
    v_mul_f32 v145, v145, v208
    v_mul_f32 v11, v11, v209
    v_mul_f32 v146, v146, v208
    v_mul_f32 v14, v14, v209
    v_mul_f32 v147, v147, v208
    v_mul_f32 v15, v15, v209
    v_mul_f32 v148, v148, v208
    v_mul_f32 v18, v18, v209
    v_mul_f32 v149, v149, v208
    v_mul_f32 v19, v19, v209
    v_cvt_pk_bf16_f32 v224, v144, v145
    v_cvt_pk_bf16_f32 v225, v146, v147
    v_cvt_pk_bf16_f32 v226, v10, v11
    v_cvt_pk_bf16_f32 v227, v14, v15
    v_cvt_pk_bf16_f32 v228, v148, v149
    v_cvt_pk_bf16_f32 v229, v18, v19
    s_add_u32 s61, s60, 0
    buffer_store_dwordx4 v[224:227], v4, s[40:43], s61 offen sc1
    s_mov_b64 exec, 0xffff
    buffer_store_dwordx2 v[228:229], v5, s[40:43], s61 offen offset:1024
    s_mov_b64 exec, -1
    v_mul_f32 v152, v152, v210
    v_mul_f32 v22, v22, v211
    v_mul_f32 v153, v153, v210
    v_mul_f32 v23, v23, v211
    v_mul_f32 v154, v154, v210
    v_mul_f32 v26, v26, v211
    v_mul_f32 v155, v155, v210
    v_mul_f32 v27, v27, v211
    v_mul_f32 v156, v156, v210
    v_mul_f32 v30, v30, v211
    v_mul_f32 v157, v157, v210
    v_mul_f32 v31, v31, v211
    v_cvt_pk_bf16_f32 v232, v152, v153
    v_cvt_pk_bf16_f32 v233, v154, v155
    v_cvt_pk_bf16_f32 v234, v22, v23
    v_cvt_pk_bf16_f32 v235, v26, v27
    v_cvt_pk_bf16_f32 v236, v156, v157
    v_cvt_pk_bf16_f32 v237, v30, v31
    ds_write_b64 v6, v[232:233] offset:0
    ds_write_b64 v6, v[234:235] offset:32
    ds_write_b64 v6, v[20:21] offset:96
    v_mov_b32 v25, v240
    s_mov_b64 exec, 0xffff
    ds_write_b64 v6, v[236:237] offset:64
    ds_write_b64 v6, v[24:25] offset:128
    s_mov_b64 exec, -1
    v_mul_f32 v160, v160, v212
    v_mul_f32 v34, v34, v213
    v_mul_f32 v161, v161, v212
    v_mul_f32 v35, v35, v213
    v_mul_f32 v162, v162, v212
    v_mul_f32 v38, v38, v213
    v_mul_f32 v163, v163, v212
    v_mul_f32 v39, v39, v213
    v_mul_f32 v164, v164, v212
    v_mul_f32 v42, v42, v213
    v_mul_f32 v165, v165, v212
    v_mul_f32 v43, v43, v213
    v_cvt_pk_bf16_f32 v224, v160, v161
    v_cvt_pk_bf16_f32 v225, v162, v163
    v_cvt_pk_bf16_f32 v226, v34, v35
    v_cvt_pk_bf16_f32 v227, v38, v39
    v_cvt_pk_bf16_f32 v228, v164, v165
    v_cvt_pk_bf16_f32 v229, v42, v43
    s_add_u32 s61, s60, 36864
    buffer_store_dwordx4 v[224:227], v4, s[40:43], s61 offen sc1
    s_mov_b64 exec, 0xffff
    buffer_store_dwordx2 v[228:229], v5, s[40:43], s61 offen offset:1024
    s_mov_b64 exec, -1
    v_mul_f32 v168, v168, v214
    v_mul_f32 v46, v46, v215
    v_mul_f32 v169, v169, v214
    v_mul_f32 v47, v47, v215
    v_mul_f32 v170, v170, v214
    v_mul_f32 v50, v50, v215
    v_mul_f32 v171, v171, v214
    v_mul_f32 v51, v51, v215
    v_mul_f32 v172, v172, v214
    v_mul_f32 v54, v54, v215
    v_mul_f32 v173, v173, v214
    v_mul_f32 v55, v55, v215
    v_cvt_pk_bf16_f32 v232, v168, v169
    v_cvt_pk_bf16_f32 v233, v170, v171
    v_cvt_pk_bf16_f32 v234, v46, v47
    v_cvt_pk_bf16_f32 v235, v50, v51
    v_cvt_pk_bf16_f32 v236, v172, v173
    v_cvt_pk_bf16_f32 v237, v54, v55
    ds_write_b64 v6, v[232:233] offset:2560
    ds_write_b64 v6, v[234:235] offset:2592
    ds_write_b64 v6, v[40:41] offset:2656
    v_mov_b32 v45, v240
    s_mov_b64 exec, 0xffff
    ds_write_b64 v6, v[236:237] offset:2624
    ds_write_b64 v6, v[44:45] offset:2688
    s_mov_b64 exec, -1
    v_mul_f32 v176, v176, v216
    v_mul_f32 v58, v58, v217
    v_mul_f32 v177, v177, v216
    v_mul_f32 v59, v59, v217
    v_mul_f32 v178, v178, v216
    v_mul_f32 v62, v62, v217
    v_mul_f32 v179, v179, v216
    v_mul_f32 v63, v63, v217
    v_mul_f32 v180, v180, v216
    v_mul_f32 v66, v66, v217
    v_mul_f32 v181, v181, v216
    v_mul_f32 v67, v67, v217
    v_cvt_pk_bf16_f32 v224, v176, v177
    v_cvt_pk_bf16_f32 v225, v178, v179
    v_cvt_pk_bf16_f32 v226, v58, v59
    v_cvt_pk_bf16_f32 v227, v62, v63
    v_cvt_pk_bf16_f32 v228, v180, v181
    v_cvt_pk_bf16_f32 v229, v66, v67
    s_add_u32 s61, s60, 73728
    buffer_store_dwordx4 v[224:227], v4, s[40:43], s61 offen sc1
    s_mov_b64 exec, 0xffff
    buffer_store_dwordx2 v[228:229], v5, s[40:43], s61 offen offset:1024
    s_mov_b64 exec, -1
    v_mul_f32 v184, v184, v218
    v_mul_f32 v70, v70, v219
    v_mul_f32 v185, v185, v218
    v_mul_f32 v71, v71, v219
    v_mul_f32 v186, v186, v218
    v_mul_f32 v74, v74, v219
    v_mul_f32 v187, v187, v218
    v_mul_f32 v75, v75, v219
    v_mul_f32 v188, v188, v218
    v_mul_f32 v78, v78, v219
    v_mul_f32 v189, v189, v218
    v_mul_f32 v79, v79, v219
    v_cvt_pk_bf16_f32 v232, v184, v185
    v_cvt_pk_bf16_f32 v233, v186, v187
    v_cvt_pk_bf16_f32 v234, v70, v71
    v_cvt_pk_bf16_f32 v235, v74, v75
    v_cvt_pk_bf16_f32 v236, v188, v189
    v_cvt_pk_bf16_f32 v237, v78, v79
    ds_write_b64 v6, v[232:233] offset:5120
    ds_write_b64 v6, v[234:235] offset:5152
    ds_write_b64 v6, v[60:61] offset:5216
    v_mov_b32 v65, v240
    s_mov_b64 exec, 0xffff
    ds_write_b64 v6, v[236:237] offset:5184
    ds_write_b64 v6, v[64:65] offset:5248
    s_mov_b64 exec, -1
    v_mul_f32 v192, v192, v220
    v_mul_f32 v82, v82, v221
    v_mul_f32 v193, v193, v220
    v_mul_f32 v83, v83, v221
    v_mul_f32 v194, v194, v220
    v_mul_f32 v86, v86, v221
    v_mul_f32 v195, v195, v220
    v_mul_f32 v87, v87, v221
    v_mul_f32 v196, v196, v220
    v_mul_f32 v112, v112, v221
    v_mul_f32 v197, v197, v220
    v_mul_f32 v113, v113, v221
    v_cvt_pk_bf16_f32 v224, v192, v193
    v_cvt_pk_bf16_f32 v225, v194, v195
    v_cvt_pk_bf16_f32 v226, v82, v83
    v_cvt_pk_bf16_f32 v227, v86, v87
    v_cvt_pk_bf16_f32 v228, v196, v197
    v_cvt_pk_bf16_f32 v229, v112, v113
    s_add_u32 s61, s60, 110592
    buffer_store_dwordx4 v[224:227], v4, s[40:43], s61 offen sc1
    s_mov_b64 exec, 0xffff
    buffer_store_dwordx2 v[228:229], v5, s[40:43], s61 offen offset:1024
    s_mov_b64 exec, -1
    v_mul_f32 v200, v200, v222
    v_mul_f32 v114, v114, v223
    v_mul_f32 v201, v201, v222
    v_mul_f32 v115, v115, v223
    v_mul_f32 v202, v202, v222
    v_mul_f32 v116, v116, v223
    v_mul_f32 v203, v203, v222
    v_mul_f32 v117, v117, v223
    v_mul_f32 v204, v204, v222
    v_mul_f32 v118, v118, v223
    v_mul_f32 v205, v205, v222
    v_mul_f32 v119, v119, v223
    v_cvt_pk_bf16_f32 v232, v200, v201
    v_cvt_pk_bf16_f32 v233, v202, v203
    v_cvt_pk_bf16_f32 v234, v114, v115
    v_cvt_pk_bf16_f32 v235, v116, v117
    v_cvt_pk_bf16_f32 v236, v204, v205
    v_cvt_pk_bf16_f32 v237, v118, v119
    ds_write_b64 v6, v[232:233] offset:7680
    ds_write_b64 v6, v[234:235] offset:7712
    ds_write_b64 v6, v[80:81] offset:7776
    v_mov_b32 v85, v240
    s_mov_b64 exec, 0xffff
    ds_write_b64 v6, v[236:237] offset:7744
    ds_write_b64 v6, v[84:85] offset:7808
    s_mov_b64 exec, -1
    v_lshrrev_b32 v2, 4, v1
    v_lshlrev_b32 v2, 2, v2
    v_bfe_u32 v3, v1, 2, 2
    v_add_u32 v2, v2, v3
    v_mul_u32_u24 v2, 160, v2
    v_and_b32 v3, 3, v1
    v_lshl_add_u32 v2, v3, 3, v2
    v_add_u32 v2, s62, v2
    s_waitcnt lgkmcnt(0)
    ds_read_b64_tr_b16 v[144:145], v2 offset:0
    ds_read_b64_tr_b16 v[146:147], v2 offset:2560
    ds_read_b64_tr_b16 v[148:149], v2 offset:32
    ds_read_b64_tr_b16 v[150:151], v2 offset:2592
    ds_read_b64_tr_b16 v[152:153], v2 offset:64
    ds_read_b64_tr_b16 v[154:155], v2 offset:2624
    ds_read_b64_tr_b16 v[156:157], v2 offset:96
    ds_read_b64_tr_b16 v[158:159], v2 offset:2656
    ds_read_b64_tr_b16 v[160:161], v2 offset:128
    ds_read_b64_tr_b16 v[162:163], v2 offset:2688
    ds_read_b64_tr_b16 v[164:165], v2 offset:5120
    ds_read_b64_tr_b16 v[166:167], v2 offset:7680
    ds_read_b64_tr_b16 v[168:169], v2 offset:5152
    ds_read_b64_tr_b16 v[170:171], v2 offset:7712
    ds_read_b64_tr_b16 v[172:173], v2 offset:5184
    ds_read_b64_tr_b16 v[174:175], v2 offset:7744
    ds_read_b64_tr_b16 v[176:177], v2 offset:5216
    ds_read_b64_tr_b16 v[178:179], v2 offset:7776
    ds_read_b64_tr_b16 v[180:181], v2 offset:5248
    ds_read_b64_tr_b16 v[182:183], v2 offset:7808
    s_waitcnt lgkmcnt(0)
    v_mfma_f32_16x16x32_bf16 v[8:11], v[144:147], v[156:159], 0
    v_mfma_f32_16x16x32_bf16 v[12:15], v[144:147], v[160:163], 0
    v_mfma_f32_16x16x32_bf16 v[16:19], v[148:151], v[156:159], 0
    v_mfma_f32_16x16x32_bf16 v[20:23], v[148:151], v[160:163], 0
    v_mfma_f32_16x16x32_bf16 v[24:27], v[152:155], v[156:159], 0
    v_mfma_f32_16x16x32_bf16 v[28:31], v[152:155], v[160:163], 0
    v_mfma_f32_16x16x32_bf16 v[8:11], v[164:167], v[176:179], v[8:11]
    v_mfma_f32_16x16x32_bf16 v[12:15], v[164:167], v[180:183], v[12:15]
    v_mfma_f32_16x16x32_bf16 v[16:19], v[168:171], v[176:179], v[16:19]
    v_mfma_f32_16x16x32_bf16 v[20:23], v[168:171], v[180:183], v[20:23]
    v_mfma_f32_16x16x32_bf16 v[24:27], v[172:175], v[176:179], v[24:27]
    v_mfma_f32_16x16x32_bf16 v[28:31], v[172:175], v[180:183], v[28:31]
    s_mul_i32 s62, s52, 6144
    s_add_u32 s62, s62, 92416
    v_lshlrev_b32 v2, 4, v1
    v_add_u32 v3, s62, v2
    s_nop 6
    ds_write_b128 v3, v[8:11] offset:0
    ds_write_b128 v3, v[12:15] offset:1024
    ds_write_b128 v3, v[16:19] offset:2048
    ds_write_b128 v3, v[20:23] offset:3072
    ds_write_b128 v3, v[24:27] offset:4096
    ds_write_b128 v3, v[28:31] offset:5120
    s_waitcnt lgkmcnt(0)
    v_mov_b32 v3, 0
    v_mov_b32 v4, 1
    s_mov_b64 exec, 1
    ds_add_rtn_u32 v4, v3, v4 offset:10240
    s_waitcnt lgkmcnt(0)
    s_mov_b64 exec, -1
    v_readfirstlane_b32 s60, v4
    s_nop 3
    s_cmp_lg_u32 s60, 3
    s_cbranch_scc1 k1_kernel_fin
    v_add_u32 v3, 92416, v2
    ds_read_b128 v[32:35], v3 offset:0
    ds_read_b128 v[36:39], v3 offset:1024
    ds_read_b128 v[40:43], v3 offset:2048
    ds_read_b128 v[44:47], v3 offset:3072
    ds_read_b128 v[48:51], v3 offset:4096
    ds_read_b128 v[52:55], v3 offset:5120
    ds_read_b128 v[56:59], v3 offset:6144
    ds_read_b128 v[60:63], v3 offset:7168
    ds_read_b128 v[64:67], v3 offset:8192
    ds_read_b128 v[68:71], v3 offset:9216
    ds_read_b128 v[72:75], v3 offset:10240
    ds_read_b128 v[76:79], v3 offset:11264
    ds_read_b128 v[80:83], v3 offset:12288
    ds_read_b128 v[84:87], v3 offset:13312
    ds_read_b128 v[88:91], v3 offset:14336
    ds_read_b128 v[92:95], v3 offset:15360
    ds_read_b128 v[96:99], v3 offset:16384
    ds_read_b128 v[100:103], v3 offset:17408
    ds_read_b128 v[104:107], v3 offset:18432
    ds_read_b128 v[108:111], v3 offset:19456
    ds_read_b128 v[112:115], v3 offset:20480
    ds_read_b128 v[116:119], v3 offset:21504
    ds_read_b128 v[120:123], v3 offset:22528
    ds_read_b128 v[124:127], v3 offset:23552
    s_waitcnt lgkmcnt(0)
    v_add_f32 v8, v32, v56
    v_add_f32 v80, v80, v104
    v_add_f32 v9, v33, v57
    v_add_f32 v81, v81, v105
    v_add_f32 v10, v34, v58
    v_add_f32 v82, v82, v106
    v_add_f32 v11, v35, v59
    v_add_f32 v83, v83, v107
    v_add_f32 v12, v36, v60
    v_add_f32 v84, v84, v108
    v_add_f32 v13, v37, v61
    v_add_f32 v85, v85, v109
    v_add_f32 v14, v38, v62
    v_add_f32 v86, v86, v110
    v_add_f32 v15, v39, v63
    v_add_f32 v87, v87, v111
    v_add_f32 v16, v40, v64
    v_add_f32 v88, v88, v112
    v_add_f32 v17, v41, v65
    v_add_f32 v89, v89, v113
    v_add_f32 v18, v42, v66
    v_add_f32 v90, v90, v114
    v_add_f32 v19, v43, v67
    v_add_f32 v91, v91, v115
    v_add_f32 v20, v44, v68
    v_add_f32 v92, v92, v116
    v_add_f32 v21, v45, v69
    v_add_f32 v93, v93, v117
    v_add_f32 v22, v46, v70
    v_add_f32 v94, v94, v118
    v_add_f32 v23, v47, v71
    v_add_f32 v95, v95, v119
    v_add_f32 v24, v48, v72
    v_add_f32 v96, v96, v120
    v_add_f32 v25, v49, v73
    v_add_f32 v97, v97, v121
    v_add_f32 v26, v50, v74
    v_add_f32 v98, v98, v122
    v_add_f32 v27, v51, v75
    v_add_f32 v99, v99, v123
    v_add_f32 v28, v52, v76
    v_add_f32 v100, v100, v124
    v_add_f32 v29, v53, v77
    v_add_f32 v101, v101, v125
    v_add_f32 v30, v54, v78
    v_add_f32 v102, v102, v126
    v_add_f32 v31, v55, v79
    v_add_f32 v103, v103, v127
    v_add_f32 v8, v8, v80
    v_add_f32 v9, v9, v81
    v_add_f32 v10, v10, v82
    v_add_f32 v11, v11, v83
    v_add_f32 v12, v12, v84
    v_add_f32 v13, v13, v85
    v_add_f32 v14, v14, v86
    v_add_f32 v15, v15, v87
    v_add_f32 v16, v16, v88
    v_add_f32 v17, v17, v89
    v_add_f32 v18, v18, v90
    v_add_f32 v19, v19, v91
    v_add_f32 v20, v20, v92
    v_add_f32 v21, v21, v93
    v_add_f32 v22, v22, v94
    v_add_f32 v23, v23, v95
    v_add_f32 v24, v24, v96
    v_add_f32 v25, v25, v97
    v_add_f32 v26, v26, v98
    v_add_f32 v27, v27, v99
    v_add_f32 v28, v28, v100
    v_add_f32 v29, v29, v101
    v_add_f32 v30, v30, v102
    v_add_f32 v31, v31, v103
    s_lshl_b32 s60, s65, 3
    s_add_u32 s60, s60, s66
    s_mul_i32 s60, s60, 6144
    s_add_u32 s61, s60, 0
    buffer_store_dwordx4 v[8:11], v2, s[44:47], s61 offen sc1
    s_add_u32 s61, s60, 1024
    buffer_store_dwordx4 v[12:15], v2, s[44:47], s61 offen sc1
    s_add_u32 s61, s60, 2048
    buffer_store_dwordx4 v[16:19], v2, s[44:47], s61 offen sc1
    s_add_u32 s61, s60, 3072
    buffer_store_dwordx4 v[20:23], v2, s[44:47], s61 offen sc1
    s_add_u32 s61, s60, 4096
    buffer_store_dwordx4 v[24:27], v2, s[44:47], s61 offen sc1
    s_add_u32 s61, s60, 5120
    buffer_store_dwordx4 v[28:31], v2, s[44:47], s61 offen sc1
    s_waitcnt vmcnt(0)
    s_mov_b32 s28, s24
    s_and_b32 s29, s25, 0xffff
    s_mov_b32 s30, 256
    s_mov_b32 s31, 0x00020000
    s_lshl_b32 s60, s65, 2
    v_mov_b32 v3, s60
    v_mov_b32 v4, 1
    s_mov_b64 exec, 1
    buffer_atomic_add v4, v3, s[28:31], 0 offen sc0
    s_waitcnt vmcnt(0)
    s_mov_b64 exec, -1
    v_readfirstlane_b32 s60, v4
    s_nop 3
    s_cmp_lg_u32 s60, 7
    s_cbranch_scc1 k1_kernel_fin
    s_mul_i32 s60, s65, 49152
    s_add_u32 s61, s60, 0
    buffer_load_dwordx4 v[32:35], v2, s[44:47], s61 offen sc1
    s_add_u32 s61, s60, 1024
    buffer_load_dwordx4 v[36:39], v2, s[44:47], s61 offen sc1
    s_add_u32 s61, s60, 2048
    buffer_load_dwordx4 v[40:43], v2, s[44:47], s61 offen sc1
    s_add_u32 s61, s60, 3072
    buffer_load_dwordx4 v[44:47], v2, s[44:47], s61 offen sc1
    s_add_u32 s61, s60, 4096
    buffer_load_dwordx4 v[48:51], v2, s[44:47], s61 offen sc1
    s_add_u32 s61, s60, 5120
    buffer_load_dwordx4 v[52:55], v2, s[44:47], s61 offen sc1
    s_add_u32 s61, s60, 6144
    buffer_load_dwordx4 v[56:59], v2, s[44:47], s61 offen sc1
    s_add_u32 s61, s60, 7168
    buffer_load_dwordx4 v[60:63], v2, s[44:47], s61 offen sc1
    s_add_u32 s61, s60, 8192
    buffer_load_dwordx4 v[64:67], v2, s[44:47], s61 offen sc1
    s_add_u32 s61, s60, 9216
    buffer_load_dwordx4 v[68:71], v2, s[44:47], s61 offen sc1
    s_add_u32 s61, s60, 10240
    buffer_load_dwordx4 v[72:75], v2, s[44:47], s61 offen sc1
    s_add_u32 s61, s60, 11264
    buffer_load_dwordx4 v[76:79], v2, s[44:47], s61 offen sc1
    s_add_u32 s61, s60, 12288
    buffer_load_dwordx4 v[80:83], v2, s[44:47], s61 offen sc1
    s_add_u32 s61, s60, 13312
    buffer_load_dwordx4 v[84:87], v2, s[44:47], s61 offen sc1
    s_add_u32 s61, s60, 14336
    buffer_load_dwordx4 v[88:91], v2, s[44:47], s61 offen sc1
    s_add_u32 s61, s60, 15360
    buffer_load_dwordx4 v[92:95], v2, s[44:47], s61 offen sc1
    s_add_u32 s61, s60, 16384
    buffer_load_dwordx4 v[96:99], v2, s[44:47], s61 offen sc1
    s_add_u32 s61, s60, 17408
    buffer_load_dwordx4 v[100:103], v2, s[44:47], s61 offen sc1
    s_add_u32 s61, s60, 18432
    buffer_load_dwordx4 v[104:107], v2, s[44:47], s61 offen sc1
    s_add_u32 s61, s60, 19456
    buffer_load_dwordx4 v[108:111], v2, s[44:47], s61 offen sc1
    s_add_u32 s61, s60, 20480
    buffer_load_dwordx4 v[112:115], v2, s[44:47], s61 offen sc1
    s_add_u32 s61, s60, 21504
    buffer_load_dwordx4 v[116:119], v2, s[44:47], s61 offen sc1
    s_add_u32 s61, s60, 22528
    buffer_load_dwordx4 v[120:123], v2, s[44:47], s61 offen sc1
    s_add_u32 s61, s60, 23552
    buffer_load_dwordx4 v[124:127], v2, s[44:47], s61 offen sc1
    s_add_u32 s61, s60, 24576
    buffer_load_dwordx4 v[128:131], v2, s[44:47], s61 offen sc1
    s_add_u32 s61, s60, 25600
    buffer_load_dwordx4 v[132:135], v2, s[44:47], s61 offen sc1
    s_add_u32 s61, s60, 26624
    buffer_load_dwordx4 v[136:139], v2, s[44:47], s61 offen sc1
    s_add_u32 s61, s60, 27648
    buffer_load_dwordx4 v[140:143], v2, s[44:47], s61 offen sc1
    s_add_u32 s61, s60, 28672
    buffer_load_dwordx4 v[144:147], v2, s[44:47], s61 offen sc1
    s_add_u32 s61, s60, 29696
    buffer_load_dwordx4 v[148:151], v2, s[44:47], s61 offen sc1
    s_add_u32 s61, s60, 30720
    buffer_load_dwordx4 v[152:155], v2, s[44:47], s61 offen sc1
    s_add_u32 s61, s60, 31744
    buffer_load_dwordx4 v[156:159], v2, s[44:47], s61 offen sc1
    s_add_u32 s61, s60, 32768
    buffer_load_dwordx4 v[160:163], v2, s[44:47], s61 offen sc1
    s_add_u32 s61, s60, 33792
    buffer_load_dwordx4 v[164:167], v2, s[44:47], s61 offen sc1
    s_add_u32 s61, s60, 34816
    buffer_load_dwordx4 v[168:171], v2, s[44:47], s61 offen sc1
    s_add_u32 s61, s60, 35840
    buffer_load_dwordx4 v[172:175], v2, s[44:47], s61 offen sc1
    s_add_u32 s61, s60, 36864
    buffer_load_dwordx4 v[176:179], v2, s[44:47], s61 offen sc1
    s_add_u32 s61, s60, 37888
    buffer_load_dwordx4 v[180:183], v2, s[44:47], s61 offen sc1
    s_add_u32 s61, s60, 38912
    buffer_load_dwordx4 v[184:187], v2, s[44:47], s61 offen sc1
    s_add_u32 s61, s60, 39936
    buffer_load_dwordx4 v[188:191], v2, s[44:47], s61 offen sc1
    s_add_u32 s61, s60, 40960
    buffer_load_dwordx4 v[192:195], v2, s[44:47], s61 offen sc1
    s_add_u32 s61, s60, 41984
    buffer_load_dwordx4 v[196:199], v2, s[44:47], s61 offen sc1
    s_add_u32 s61, s60, 43008
    buffer_load_dwordx4 v[200:203], v2, s[44:47], s61 offen sc1
    s_add_u32 s61, s60, 44032
    buffer_load_dwordx4 v[204:207], v2, s[44:47], s61 offen sc1
    s_add_u32 s61, s60, 45056
    buffer_load_dwordx4 v[208:211], v2, s[44:47], s61 offen sc1
    s_add_u32 s61, s60, 46080
    buffer_load_dwordx4 v[212:215], v2, s[44:47], s61 offen sc1
    s_add_u32 s61, s60, 47104
    buffer_load_dwordx4 v[216:219], v2, s[44:47], s61 offen sc1
    s_add_u32 s61, s60, 48128
    buffer_load_dwordx4 v[220:223], v2, s[44:47], s61 offen sc1
    s_waitcnt vmcnt(42)
    v_mov_b32 v8, v32
    v_mov_b32 v9, v33
    v_mov_b32 v10, v34
    v_mov_b32 v11, v35
    v_mov_b32 v12, v36
    v_mov_b32 v13, v37
    v_mov_b32 v14, v38
    v_mov_b32 v15, v39
    v_mov_b32 v16, v40
    v_mov_b32 v17, v41
    v_mov_b32 v18, v42
    v_mov_b32 v19, v43
    v_mov_b32 v20, v44
    v_mov_b32 v21, v45
    v_mov_b32 v22, v46
    v_mov_b32 v23, v47
    v_mov_b32 v24, v48
    v_mov_b32 v25, v49
    v_mov_b32 v26, v50
    v_mov_b32 v27, v51
    v_mov_b32 v28, v52
    v_mov_b32 v29, v53
    v_mov_b32 v30, v54
    v_mov_b32 v31, v55
    s_waitcnt vmcnt(36)
    v_add_f32 v8, v8, v56
    v_add_f32 v9, v9, v57
    v_add_f32 v10, v10, v58
    v_add_f32 v11, v11, v59
    v_add_f32 v12, v12, v60
    v_add_f32 v13, v13, v61
    v_add_f32 v14, v14, v62
    v_add_f32 v15, v15, v63
    v_add_f32 v16, v16, v64
    v_add_f32 v17, v17, v65
    v_add_f32 v18, v18, v66
    v_add_f32 v19, v19, v67
    v_add_f32 v20, v20, v68
    v_add_f32 v21, v21, v69
    v_add_f32 v22, v22, v70
    v_add_f32 v23, v23, v71
    v_add_f32 v24, v24, v72
    v_add_f32 v25, v25, v73
    v_add_f32 v26, v26, v74
    v_add_f32 v27, v27, v75
    v_add_f32 v28, v28, v76
    v_add_f32 v29, v29, v77
    v_add_f32 v30, v30, v78
    v_add_f32 v31, v31, v79
    s_waitcnt vmcnt(30)
    v_add_f32 v8, v8, v80
    v_add_f32 v9, v9, v81
    v_add_f32 v10, v10, v82
    v_add_f32 v11, v11, v83
    v_add_f32 v12, v12, v84
    v_add_f32 v13, v13, v85
    v_add_f32 v14, v14, v86
    v_add_f32 v15, v15, v87
    v_add_f32 v16, v16, v88
    v_add_f32 v17, v17, v89
    v_add_f32 v18, v18, v90
    v_add_f32 v19, v19, v91
    v_add_f32 v20, v20, v92
    v_add_f32 v21, v21, v93
    v_add_f32 v22, v22, v94
    v_add_f32 v23, v23, v95
    v_add_f32 v24, v24, v96
    v_add_f32 v25, v25, v97
    v_add_f32 v26, v26, v98
    v_add_f32 v27, v27, v99
    v_add_f32 v28, v28, v100
    v_add_f32 v29, v29, v101
    v_add_f32 v30, v30, v102
    v_add_f32 v31, v31, v103
    s_waitcnt vmcnt(24)
    v_add_f32 v8, v8, v104
    v_add_f32 v9, v9, v105
    v_add_f32 v10, v10, v106
    v_add_f32 v11, v11, v107
    v_add_f32 v12, v12, v108
    v_add_f32 v13, v13, v109
    v_add_f32 v14, v14, v110
    v_add_f32 v15, v15, v111
    v_add_f32 v16, v16, v112
    v_add_f32 v17, v17, v113
    v_add_f32 v18, v18, v114
    v_add_f32 v19, v19, v115
    v_add_f32 v20, v20, v116
    v_add_f32 v21, v21, v117
    v_add_f32 v22, v22, v118
    v_add_f32 v23, v23, v119
    v_add_f32 v24, v24, v120
    v_add_f32 v25, v25, v121
    v_add_f32 v26, v26, v122
    v_add_f32 v27, v27, v123
    v_add_f32 v28, v28, v124
    v_add_f32 v29, v29, v125
    v_add_f32 v30, v30, v126
    v_add_f32 v31, v31, v127
    s_waitcnt vmcnt(18)
    v_add_f32 v8, v8, v128
    v_add_f32 v9, v9, v129
    v_add_f32 v10, v10, v130
    v_add_f32 v11, v11, v131
    v_add_f32 v12, v12, v132
    v_add_f32 v13, v13, v133
    v_add_f32 v14, v14, v134
    v_add_f32 v15, v15, v135
    v_add_f32 v16, v16, v136
    v_add_f32 v17, v17, v137
    v_add_f32 v18, v18, v138
    v_add_f32 v19, v19, v139
    v_add_f32 v20, v20, v140
    v_add_f32 v21, v21, v141
    v_add_f32 v22, v22, v142
    v_add_f32 v23, v23, v143
    v_add_f32 v24, v24, v144
    v_add_f32 v25, v25, v145
    v_add_f32 v26, v26, v146
    v_add_f32 v27, v27, v147
    v_add_f32 v28, v28, v148
    v_add_f32 v29, v29, v149
    v_add_f32 v30, v30, v150
    v_add_f32 v31, v31, v151
    s_waitcnt vmcnt(12)
    v_add_f32 v8, v8, v152
    v_add_f32 v9, v9, v153
    v_add_f32 v10, v10, v154
    v_add_f32 v11, v11, v155
    v_add_f32 v12, v12, v156
    v_add_f32 v13, v13, v157
    v_add_f32 v14, v14, v158
    v_add_f32 v15, v15, v159
    v_add_f32 v16, v16, v160
    v_add_f32 v17, v17, v161
    v_add_f32 v18, v18, v162
    v_add_f32 v19, v19, v163
    v_add_f32 v20, v20, v164
    v_add_f32 v21, v21, v165
    v_add_f32 v22, v22, v166
    v_add_f32 v23, v23, v167
    v_add_f32 v24, v24, v168
    v_add_f32 v25, v25, v169
    v_add_f32 v26, v26, v170
    v_add_f32 v27, v27, v171
    v_add_f32 v28, v28, v172
    v_add_f32 v29, v29, v173
    v_add_f32 v30, v30, v174
    v_add_f32 v31, v31, v175
    s_waitcnt vmcnt(6)
    v_add_f32 v8, v8, v176
    v_add_f32 v9, v9, v177
    v_add_f32 v10, v10, v178
    v_add_f32 v11, v11, v179
    v_add_f32 v12, v12, v180
    v_add_f32 v13, v13, v181
    v_add_f32 v14, v14, v182
    v_add_f32 v15, v15, v183
    v_add_f32 v16, v16, v184
    v_add_f32 v17, v17, v185
    v_add_f32 v18, v18, v186
    v_add_f32 v19, v19, v187
    v_add_f32 v20, v20, v188
    v_add_f32 v21, v21, v189
    v_add_f32 v22, v22, v190
    v_add_f32 v23, v23, v191
    v_add_f32 v24, v24, v192
    v_add_f32 v25, v25, v193
    v_add_f32 v26, v26, v194
    v_add_f32 v27, v27, v195
    v_add_f32 v28, v28, v196
    v_add_f32 v29, v29, v197
    v_add_f32 v30, v30, v198
    v_add_f32 v31, v31, v199
    s_waitcnt vmcnt(0)
    v_add_f32 v8, v8, v200
    v_add_f32 v9, v9, v201
    v_add_f32 v10, v10, v202
    v_add_f32 v11, v11, v203
    v_add_f32 v12, v12, v204
    v_add_f32 v13, v13, v205
    v_add_f32 v14, v14, v206
    v_add_f32 v15, v15, v207
    v_add_f32 v16, v16, v208
    v_add_f32 v17, v17, v209
    v_add_f32 v18, v18, v210
    v_add_f32 v19, v19, v211
    v_add_f32 v20, v20, v212
    v_add_f32 v21, v21, v213
    v_add_f32 v22, v22, v214
    v_add_f32 v23, v23, v215
    v_add_f32 v24, v24, v216
    v_add_f32 v25, v25, v217
    v_add_f32 v26, v26, v218
    v_add_f32 v27, v27, v219
    v_add_f32 v28, v28, v220
    v_add_f32 v29, v29, v221
    v_add_f32 v30, v30, v222
    v_add_f32 v31, v31, v223
    s_mul_i32 s60, s65, 3072
    v_cvt_pk_bf16_f32 v8, v8, v9
    v_cvt_pk_bf16_f32 v9, v10, v11
    v_cvt_pk_bf16_f32 v10, v12, v13
    v_cvt_pk_bf16_f32 v11, v14, v15
    buffer_store_dwordx4 v[8:11], v2, s[48:51], s60 offen offset:0 sc1
    v_cvt_pk_bf16_f32 v16, v16, v17
    v_cvt_pk_bf16_f32 v17, v18, v19
    v_cvt_pk_bf16_f32 v18, v20, v21
    v_cvt_pk_bf16_f32 v19, v22, v23
    buffer_store_dwordx4 v[16:19], v2, s[48:51], s60 offen offset:1024 sc1
    v_cvt_pk_bf16_f32 v24, v24, v25
    v_cvt_pk_bf16_f32 v25, v26, v27
    v_cvt_pk_bf16_f32 v26, v28, v29
    v_cvt_pk_bf16_f32 v27, v30, v31
    buffer_store_dwordx4 v[24:27], v2, s[48:51], s60 offen offset:2048 sc1
k1_kernel_fin:
k1_kernel_end:
    s_endpgm
.globl k2_kernel
.p2align 8
.type k2_kernel,@function
k2_kernel:
    s_cmp_ge_u32 s2, 256
    s_cbranch_scc1 k2_kernel_end
    s_load_dwordx16 s[4:19], s[0:1], 0
    s_load_dwordx8 s[20:27], s[0:1], 64
    v_and_b32 v1, 63, v0
    v_lshrrev_b32 v2, 6, v0
    s_nop 0
    v_readfirstlane_b32 s73, v2
    s_and_b32 s52, s73, 3
    s_and_b32 s60, s2, 7
    s_lshr_b32 s61, s2, 3
    s_lshl_b32 s57, s60, 3
    s_lshr_b32 s62, s61, 2
    s_add_u32 s57, s57, s62
    s_and_b32 s65, s61, 3
    s_mul_i32 s58, s65, 144
    s_waitcnt lgkmcnt(0)
    s_mov_b32 s28, s26
    s_and_b32 s29, s27, 0xffff
    s_mov_b32 s30, 4719104
    s_mov_b32 s31, 0x00020000
    s_add_u32 s32, s26, 70254592
    s_addc_u32 s33, s27, 0
    s_and_b32 s33, s33, 0xffff
    s_mov_b32 s34, 663552
    s_mov_b32 s35, 0x00020000
    s_add_u32 s36, s26, 12582912
    s_addc_u32 s37, s27, 0
    s_and_b32 s37, s37, 0xffff
    s_mov_b32 s38, 98304
    s_mov_b32 s39, 0x00020000
    s_add_u32 s40, s26, 13631488
    s_addc_u32 s41, s27, 0
    s_and_b32 s41, s41, 0xffff
    s_mov_b32 s42, 2359296
    s_mov_b32 s43, 0x00020000
    s_mov_b32 s44, s4
    s_and_b32 s45, s5, 0xffff
    s_mov_b32 s46, 2359296
    s_mov_b32 s47, 0x00020000
    s_add_u32 s48, s26, 60817408
    s_addc_u32 s49, s27, 0
    s_and_b32 s49, s49, 0xffff
    s_mov_b32 s50, 131072
    s_mov_b32 s51, 0x00020000
    s_mul_i32 s64, s65, 165888
    s_mul_i32 s53, s52, 4608
    s_add_u32 s53, s53, 37376
    s_lshl_b32 s60, s52, 4
    v_add_u32 v2, 0, v1
    v_mul_u32_u24 v3, 3641, v2
    v_lshrrev_b32 v3, 16, v3
    v_mul_u32_u24 v4, 18, v3
    v_sub_u32 v2, v2, v4
    v_and_b32 v4, 3, v3
    v_and_b32 v5, 4, v3
    v_lshl_or_b32 v4, v5, 1, v4
    v_and_b32 v5, 8, v3
    v_lshrrev_b32 v5, 1, v5
    v_or_b32 v4, v4, v5
    v_add_u32 v4, s60, v4
    s_mov_b32 s61, 288
    v_mul_lo_u32 v4, v4, s61
    v_lshlrev_b32 v2, 4, v2
    v_add_u32 v8, v4, v2
    v_add_u32 v8, s64, v8
    v_add_u32 v2, 64, v1
    v_mul_u32_u24 v3, 3641, v2
    v_lshrrev_b32 v3, 16, v3
    v_mul_u32_u24 v4, 18, v3
    v_sub_u32 v2, v2, v4
    v_and_b32 v4, 3, v3
    v_and_b32 v5, 4, v3
    v_lshl_or_b32 v4, v5, 1, v4
    v_and_b32 v5, 8, v3
    v_lshrrev_b32 v5, 1, v5
    v_or_b32 v4, v4, v5
    v_add_u32 v4, s60, v4
    s_mov_b32 s61, 288
    v_mul_lo_u32 v4, v4, s61
    v_lshlrev_b32 v2, 4, v2
    v_add_u32 v9, v4, v2
    v_add_u32 v9, s64, v9
    v_add_u32 v2, 128, v1
    v_mul_u32_u24 v3, 3641, v2
    v_lshrrev_b32 v3, 16, v3
    v_mul_u32_u24 v4, 18, v3
    v_sub_u32 v2, v2, v4
    v_and_b32 v4, 3, v3
    v_and_b32 v5, 4, v3
    v_lshl_or_b32 v4, v5, 1, v4
    v_and_b32 v5, 8, v3
    v_lshrrev_b32 v5, 1, v5
    v_or_b32 v4, v4, v5
    v_add_u32 v4, s60, v4
    s_mov_b32 s61, 288
    v_mul_lo_u32 v4, v4, s61
    v_lshlrev_b32 v2, 4, v2
    v_add_u32 v10, v4, v2
    v_add_u32 v10, s64, v10
    v_add_u32 v2, 192, v1
    v_mul_u32_u24 v3, 3641, v2
    v_lshrrev_b32 v3, 16, v3
    v_mul_u32_u24 v4, 18, v3
    v_sub_u32 v2, v2, v4
    v_and_b32 v4, 3, v3
    v_and_b32 v5, 4, v3
    v_lshl_or_b32 v4, v5, 1, v4
    v_and_b32 v5, 8, v3
    v_lshrrev_b32 v5, 1, v5
    v_or_b32 v4, v4, v5
    v_add_u32 v4, s60, v4
    s_mov_b32 s61, 288
    v_mul_lo_u32 v4, v4, s61
    v_lshlrev_b32 v2, 4, v2
    v_add_u32 v11, v4, v2
    v_add_u32 v11, s64, v11
    v_add_u32 v2, 256, v1
    v_mul_u32_u24 v3, 3641, v2
    v_lshrrev_b32 v3, 16, v3
    v_mul_u32_u24 v4, 18, v3
    v_sub_u32 v2, v2, v4
    v_and_b32 v4, 3, v3
    v_and_b32 v5, 4, v3
    v_lshl_or_b32 v4, v5, 1, v4
    v_and_b32 v5, 8, v3
    v_lshrrev_b32 v5, 1, v5
    v_or_b32 v4, v4, v5
    v_add_u32 v4, s60, v4
    s_mov_b32 s61, 288
    v_mul_lo_u32 v4, v4, s61
    v_lshlrev_b32 v2, 4, v2
    v_add_u32 v12, v4, v2
    v_add_u32 v12, s64, v12
    v_lshrrev_b32 v2, 5, v1
    v_lshlrev_b32 v2, 4, v2
    v_bfe_u32 v3, v1, 4, 1
    v_lshl_or_b32 v2, v3, 2, v2
    v_bfe_u32 v3, v1, 2, 2
    v_add_u32 v2, v2, v3
    v_mul_u32_u24 v2, 288, v2
    v_and_b32 v3, 3, v1
    v_lshl_add_u32 v2, v3, 3, v2
    v_add_u32 v13, 37376, v2
    v_add_u32 v14, 55808, v2
    v_add_u32 v15, 74240, v2
    v_add_u32 v16, 92672, v2
    s_lshl_b32 s64, s58, 1
    s_lshr_b32 s66, s52, 1
    s_lshl_b32 s60, s66, 7
    v_add_u32 v13, s60, v13
    v_add_u32 v14, s60, v14
    v_add_u32 v15, s60, v15
    v_add_u32 v16, s60, v16
    s_mov_b32 s55, 0
    s_mov_b32 s54, 0
    v_lshlrev_b32 v236, 4, v1
    v_and_b32 v237, 15, v1
    v_lshlrev_b32 v237, 3, v237
    v_lshlrev_b32 v238, 3, v1
    v_and_b32 v242, 15, v1
    v_mul_u32_u24 v242, 1168, v242
    v_lshrrev_b32 v243, 4, v1
    v_lshl_add_u32 v239, v243, 3, v242
    s_mul_i32 s60, s73, 144
    v_add_u32 v239, s60, v239
    v_lshl_add_u32 v240, v243, 4, v242
    s_and_b32 s60, s52, 1
    s_mul_i32 s60, s60, 18688
    v_add_u32 v240, s60, v240
    s_mul_i32 s67, s57, 73728
    s_mul_i32 s60, s73, 4608
    s_add_u32 s67, s67, s60
    s_mul_i32 s68, s73, 12288
    s_cmp_ge_u32 s73, 4
    s_cbranch_scc1 k2_kernel_noring
    s_add_u32 m0, s53, 0
    s_nop 0
    buffer_load_dwordx4 v8, s[32:35], s54 offen lds
    s_add_u32 m0, s53, 1024
    s_nop 0
    buffer_load_dwordx4 v9, s[32:35], s54 offen lds
    s_add_u32 m0, s53, 2048
    s_nop 0
    buffer_load_dwordx4 v10, s[32:35], s54 offen lds
    s_add_u32 m0, s53, 3072
    s_nop 0
    buffer_load_dwordx4 v11, s[32:35], s54 offen lds
    s_add_u32 m0, s53, 4096
    s_nop 0
    s_mov_b32 exec_hi, 0
    buffer_load_dwordx4 v12, s[32:35], s54 offen lds
    s_mov_b32 exec_hi, -1
    s_add_u32 s54, s54, 18432
    s_add_u32 s55, s55, 128
    s_add_u32 m0, s53, 18432
    s_nop 0
    buffer_load_dwordx4 v8, s[32:35], s54 offen lds
    s_add_u32 m0, s53, 19456
    s_nop 0
    buffer_load_dwordx4 v9, s[32:35], s54 offen lds
    s_add_u32 m0, s53, 20480
    s_nop 0
    buffer_load_dwordx4 v10, s[32:35], s54 offen lds
    s_add_u32 m0, s53, 21504
    s_nop 0
    buffer_load_dwordx4 v11, s[32:35], s54 offen lds
    s_add_u32 m0, s53, 22528
    s_nop 0
    s_mov_b32 exec_hi, 0
    buffer_load_dwordx4 v12, s[32:35], s54 offen lds
    s_mov_b32 exec_hi, -1
    s_add_u32 s54, s54, 18432
    s_add_u32 s55, s55, 128
    s_add_u32 m0, s53, 36864
    s_nop 0
    buffer_load_dwordx4 v8, s[32:35], s54 offen lds
    s_add_u32 m0, s53, 37888
    s_nop 0
    buffer_load_dwordx4 v9, s[32:35], s54 offen lds
    s_add_u32 m0, s53, 38912
    s_nop 0
    buffer_load_dwordx4 v10, s[32:35], s54 offen lds
    s_add_u32 m0, s53, 39936
    s_nop 0
    buffer_load_dwordx4 v11, s[32:35], s54 offen lds
    s_add_u32 m0, s53, 40960
    s_nop 0
    s_mov_b32 exec_hi, 0
    buffer_load_dwordx4 v12, s[32:35], s54 offen lds
    s_mov_b32 exec_hi, -1
    s_add_u32 s54, s54, 18432
    s_add_u32 s55, s55, 128
    s_add_u32 m0, s53, 55296
    s_nop 0
    buffer_load_dwordx4 v8, s[32:35], s54 offen lds
    s_add_u32 m0, s53, 56320
    s_nop 0
    buffer_load_dwordx4 v9, s[32:35], s54 offen lds
    s_add_u32 m0, s53, 57344
    s_nop 0
    buffer_load_dwordx4 v10, s[32:35], s54 offen lds
    s_add_u32 m0, s53, 58368
    s_nop 0
    buffer_load_dwordx4 v11, s[32:35], s54 offen lds
    s_add_u32 m0, s53, 59392
    s_nop 0
    s_mov_b32 exec_hi, 0
    buffer_load_dwordx4 v12, s[32:35], s54 offen lds
    s_mov_b32 exec_hi, -1
    s_add_u32 s54, s54, 18432
    s_add_u32 s55, s55, 128
k2_kernel_noring:
    buffer_load_dwordx4 v[20:23], v236, s[36:39], s68 offen offset:0
    buffer_load_dwordx4 v[24:27], v236, s[36:39], s68 offen offset:1024
    buffer_load_dwordx4 v[28:31], v236, s[36:39], s68 offen offset:2048
    s_add_u32 s60, s67, 0
    buffer_load_dwordx4 v[32:35], v236, s[28:31], s60 offen
    buffer_load_dwordx2 v[36:37], v237, s[28:31], s60 offen offset:1024
    s_add_u32 s60, s67, 36864
    buffer_load_dwordx4 v[38:41], v236, s[28:31], s60 offen
    buffer_load_dwordx2 v[42:43], v237, s[28:31], s60 offen offset:1024
    s_add_u32 s68, s68, 3072
    s_add_u32 s67, s67, 1152
    buffer_load_dwordx4 v[44:47], v236, s[36:39], s68 offen offset:0
    buffer_load_dwordx4 v[48:51], v236, s[36:39], s68 offen offset:1024
    buffer_load_dwordx4 v[52:55], v236, s[36:39], s68 offen offset:2048
    s_add_u32 s60, s67, 0
    buffer_load_dwordx4 v[56:59], v236, s[28:31], s60 offen
    buffer_load_dwordx2 v[60:61], v237, s[28:31], s60 offen offset:1024
    s_add_u32 s60, s67, 36864
    buffer_load_dwordx4 v[62:65], v236, s[28:31], s60 offen
    buffer_load_dwordx2 v[66:67], v237, s[28:31], s60 offen offset:1024
    s_add_u32 s68, s68, 3072
    s_add_u32 s67, s67, 1152
    buffer_load_dwordx4 v[68:71], v236, s[36:39], s68 offen offset:0
    buffer_load_dwordx4 v[72:75], v236, s[36:39], s68 offen offset:1024
    buffer_load_dwordx4 v[76:79], v236, s[36:39], s68 offen offset:2048
    s_add_u32 s60, s67, 0
    buffer_load_dwordx4 v[80:83], v236, s[28:31], s60 offen
    buffer_load_dwordx2 v[84:85], v237, s[28:31], s60 offen offset:1024
    s_add_u32 s60, s67, 36864
    buffer_load_dwordx4 v[86:89], v236, s[28:31], s60 offen
    buffer_load_dwordx2 v[90:91], v237, s[28:31], s60 offen offset:1024
    s_add_u32 s68, s68, 3072
    s_add_u32 s67, s67, 1152
    buffer_load_dwordx4 v[92:95], v236, s[36:39], s68 offen offset:0
    buffer_load_dwordx4 v[96:99], v236, s[36:39], s68 offen offset:1024
    buffer_load_dwordx4 v[100:103], v236, s[36:39], s68 offen offset:2048
    s_add_u32 s60, s67, 0
    buffer_load_dwordx4 v[104:107], v236, s[28:31], s60 offen
    buffer_load_dwordx2 v[108:109], v237, s[28:31], s60 offen offset:1024
    s_add_u32 s60, s67, 36864
    buffer_load_dwordx4 v[110:113], v236, s[28:31], s60 offen
    buffer_load_dwordx2 v[114:115], v237, s[28:31], s60 offen offset:1024
    s_add_u32 s68, s68, 3072
    s_add_u32 s67, s67, 1152
    s_waitcnt vmcnt(21)
    v_mov_b32_dpp v250, v22 row_newbcast:2 row_mask:0xf bank_mask:0xf
    v_mov_b32_dpp v251, v23 row_newbcast:2 row_mask:0xf bank_mask:0xf
    v_mov_b32_dpp v252, v26 row_newbcast:2 row_mask:0xf bank_mask:0xf
    v_mov_b32_dpp v253, v27 row_newbcast:2 row_mask:0xf bank_mask:0xf
    v_mov_b32_dpp v254, v30 row_newbcast:2 row_mask:0xf bank_mask:0xf
    v_mov_b32_dpp v255, v31 row_newbcast:2 row_mask:0xf bank_mask:0xf
    s_nop 1
    v_mfma_f32_16x16x16_bf16 v[212:215], v[20:21], v[32:33], 0
    v_mfma_f32_16x16x16_bf16 v[216:219], v[22:23], v[32:33], 0
    v_mfma_f32_16x16x16_bf16 v[220:223], v[250:251], v[32:33], 0
    v_mfma_f32_16x16x16_bf16 v[224:227], v[20:21], v[38:39], 0
    v_mfma_f32_16x16x16_bf16 v[228:231], v[22:23], v[38:39], 0
    v_mfma_f32_16x16x16_bf16 v[232:235], v[250:251], v[38:39], 0
    v_mfma_f32_16x16x16_bf16 v[212:215], v[24:25], v[34:35], v[212:215]
    v_mfma_f32_16x16x16_bf16 v[216:219], v[26:27], v[34:35], v[216:219]
    v_mfma_f32_16x16x16_bf16 v[220:223], v[252:253], v[34:35], v[220:223]
    v_mfma_f32_16x16x16_bf16 v[224:227], v[24:25], v[40:41], v[224:227]
    v_mfma_f32_16x16x16_bf16 v[228:231], v[26:27], v[40:41], v[228:231]
    v_mfma_f32_16x16x16_bf16 v[232:235], v[252:253], v[40:41], v[232:235]
    v_mfma_f32_16x16x16_bf16 v[212:215], v[28:29], v[36:37], v[212:215]
    v_mfma_f32_16x16x16_bf16 v[216:219], v[30:31], v[36:37], v[216:219]
    v_mfma_f32_16x16x16_bf16 v[220:223], v[254:255], v[36:37], v[220:223]
    v_mfma_f32_16x16x16_bf16 v[224:227], v[28:29], v[42:43], v[224:227]
    v_mfma_f32_16x16x16_bf16 v[228:231], v[30:31], v[42:43], v[228:231]
    v_mfma_f32_16x16x16_bf16 v[232:235], v[254:255], v[42:43], v[232:235]
    s_waitcnt vmcnt(14)
    v_mov_b32_dpp v250, v46 row_newbcast:2 row_mask:0xf bank_mask:0xf
    v_mov_b32_dpp v251, v47 row_newbcast:2 row_mask:0xf bank_mask:0xf
    v_mov_b32_dpp v252, v50 row_newbcast:2 row_mask:0xf bank_mask:0xf
    v_mov_b32_dpp v253, v51 row_newbcast:2 row_mask:0xf bank_mask:0xf
    v_mov_b32_dpp v254, v54 row_newbcast:2 row_mask:0xf bank_mask:0xf
    v_mov_b32_dpp v255, v55 row_newbcast:2 row_mask:0xf bank_mask:0xf
    s_nop 1
    v_mfma_f32_16x16x16_bf16 v[20:23], v[44:45], v[56:57], 0
    v_mfma_f32_16x16x16_bf16 v[24:27], v[46:47], v[56:57], 0
    v_mfma_f32_16x16x16_bf16 v[28:31], v[250:251], v[56:57], 0
    v_mfma_f32_16x16x16_bf16 v[32:35], v[44:45], v[62:63], 0
    v_mfma_f32_16x16x16_bf16 v[36:39], v[46:47], v[62:63], 0
    v_mfma_f32_16x16x16_bf16 v[40:43], v[250:251], v[62:63], 0
    v_mfma_f32_16x16x16_bf16 v[20:23], v[48:49], v[58:59], v[20:23]
    v_mfma_f32_16x16x16_bf16 v[24:27], v[50:51], v[58:59], v[24:27]
    v_mfma_f32_16x16x16_bf16 v[28:31], v[252:253], v[58:59], v[28:31]
    v_mfma_f32_16x16x16_bf16 v[32:35], v[48:49], v[64:65], v[32:35]
    v_mfma_f32_16x16x16_bf16 v[36:39], v[50:51], v[64:65], v[36:39]
    v_mfma_f32_16x16x16_bf16 v[40:43], v[252:253], v[64:65], v[40:43]
    v_mfma_f32_16x16x16_bf16 v[20:23], v[52:53], v[60:61], v[20:23]
    v_mfma_f32_16x16x16_bf16 v[24:27], v[54:55], v[60:61], v[24:27]
    v_mfma_f32_16x16x16_bf16 v[28:31], v[254:255], v[60:61], v[28:31]
    v_mfma_f32_16x16x16_bf16 v[32:35], v[52:53], v[66:67], v[32:35]
    v_mfma_f32_16x16x16_bf16 v[36:39], v[54:55], v[66:67], v[36:39]
    v_mfma_f32_16x16x16_bf16 v[40:43], v[254:255], v[66:67], v[40:43]
    v_cvt_pk_bf16_f32 v242, v220, v220
    v_lshlrev_b32 v220, 16, v242
    v_add_f32 v220, 0x358637bd, v220
    v_cvt_pk_bf16_f32 v242, v220, v220
    v_lshlrev_b32 v220, 16, v242
    v_rcp_f32 v220, v220
    v_cvt_pk_bf16_f32 v243, v212, v213
    v_cvt_pk_bf16_f32 v244, v214, v215
    v_cvt_pk_bf16_f32 v245, v216, v217
    v_lshlrev_b32 v212, 16, v243
    v_and_b32 v213, 0xffff0000, v243
    v_lshlrev_b32 v214, 16, v244
    v_and_b32 v215, 0xffff0000, v244
    v_lshlrev_b32 v216, 16, v245
    v_and_b32 v217, 0xffff0000, v245
    v_mul_f32 v212, v212, v220
    v_mul_f32 v213, v213, v220
    v_mul_f32 v214, v214, v220
    v_mul_f32 v215, v215, v220
    v_mul_f32 v216, v216, v220
    v_mul_f32 v217, v217, v220
    v_cvt_pk_bf16_f32 v221, v212, v213
    v_cvt_pk_bf16_f32 v222, v214, v215
    v_cvt_pk_bf16_f32 v223, v216, v217
    ds_write_b32 v239, v221 offset:0
    ds_write_b32 v239, v222 offset:4
    s_mov_b64 exec, 0xffff
    ds_write_b32 v239, v223 offset:32
    s_mov_b64 exec, -1
    v_cvt_pk_bf16_f32 v242, v232, v232
    v_lshlrev_b32 v232, 16, v242
    v_add_f32 v232, 0x358637bd, v232
    v_cvt_pk_bf16_f32 v242, v232, v232
    v_lshlrev_b32 v232, 16, v242
    v_rcp_f32 v232, v232
    v_cvt_pk_bf16_f32 v243, v224, v225
    v_cvt_pk_bf16_f32 v244, v226, v227
    v_cvt_pk_bf16_f32 v245, v228, v229
    v_lshlrev_b32 v224, 16, v243
    v_and_b32 v225, 0xffff0000, v243
    v_lshlrev_b32 v226, 16, v244
    v_and_b32 v227, 0xffff0000, v244
    v_lshlrev_b32 v228, 16, v245
    v_and_b32 v229, 0xffff0000, v245
    v_mul_f32 v224, v224, v232
    v_mul_f32 v225, v225, v232
    v_mul_f32 v226, v226, v232
    v_mul_f32 v227, v227, v232
    v_mul_f32 v228, v228, v232
    v_mul_f32 v229, v229, v232
    v_cvt_pk_bf16_f32 v233, v224, v225
    v_cvt_pk_bf16_f32 v234, v226, v227
    v_cvt_pk_bf16_f32 v235, v228, v229
    ds_write_b32 v239, v233 offset:18688
    ds_write_b32 v239, v234 offset:18692
    s_mov_b64 exec, 0xffff
    ds_write_b32 v239, v235 offset:18720
    s_mov_b64 exec, -1
    s_waitcnt vmcnt(7)
    v_mov_b32_dpp v250, v70 row_newbcast:2 row_mask:0xf bank_mask:0xf
    v_mov_b32_dpp v251, v71 row_newbcast:2 row_mask:0xf bank_mask:0xf
    v_mov_b32_dpp v252, v74 row_newbcast:2 row_mask:0xf bank_mask:0xf
    v_mov_b32_dpp v253, v75 row_newbcast:2 row_mask:0xf bank_mask:0xf
    v_mov_b32_dpp v254, v78 row_newbcast:2 row_mask:0xf bank_mask:0xf
    v_mov_b32_dpp v255, v79 row_newbcast:2 row_mask:0xf bank_mask:0xf
    s_nop 1
    v_mfma_f32_16x16x16_bf16 v[44:47], v[68:69], v[80:81], 0
    v_mfma_f32_16x16x16_bf16 v[48:51], v[70:71], v[80:81], 0
    v_mfma_f32_16x16x16_bf16 v[52:55], v[250:251], v[80:81], 0
    v_mfma_f32_16x16x16_bf16 v[56:59], v[68:69], v[86:87], 0
    v_mfma_f32_16x16x16_bf16 v[60:63], v[70:71], v[86:87], 0
    v_mfma_f32_16x16x16_bf16 v[64:67], v[250:251], v[86:87], 0
    v_mfma_f32_16x16x16_bf16 v[44:47], v[72:73], v[82:83], v[44:47]
    v_mfma_f32_16x16x16_bf16 v[48:51], v[74:75], v[82:83], v[48:51]
    v_mfma_f32_16x16x16_bf16 v[52:55], v[252:253], v[82:83], v[52:55]
    v_mfma_f32_16x16x16_bf16 v[56:59], v[72:73], v[88:89], v[56:59]
    v_mfma_f32_16x16x16_bf16 v[60:63], v[74:75], v[88:89], v[60:63]
    v_mfma_f32_16x16x16_bf16 v[64:67], v[252:253], v[88:89], v[64:67]
    v_mfma_f32_16x16x16_bf16 v[44:47], v[76:77], v[84:85], v[44:47]
    v_mfma_f32_16x16x16_bf16 v[48:51], v[78:79], v[84:85], v[48:51]
    v_mfma_f32_16x16x16_bf16 v[52:55], v[254:255], v[84:85], v[52:55]
    v_mfma_f32_16x16x16_bf16 v[56:59], v[76:77], v[90:91], v[56:59]
    v_mfma_f32_16x16x16_bf16 v[60:63], v[78:79], v[90:91], v[60:63]
    v_mfma_f32_16x16x16_bf16 v[64:67], v[254:255], v[90:91], v[64:67]
    v_cvt_pk_bf16_f32 v242, v28, v28
    v_lshlrev_b32 v28, 16, v242
    v_add_f32 v28, 0x358637bd, v28
    v_cvt_pk_bf16_f32 v242, v28, v28
    v_lshlrev_b32 v28, 16, v242
    v_rcp_f32 v28, v28
    v_cvt_pk_bf16_f32 v243, v20, v21
    v_cvt_pk_bf16_f32 v244, v22, v23
    v_cvt_pk_bf16_f32 v245, v24, v25
    v_lshlrev_b32 v20, 16, v243
    v_and_b32 v21, 0xffff0000, v243
    v_lshlrev_b32 v22, 16, v244
    v_and_b32 v23, 0xffff0000, v244
    v_lshlrev_b32 v24, 16, v245
    v_and_b32 v25, 0xffff0000, v245
    v_mul_f32 v20, v20, v28
    v_mul_f32 v21, v21, v28
    v_mul_f32 v22, v22, v28
    v_mul_f32 v23, v23, v28
    v_mul_f32 v24, v24, v28
    v_mul_f32 v25, v25, v28
    v_cvt_pk_bf16_f32 v29, v20, v21
    v_cvt_pk_bf16_f32 v30, v22, v23
    v_cvt_pk_bf16_f32 v31, v24, v25
    ds_write_b32 v239, v29 offset:36
    ds_write_b32 v239, v30 offset:40
    s_mov_b64 exec, 0xffff
    ds_write_b32 v239, v31 offset:68
    s_mov_b64 exec, -1
    v_cvt_pk_bf16_f32 v242, v40, v40
    v_lshlrev_b32 v40, 16, v242
    v_add_f32 v40, 0x358637bd, v40
    v_cvt_pk_bf16_f32 v242, v40, v40
    v_lshlrev_b32 v40, 16, v242
    v_rcp_f32 v40, v40
    v_cvt_pk_bf16_f32 v243, v32, v33
    v_cvt_pk_bf16_f32 v244, v34, v35
    v_cvt_pk_bf16_f32 v245, v36, v37
    v_lshlrev_b32 v32, 16, v243
    v_and_b32 v33, 0xffff0000, v243
    v_lshlrev_b32 v34, 16, v244
    v_and_b32 v35, 0xffff0000, v244
    v_lshlrev_b32 v36, 16, v245
    v_and_b32 v37, 0xffff0000, v245
    v_mul_f32 v32, v32, v40
    v_mul_f32 v33, v33, v40
    v_mul_f32 v34, v34, v40
    v_mul_f32 v35, v35, v40
    v_mul_f32 v36, v36, v40
    v_mul_f32 v37, v37, v40
    v_cvt_pk_bf16_f32 v41, v32, v33
    v_cvt_pk_bf16_f32 v42, v34, v35
    v_cvt_pk_bf16_f32 v43, v36, v37
    ds_write_b32 v239, v41 offset:18724
    ds_write_b32 v239, v42 offset:18728
    s_mov_b64 exec, 0xffff
    ds_write_b32 v239, v43 offset:18756
    s_mov_b64 exec, -1
    s_waitcnt vmcnt(0)
    v_mov_b32_dpp v250, v94 row_newbcast:2 row_mask:0xf bank_mask:0xf
    v_mov_b32_dpp v251, v95 row_newbcast:2 row_mask:0xf bank_mask:0xf
    v_mov_b32_dpp v252, v98 row_newbcast:2 row_mask:0xf bank_mask:0xf
    v_mov_b32_dpp v253, v99 row_newbcast:2 row_mask:0xf bank_mask:0xf
    v_mov_b32_dpp v254, v102 row_newbcast:2 row_mask:0xf bank_mask:0xf
    v_mov_b32_dpp v255, v103 row_newbcast:2 row_mask:0xf bank_mask:0xf
    s_nop 1
    v_mfma_f32_16x16x16_bf16 v[68:71], v[92:93], v[104:105], 0
    v_mfma_f32_16x16x16_bf16 v[72:75], v[94:95], v[104:105], 0
    v_mfma_f32_16x16x16_bf16 v[76:79], v[250:251], v[104:105], 0
    v_mfma_f32_16x16x16_bf16 v[80:83], v[92:93], v[110:111], 0
    v_mfma_f32_16x16x16_bf16 v[84:87], v[94:95], v[110:111], 0
    v_mfma_f32_16x16x16_bf16 v[88:91], v[250:251], v[110:111], 0
    v_mfma_f32_16x16x16_bf16 v[68:71], v[96:97], v[106:107], v[68:71]
    v_mfma_f32_16x16x16_bf16 v[72:75], v[98:99], v[106:107], v[72:75]
    v_mfma_f32_16x16x16_bf16 v[76:79], v[252:253], v[106:107], v[76:79]
    v_mfma_f32_16x16x16_bf16 v[80:83], v[96:97], v[112:113], v[80:83]
    v_mfma_f32_16x16x16_bf16 v[84:87], v[98:99], v[112:113], v[84:87]
    v_mfma_f32_16x16x16_bf16 v[88:91], v[252:253], v[112:113], v[88:91]
    v_mfma_f32_16x16x16_bf16 v[68:71], v[100:101], v[108:109], v[68:71]
    v_mfma_f32_16x16x16_bf16 v[72:75], v[102:103], v[108:109], v[72:75]
    v_mfma_f32_16x16x16_bf16 v[76:79], v[254:255], v[108:109], v[76:79]
    v_mfma_f32_16x16x16_bf16 v[80:83], v[100:101], v[114:115], v[80:83]
    v_mfma_f32_16x16x16_bf16 v[84:87], v[102:103], v[114:115], v[84:87]
    v_mfma_f32_16x16x16_bf16 v[88:91], v[254:255], v[114:115], v[88:91]
    v_cvt_pk_bf16_f32 v242, v52, v52
    v_lshlrev_b32 v52, 16, v242
    v_add_f32 v52, 0x358637bd, v52
    v_cvt_pk_bf16_f32 v242, v52, v52
    v_lshlrev_b32 v52, 16, v242
    v_rcp_f32 v52, v52
    v_cvt_pk_bf16_f32 v243, v44, v45
    v_cvt_pk_bf16_f32 v244, v46, v47
    v_cvt_pk_bf16_f32 v245, v48, v49
    v_lshlrev_b32 v44, 16, v243
    v_and_b32 v45, 0xffff0000, v243
    v_lshlrev_b32 v46, 16, v244
    v_and_b32 v47, 0xffff0000, v244
    v_lshlrev_b32 v48, 16, v245
    v_and_b32 v49, 0xffff0000, v245
    v_mul_f32 v44, v44, v52
    v_mul_f32 v45, v45, v52
    v_mul_f32 v46, v46, v52
    v_mul_f32 v47, v47, v52
    v_mul_f32 v48, v48, v52
    v_mul_f32 v49, v49, v52
    v_cvt_pk_bf16_f32 v53, v44, v45
    v_cvt_pk_bf16_f32 v54, v46, v47
    v_cvt_pk_bf16_f32 v55, v48, v49
    ds_write_b32 v239, v53 offset:72
    ds_write_b32 v239, v54 offset:76
    s_mov_b64 exec, 0xffff
    ds_write_b32 v239, v55 offset:104
    s_mov_b64 exec, -1
    v_cvt_pk_bf16_f32 v242, v64, v64
    v_lshlrev_b32 v64, 16, v242
    v_add_f32 v64, 0x358637bd, v64
    v_cvt_pk_bf16_f32 v242, v64, v64
    v_lshlrev_b32 v64, 16, v242
    v_rcp_f32 v64, v64
    v_cvt_pk_bf16_f32 v243, v56, v57
    v_cvt_pk_bf16_f32 v244, v58, v59
    v_cvt_pk_bf16_f32 v245, v60, v61
    v_lshlrev_b32 v56, 16, v243
    v_and_b32 v57, 0xffff0000, v243
    v_lshlrev_b32 v58, 16, v244
    v_and_b32 v59, 0xffff0000, v244
    v_lshlrev_b32 v60, 16, v245
    v_and_b32 v61, 0xffff0000, v245
    v_mul_f32 v56, v56, v64
    v_mul_f32 v57, v57, v64
    v_mul_f32 v58, v58, v64
    v_mul_f32 v59, v59, v64
    v_mul_f32 v60, v60, v64
    v_mul_f32 v61, v61, v64
    v_cvt_pk_bf16_f32 v65, v56, v57
    v_cvt_pk_bf16_f32 v66, v58, v59
    v_cvt_pk_bf16_f32 v67, v60, v61
    ds_write_b32 v239, v65 offset:18760
    ds_write_b32 v239, v66 offset:18764
    s_mov_b64 exec, 0xffff
    ds_write_b32 v239, v67 offset:18792
    s_mov_b64 exec, -1
    s_nop 7
    s_nop 3
    v_cvt_pk_bf16_f32 v242, v76, v76
    v_lshlrev_b32 v76, 16, v242
    v_add_f32 v76, 0x358637bd, v76
    v_cvt_pk_bf16_f32 v242, v76, v76
    v_lshlrev_b32 v76, 16, v242
    v_rcp_f32 v76, v76
    v_cvt_pk_bf16_f32 v243, v68, v69
    v_cvt_pk_bf16_f32 v244, v70, v71
    v_cvt_pk_bf16_f32 v245, v72, v73
    v_lshlrev_b32 v68, 16, v243
    v_and_b32 v69, 0xffff0000, v243
    v_lshlrev_b32 v70, 16, v244
    v_and_b32 v71, 0xffff0000, v244
    v_lshlrev_b32 v72, 16, v245
    v_and_b32 v73, 0xffff0000, v245
    v_mul_f32 v68, v68, v76
    v_mul_f32 v69, v69, v76
    v_mul_f32 v70, v70, v76
    v_mul_f32 v71, v71, v76
    v_mul_f32 v72, v72, v76
    v_mul_f32 v73, v73, v76
    v_cvt_pk_bf16_f32 v77, v68, v69
    v_cvt_pk_bf16_f32 v78, v70, v71
    v_cvt_pk_bf16_f32 v79, v72, v73
    ds_write_b32 v239, v77 offset:108
    ds_write_b32 v239, v78 offset:112
    s_mov_b64 exec, 0xffff
    ds_write_b32 v239, v79 offset:140
    s_mov_b64 exec, -1
    v_cvt_pk_bf16_f32 v242, v88, v88
    v_lshlrev_b32 v88, 16, v242
    v_add_f32 v88, 0x358637bd, v88
    v_cvt_pk_bf16_f32 v242, v88, v88
    v_lshlrev_b32 v88, 16, v242
    v_rcp_f32 v88, v88
    v_cvt_pk_bf16_f32 v243, v80, v81
    v_cvt_pk_bf16_f32 v244, v82, v83
    v_cvt_pk_bf16_f32 v245, v84, v85
    v_lshlrev_b32 v80, 16, v243
    v_and_b32 v81, 0xffff0000, v243
    v_lshlrev_b32 v82, 16, v244
    v_and_b32 v83, 0xffff0000, v244
    v_lshlrev_b32 v84, 16, v245
    v_and_b32 v85, 0xffff0000, v245
    v_mul_f32 v80, v80, v88
    v_mul_f32 v81, v81, v88
    v_mul_f32 v82, v82, v88
    v_mul_f32 v83, v83, v88
    v_mul_f32 v84, v84, v88
    v_mul_f32 v85, v85, v88
    v_cvt_pk_bf16_f32 v89, v80, v81
    v_cvt_pk_bf16_f32 v90, v82, v83
    v_cvt_pk_bf16_f32 v91, v84, v85
    ds_write_b32 v239, v89 offset:18796
    ds_write_b32 v239, v90 offset:18800
    s_mov_b64 exec, 0xffff
    ds_write_b32 v239, v91 offset:18828
    s_mov_b64 exec, -1
    s_cmp_lt_u32 s73, 4
    s_cbranch_scc1 k2_kernel_gemm
    s_waitcnt lgkmcnt(0)
    s_barrier
    s_branch k2_kernel_end
k2_kernel_gemm:
    v_mov_b32 v84, 0
    v_mov_b32 v85, 0
    v_mov_b32 v86, 0
    v_mov_b32 v87, 0
    v_mov_b32 v88, 0
    v_mov_b32 v89, 0
    v_mov_b32 v90, 0
    v_mov_b32 v91, 0
    v_mov_b32 v92, 0
    v_mov_b32 v93, 0
    v_mov_b32 v94, 0
    v_mov_b32 v95, 0
    v_mov_b32 v96, 0
    v_mov_b32 v97, 0
    v_mov_b32 v98, 0
    v_mov_b32 v99, 0
    v_mov_b32 v100, 0
    v_mov_b32 v101, 0
    v_mov_b32 v102, 0
    v_mov_b32 v103, 0
    s_and_b32 s60, s52, 1
    s_lshl_b32 s60, s60, 4
    s_lshl_b32 s61, s57, 5
    s_add_u32 s60, s60, s61
    v_and_b32 v120, 15, v1
    v_add_u32 v120, s60, v120
    v_mov_b32 v129, v120
    v_mul_u32_u24 v120, 1152, v120
    v_lshrrev_b32 v121, 4, v1
    v_lshl_add_u32 v120, v121, 3, v120
    s_lshl_b32 s61, s66, 7
    s_add_u32 s61, s61, s64
    v_add_u32 v128, s61, v120
    buffer_load_dwordx2 v[60:61], v128, s[44:47], 0 offen offset:0
    buffer_load_dwordx2 v[62:63], v128, s[44:47], 0 offen offset:32
    buffer_load_dwordx2 v[64:65], v128, s[44:47], 0 offen offset:64
    buffer_load_dwordx2 v[66:67], v128, s[44:47], 0 offen offset:96
    buffer_load_dwordx2 v[68:69], v128, s[44:47], 0 offen offset:128
    s_waitcnt vmcnt(20) lgkmcnt(0)
    s_barrier
    ds_read_b128 v[72:75], v240 offset:0
    ds_read_b64_tr_b16 v[20:21], v13 offset:0
    ds_read_b64_tr_b16 v[22:23], v13 offset:2304
    ds_read_b64_tr_b16 v[24:25], v13 offset:32
    ds_read_b64_tr_b16 v[26:27], v13 offset:2336
    ds_read_b64_tr_b16 v[28:29], v13 offset:64
    ds_read_b64_tr_b16 v[30:31], v13 offset:2368
    ds_read_b64_tr_b16 v[32:33], v13 offset:96
    ds_read_b64_tr_b16 v[34:35], v13 offset:2400
    ds_read_b64_tr_b16 v[36:37], v13 offset:128
    ds_read_b64_tr_b16 v[38:39], v13 offset:2432
    s_waitcnt lgkmcnt(0)
    ds_read_b128 v[76:79], v240 offset:64
    ds_read_b64_tr_b16 v[40:41], v13 offset:9216
    v_mfma_f32_16x16x32_bf16 v[84:87], v[20:23], v[72:75], v[84:87]
    ds_read_b64_tr_b16 v[42:43], v13 offset:11520
    ds_read_b64_tr_b16 v[44:45], v13 offset:9248
    v_mfma_f32_16x16x32_bf16 v[88:91], v[24:27], v[72:75], v[88:91]
    ds_read_b64_tr_b16 v[46:47], v13 offset:11552
    ds_read_b64_tr_b16 v[48:49], v13 offset:9280
    v_mfma_f32_16x16x32_bf16 v[92:95], v[28:31], v[72:75], v[92:95]
    ds_read_b64_tr_b16 v[50:51], v13 offset:11584
    ds_read_b64_tr_b16 v[52:53], v13 offset:9312
    v_mfma_f32_16x16x32_bf16 v[96:99], v[32:35], v[72:75], v[96:99]
    ds_read_b64_tr_b16 v[54:55], v13 offset:11616
    ds_read_b64_tr_b16 v[56:57], v13 offset:9344
    v_mfma_f32_16x16x32_bf16 v[100:103], v[36:39], v[72:75], v[100:103]
    ds_read_b64_tr_b16 v[58:59], v13 offset:11648
    s_waitcnt vmcnt(15) lgkmcnt(0)
    s_barrier
    s_add_u32 m0, s53, 0
    s_nop 0
    buffer_load_dwordx4 v8, s[32:35], s54 offen lds
    s_add_u32 m0, s53, 1024
    s_nop 0
    buffer_load_dwordx4 v9, s[32:35], s54 offen lds
    s_add_u32 m0, s53, 2048
    s_nop 0
    buffer_load_dwordx4 v10, s[32:35], s54 offen lds
    s_add_u32 m0, s53, 3072
    s_nop 0
    buffer_load_dwordx4 v11, s[32:35], s54 offen lds
    s_add_u32 m0, s53, 4096
    s_nop 0
    s_mov_b32 exec_hi, 0
    buffer_load_dwordx4 v12, s[32:35], s54 offen lds
    s_mov_b32 exec_hi, -1
    s_add_u32 s54, s54, 18432
    s_add_u32 s55, s55, 128
    ds_read_b128 v[72:75], v240 offset:128
    ds_read_b64_tr_b16 v[20:21], v14 offset:0
    v_mfma_f32_16x16x32_bf16 v[84:87], v[40:43], v[76:79], v[84:87]
    ds_read_b64_tr_b16 v[22:23], v14 offset:2304
    ds_read_b64_tr_b16 v[24:25], v14 offset:32
    v_mfma_f32_16x16x32_bf16 v[88:91], v[44:47], v[76:79], v[88:91]
    ds_read_b64_tr_b16 v[26:27], v14 offset:2336
    ds_read_b64_tr_b16 v[28:29], v14 offset:64
    v_mfma_f32_16x16x32_bf16 v[92:95], v[48:51], v[76:79], v[92:95]
    ds_read_b64_tr_b16 v[30:31], v14 offset:2368
    ds_read_b64_tr_b16 v[32:33], v14 offset:96
    v_mfma_f32_16x16x32_bf16 v[96:99], v[52:55], v[76:79], v[96:99]
    ds_read_b64_tr_b16 v[34:35], v14 offset:2400
    ds_read_b64_tr_b16 v[36:37], v14 offset:128
    v_mfma_f32_16x16x32_bf16 v[100:103], v[56:59], v[76:79], v[100:103]
    ds_read_b64_tr_b16 v[38:39], v14 offset:2432
    s_waitcnt lgkmcnt(0)
    ds_read_b128 v[76:79], v240 offset:192
    ds_read_b64_tr_b16 v[40:41], v14 offset:9216
    v_mfma_f32_16x16x32_bf16 v[84:87], v[20:23], v[72:75], v[84:87]
    ds_read_b64_tr_b16 v[42:43], v14 offset:11520
    ds_read_b64_tr_b16 v[44:45], v14 offset:9248
    v_mfma_f32_16x16x32_bf16 v[88:91], v[24:27], v[72:75], v[88:91]
    ds_read_b64_tr_b16 v[46:47], v14 offset:11552
    ds_read_b64_tr_b16 v[48:49], v14 offset:9280
    v_mfma_f32_16x16x32_bf16 v[92:95], v[28:31], v[72:75], v[92:95]
    ds_read_b64_tr_b16 v[50:51], v14 offset:11584
    ds_read_b64_tr_b16 v[52:53], v14 offset:9312
    v_mfma_f32_16x16x32_bf16 v[96:99], v[32:35], v[72:75], v[96:99]
    ds_read_b64_tr_b16 v[54:55], v14 offset:11616
    ds_read_b64_tr_b16 v[56:57], v14 offset:9344
    v_mfma_f32_16x16x32_bf16 v[100:103], v[36:39], v[72:75], v[100:103]
    ds_read_b64_tr_b16 v[58:59], v14 offset:11648
    s_waitcnt vmcnt(15) lgkmcnt(0)
    s_barrier
    s_add_u32 m0, s53, 18432
    s_nop 0
    buffer_load_dwordx4 v8, s[32:35], s54 offen lds
    s_add_u32 m0, s53, 19456
    s_nop 0
    buffer_load_dwordx4 v9, s[32:35], s54 offen lds
    s_add_u32 m0, s53, 20480
    s_nop 0
    buffer_load_dwordx4 v10, s[32:35], s54 offen lds
    s_add_u32 m0, s53, 21504
    s_nop 0
    buffer_load_dwordx4 v11, s[32:35], s54 offen lds
    s_add_u32 m0, s53, 22528
    s_nop 0
    s_mov_b32 exec_hi, 0
    buffer_load_dwordx4 v12, s[32:35], s54 offen lds
    s_mov_b32 exec_hi, -1
    s_add_u32 s54, s54, 18432
    s_add_u32 s55, s55, 128
    ds_read_b128 v[72:75], v240 offset:256
    ds_read_b64_tr_b16 v[20:21], v15 offset:0
    v_mfma_f32_16x16x32_bf16 v[84:87], v[40:43], v[76:79], v[84:87]
    ds_read_b64_tr_b16 v[22:23], v15 offset:2304
    ds_read_b64_tr_b16 v[24:25], v15 offset:32
    v_mfma_f32_16x16x32_bf16 v[88:91], v[44:47], v[76:79], v[88:91]
    ds_read_b64_tr_b16 v[26:27], v15 offset:2336
    ds_read_b64_tr_b16 v[28:29], v15 offset:64
    v_mfma_f32_16x16x32_bf16 v[92:95], v[48:51], v[76:79], v[92:95]
    ds_read_b64_tr_b16 v[30:31], v15 offset:2368
    ds_read_b64_tr_b16 v[32:33], v15 offset:96
    v_mfma_f32_16x16x32_bf16 v[96:99], v[52:55], v[76:79], v[96:99]
    ds_read_b64_tr_b16 v[34:35], v15 offset:2400
    ds_read_b64_tr_b16 v[36:37], v15 offset:128
    v_mfma_f32_16x16x32_bf16 v[100:103], v[56:59], v[76:79], v[100:103]
    ds_read_b64_tr_b16 v[38:39], v15 offset:2432
    s_waitcnt lgkmcnt(0)
    ds_read_b128 v[76:79], v240 offset:320
    ds_read_b64_tr_b16 v[40:41], v15 offset:9216
    v_mfma_f32_16x16x32_bf16 v[84:87], v[20:23], v[72:75], v[84:87]
    ds_read_b64_tr_b16 v[42:43], v15 offset:11520
    ds_read_b64_tr_b16 v[44:45], v15 offset:9248
    v_mfma_f32_16x16x32_bf16 v[88:91], v[24:27], v[72:75], v[88:91]
    ds_read_b64_tr_b16 v[46:47], v15 offset:11552
    ds_read_b64_tr_b16 v[48:49], v15 offset:9280
    v_mfma_f32_16x16x32_bf16 v[92:95], v[28:31], v[72:75], v[92:95]
    ds_read_b64_tr_b16 v[50:51], v15 offset:11584
    ds_read_b64_tr_b16 v[52:53], v15 offset:9312
    v_mfma_f32_16x16x32_bf16 v[96:99], v[32:35], v[72:75], v[96:99]
    ds_read_b64_tr_b16 v[54:55], v15 offset:11616
    ds_read_b64_tr_b16 v[56:57], v15 offset:9344
    v_mfma_f32_16x16x32_bf16 v[100:103], v[36:39], v[72:75], v[100:103]
    ds_read_b64_tr_b16 v[58:59], v15 offset:11648
    s_waitcnt vmcnt(15) lgkmcnt(0)
    s_barrier
    s_add_u32 m0, s53, 36864
    s_nop 0
    buffer_load_dwordx4 v8, s[32:35], s54 offen lds
    s_add_u32 m0, s53, 37888
    s_nop 0
    buffer_load_dwordx4 v9, s[32:35], s54 offen lds
    s_add_u32 m0, s53, 38912
    s_nop 0
    buffer_load_dwordx4 v10, s[32:35], s54 offen lds
    s_add_u32 m0, s53, 39936
    s_nop 0
    buffer_load_dwordx4 v11, s[32:35], s54 offen lds
    s_add_u32 m0, s53, 40960
    s_nop 0
    s_mov_b32 exec_hi, 0
    buffer_load_dwordx4 v12, s[32:35], s54 offen lds
    s_mov_b32 exec_hi, -1
    s_add_u32 s54, s54, 18432
    s_add_u32 s55, s55, 128
    ds_read_b128 v[72:75], v240 offset:384
    ds_read_b64_tr_b16 v[20:21], v16 offset:0
    v_mfma_f32_16x16x32_bf16 v[84:87], v[40:43], v[76:79], v[84:87]
    ds_read_b64_tr_b16 v[22:23], v16 offset:2304
    ds_read_b64_tr_b16 v[24:25], v16 offset:32
    v_mfma_f32_16x16x32_bf16 v[88:91], v[44:47], v[76:79], v[88:91]
    ds_read_b64_tr_b16 v[26:27], v16 offset:2336
    ds_read_b64_tr_b16 v[28:29], v16 offset:64
    v_mfma_f32_16x16x32_bf16 v[92:95], v[48:51], v[76:79], v[92:95]
    ds_read_b64_tr_b16 v[30:31], v16 offset:2368
    ds_read_b64_tr_b16 v[32:33], v16 offset:96
    v_mfma_f32_16x16x32_bf16 v[96:99], v[52:55], v[76:79], v[96:99]
    ds_read_b64_tr_b16 v[34:35], v16 offset:2400
    ds_read_b64_tr_b16 v[36:37], v16 offset:128
    v_mfma_f32_16x16x32_bf16 v[100:103], v[56:59], v[76:79], v[100:103]
    ds_read_b64_tr_b16 v[38:39], v16 offset:2432
    s_waitcnt lgkmcnt(0)
    ds_read_b128 v[76:79], v240 offset:448
    ds_read_b64_tr_b16 v[40:41], v16 offset:9216
    v_mfma_f32_16x16x32_bf16 v[84:87], v[20:23], v[72:75], v[84:87]
    ds_read_b64_tr_b16 v[42:43], v16 offset:11520
    ds_read_b64_tr_b16 v[44:45], v16 offset:9248
    v_mfma_f32_16x16x32_bf16 v[88:91], v[24:27], v[72:75], v[88:91]
    ds_read_b64_tr_b16 v[46:47], v16 offset:11552
    ds_read_b64_tr_b16 v[48:49], v16 offset:9280
    v_mfma_f32_16x16x32_bf16 v[92:95], v[28:31], v[72:75], v[92:95]
    ds_read_b64_tr_b16 v[50:51], v16 offset:11584
    ds_read_b64_tr_b16 v[52:53], v16 offset:9312
    v_mfma_f32_16x16x32_bf16 v[96:99], v[32:35], v[72:75], v[96:99]
    ds_read_b64_tr_b16 v[54:55], v16 offset:11616
    ds_read_b64_tr_b16 v[56:57], v16 offset:9344
    v_mfma_f32_16x16x32_bf16 v[100:103], v[36:39], v[72:75], v[100:103]
    ds_read_b64_tr_b16 v[58:59], v16 offset:11648
    s_waitcnt vmcnt(10) lgkmcnt(0)
    s_barrier
    s_add_u32 m0, s53, 55296
    s_nop 0
    buffer_load_dwordx4 v8, s[32:35], s54 offen lds
    s_add_u32 m0, s53, 56320
    s_nop 0
    buffer_load_dwordx4 v9, s[32:35], s54 offen lds
    s_add_u32 m0, s53, 57344
    s_nop 0
    buffer_load_dwordx4 v10, s[32:35], s54 offen lds
    s_add_u32 m0, s53, 58368
    s_nop 0
    buffer_load_dwordx4 v11, s[32:35], s54 offen lds
    s_add_u32 m0, s53, 59392
    s_nop 0
    s_mov_b32 exec_hi, 0
    buffer_load_dwordx4 v12, s[32:35], s54 offen lds
    s_mov_b32 exec_hi, -1
    s_add_u32 s54, s54, 18432
    s_add_u32 s55, s55, 128
    ds_read_b128 v[72:75], v240 offset:512
    ds_read_b64_tr_b16 v[20:21], v13 offset:0
    v_mfma_f32_16x16x32_bf16 v[84:87], v[40:43], v[76:79], v[84:87]
    ds_read_b64_tr_b16 v[22:23], v13 offset:2304
    ds_read_b64_tr_b16 v[24:25], v13 offset:32
    v_mfma_f32_16x16x32_bf16 v[88:91], v[44:47], v[76:79], v[88:91]
    ds_read_b64_tr_b16 v[26:27], v13 offset:2336
    ds_read_b64_tr_b16 v[28:29], v13 offset:64
    v_mfma_f32_16x16x32_bf16 v[92:95], v[48:51], v[76:79], v[92:95]
    ds_read_b64_tr_b16 v[30:31], v13 offset:2368
    ds_read_b64_tr_b16 v[32:33], v13 offset:96
    v_mfma_f32_16x16x32_bf16 v[96:99], v[52:55], v[76:79], v[96:99]
    ds_read_b64_tr_b16 v[34:35], v13 offset:2400
    ds_read_b64_tr_b16 v[36:37], v13 offset:128
    v_mfma_f32_16x16x32_bf16 v[100:103], v[56:59], v[76:79], v[100:103]
    ds_read_b64_tr_b16 v[38:39], v13 offset:2432
    s_waitcnt lgkmcnt(0)
    ds_read_b128 v[76:79], v240 offset:576
    ds_read_b64_tr_b16 v[40:41], v13 offset:9216
    v_mfma_f32_16x16x32_bf16 v[84:87], v[20:23], v[72:75], v[84:87]
    ds_read_b64_tr_b16 v[42:43], v13 offset:11520
    ds_read_b64_tr_b16 v[44:45], v13 offset:9248
    v_mfma_f32_16x16x32_bf16 v[88:91], v[24:27], v[72:75], v[88:91]
    ds_read_b64_tr_b16 v[46:47], v13 offset:11552
    ds_read_b64_tr_b16 v[48:49], v13 offset:9280
    v_mfma_f32_16x16x32_bf16 v[92:95], v[28:31], v[72:75], v[92:95]
    ds_read_b64_tr_b16 v[50:51], v13 offset:11584
    ds_read_b64_tr_b16 v[52:53], v13 offset:9312
    v_mfma_f32_16x16x32_bf16 v[96:99], v[32:35], v[72:75], v[96:99]
    ds_read_b64_tr_b16 v[54:55], v13 offset:11616
    ds_read_b64_tr_b16 v[56:57], v13 offset:9344
    v_mfma_f32_16x16x32_bf16 v[100:103], v[36:39], v[72:75], v[100:103]
    ds_read_b64_tr_b16 v[58:59], v13 offset:11648
    s_waitcnt vmcnt(10) lgkmcnt(0)
    s_barrier
    s_add_u32 m0, s53, 0
    s_nop 0
    buffer_load_dwordx4 v8, s[32:35], s54 offen lds
    s_add_u32 m0, s53, 1024
    s_nop 0
    buffer_load_dwordx4 v9, s[32:35], s54 offen lds
    s_add_u32 m0, s53, 2048
    s_nop 0
    buffer_load_dwordx4 v10, s[32:35], s54 offen lds
    s_add_u32 m0, s53, 3072
    s_nop 0
    buffer_load_dwordx4 v11, s[32:35], s54 offen lds
    s_add_u32 m0, s53, 4096
    s_nop 0
    s_mov_b32 exec_hi, 0
    buffer_load_dwordx4 v12, s[32:35], s54 offen lds
    s_mov_b32 exec_hi, -1
    s_add_u32 s54, s54, 18432
    s_add_u32 s55, s55, 128
    ds_read_b128 v[72:75], v240 offset:640
    ds_read_b64_tr_b16 v[20:21], v14 offset:0
    v_mfma_f32_16x16x32_bf16 v[84:87], v[40:43], v[76:79], v[84:87]
    ds_read_b64_tr_b16 v[22:23], v14 offset:2304
    ds_read_b64_tr_b16 v[24:25], v14 offset:32
    v_mfma_f32_16x16x32_bf16 v[88:91], v[44:47], v[76:79], v[88:91]
    ds_read_b64_tr_b16 v[26:27], v14 offset:2336
    ds_read_b64_tr_b16 v[28:29], v14 offset:64
    v_mfma_f32_16x16x32_bf16 v[92:95], v[48:51], v[76:79], v[92:95]
    ds_read_b64_tr_b16 v[30:31], v14 offset:2368
    ds_read_b64_tr_b16 v[32:33], v14 offset:96
    v_mfma_f32_16x16x32_bf16 v[96:99], v[52:55], v[76:79], v[96:99]
    ds_read_b64_tr_b16 v[34:35], v14 offset:2400
    ds_read_b64_tr_b16 v[36:37], v14 offset:128
    v_mfma_f32_16x16x32_bf16 v[100:103], v[56:59], v[76:79], v[100:103]
    ds_read_b64_tr_b16 v[38:39], v14 offset:2432
    s_waitcnt lgkmcnt(0)
    ds_read_b128 v[76:79], v240 offset:704
    ds_read_b64_tr_b16 v[40:41], v14 offset:9216
    v_mfma_f32_16x16x32_bf16 v[84:87], v[20:23], v[72:75], v[84:87]
    ds_read_b64_tr_b16 v[42:43], v14 offset:11520
    ds_read_b64_tr_b16 v[44:45], v14 offset:9248
    v_mfma_f32_16x16x32_bf16 v[88:91], v[24:27], v[72:75], v[88:91]
    ds_read_b64_tr_b16 v[46:47], v14 offset:11552
    ds_read_b64_tr_b16 v[48:49], v14 offset:9280
    v_mfma_f32_16x16x32_bf16 v[92:95], v[28:31], v[72:75], v[92:95]
    ds_read_b64_tr_b16 v[50:51], v14 offset:11584
    ds_read_b64_tr_b16 v[52:53], v14 offset:9312
    v_mfma_f32_16x16x32_bf16 v[96:99], v[32:35], v[72:75], v[96:99]
    ds_read_b64_tr_b16 v[54:55], v14 offset:11616
    ds_read_b64_tr_b16 v[56:57], v14 offset:9344
    v_mfma_f32_16x16x32_bf16 v[100:103], v[36:39], v[72:75], v[100:103]
    ds_read_b64_tr_b16 v[58:59], v14 offset:11648
    s_waitcnt vmcnt(10) lgkmcnt(0)
    s_barrier
    ds_read_b128 v[72:75], v240 offset:768
    ds_read_b64_tr_b16 v[20:21], v15 offset:0
    v_mfma_f32_16x16x32_bf16 v[84:87], v[40:43], v[76:79], v[84:87]
    ds_read_b64_tr_b16 v[22:23], v15 offset:2304
    ds_read_b64_tr_b16 v[24:25], v15 offset:32
    v_mfma_f32_16x16x32_bf16 v[88:91], v[44:47], v[76:79], v[88:91]
    ds_read_b64_tr_b16 v[26:27], v15 offset:2336
    ds_read_b64_tr_b16 v[28:29], v15 offset:64
    v_mfma_f32_16x16x32_bf16 v[92:95], v[48:51], v[76:79], v[92:95]
    ds_read_b64_tr_b16 v[30:31], v15 offset:2368
    ds_read_b64_tr_b16 v[32:33], v15 offset:96
    v_mfma_f32_16x16x32_bf16 v[96:99], v[52:55], v[76:79], v[96:99]
    ds_read_b64_tr_b16 v[34:35], v15 offset:2400
    ds_read_b64_tr_b16 v[36:37], v15 offset:128
    v_mfma_f32_16x16x32_bf16 v[100:103], v[56:59], v[76:79], v[100:103]
    ds_read_b64_tr_b16 v[38:39], v15 offset:2432
    s_waitcnt lgkmcnt(0)
    ds_read_b128 v[76:79], v240 offset:832
    ds_read_b64_tr_b16 v[40:41], v15 offset:9216
    v_mfma_f32_16x16x32_bf16 v[84:87], v[20:23], v[72:75], v[84:87]
    ds_read_b64_tr_b16 v[42:43], v15 offset:11520
    ds_read_b64_tr_b16 v[44:45], v15 offset:9248
    v_mfma_f32_16x16x32_bf16 v[88:91], v[24:27], v[72:75], v[88:91]
    ds_read_b64_tr_b16 v[46:47], v15 offset:11552
    ds_read_b64_tr_b16 v[48:49], v15 offset:9280
    v_mfma_f32_16x16x32_bf16 v[92:95], v[28:31], v[72:75], v[92:95]
    ds_read_b64_tr_b16 v[50:51], v15 offset:11584
    ds_read_b64_tr_b16 v[52:53], v15 offset:9312
    v_mfma_f32_16x16x32_bf16 v[96:99], v[32:35], v[72:75], v[96:99]
    ds_read_b64_tr_b16 v[54:55], v15 offset:11616
    ds_read_b64_tr_b16 v[56:57], v15 offset:9344
    v_mfma_f32_16x16x32_bf16 v[100:103], v[36:39], v[72:75], v[100:103]
    ds_read_b64_tr_b16 v[58:59], v15 offset:11648
    s_waitcnt vmcnt(5) lgkmcnt(0)
    s_barrier
    ds_read_b128 v[72:75], v240 offset:896
    ds_read_b64_tr_b16 v[20:21], v16 offset:0
    v_mfma_f32_16x16x32_bf16 v[84:87], v[40:43], v[76:79], v[84:87]
    ds_read_b64_tr_b16 v[22:23], v16 offset:2304
    ds_read_b64_tr_b16 v[24:25], v16 offset:32
    v_mfma_f32_16x16x32_bf16 v[88:91], v[44:47], v[76:79], v[88:91]
    ds_read_b64_tr_b16 v[26:27], v16 offset:2336
    ds_read_b64_tr_b16 v[28:29], v16 offset:64
    v_mfma_f32_16x16x32_bf16 v[92:95], v[48:51], v[76:79], v[92:95]
    ds_read_b64_tr_b16 v[30:31], v16 offset:2368
    ds_read_b64_tr_b16 v[32:33], v16 offset:96
    v_mfma_f32_16x16x32_bf16 v[96:99], v[52:55], v[76:79], v[96:99]
    ds_read_b64_tr_b16 v[34:35], v16 offset:2400
    ds_read_b64_tr_b16 v[36:37], v16 offset:128
    v_mfma_f32_16x16x32_bf16 v[100:103], v[56:59], v[76:79], v[100:103]
    ds_read_b64_tr_b16 v[38:39], v16 offset:2432
    s_waitcnt lgkmcnt(0)
    ds_read_b128 v[76:79], v240 offset:960
    ds_read_b64_tr_b16 v[40:41], v16 offset:9216
    v_mfma_f32_16x16x32_bf16 v[84:87], v[20:23], v[72:75], v[84:87]
    ds_read_b64_tr_b16 v[42:43], v16 offset:11520
    ds_read_b64_tr_b16 v[44:45], v16 offset:9248
    v_mfma_f32_16x16x32_bf16 v[88:91], v[24:27], v[72:75], v[88:91]
    ds_read_b64_tr_b16 v[46:47], v16 offset:11552
    ds_read_b64_tr_b16 v[48:49], v16 offset:9280
    v_mfma_f32_16x16x32_bf16 v[92:95], v[28:31], v[72:75], v[92:95]
    ds_read_b64_tr_b16 v[50:51], v16 offset:11584
    ds_read_b64_tr_b16 v[52:53], v16 offset:9312
    v_mfma_f32_16x16x32_bf16 v[96:99], v[32:35], v[72:75], v[96:99]
    ds_read_b64_tr_b16 v[54:55], v16 offset:11616
    ds_read_b64_tr_b16 v[56:57], v16 offset:9344
    v_mfma_f32_16x16x32_bf16 v[100:103], v[36:39], v[72:75], v[100:103]
    ds_read_b64_tr_b16 v[58:59], v16 offset:11648
    s_waitcnt vmcnt(0) lgkmcnt(0)
    s_barrier
    ds_read_b128 v[72:75], v240 offset:1024
    ds_read_b64_tr_b16 v[20:21], v13 offset:0
    v_mfma_f32_16x16x32_bf16 v[84:87], v[40:43], v[76:79], v[84:87]
    ds_read_b64_tr_b16 v[22:23], v13 offset:2304
    ds_read_b64_tr_b16 v[24:25], v13 offset:32
    v_mfma_f32_16x16x32_bf16 v[88:91], v[44:47], v[76:79], v[88:91]
    ds_read_b64_tr_b16 v[26:27], v13 offset:2336
    ds_read_b64_tr_b16 v[28:29], v13 offset:64
    v_mfma_f32_16x16x32_bf16 v[92:95], v[48:51], v[76:79], v[92:95]
    ds_read_b64_tr_b16 v[30:31], v13 offset:2368
    ds_read_b64_tr_b16 v[32:33], v13 offset:96
    v_mfma_f32_16x16x32_bf16 v[96:99], v[52:55], v[76:79], v[96:99]
    ds_read_b64_tr_b16 v[34:35], v13 offset:2400
    ds_read_b64_tr_b16 v[36:37], v13 offset:128
    v_mfma_f32_16x16x32_bf16 v[100:103], v[56:59], v[76:79], v[100:103]
    ds_read_b64_tr_b16 v[38:39], v13 offset:2432
    s_waitcnt lgkmcnt(0)
    ds_read_b128 v[76:79], v240 offset:1088
    ds_read_b64_tr_b16 v[40:41], v13 offset:9216
    v_mfma_f32_16x16x32_bf16 v[84:87], v[20:23], v[72:75], v[84:87]
    ds_read_b64_tr_b16 v[42:43], v13 offset:11520
    ds_read_b64_tr_b16 v[44:45], v13 offset:9248
    v_mfma_f32_16x16x32_bf16 v[88:91], v[24:27], v[72:75], v[88:91]
    ds_read_b64_tr_b16 v[46:47], v13 offset:11552
    ds_read_b64_tr_b16 v[48:49], v13 offset:9280
    v_mfma_f32_16x16x32_bf16 v[92:95], v[28:31], v[72:75], v[92:95]
    ds_read_b64_tr_b16 v[50:51], v13 offset:11584
    ds_read_b64_tr_b16 v[52:53], v13 offset:9312
    v_mfma_f32_16x16x32_bf16 v[96:99], v[32:35], v[72:75], v[96:99]
    ds_read_b64_tr_b16 v[54:55], v13 offset:11616
    ds_read_b64_tr_b16 v[56:57], v13 offset:9344
    v_mfma_f32_16x16x32_bf16 v[100:103], v[36:39], v[72:75], v[100:103]
    ds_read_b64_tr_b16 v[58:59], v13 offset:11648
    s_waitcnt lgkmcnt(0)
    s_barrier
    v_mfma_f32_16x16x32_bf16 v[84:87], v[40:43], v[76:79], v[84:87]
    v_mfma_f32_16x16x32_bf16 v[88:91], v[44:47], v[76:79], v[88:91]
    v_mfma_f32_16x16x32_bf16 v[92:95], v[48:51], v[76:79], v[92:95]
    v_mfma_f32_16x16x32_bf16 v[96:99], v[52:55], v[76:79], v[96:99]
    v_mfma_f32_16x16x32_bf16 v[100:103], v[56:59], v[76:79], v[100:103]
    s_waitcnt vmcnt(0)
    s_nop 7
    v_mov_b32 v130, 0
    v_mov_b32 v131, 0
    s_cmp_eq_u32 s66, 1
    s_cselect_b32 s60, 0, 1.0
    v_cvt_pk_bf16_f32 v120, v84, v85
    v_lshlrev_b32 v121, 16, v120
    v_and_b32 v122, 0xffff0000, v120
    v_lshlrev_b32 v123, 16, v60
    v_and_b32 v124, 0xffff0000, v60
    v_add_f32 v121, v121, v123
    v_add_f32 v122, v122, v124
    v_cvt_pk_bf16_f32 v60, v121, v122
    v_lshlrev_b32 v121, 16, v60
    v_and_b32 v122, 0xffff0000, v60
    v_mul_f32 v121, s60, v121
    v_mul_f32 v122, s60, v122
    v_add_f32 v130, v130, v121
    v_fmac_f32 v131, v121, v121
    v_add_f32 v130, v130, v122
    v_fmac_f32 v131, v122, v122
    v_cvt_pk_bf16_f32 v120, v86, v87
    v_lshlrev_b32 v121, 16, v120
    v_and_b32 v122, 0xffff0000, v120
    v_lshlrev_b32 v123, 16, v61
    v_and_b32 v124, 0xffff0000, v61
    v_add_f32 v121, v121, v123
    v_add_f32 v122, v122, v124
    v_cvt_pk_bf16_f32 v61, v121, v122
    v_lshlrev_b32 v121, 16, v61
    v_and_b32 v122, 0xffff0000, v61
    v_mul_f32 v121, s60, v121
    v_mul_f32 v122, s60, v122
    v_add_f32 v130, v130, v121
    v_fmac_f32 v131, v121, v121
    v_add_f32 v130, v130, v122
    v_fmac_f32 v131, v122, v122
    buffer_store_dwordx2 v[60:61], v128, s[40:43], 0 offen offset:0
    v_cvt_pk_bf16_f32 v120, v88, v89
    v_lshlrev_b32 v121, 16, v120
    v_and_b32 v122, 0xffff0000, v120
    v_lshlrev_b32 v123, 16, v62
    v_and_b32 v124, 0xffff0000, v62
    v_add_f32 v121, v121, v123
    v_add_f32 v122, v122, v124
    v_cvt_pk_bf16_f32 v62, v121, v122
    v_lshlrev_b32 v121, 16, v62
    v_and_b32 v122, 0xffff0000, v62
    v_add_f32 v130, v130, v121
    v_fmac_f32 v131, v121, v121
    v_add_f32 v130, v130, v122
    v_fmac_f32 v131, v122, v122
    v_cvt_pk_bf16_f32 v120, v90, v91
    v_lshlrev_b32 v121, 16, v120
    v_and_b32 v122, 0xffff0000, v120
    v_lshlrev_b32 v123, 16, v63
    v_and_b32 v124, 0xffff0000, v63
    v_add_f32 v121, v121, v123
    v_add_f32 v122, v122, v124
    v_cvt_pk_bf16_f32 v63, v121, v122
    v_lshlrev_b32 v121, 16, v63
    v_and_b32 v122, 0xffff0000, v63
    v_add_f32 v130, v130, v121
    v_fmac_f32 v131, v121, v121
    v_add_f32 v130, v130, v122
    v_fmac_f32 v131, v122, v122
    buffer_store_dwordx2 v[62:63], v128, s[40:43], 0 offen offset:32
    v_cvt_pk_bf16_f32 v120, v92, v93
    v_lshlrev_b32 v121, 16, v120
    v_and_b32 v122, 0xffff0000, v120
    v_lshlrev_b32 v123, 16, v64
    v_and_b32 v124, 0xffff0000, v64
    v_add_f32 v121, v121, v123
    v_add_f32 v122, v122, v124
    v_cvt_pk_bf16_f32 v64, v121, v122
    v_lshlrev_b32 v121, 16, v64
    v_and_b32 v122, 0xffff0000, v64
    v_add_f32 v130, v130, v121
    v_fmac_f32 v131, v121, v121
    v_add_f32 v130, v130, v122
    v_fmac_f32 v131, v122, v122
    v_cvt_pk_bf16_f32 v120, v94, v95
    v_lshlrev_b32 v121, 16, v120
    v_and_b32 v122, 0xffff0000, v120
    v_lshlrev_b32 v123, 16, v65
    v_and_b32 v124, 0xffff0000, v65
    v_add_f32 v121, v121, v123
    v_add_f32 v122, v122, v124
    v_cvt_pk_bf16_f32 v65, v121, v122
    v_lshlrev_b32 v121, 16, v65
    v_and_b32 v122, 0xffff0000, v65
    v_add_f32 v130, v130, v121
    v_fmac_f32 v131, v121, v121
    v_add_f32 v130, v130, v122
    v_fmac_f32 v131, v122, v122
    buffer_store_dwordx2 v[64:65], v128, s[40:43], 0 offen offset:64
    v_cvt_pk_bf16_f32 v120, v96, v97
    v_lshlrev_b32 v121, 16, v120
    v_and_b32 v122, 0xffff0000, v120
    v_lshlrev_b32 v123, 16, v66
    v_and_b32 v124, 0xffff0000, v66
    v_add_f32 v121, v121, v123
    v_add_f32 v122, v122, v124
    v_cvt_pk_bf16_f32 v66, v121, v122
    v_lshlrev_b32 v121, 16, v66
    v_and_b32 v122, 0xffff0000, v66
    v_add_f32 v130, v130, v121
    v_fmac_f32 v131, v121, v121
    v_add_f32 v130, v130, v122
    v_fmac_f32 v131, v122, v122
    v_cvt_pk_bf16_f32 v120, v98, v99
    v_lshlrev_b32 v121, 16, v120
    v_and_b32 v122, 0xffff0000, v120
    v_lshlrev_b32 v123, 16, v67
    v_and_b32 v124, 0xffff0000, v67
    v_add_f32 v121, v121, v123
    v_add_f32 v122, v122, v124
    v_cvt_pk_bf16_f32 v67, v121, v122
    v_lshlrev_b32 v121, 16, v67
    v_and_b32 v122, 0xffff0000, v67
    v_add_f32 v130, v130, v121
    v_fmac_f32 v131, v121, v121
    v_add_f32 v130, v130, v122
    v_fmac_f32 v131, v122, v122
    buffer_store_dwordx2 v[66:67], v128, s[40:43], 0 offen offset:96
    v_cvt_pk_bf16_f32 v120, v100, v101
    v_lshlrev_b32 v121, 16, v120
    v_and_b32 v122, 0xffff0000, v120
    v_lshlrev_b32 v123, 16, v68
    v_and_b32 v124, 0xffff0000, v68
    v_add_f32 v121, v121, v123
    v_add_f32 v122, v122, v124
    v_cvt_pk_bf16_f32 v68, v121, v122
    v_lshlrev_b32 v121, 16, v68
    v_and_b32 v122, 0xffff0000, v68
    v_add_f32 v130, v130, v121
    v_fmac_f32 v131, v121, v121
    v_add_f32 v130, v130, v122
    v_fmac_f32 v131, v122, v122
    v_cvt_pk_bf16_f32 v120, v102, v103
    v_lshlrev_b32 v121, 16, v120
    v_and_b32 v122, 0xffff0000, v120
    v_lshlrev_b32 v123, 16, v69
    v_and_b32 v124, 0xffff0000, v69
    v_add_f32 v121, v121, v123
    v_add_f32 v122, v122, v124
    v_cvt_pk_bf16_f32 v69, v121, v122
    v_lshlrev_b32 v121, 16, v69
    v_and_b32 v122, 0xffff0000, v69
    v_add_f32 v130, v130, v121
    v_fmac_f32 v131, v121, v121
    v_add_f32 v130, v130, v122
    v_fmac_f32 v131, v122, v122
    buffer_store_dwordx2 v[68:69], v128, s[40:43], 0 offen offset:128
    v_xor_b32 v122, 16, v1
    v_lshlrev_b32 v122, 2, v122
    v_xor_b32 v123, 32, v1
    v_lshlrev_b32 v123, 2, v123
    ds_bpermute_b32 v120, v122, v130
    ds_bpermute_b32 v121, v122, v131
    s_waitcnt lgkmcnt(0)
    v_add_f32 v130, v130, v120
    v_add_f32 v131, v131, v121
    ds_bpermute_b32 v120, v123, v130
    ds_bpermute_b32 v121, v123, v131
    s_waitcnt lgkmcnt(0)
    v_add_f32 v130, v130, v120
    v_add_f32 v131, v131, v121
    s_lshl_b32 s60, s65, 1
    s_add_u32 s60, s60, s66
    s_lshl_b32 s60, s60, 3
    v_lshlrev_b32 v120, 6, v129
    v_add_u32 v120, s60, v120
    s_mov_b64 exec, 0xffff
    buffer_store_dwordx2 v[130:131], v120, s[48:51], 0 offen
    s_mov_b64 exec, -1
k2_kernel_end:
    s_endpgm
.globl k3_kernel
.p2align 8
.type k3_kernel,@function
k3_kernel:
    s_cmp_ge_u32 s2, 256
    s_cbranch_scc1 k3_kernel_end
    s_load_dwordx16 s[4:19], s[0:1], 0
    s_load_dwordx8 s[20:27], s[0:1], 64
    v_and_b32 v1, 63, v0
    v_lshrrev_b32 v2, 6, v0
    s_nop 0
    v_readfirstlane_b32 s72, v2
    s_and_b32 s52, s72, 3
    s_lshr_b32 s72, s72, 2
    s_and_b32 s60, s2, 7
    s_lshr_b32 s61, s2, 3
    s_lshr_b32 s57, s60, 1
    s_lshl_b32 s57, s57, 2
    s_and_b32 s62, s61, 3
    s_add_u32 s57, s57, s62
    s_lshl_b32 s57, s57, 7
    s_and_b32 s65, s60, 1
    s_lshl_b32 s65, s65, 3
    s_lshr_b32 s62, s61, 2
    s_add_u32 s65, s65, s62
    s_mul_i32 s58, s65, 288
    s_waitcnt lgkmcnt(0)
    s_add_u32 s28, s26, 13631488
    s_addc_u32 s29, s27, 0
    s_and_b32 s29, s29, 0xffff
    s_mov_b32 s30, 2359296
    s_mov_b32 s31, 0x00020000
    s_add_u32 s32, s26, 71303168
    s_addc_u32 s33, s27, 0
    s_and_b32 s33, s33, 0xffff
    s_mov_b32 s34, 5308416
    s_mov_b32 s35, 0x00020000
    s_add_u32 s36, s26, 61865984
    s_addc_u32 s37, s27, 0
    s_and_b32 s37, s37, 0xffff
    s_mov_b32 s38, 18432
    s_mov_b32 s39, 0x00020000
    s_add_u32 s44, s26, 60817408
    s_addc_u32 s45, s27, 0
    s_and_b32 s45, s45, 0xffff
    s_mov_b32 s46, 131072
    s_mov_b32 s47, 0x00020000
    s_add_u32 s48, s26, 48234496
    s_addc_u32 s49, s27, 0
    s_and_b32 s49, s49, 0xffff
    s_mov_b32 s50, 16384
    s_mov_b32 s51, 0x00020000
    s_cmp_ge_u32 s65, 8
    s_mov_b32 s61, 16777216
    s_cselect_b32 s60, 27262976, s61
    s_add_u32 s40, s26, s60
    s_addc_u32 s41, s27, 0
    s_and_b32 s41, s41, 0xffff
    s_mov_b32 s42, 9437184
    s_mov_b32 s43, 0x00020000
    s_mul_i32 s63, s52, 32
    s_add_u32 s63, s63, s57
    s_mul_i32 s64, s65, 331776
    s_mul_i32 s53, s52, 4608
    s_add_u32 s53, s53, 65536
    s_lshl_b32 s60, s52, 4
    v_add_u32 v2, 0, v1
    v_mul_u32_u24 v3, 3641, v2
    v_lshrrev_b32 v3, 16, v3
    v_mul_u32_u24 v4, 18, v3
    v_sub_u32 v2, v2, v4
    v_and_b32 v4, 3, v3
    v_and_b32 v5, 4, v3
    v_lshl_or_b32 v4, v5, 1, v4
    v_and_b32 v5, 8, v3
    v_lshrrev_b32 v5, 1, v5
    v_or_b32 v4, v4, v5
    v_add_u32 v4, s60, v4
    s_mov_b32 s61, 288
    v_mul_lo_u32 v4, v4, s61
    v_lshlrev_b32 v2, 4, v2
    v_add_u32 v80, v4, v2
    v_add_u32 v80, s64, v80
    v_add_u32 v2, 64, v1
    v_mul_u32_u24 v3, 3641, v2
    v_lshrrev_b32 v3, 16, v3
    v_mul_u32_u24 v4, 18, v3
    v_sub_u32 v2, v2, v4
    v_and_b32 v4, 3, v3
    v_and_b32 v5, 4, v3
    v_lshl_or_b32 v4, v5, 1, v4
    v_and_b32 v5, 8, v3
    v_lshrrev_b32 v5, 1, v5
    v_or_b32 v4, v4, v5
    v_add_u32 v4, s60, v4
    s_mov_b32 s61, 288
    v_mul_lo_u32 v4, v4, s61
    v_lshlrev_b32 v2, 4, v2
    v_add_u32 v81, v4, v2
    v_add_u32 v81, s64, v81
    v_add_u32 v2, 128, v1
    v_mul_u32_u24 v3, 3641, v2
    v_lshrrev_b32 v3, 16, v3
    v_mul_u32_u24 v4, 18, v3
    v_sub_u32 v2, v2, v4
    v_and_b32 v4, 3, v3
    v_and_b32 v5, 4, v3
    v_lshl_or_b32 v4, v5, 1, v4
    v_and_b32 v5, 8, v3
    v_lshrrev_b32 v5, 1, v5
    v_or_b32 v4, v4, v5
    v_add_u32 v4, s60, v4
    s_mov_b32 s61, 288
    v_mul_lo_u32 v4, v4, s61
    v_lshlrev_b32 v2, 4, v2
    v_add_u32 v82, v4, v2
    v_add_u32 v82, s64, v82
    v_add_u32 v2, 192, v1
    v_mul_u32_u24 v3, 3641, v2
    v_lshrrev_b32 v3, 16, v3
    v_mul_u32_u24 v4, 18, v3
    v_sub_u32 v2, v2, v4
    v_and_b32 v4, 3, v3
    v_and_b32 v5, 4, v3
    v_lshl_or_b32 v4, v5, 1, v4
    v_and_b32 v5, 8, v3
    v_lshrrev_b32 v5, 1, v5
    v_or_b32 v4, v4, v5
    v_add_u32 v4, s60, v4
    s_mov_b32 s61, 288
    v_mul_lo_u32 v4, v4, s61
    v_lshlrev_b32 v2, 4, v2
    v_add_u32 v83, v4, v2
    v_add_u32 v83, s64, v83
    v_add_u32 v2, 256, v1
    v_mul_u32_u24 v3, 3641, v2
    v_lshrrev_b32 v3, 16, v3
    v_mul_u32_u24 v4, 18, v3
    v_sub_u32 v2, v2, v4
    v_and_b32 v4, 3, v3
    v_and_b32 v5, 4, v3
    v_lshl_or_b32 v4, v5, 1, v4
    v_and_b32 v5, 8, v3
    v_lshrrev_b32 v5, 1, v5
    v_or_b32 v4, v4, v5
    v_add_u32 v4, s60, v4
    s_mov_b32 s61, 288
    v_mul_lo_u32 v4, v4, s61
    v_lshlrev_b32 v2, 4, v2
    v_add_u32 v84, v4, v2
    v_add_u32 v84, s64, v84
    v_lshrrev_b32 v2, 5, v1
    v_lshlrev_b32 v2, 4, v2
    v_bfe_u32 v3, v1, 4, 1
    v_lshl_or_b32 v2, v3, 2, v2
    v_bfe_u32 v3, v1, 2, 2
    v_add_u32 v2, v2, v3
    v_mul_u32_u24 v2, 288, v2
    v_and_b32 v3, 3, v1
    v_lshl_add_u32 v2, v3, 3, v2
    v_add_u32 v85, 65536, v2
    v_add_u32 v86, 83968, v2
    v_add_u32 v87, 102400, v2
    v_add_u32 v88, 120832, v2
    s_mul_i32 s59, s52, 4096
    v_lshrrev_b32 v2, 3, v1
    v_and_b32 v3, 7, v1
    v_xor_b32 v3, v3, v2
    v_add_u32 v2, s63, v2
    s_mov_b32 s60, 1152
    v_mul_lo_u32 v2, v2, s60
    v_lshl_add_u32 v2, v3, 4, v2
    v_add_u32 v89, 0, v2
    v_add_u32 v90, 9216, v2
    v_add_u32 v91, 18432, v2
    v_add_u32 v92, 27648, v2
    v_and_b32 v2, 15, v1
    v_lshrrev_b32 v3, 4, v1
    v_and_b32 v4, 7, v1
    v_xor_b32 v3, v3, v4
    v_lshlrev_b32 v3, 4, v3
    v_lshl_add_u32 v2, v2, 7, v3
    v_add_u32 v93, s59, v2
    v_xor_b32 v94, 64, v93
    s_cmp_ge_u32 s65, 8
    s_movk_i32 s61, 4608
    s_cselect_b32 s68, 288, s61
    s_movk_i32 s61, 288
    s_cselect_b32 s69, 589824, s61
    s_and_b32 s60, s65, 7
    s_lshl_b32 s61, s69, 1
    s_mul_i32 s60, s60, s61
    s_mul_i32 s61, s63, s68
    s_add_u32 s60, s60, s61
    s_lshl_b32 s62, s52, 8
    v_add_u32 v248, 0, v1
    v_mul_u32_u24 v249, 3641, v248
    v_lshrrev_b32 v249, 16, v249
    v_mul_u32_u24 v250, 18, v249
    v_sub_u32 v248, v248, v250
    v_mul_lo_u32 v249, v249, s68
    v_lshl_add_u32 v248, v248, 4, v249
    v_add_u32 v226, s60, v248
    v_add_u32 v248, 64, v1
    v_mul_u32_u24 v249, 3641, v248
    v_lshrrev_b32 v249, 16, v249
    v_mul_u32_u24 v250, 18, v249
    v_sub_u32 v248, v248, v250
    v_mul_lo_u32 v249, v249, s68
    v_lshl_add_u32 v248, v248, 4, v249
    v_add_u32 v227, s60, v248
    v_add_u32 v248, 128, v1
    v_mul_u32_u24 v249, 3641, v248
    v_lshrrev_b32 v249, 16, v249
    v_mul_u32_u24 v250, 18, v249
    v_sub_u32 v248, v248, v250
    v_mul_lo_u32 v249, v249, s68
    v_lshl_add_u32 v248, v248, 4, v249
    v_add_u32 v228, s60, v248
    v_add_u32 v248, 192, v1
    v_mul_u32_u24 v249, 3641, v248
    v_lshrrev_b32 v249, 16, v249
    v_mul_u32_u24 v250, 18, v249
    v_sub_u32 v248, v248, v250
    v_mul_lo_u32 v249, v249, s68
    v_lshl_add_u32 v248, v248, 4, v249
    v_add_u32 v229, s60, v248
    v_add_u32 v248, 256, v1
    v_mul_u32_u24 v249, 3641, v248
    v_lshrrev_b32 v249, 16, v249
    v_mul_u32_u24 v250, 18, v249
    v_sub_u32 v248, v248, v250
    v_mul_lo_u32 v249, v249, s68
    v_lshl_add_u32 v248, v248, 4, v249
    v_add_u32 v230, s60, v248
    v_add_u32 v248, 320, v1
    v_mul_u32_u24 v249, 3641, v248
    v_lshrrev_b32 v249, 16, v249
    v_mul_u32_u24 v250, 18, v249
    v_sub_u32 v248, v248, v250
    v_mul_lo_u32 v249, v249, s68
    v_lshl_add_u32 v248, v248, 4, v249
    v_add_u32 v231, s60, v248
    v_add_u32 v248, 384, v1
    v_mul_u32_u24 v249, 3641, v248
    v_lshrrev_b32 v249, 16, v249
    v_mul_u32_u24 v250, 18, v249
    v_sub_u32 v248, v248, v250
    v_mul_lo_u32 v249, v249, s68
    v_lshl_add_u32 v248, v248, 4, v249
    v_add_u32 v232, s60, v248
    v_add_u32 v248, 448, v1
    v_mul_u32_u24 v249, 3641, v248
    v_lshrrev_b32 v249, 16, v249
    v_mul_u32_u24 v250, 18, v249
    v_sub_u32 v248, v248, v250
    v_mul_lo_u32 v249, v249, s68
    v_lshl_add_u32 v248, v248, 4, v249
    v_add_u32 v233, s60, v248
    v_add_u32 v248, 512, v1
    v_mul_u32_u24 v249, 3641, v248
    v_lshrrev_b32 v249, 16, v249
    v_mul_u32_u24 v250, 18, v249
    v_sub_u32 v248, v248, v250
    v_mul_lo_u32 v249, v249, s68
    v_lshl_add_u32 v248, v248, 4, v249
    v_add_u32 v234, s60, v248
    s_mul_i32 s61, s52, 4608
    s_add_u32 s61, s61, 139264
    v_and_b32 v248, 15, v1
    v_mul_u32_u24 v248, 288, v248
    v_lshrrev_b32 v249, 4, v1
    v_lshl_add_u32 v248, v249, 3, v248
    v_add_u32 v4, s61, v248
    v_lshlrev_b32 v248, 4, v1
    v_add_u32 v5, s61, v248
    v_mov_b32 v224, 0xc0135761
    v_mov_b32 v225, 0xbdd2d3e8
    v_xor_b32 v2, 16, v1
    v_lshlrev_b32 v2, 2, v2
    v_xor_b32 v3, 32, v1
    v_lshlrev_b32 v3, 2, v3
    s_cmp_eq_u32 s72, 0
    s_cbranch_scc1 k3_kernel_comp
    s_mov_b32 s55, 0
    s_mov_b32 s54, 0
    s_add_u32 m0, s59, 0
    s_nop 0
    buffer_load_dwordx4 v89, s[28:31], s55 offen lds
    s_add_u32 m0, s59, 1024
    s_nop 0
    buffer_load_dwordx4 v90, s[28:31], s55 offen lds
    s_add_u32 m0, s59, 2048
    s_nop 0
    buffer_load_dwordx4 v91, s[28:31], s55 offen lds
    s_add_u32 m0, s59, 3072
    s_nop 0
    buffer_load_dwordx4 v92, s[28:31], s55 offen lds
    s_add_u32 m0, s53, 0
    s_nop 0
    buffer_load_dwordx4 v80, s[32:35], s54 offen lds
    s_add_u32 m0, s53, 1024
    s_nop 0
    buffer_load_dwordx4 v81, s[32:35], s54 offen lds
    s_add_u32 m0, s53, 2048
    s_nop 0
    buffer_load_dwordx4 v82, s[32:35], s54 offen lds
    s_add_u32 m0, s53, 3072
    s_nop 0
    buffer_load_dwordx4 v83, s[32:35], s54 offen lds
    s_add_u32 m0, s53, 4096
    s_nop 0
    s_mov_b32 exec_hi, 0
    buffer_load_dwordx4 v84, s[32:35], s54 offen lds
    s_mov_b32 exec_hi, -1
    s_mov_b32 s55, 128
    s_mov_b32 s54, 18432
    s_add_u32 m0, s59, 16384
    s_nop 0
    buffer_load_dwordx4 v89, s[28:31], s55 offen lds
    s_add_u32 m0, s59, 17408
    s_nop 0
    buffer_load_dwordx4 v90, s[28:31], s55 offen lds
    s_add_u32 m0, s59, 18432
    s_nop 0
    buffer_load_dwordx4 v91, s[28:31], s55 offen lds
    s_add_u32 m0, s59, 19456
    s_nop 0
    buffer_load_dwordx4 v92, s[28:31], s55 offen lds
    s_add_u32 m0, s53, 18432
    s_nop 0
    buffer_load_dwordx4 v80, s[32:35], s54 offen lds
    s_add_u32 m0, s53, 19456
    s_nop 0
    buffer_load_dwordx4 v81, s[32:35], s54 offen lds
    s_add_u32 m0, s53, 20480
    s_nop 0
    buffer_load_dwordx4 v82, s[32:35], s54 offen lds
    s_add_u32 m0, s53, 21504
    s_nop 0
    buffer_load_dwordx4 v83, s[32:35], s54 offen lds
    s_add_u32 m0, s53, 22528
    s_nop 0
    s_mov_b32 exec_hi, 0
    buffer_load_dwordx4 v84, s[32:35], s54 offen lds
    s_mov_b32 exec_hi, -1
    s_mov_b32 s55, 256
    s_mov_b32 s54, 36864
    s_add_u32 m0, s59, 32768
    s_nop 0
    buffer_load_dwordx4 v89, s[28:31], s55 offen lds
    s_add_u32 m0, s59, 33792
    s_nop 0
    buffer_load_dwordx4 v90, s[28:31], s55 offen lds
    s_add_u32 m0, s59, 34816
    s_nop 0
    buffer_load_dwordx4 v91, s[28:31], s55 offen lds
    s_add_u32 m0, s59, 35840
    s_nop 0
    buffer_load_dwordx4 v92, s[28:31], s55 offen lds
    s_add_u32 m0, s53, 36864
    s_nop 0
    buffer_load_dwordx4 v80, s[32:35], s54 offen lds
    s_add_u32 m0, s53, 37888
    s_nop 0
    buffer_load_dwordx4 v81, s[32:35], s54 offen lds
    s_add_u32 m0, s53, 38912
    s_nop 0
    buffer_load_dwordx4 v82, s[32:35], s54 offen lds
    s_add_u32 m0, s53, 39936
    s_nop 0
    buffer_load_dwordx4 v83, s[32:35], s54 offen lds
    s_add_u32 m0, s53, 40960
    s_nop 0
    s_mov_b32 exec_hi, 0
    buffer_load_dwordx4 v84, s[32:35], s54 offen lds
    s_mov_b32 exec_hi, -1
    s_mov_b32 s55, 384
    s_mov_b32 s54, 55296
    s_add_u32 m0, s59, 49152
    s_nop 0
    buffer_load_dwordx4 v89, s[28:31], s55 offen lds
    s_add_u32 m0, s59, 50176
    s_nop 0
    buffer_load_dwordx4 v90, s[28:31], s55 offen lds
    s_add_u32 m0, s59, 51200
    s_nop 0
    buffer_load_dwordx4 v91, s[28:31], s55 offen lds
    s_add_u32 m0, s59, 52224
    s_nop 0
    buffer_load_dwordx4 v92, s[28:31], s55 offen lds
    s_add_u32 m0, s53, 55296
    s_nop 0
    buffer_load_dwordx4 v80, s[32:35], s54 offen lds
    s_add_u32 m0, s53, 56320
    s_nop 0
    buffer_load_dwordx4 v81, s[32:35], s54 offen lds
    s_add_u32 m0, s53, 57344
    s_nop 0
    buffer_load_dwordx4 v82, s[32:35], s54 offen lds
    s_add_u32 m0, s53, 58368
    s_nop 0
    buffer_load_dwordx4 v83, s[32:35], s54 offen lds
    s_add_u32 m0, s53, 59392
    s_nop 0
    s_mov_b32 exec_hi, 0
    buffer_load_dwordx4 v84, s[32:35], s54 offen lds
    s_mov_b32 exec_hi, -1
    s_waitcnt vmcnt(27)
    s_barrier
    s_waitcnt vmcnt(18)
    s_barrier
    s_mov_b32 s55, 512
    s_mov_b32 s54, 73728
    s_add_u32 m0, s59, 0
    s_nop 0
    buffer_load_dwordx4 v89, s[28:31], s55 offen lds
    s_add_u32 m0, s59, 1024
    s_nop 0
    buffer_load_dwordx4 v90, s[28:31], s55 offen lds
    s_add_u32 m0, s59, 2048
    s_nop 0
    buffer_load_dwordx4 v91, s[28:31], s55 offen lds
    s_add_u32 m0, s59, 3072
    s_nop 0
    buffer_load_dwordx4 v92, s[28:31], s55 offen lds
    s_add_u32 m0, s53, 0
    s_nop 0
    buffer_load_dwordx4 v80, s[32:35], s54 offen lds
    s_add_u32 m0, s53, 1024
    s_nop 0
    buffer_load_dwordx4 v81, s[32:35], s54 offen lds
    s_add_u32 m0, s53, 2048
    s_nop 0
    buffer_load_dwordx4 v82, s[32:35], s54 offen lds
    s_add_u32 m0, s53, 3072
    s_nop 0
    buffer_load_dwordx4 v83, s[32:35], s54 offen lds
    s_add_u32 m0, s53, 4096
    s_nop 0
    s_mov_b32 exec_hi, 0
    buffer_load_dwordx4 v84, s[32:35], s54 offen lds
    s_mov_b32 exec_hi, -1
    s_waitcnt vmcnt(18)
    s_barrier
    s_mov_b32 s55, 640
    s_mov_b32 s54, 92160
    s_add_u32 m0, s59, 16384
    s_nop 0
    buffer_load_dwordx4 v89, s[28:31], s55 offen lds
    s_add_u32 m0, s59, 17408
    s_nop 0
    buffer_load_dwordx4 v90, s[28:31], s55 offen lds
    s_add_u32 m0, s59, 18432
    s_nop 0
    buffer_load_dwordx4 v91, s[28:31], s55 offen lds
    s_add_u32 m0, s59, 19456
    s_nop 0
    buffer_load_dwordx4 v92, s[28:31], s55 offen lds
    s_add_u32 m0, s53, 18432
    s_nop 0
    buffer_load_dwordx4 v80, s[32:35], s54 offen lds
    s_add_u32 m0, s53, 19456
    s_nop 0
    buffer_load_dwordx4 v81, s[32:35], s54 offen lds
    s_add_u32 m0, s53, 20480
    s_nop 0
    buffer_load_dwordx4 v82, s[32:35], s54 offen lds
    s_add_u32 m0, s53, 21504
    s_nop 0
    buffer_load_dwordx4 v83, s[32:35], s54 offen lds
    s_add_u32 m0, s53, 22528
    s_nop 0
    s_mov_b32 exec_hi, 0
    buffer_load_dwordx4 v84, s[32:35], s54 offen lds
    s_mov_b32 exec_hi, -1
    s_waitcnt vmcnt(18)
    s_barrier
    s_mov_b32 s55, 768
    s_mov_b32 s54, 110592
    s_add_u32 m0, s59, 32768
    s_nop 0
    buffer_load_dwordx4 v89, s[28:31], s55 offen lds
    s_add_u32 m0, s59, 33792
    s_nop 0
    buffer_load_dwordx4 v90, s[28:31], s55 offen lds
    s_add_u32 m0, s59, 34816
    s_nop 0
    buffer_load_dwordx4 v91, s[28:31], s55 offen lds
    s_add_u32 m0, s59, 35840
    s_nop 0
    buffer_load_dwordx4 v92, s[28:31], s55 offen lds
    s_add_u32 m0, s53, 36864
    s_nop 0
    buffer_load_dwordx4 v80, s[32:35], s54 offen lds
    s_add_u32 m0, s53, 37888
    s_nop 0
    buffer_load_dwordx4 v81, s[32:35], s54 offen lds
    s_add_u32 m0, s53, 38912
    s_nop 0
    buffer_load_dwordx4 v82, s[32:35], s54 offen lds
    s_add_u32 m0, s53, 39936
    s_nop 0
    buffer_load_dwordx4 v83, s[32:35], s54 offen lds
    s_add_u32 m0, s53, 40960
    s_nop 0
    s_mov_b32 exec_hi, 0
    buffer_load_dwordx4 v84, s[32:35], s54 offen lds
    s_mov_b32 exec_hi, -1
    s_waitcnt vmcnt(18)
    s_barrier
    s_mov_b32 s55, 896
    s_mov_b32 s54, 129024
    s_add_u32 m0, s59, 49152
    s_nop 0
    buffer_load_dwordx4 v89, s[28:31], s55 offen lds
    s_add_u32 m0, s59, 50176
    s_nop 0
    buffer_load_dwordx4 v90, s[28:31], s55 offen lds
    s_add_u32 m0, s59, 51200
    s_nop 0
    buffer_load_dwordx4 v91, s[28:31], s55 offen lds
    s_add_u32 m0, s59, 52224
    s_nop 0
    buffer_load_dwordx4 v92, s[28:31], s55 offen lds
    s_add_u32 m0, s53, 55296
    s_nop 0
    buffer_load_dwordx4 v80, s[32:35], s54 offen lds
    s_add_u32 m0, s53, 56320
    s_nop 0
    buffer_load_dwordx4 v81, s[32:35], s54 offen lds
    s_add_u32 m0, s53, 57344
    s_nop 0
    buffer_load_dwordx4 v82, s[32:35], s54 offen lds
    s_add_u32 m0, s53, 58368
    s_nop 0
    buffer_load_dwordx4 v83, s[32:35], s54 offen lds
    s_add_u32 m0, s53, 59392
    s_nop 0
    s_mov_b32 exec_hi, 0
    buffer_load_dwordx4 v84, s[32:35], s54 offen lds
    s_mov_b32 exec_hi, -1
    s_waitcnt vmcnt(18)
    s_barrier
    s_mov_b32 s55, 1024
    s_mov_b32 s54, 147456
    s_add_u32 m0, s59, 0
    s_nop 0
    buffer_load_dwordx4 v89, s[28:31], s55 offen lds
    s_add_u32 m0, s59, 1024
    s_nop 0
    buffer_load_dwordx4 v90, s[28:31], s55 offen lds
    s_add_u32 m0, s59, 2048
    s_nop 0
    buffer_load_dwordx4 v91, s[28:31], s55 offen lds
    s_add_u32 m0, s59, 3072
    s_nop 0
    buffer_load_dwordx4 v92, s[28:31], s55 offen lds
    s_add_u32 m0, s53, 0
    s_nop 0
    buffer_load_dwordx4 v80, s[32:35], s54 offen lds
    s_add_u32 m0, s53, 1024
    s_nop 0
    buffer_load_dwordx4 v81, s[32:35], s54 offen lds
    s_add_u32 m0, s53, 2048
    s_nop 0
    buffer_load_dwordx4 v82, s[32:35], s54 offen lds
    s_add_u32 m0, s53, 3072
    s_nop 0
    buffer_load_dwordx4 v83, s[32:35], s54 offen lds
    s_add_u32 m0, s53, 4096
    s_nop 0
    s_mov_b32 exec_hi, 0
    buffer_load_dwordx4 v84, s[32:35], s54 offen lds
    s_mov_b32 exec_hi, -1
    s_waitcnt vmcnt(18)
    s_barrier
    s_mov_b32 s55, 0
    s_mov_b32 s54, 165888
    s_add_u32 m0, s59, 16384
    s_nop 0
    buffer_load_dwordx4 v89, s[28:31], s55 offen lds
    s_add_u32 m0, s59, 17408
    s_nop 0
    buffer_load_dwordx4 v90, s[28:31], s55 offen lds
    s_add_u32 m0, s59, 18432
    s_nop 0
    buffer_load_dwordx4 v91, s[28:31], s55 offen lds
    s_add_u32 m0, s59, 19456
    s_nop 0
    buffer_load_dwordx4 v92, s[28:31], s55 offen lds
    s_add_u32 m0, s53, 18432
    s_nop 0
    buffer_load_dwordx4 v80, s[32:35], s54 offen lds
    s_add_u32 m0, s53, 19456
    s_nop 0
    buffer_load_dwordx4 v81, s[32:35], s54 offen lds
    s_add_u32 m0, s53, 20480
    s_nop 0
    buffer_load_dwordx4 v82, s[32:35], s54 offen lds
    s_add_u32 m0, s53, 21504
    s_nop 0
    buffer_load_dwordx4 v83, s[32:35], s54 offen lds
    s_add_u32 m0, s53, 22528
    s_nop 0
    s_mov_b32 exec_hi, 0
    buffer_load_dwordx4 v84, s[32:35], s54 offen lds
    s_mov_b32 exec_hi, -1
    s_waitcnt vmcnt(18)
    s_barrier
    s_mov_b32 s55, 128
    s_mov_b32 s54, 184320
    s_add_u32 m0, s59, 32768
    s_nop 0
    buffer_load_dwordx4 v89, s[28:31], s55 offen lds
    s_add_u32 m0, s59, 33792
    s_nop 0
    buffer_load_dwordx4 v90, s[28:31], s55 offen lds
    s_add_u32 m0, s59, 34816
    s_nop 0
    buffer_load_dwordx4 v91, s[28:31], s55 offen lds
    s_add_u32 m0, s59, 35840
    s_nop 0
    buffer_load_dwordx4 v92, s[28:31], s55 offen lds
    s_add_u32 m0, s53, 36864
    s_nop 0
    buffer_load_dwordx4 v80, s[32:35], s54 offen lds
    s_add_u32 m0, s53, 37888
    s_nop 0
    buffer_load_dwordx4 v81, s[32:35], s54 offen lds
    s_add_u32 m0, s53, 38912
    s_nop 0
    buffer_load_dwordx4 v82, s[32:35], s54 offen lds
    s_add_u32 m0, s53, 39936
    s_nop 0
    buffer_load_dwordx4 v83, s[32:35], s54 offen lds
    s_add_u32 m0, s53, 40960
    s_nop 0
    s_mov_b32 exec_hi, 0
    buffer_load_dwordx4 v84, s[32:35], s54 offen lds
    s_mov_b32 exec_hi, -1
    s_waitcnt vmcnt(18)
    s_barrier
    s_mov_b32 s55, 256
    s_mov_b32 s54, 202752
    s_add_u32 m0, s59, 49152
    s_nop 0
    buffer_load_dwordx4 v89, s[28:31], s55 offen lds
    s_add_u32 m0, s59, 50176
    s_nop 0
    buffer_load_dwordx4 v90, s[28:31], s55 offen lds
    s_add_u32 m0, s59, 51200
    s_nop 0
    buffer_load_dwordx4 v91, s[28:31], s55 offen lds
    s_add_u32 m0, s59, 52224
    s_nop 0
    buffer_load_dwordx4 v92, s[28:31], s55 offen lds
    s_add_u32 m0, s53, 55296
    s_nop 0
    buffer_load_dwordx4 v80, s[32:35], s54 offen lds
    s_add_u32 m0, s53, 56320
    s_nop 0
    buffer_load_dwordx4 v81, s[32:35], s54 offen lds
    s_add_u32 m0, s53, 57344
    s_nop 0
    buffer_load_dwordx4 v82, s[32:35], s54 offen lds
    s_add_u32 m0, s53, 58368
    s_nop 0
    buffer_load_dwordx4 v83, s[32:35], s54 offen lds
    s_add_u32 m0, s53, 59392
    s_nop 0
    s_mov_b32 exec_hi, 0
    buffer_load_dwordx4 v84, s[32:35], s54 offen lds
    s_mov_b32 exec_hi, -1
    s_waitcnt vmcnt(18)
    s_barrier
    s_mov_b32 s55, 384
    s_mov_b32 s54, 221184
    s_add_u32 m0, s59, 0
    s_nop 0
    buffer_load_dwordx4 v89, s[28:31], s55 offen lds
    s_add_u32 m0, s59, 1024
    s_nop 0
    buffer_load_dwordx4 v90, s[28:31], s55 offen lds
    s_add_u32 m0, s59, 2048
    s_nop 0
    buffer_load_dwordx4 v91, s[28:31], s55 offen lds
    s_add_u32 m0, s59, 3072
    s_nop 0
    buffer_load_dwordx4 v92, s[28:31], s55 offen lds
    s_add_u32 m0, s53, 0
    s_nop 0
    buffer_load_dwordx4 v80, s[32:35], s54 offen lds
    s_add_u32 m0, s53, 1024
    s_nop 0
    buffer_load_dwordx4 v81, s[32:35], s54 offen lds
    s_add_u32 m0, s53, 2048
    s_nop 0
    buffer_load_dwordx4 v82, s[32:35], s54 offen lds
    s_add_u32 m0, s53, 3072
    s_nop 0
    buffer_load_dwordx4 v83, s[32:35], s54 offen lds
    s_add_u32 m0, s53, 4096
    s_nop 0
    s_mov_b32 exec_hi, 0
    buffer_load_dwordx4 v84, s[32:35], s54 offen lds
    s_mov_b32 exec_hi, -1
    s_waitcnt vmcnt(18)
    s_barrier
    s_mov_b32 s55, 512
    s_mov_b32 s54, 239616
    s_add_u32 m0, s59, 16384
    s_nop 0
    buffer_load_dwordx4 v89, s[28:31], s55 offen lds
    s_add_u32 m0, s59, 17408
    s_nop 0
    buffer_load_dwordx4 v90, s[28:31], s55 offen lds
    s_add_u32 m0, s59, 18432
    s_nop 0
    buffer_load_dwordx4 v91, s[28:31], s55 offen lds
    s_add_u32 m0, s59, 19456
    s_nop 0
    buffer_load_dwordx4 v92, s[28:31], s55 offen lds
    s_add_u32 m0, s53, 18432
    s_nop 0
    buffer_load_dwordx4 v80, s[32:35], s54 offen lds
    s_add_u32 m0, s53, 19456
    s_nop 0
    buffer_load_dwordx4 v81, s[32:35], s54 offen lds
    s_add_u32 m0, s53, 20480
    s_nop 0
    buffer_load_dwordx4 v82, s[32:35], s54 offen lds
    s_add_u32 m0, s53, 21504
    s_nop 0
    buffer_load_dwordx4 v83, s[32:35], s54 offen lds
    s_add_u32 m0, s53, 22528
    s_nop 0
    s_mov_b32 exec_hi, 0
    buffer_load_dwordx4 v84, s[32:35], s54 offen lds
    s_mov_b32 exec_hi, -1
    s_waitcnt vmcnt(18)
    s_barrier
    s_mov_b32 s55, 640
    s_mov_b32 s54, 258048
    s_add_u32 m0, s59, 32768
    s_nop 0
    buffer_load_dwordx4 v89, s[28:31], s55 offen lds
    s_add_u32 m0, s59, 33792
    s_nop 0
    buffer_load_dwordx4 v90, s[28:31], s55 offen lds
    s_add_u32 m0, s59, 34816
    s_nop 0
    buffer_load_dwordx4 v91, s[28:31], s55 offen lds
    s_add_u32 m0, s59, 35840
    s_nop 0
    buffer_load_dwordx4 v92, s[28:31], s55 offen lds
    s_add_u32 m0, s53, 36864
    s_nop 0
    buffer_load_dwordx4 v80, s[32:35], s54 offen lds
    s_add_u32 m0, s53, 37888
    s_nop 0
    buffer_load_dwordx4 v81, s[32:35], s54 offen lds
    s_add_u32 m0, s53, 38912
    s_nop 0
    buffer_load_dwordx4 v82, s[32:35], s54 offen lds
    s_add_u32 m0, s53, 39936
    s_nop 0
    buffer_load_dwordx4 v83, s[32:35], s54 offen lds
    s_add_u32 m0, s53, 40960
    s_nop 0
    s_mov_b32 exec_hi, 0
    buffer_load_dwordx4 v84, s[32:35], s54 offen lds
    s_mov_b32 exec_hi, -1
    s_waitcnt vmcnt(18)
    s_barrier
    s_mov_b32 s55, 768
    s_mov_b32 s54, 276480
    s_add_u32 m0, s59, 49152
    s_nop 0
    buffer_load_dwordx4 v89, s[28:31], s55 offen lds
    s_add_u32 m0, s59, 50176
    s_nop 0
    buffer_load_dwordx4 v90, s[28:31], s55 offen lds
    s_add_u32 m0, s59, 51200
    s_nop 0
    buffer_load_dwordx4 v91, s[28:31], s55 offen lds
    s_add_u32 m0, s59, 52224
    s_nop 0
    buffer_load_dwordx4 v92, s[28:31], s55 offen lds
    s_add_u32 m0, s53, 55296
    s_nop 0
    buffer_load_dwordx4 v80, s[32:35], s54 offen lds
    s_add_u32 m0, s53, 56320
    s_nop 0
    buffer_load_dwordx4 v81, s[32:35], s54 offen lds
    s_add_u32 m0, s53, 57344
    s_nop 0
    buffer_load_dwordx4 v82, s[32:35], s54 offen lds
    s_add_u32 m0, s53, 58368
    s_nop 0
    buffer_load_dwordx4 v83, s[32:35], s54 offen lds
    s_add_u32 m0, s53, 59392
    s_nop 0
    s_mov_b32 exec_hi, 0
    buffer_load_dwordx4 v84, s[32:35], s54 offen lds
    s_mov_b32 exec_hi, -1
    s_waitcnt vmcnt(18)
    s_barrier
    s_mov_b32 s55, 896
    s_mov_b32 s54, 294912
    s_add_u32 m0, s59, 0
    s_nop 0
    buffer_load_dwordx4 v89, s[28:31], s55 offen lds
    s_add_u32 m0, s59, 1024
    s_nop 0
    buffer_load_dwordx4 v90, s[28:31], s55 offen lds
    s_add_u32 m0, s59, 2048
    s_nop 0
    buffer_load_dwordx4 v91, s[28:31], s55 offen lds
    s_add_u32 m0, s59, 3072
    s_nop 0
    buffer_load_dwordx4 v92, s[28:31], s55 offen lds
    s_add_u32 m0, s53, 0
    s_nop 0
    buffer_load_dwordx4 v80, s[32:35], s54 offen lds
    s_add_u32 m0, s53, 1024
    s_nop 0
    buffer_load_dwordx4 v81, s[32:35], s54 offen lds
    s_add_u32 m0, s53, 2048
    s_nop 0
    buffer_load_dwordx4 v82, s[32:35], s54 offen lds
    s_add_u32 m0, s53, 3072
    s_nop 0
    buffer_load_dwordx4 v83, s[32:35], s54 offen lds
    s_add_u32 m0, s53, 4096
    s_nop 0
    s_mov_b32 exec_hi, 0
    buffer_load_dwordx4 v84, s[32:35], s54 offen lds
    s_mov_b32 exec_hi, -1
    s_waitcnt vmcnt(18)
    s_barrier
    s_mov_b32 s55, 1024
    s_mov_b32 s54, 313344
    s_add_u32 m0, s59, 16384
    s_nop 0
    buffer_load_dwordx4 v89, s[28:31], s55 offen lds
    s_add_u32 m0, s59, 17408
    s_nop 0
    buffer_load_dwordx4 v90, s[28:31], s55 offen lds
    s_add_u32 m0, s59, 18432
    s_nop 0
    buffer_load_dwordx4 v91, s[28:31], s55 offen lds
    s_add_u32 m0, s59, 19456
    s_nop 0
    buffer_load_dwordx4 v92, s[28:31], s55 offen lds
    s_add_u32 m0, s53, 18432
    s_nop 0
    buffer_load_dwordx4 v80, s[32:35], s54 offen lds
    s_add_u32 m0, s53, 19456
    s_nop 0
    buffer_load_dwordx4 v81, s[32:35], s54 offen lds
    s_add_u32 m0, s53, 20480
    s_nop 0
    buffer_load_dwordx4 v82, s[32:35], s54 offen lds
    s_add_u32 m0, s53, 21504
    s_nop 0
    buffer_load_dwordx4 v83, s[32:35], s54 offen lds
    s_add_u32 m0, s53, 22528
    s_nop 0
    s_mov_b32 exec_hi, 0
    buffer_load_dwordx4 v84, s[32:35], s54 offen lds
    s_mov_b32 exec_hi, -1
    s_waitcnt vmcnt(18)
    s_barrier
    s_waitcnt vmcnt(9)
    s_barrier
    s_waitcnt vmcnt(0)
    s_barrier
    s_waitcnt vmcnt(0)
    s_barrier
    s_branch k3_kernel_end
k3_kernel_comp:
    v_and_b32 v248, 15, v1
    v_add_u32 v248, s63, v248
    v_mul_u32_u24 v6, 64, v248
    buffer_load_dwordx4 v[8:11], v6, s[44:47], 0 offen offset:0
    buffer_load_dwordx4 v[12:15], v6, s[44:47], 0 offen offset:16
    buffer_load_dwordx4 v[16:19], v6, s[44:47], 0 offen offset:32
    buffer_load_dwordx4 v[20:23], v6, s[44:47], 0 offen offset:48
    buffer_load_dwordx4 v[32:35], v6, s[44:47], 0 offen offset:1024
    buffer_load_dwordx4 v[36:39], v6, s[44:47], 0 offen offset:1040
    buffer_load_dwordx4 v[40:43], v6, s[44:47], 0 offen offset:1056
    buffer_load_dwordx4 v[44:47], v6, s[44:47], 0 offen offset:1072
    v_lshrrev_b32 v248, 4, v1
    v_lshlrev_b32 v248, 4, v248
    s_lshl_b32 s60, s58, 2
    v_add_u32 v6, s60, v248
    buffer_load_dwordx4 v[184:187], v6, s[36:39], 0 offen offset:0
    buffer_load_dwordx4 v[188:191], v6, s[36:39], 0 offen offset:64
    buffer_load_dwordx4 v[192:195], v6, s[36:39], 0 offen offset:128
    buffer_load_dwordx4 v[196:199], v6, s[36:39], 0 offen offset:192
    buffer_load_dwordx4 v[200:203], v6, s[36:39], 0 offen offset:256
    buffer_load_dwordx4 v[204:207], v6, s[36:39], 0 offen offset:320
    buffer_load_dwordx4 v[208:211], v6, s[36:39], 0 offen offset:384
    buffer_load_dwordx4 v[212:215], v6, s[36:39], 0 offen offset:448
    buffer_load_dwordx4 v[216:219], v6, s[36:39], 0 offen offset:512
    s_waitcnt vmcnt(9)
    v_add_f32 v8, v8, v10
    v_add_f32 v9, v9, v11
    v_add_f32 v8, v8, v12
    v_add_f32 v9, v9, v13
    v_add_f32 v8, v8, v14
    v_add_f32 v9, v9, v15
    v_add_f32 v8, v8, v16
    v_add_f32 v9, v9, v17
    v_add_f32 v8, v8, v18
    v_add_f32 v9, v9, v19
    v_add_f32 v8, v8, v20
    v_add_f32 v9, v9, v21
    v_add_f32 v8, v8, v22
    v_add_f32 v9, v9, v23
    v_mul_f32 v220, 0.001736111111111111, v8
    v_mul_f32 v222, 0.001736111111111111, v9
    v_fma_f32 v222, -v220, v220, v222
    v_max_f32 v222, 0, v222
    v_cvt_pk_bf16_f32 v248, v220, v220
    v_lshlrev_b32 v220, 16, v248
    v_cvt_pk_bf16_f32 v248, v222, v222
    v_lshlrev_b32 v222, 16, v248
    v_add_f32 v222, 0x3727c5ac, v222
    v_cvt_pk_bf16_f32 v248, v222, v222
    v_lshlrev_b32 v222, 16, v248
    v_sqrt_f32 v222, v222
    s_nop 0
    v_cvt_pk_bf16_f32 v248, v222, v222
    v_lshlrev_b32 v222, 16, v248
    v_rcp_f32 v222, v222
    s_nop 0
    v_sub_f32 v220, 0, v220
    v_add_f32 v32, v32, v34
    v_add_f32 v33, v33, v35
    v_add_f32 v32, v32, v36
    v_add_f32 v33, v33, v37
    v_add_f32 v32, v32, v38
    v_add_f32 v33, v33, v39
    v_add_f32 v32, v32, v40
    v_add_f32 v33, v33, v41
    v_add_f32 v32, v32, v42
    v_add_f32 v33, v33, v43
    v_add_f32 v32, v32, v44
    v_add_f32 v33, v33, v45
    v_add_f32 v32, v32, v46
    v_add_f32 v33, v33, v47
    v_mul_f32 v221, 0.001736111111111111, v32
    v_mul_f32 v223, 0.001736111111111111, v33
    v_fma_f32 v223, -v221, v221, v223
    v_max_f32 v223, 0, v223
    v_cvt_pk_bf16_f32 v248, v221, v221
    v_lshlrev_b32 v221, 16, v248
    v_cvt_pk_bf16_f32 v248, v223, v223
    v_lshlrev_b32 v223, 16, v248
    v_add_f32 v223, 0x3727c5ac, v223
    v_cvt_pk_bf16_f32 v248, v223, v223
    v_lshlrev_b32 v223, 16, v248
    v_sqrt_f32 v223, v223
    s_nop 0
    v_cvt_pk_bf16_f32 v248, v223, v223
    v_lshlrev_b32 v223, 16, v248
    v_rcp_f32 v223, v223
    s_nop 0
    v_sub_f32 v221, 0, v221
    v_mov_b32 v8, 0
    v_mov_b32 v9, 0
    v_mov_b32 v10, 0
    v_mov_b32 v11, 0
    v_mov_b32 v12, 0
    v_mov_b32 v13, 0
    v_mov_b32 v14, 0
    v_mov_b32 v15, 0
    v_mov_b32 v16, 0
    v_mov_b32 v17, 0
    v_mov_b32 v18, 0
    v_mov_b32 v19, 0
    v_mov_b32 v20, 0
    v_mov_b32 v21, 0
    v_mov_b32 v22, 0
    v_mov_b32 v23, 0
    v_mov_b32 v24, 0
    v_mov_b32 v25, 0
    v_mov_b32 v26, 0
    v_mov_b32 v27, 0
    v_mov_b32 v28, 0
    v_mov_b32 v29, 0
    v_mov_b32 v30, 0
    v_mov_b32 v31, 0
    v_mov_b32 v32, 0
    v_mov_b32 v33, 0
    v_mov_b32 v34, 0
    v_mov_b32 v35, 0
    v_mov_b32 v36, 0
    v_mov_b32 v37, 0
    v_mov_b32 v38, 0
    v_mov_b32 v39, 0
    v_mov_b32 v40, 0
    v_mov_b32 v41, 0
    v_mov_b32 v42, 0
    v_mov_b32 v43, 0
    v_mov_b32 v44, 0
    v_mov_b32 v45, 0
    v_mov_b32 v46, 0
    v_mov_b32 v47, 0
    v_mov_b32 v48, 0
    v_mov_b32 v49, 0
    v_mov_b32 v50, 0
    v_mov_b32 v51, 0
    v_mov_b32 v52, 0
    v_mov_b32 v53, 0
    v_mov_b32 v54, 0
    v_mov_b32 v55, 0
    v_mov_b32 v56, 0
    v_mov_b32 v57, 0
    v_mov_b32 v58, 0
    v_mov_b32 v59, 0
    v_mov_b32 v60, 0
    v_mov_b32 v61, 0
    v_mov_b32 v62, 0
    v_mov_b32 v63, 0
    v_mov_b32 v64, 0
    v_mov_b32 v65, 0
    v_mov_b32 v66, 0
    v_mov_b32 v67, 0
    v_mov_b32 v68, 0
    v_mov_b32 v69, 0
    v_mov_b32 v70, 0
    v_mov_b32 v71, 0
    v_mov_b32 v72, 0
    v_mov_b32 v73, 0
    v_mov_b32 v74, 0
    v_mov_b32 v75, 0
    v_mov_b32 v76, 0
    v_mov_b32 v77, 0
    v_mov_b32 v78, 0
    v_mov_b32 v79, 0
    s_barrier
    ds_read_b128 v[168:171], v93 offset:0
    ds_read_b128 v[172:175], v93 offset:2048
    ds_read_b64_tr_b16 v[96:97], v85 offset:0
    ds_read_b64_tr_b16 v[98:99], v85 offset:2304
    ds_read_b64_tr_b16 v[100:101], v85 offset:32
    ds_read_b64_tr_b16 v[102:103], v85 offset:2336
    ds_read_b64_tr_b16 v[104:105], v85 offset:64
    ds_read_b64_tr_b16 v[106:107], v85 offset:2368
    ds_read_b64_tr_b16 v[108:109], v85 offset:96
    ds_read_b64_tr_b16 v[110:111], v85 offset:2400
    ds_read_b64_tr_b16 v[112:113], v85 offset:128
    ds_read_b64_tr_b16 v[114:115], v85 offset:2432
    ds_read_b64_tr_b16 v[116:117], v85 offset:160
    ds_read_b64_tr_b16 v[118:119], v85 offset:2464
    ds_read_b64_tr_b16 v[120:121], v85 offset:192
    ds_read_b64_tr_b16 v[122:123], v85 offset:2496
    ds_read_b64_tr_b16 v[124:125], v85 offset:224
    ds_read_b64_tr_b16 v[126:127], v85 offset:2528
    ds_read_b64_tr_b16 v[128:129], v85 offset:256
    ds_read_b64_tr_b16 v[130:131], v85 offset:2560
    s_waitcnt lgkmcnt(0)
    ds_read_b128 v[176:179], v94 offset:0
    ds_read_b128 v[180:183], v94 offset:2048
    v_mfma_f32_16x16x32_bf16 v[8:11], v[96:99], v[168:171], v[8:11]
    ds_read_b64_tr_b16 v[132:133], v85 offset:9216
    ds_read_b64_tr_b16 v[134:135], v85 offset:11520
    v_mfma_f32_16x16x32_bf16 v[44:47], v[96:99], v[172:175], v[44:47]
    ds_read_b64_tr_b16 v[136:137], v85 offset:9248
    ds_read_b64_tr_b16 v[138:139], v85 offset:11552
    v_mfma_f32_16x16x32_bf16 v[12:15], v[100:103], v[168:171], v[12:15]
    ds_read_b64_tr_b16 v[140:141], v85 offset:9280
    ds_read_b64_tr_b16 v[142:143], v85 offset:11584
    v_mfma_f32_16x16x32_bf16 v[48:51], v[100:103], v[172:175], v[48:51]
    ds_read_b64_tr_b16 v[144:145], v85 offset:9312
    ds_read_b64_tr_b16 v[146:147], v85 offset:11616
    v_mfma_f32_16x16x32_bf16 v[16:19], v[104:107], v[168:171], v[16:19]
    ds_read_b64_tr_b16 v[148:149], v85 offset:9344
    ds_read_b64_tr_b16 v[150:151], v85 offset:11648
    v_mfma_f32_16x16x32_bf16 v[52:55], v[104:107], v[172:175], v[52:55]
    ds_read_b64_tr_b16 v[152:153], v85 offset:9376
    ds_read_b64_tr_b16 v[154:155], v85 offset:11680
    v_mfma_f32_16x16x32_bf16 v[20:23], v[108:111], v[168:171], v[20:23]
    ds_read_b64_tr_b16 v[156:157], v85 offset:9408
    ds_read_b64_tr_b16 v[158:159], v85 offset:11712
    v_mfma_f32_16x16x32_bf16 v[56:59], v[108:111], v[172:175], v[56:59]
    ds_read_b64_tr_b16 v[160:161], v85 offset:9440
    ds_read_b64_tr_b16 v[162:163], v85 offset:11744
    v_mfma_f32_16x16x32_bf16 v[24:27], v[112:115], v[168:171], v[24:27]
    ds_read_b64_tr_b16 v[164:165], v85 offset:9472
    ds_read_b64_tr_b16 v[166:167], v85 offset:11776
    v_mfma_f32_16x16x32_bf16 v[60:63], v[112:115], v[172:175], v[60:63]
    v_mfma_f32_16x16x32_bf16 v[28:31], v[116:119], v[168:171], v[28:31]
    v_mfma_f32_16x16x32_bf16 v[64:67], v[116:119], v[172:175], v[64:67]
    v_mfma_f32_16x16x32_bf16 v[32:35], v[120:123], v[168:171], v[32:35]
    v_mfma_f32_16x16x32_bf16 v[68:71], v[120:123], v[172:175], v[68:71]
    v_mfma_f32_16x16x32_bf16 v[36:39], v[124:127], v[168:171], v[36:39]
    v_mfma_f32_16x16x32_bf16 v[72:75], v[124:127], v[172:175], v[72:75]
    v_mfma_f32_16x16x32_bf16 v[40:43], v[128:131], v[168:171], v[40:43]
    v_mfma_f32_16x16x32_bf16 v[76:79], v[128:131], v[172:175], v[76:79]
    s_waitcnt lgkmcnt(0)
    s_barrier
    ds_read_b128 v[168:171], v93 offset:16384
    ds_read_b128 v[172:175], v93 offset:18432
    v_mfma_f32_16x16x32_bf16 v[8:11], v[132:135], v[176:179], v[8:11]
    ds_read_b64_tr_b16 v[96:97], v86 offset:0
    ds_read_b64_tr_b16 v[98:99], v86 offset:2304
    v_mfma_f32_16x16x32_bf16 v[44:47], v[132:135], v[180:183], v[44:47]
    ds_read_b64_tr_b16 v[100:101], v86 offset:32
    ds_read_b64_tr_b16 v[102:103], v86 offset:2336
    v_mfma_f32_16x16x32_bf16 v[12:15], v[136:139], v[176:179], v[12:15]
    ds_read_b64_tr_b16 v[104:105], v86 offset:64
    ds_read_b64_tr_b16 v[106:107], v86 offset:2368
    v_mfma_f32_16x16x32_bf16 v[48:51], v[136:139], v[180:183], v[48:51]
    ds_read_b64_tr_b16 v[108:109], v86 offset:96
    ds_read_b64_tr_b16 v[110:111], v86 offset:2400
    v_mfma_f32_16x16x32_bf16 v[16:19], v[140:143], v[176:179], v[16:19]
    ds_read_b64_tr_b16 v[112:113], v86 offset:128
    ds_read_b64_tr_b16 v[114:115], v86 offset:2432
    v_mfma_f32_16x16x32_bf16 v[52:55], v[140:143], v[180:183], v[52:55]
    ds_read_b64_tr_b16 v[116:117], v86 offset:160
    ds_read_b64_tr_b16 v[118:119], v86 offset:2464
    v_mfma_f32_16x16x32_bf16 v[20:23], v[144:147], v[176:179], v[20:23]
    ds_read_b64_tr_b16 v[120:121], v86 offset:192
    ds_read_b64_tr_b16 v[122:123], v86 offset:2496
    v_mfma_f32_16x16x32_bf16 v[56:59], v[144:147], v[180:183], v[56:59]
    ds_read_b64_tr_b16 v[124:125], v86 offset:224
    ds_read_b64_tr_b16 v[126:127], v86 offset:2528
    v_mfma_f32_16x16x32_bf16 v[24:27], v[148:151], v[176:179], v[24:27]
    ds_read_b64_tr_b16 v[128:129], v86 offset:256
    ds_read_b64_tr_b16 v[130:131], v86 offset:2560
    v_mfma_f32_16x16x32_bf16 v[60:63], v[148:151], v[180:183], v[60:63]
    v_mfma_f32_16x16x32_bf16 v[28:31], v[152:155], v[176:179], v[28:31]
    v_mfma_f32_16x16x32_bf16 v[64:67], v[152:155], v[180:183], v[64:67]
    v_mfma_f32_16x16x32_bf16 v[32:35], v[156:159], v[176:179], v[32:35]
    v_mfma_f32_16x16x32_bf16 v[68:71], v[156:159], v[180:183], v[68:71]
    v_mfma_f32_16x16x32_bf16 v[36:39], v[160:163], v[176:179], v[36:39]
    v_mfma_f32_16x16x32_bf16 v[72:75], v[160:163], v[180:183], v[72:75]
    v_mfma_f32_16x16x32_bf16 v[40:43], v[164:167], v[176:179], v[40:43]
    v_mfma_f32_16x16x32_bf16 v[76:79], v[164:167], v[180:183], v[76:79]
    s_waitcnt lgkmcnt(0)
    ds_read_b128 v[176:179], v94 offset:16384
    ds_read_b128 v[180:183], v94 offset:18432
    v_mfma_f32_16x16x32_bf16 v[8:11], v[96:99], v[168:171], v[8:11]
    ds_read_b64_tr_b16 v[132:133], v86 offset:9216
    ds_read_b64_tr_b16 v[134:135], v86 offset:11520
    v_mfma_f32_16x16x32_bf16 v[44:47], v[96:99], v[172:175], v[44:47]
    ds_read_b64_tr_b16 v[136:137], v86 offset:9248
    ds_read_b64_tr_b16 v[138:139], v86 offset:11552
    v_mfma_f32_16x16x32_bf16 v[12:15], v[100:103], v[168:171], v[12:15]
    ds_read_b64_tr_b16 v[140:141], v86 offset:9280
    ds_read_b64_tr_b16 v[142:143], v86 offset:11584
    v_mfma_f32_16x16x32_bf16 v[48:51], v[100:103], v[172:175], v[48:51]
    ds_read_b64_tr_b16 v[144:145], v86 offset:9312
    ds_read_b64_tr_b16 v[146:147], v86 offset:11616
    v_mfma_f32_16x16x32_bf16 v[16:19], v[104:107], v[168:171], v[16:19]
    ds_read_b64_tr_b16 v[148:149], v86 offset:9344
    ds_read_b64_tr_b16 v[150:151], v86 offset:11648
    v_mfma_f32_16x16x32_bf16 v[52:55], v[104:107], v[172:175], v[52:55]
    ds_read_b64_tr_b16 v[152:153], v86 offset:9376
    ds_read_b64_tr_b16 v[154:155], v86 offset:11680
    v_mfma_f32_16x16x32_bf16 v[20:23], v[108:111], v[168:171], v[20:23]
    ds_read_b64_tr_b16 v[156:157], v86 offset:9408
    ds_read_b64_tr_b16 v[158:159], v86 offset:11712
    v_mfma_f32_16x16x32_bf16 v[56:59], v[108:111], v[172:175], v[56:59]
    ds_read_b64_tr_b16 v[160:161], v86 offset:9440
    ds_read_b64_tr_b16 v[162:163], v86 offset:11744
    v_mfma_f32_16x16x32_bf16 v[24:27], v[112:115], v[168:171], v[24:27]
    ds_read_b64_tr_b16 v[164:165], v86 offset:9472
    ds_read_b64_tr_b16 v[166:167], v86 offset:11776
    v_mfma_f32_16x16x32_bf16 v[60:63], v[112:115], v[172:175], v[60:63]
    v_mfma_f32_16x16x32_bf16 v[28:31], v[116:119], v[168:171], v[28:31]
    v_mfma_f32_16x16x32_bf16 v[64:67], v[116:119], v[172:175], v[64:67]
    v_mfma_f32_16x16x32_bf16 v[32:35], v[120:123], v[168:171], v[32:35]
    v_mfma_f32_16x16x32_bf16 v[68:71], v[120:123], v[172:175], v[68:71]
    v_mfma_f32_16x16x32_bf16 v[36:39], v[124:127], v[168:171], v[36:39]
    v_mfma_f32_16x16x32_bf16 v[72:75], v[124:127], v[172:175], v[72:75]
    v_mfma_f32_16x16x32_bf16 v[40:43], v[128:131], v[168:171], v[40:43]
    v_mfma_f32_16x16x32_bf16 v[76:79], v[128:131], v[172:175], v[76:79]
    s_waitcnt lgkmcnt(0)
    s_barrier
    ds_read_b128 v[168:171], v93 offset:32768
    ds_read_b128 v[172:175], v93 offset:34816
    v_mfma_f32_16x16x32_bf16 v[8:11], v[132:135], v[176:179], v[8:11]
    ds_read_b64_tr_b16 v[96:97], v87 offset:0
    ds_read_b64_tr_b16 v[98:99], v87 offset:2304
    v_mfma_f32_16x16x32_bf16 v[44:47], v[132:135], v[180:183], v[44:47]
    ds_read_b64_tr_b16 v[100:101], v87 offset:32
    ds_read_b64_tr_b16 v[102:103], v87 offset:2336
    v_mfma_f32_16x16x32_bf16 v[12:15], v[136:139], v[176:179], v[12:15]
    ds_read_b64_tr_b16 v[104:105], v87 offset:64
    ds_read_b64_tr_b16 v[106:107], v87 offset:2368
    v_mfma_f32_16x16x32_bf16 v[48:51], v[136:139], v[180:183], v[48:51]
    ds_read_b64_tr_b16 v[108:109], v87 offset:96
    ds_read_b64_tr_b16 v[110:111], v87 offset:2400
    v_mfma_f32_16x16x32_bf16 v[16:19], v[140:143], v[176:179], v[16:19]
    ds_read_b64_tr_b16 v[112:113], v87 offset:128
    ds_read_b64_tr_b16 v[114:115], v87 offset:2432
    v_mfma_f32_16x16x32_bf16 v[52:55], v[140:143], v[180:183], v[52:55]
    ds_read_b64_tr_b16 v[116:117], v87 offset:160
    ds_read_b64_tr_b16 v[118:119], v87 offset:2464
    v_mfma_f32_16x16x32_bf16 v[20:23], v[144:147], v[176:179], v[20:23]
    ds_read_b64_tr_b16 v[120:121], v87 offset:192
    ds_read_b64_tr_b16 v[122:123], v87 offset:2496
    v_mfma_f32_16x16x32_bf16 v[56:59], v[144:147], v[180:183], v[56:59]
    ds_read_b64_tr_b16 v[124:125], v87 offset:224
    ds_read_b64_tr_b16 v[126:127], v87 offset:2528
    v_mfma_f32_16x16x32_bf16 v[24:27], v[148:151], v[176:179], v[24:27]
    ds_read_b64_tr_b16 v[128:129], v87 offset:256
    ds_read_b64_tr_b16 v[130:131], v87 offset:2560
    v_mfma_f32_16x16x32_bf16 v[60:63], v[148:151], v[180:183], v[60:63]
    v_mfma_f32_16x16x32_bf16 v[28:31], v[152:155], v[176:179], v[28:31]
    v_mfma_f32_16x16x32_bf16 v[64:67], v[152:155], v[180:183], v[64:67]
    v_mfma_f32_16x16x32_bf16 v[32:35], v[156:159], v[176:179], v[32:35]
    v_mfma_f32_16x16x32_bf16 v[68:71], v[156:159], v[180:183], v[68:71]
    v_mfma_f32_16x16x32_bf16 v[36:39], v[160:163], v[176:179], v[36:39]
    v_mfma_f32_16x16x32_bf16 v[72:75], v[160:163], v[180:183], v[72:75]
    v_mfma_f32_16x16x32_bf16 v[40:43], v[164:167], v[176:179], v[40:43]
    v_mfma_f32_16x16x32_bf16 v[76:79], v[164:167], v[180:183], v[76:79]
    s_waitcnt lgkmcnt(0)
    ds_read_b128 v[176:179], v94 offset:32768
    ds_read_b128 v[180:183], v94 offset:34816
    v_mfma_f32_16x16x32_bf16 v[8:11], v[96:99], v[168:171], v[8:11]
    ds_read_b64_tr_b16 v[132:133], v87 offset:9216
    ds_read_b64_tr_b16 v[134:135], v87 offset:11520
    v_mfma_f32_16x16x32_bf16 v[44:47], v[96:99], v[172:175], v[44:47]
    ds_read_b64_tr_b16 v[136:137], v87 offset:9248
    ds_read_b64_tr_b16 v[138:139], v87 offset:11552
    v_mfma_f32_16x16x32_bf16 v[12:15], v[100:103], v[168:171], v[12:15]
    ds_read_b64_tr_b16 v[140:141], v87 offset:9280
    ds_read_b64_tr_b16 v[142:143], v87 offset:11584
    v_mfma_f32_16x16x32_bf16 v[48:51], v[100:103], v[172:175], v[48:51]
    ds_read_b64_tr_b16 v[144:145], v87 offset:9312
    ds_read_b64_tr_b16 v[146:147], v87 offset:11616
    v_mfma_f32_16x16x32_bf16 v[16:19], v[104:107], v[168:171], v[16:19]
    ds_read_b64_tr_b16 v[148:149], v87 offset:9344
    ds_read_b64_tr_b16 v[150:151], v87 offset:11648
    v_mfma_f32_16x16x32_bf16 v[52:55], v[104:107], v[172:175], v[52:55]
    ds_read_b64_tr_b16 v[152:153], v87 offset:9376
    ds_read_b64_tr_b16 v[154:155], v87 offset:11680
    v_mfma_f32_16x16x32_bf16 v[20:23], v[108:111], v[168:171], v[20:23]
    ds_read_b64_tr_b16 v[156:157], v87 offset:9408
    ds_read_b64_tr_b16 v[158:159], v87 offset:11712
    v_mfma_f32_16x16x32_bf16 v[56:59], v[108:111], v[172:175], v[56:59]
    ds_read_b64_tr_b16 v[160:161], v87 offset:9440
    ds_read_b64_tr_b16 v[162:163], v87 offset:11744
    v_mfma_f32_16x16x32_bf16 v[24:27], v[112:115], v[168:171], v[24:27]
    ds_read_b64_tr_b16 v[164:165], v87 offset:9472
    ds_read_b64_tr_b16 v[166:167], v87 offset:11776
    v_mfma_f32_16x16x32_bf16 v[60:63], v[112:115], v[172:175], v[60:63]
    v_mfma_f32_16x16x32_bf16 v[28:31], v[116:119], v[168:171], v[28:31]
    v_mfma_f32_16x16x32_bf16 v[64:67], v[116:119], v[172:175], v[64:67]
    v_mfma_f32_16x16x32_bf16 v[32:35], v[120:123], v[168:171], v[32:35]
    v_mfma_f32_16x16x32_bf16 v[68:71], v[120:123], v[172:175], v[68:71]
    v_mfma_f32_16x16x32_bf16 v[36:39], v[124:127], v[168:171], v[36:39]
    v_mfma_f32_16x16x32_bf16 v[72:75], v[124:127], v[172:175], v[72:75]
    v_mfma_f32_16x16x32_bf16 v[40:43], v[128:131], v[168:171], v[40:43]
    v_mfma_f32_16x16x32_bf16 v[76:79], v[128:131], v[172:175], v[76:79]
    s_waitcnt lgkmcnt(0)
    s_barrier
    ds_read_b128 v[168:171], v93 offset:49152
    ds_read_b128 v[172:175], v93 offset:51200
    v_mfma_f32_16x16x32_bf16 v[8:11], v[132:135], v[176:179], v[8:11]
    ds_read_b64_tr_b16 v[96:97], v88 offset:0
    ds_read_b64_tr_b16 v[98:99], v88 offset:2304
    v_mfma_f32_16x16x32_bf16 v[44:47], v[132:135], v[180:183], v[44:47]
    ds_read_b64_tr_b16 v[100:101], v88 offset:32
    ds_read_b64_tr_b16 v[102:103], v88 offset:2336
    v_mfma_f32_16x16x32_bf16 v[12:15], v[136:139], v[176:179], v[12:15]
    ds_read_b64_tr_b16 v[104:105], v88 offset:64
    ds_read_b64_tr_b16 v[106:107], v88 offset:2368
    v_mfma_f32_16x16x32_bf16 v[48:51], v[136:139], v[180:183], v[48:51]
    ds_read_b64_tr_b16 v[108:109], v88 offset:96
    ds_read_b64_tr_b16 v[110:111], v88 offset:2400
    v_mfma_f32_16x16x32_bf16 v[16:19], v[140:143], v[176:179], v[16:19]
    ds_read_b64_tr_b16 v[112:113], v88 offset:128
    ds_read_b64_tr_b16 v[114:115], v88 offset:2432
    v_mfma_f32_16x16x32_bf16 v[52:55], v[140:143], v[180:183], v[52:55]
    ds_read_b64_tr_b16 v[116:117], v88 offset:160
    ds_read_b64_tr_b16 v[118:119], v88 offset:2464
    v_mfma_f32_16x16x32_bf16 v[20:23], v[144:147], v[176:179], v[20:23]
    ds_read_b64_tr_b16 v[120:121], v88 offset:192
    ds_read_b64_tr_b16 v[122:123], v88 offset:2496
    v_mfma_f32_16x16x32_bf16 v[56:59], v[144:147], v[180:183], v[56:59]
    ds_read_b64_tr_b16 v[124:125], v88 offset:224
    ds_read_b64_tr_b16 v[126:127], v88 offset:2528
    v_mfma_f32_16x16x32_bf16 v[24:27], v[148:151], v[176:179], v[24:27]
    ds_read_b64_tr_b16 v[128:129], v88 offset:256
    ds_read_b64_tr_b16 v[130:131], v88 offset:2560
    v_mfma_f32_16x16x32_bf16 v[60:63], v[148:151], v[180:183], v[60:63]
    v_mfma_f32_16x16x32_bf16 v[28:31], v[152:155], v[176:179], v[28:31]
    v_mfma_f32_16x16x32_bf16 v[64:67], v[152:155], v[180:183], v[64:67]
    v_mfma_f32_16x16x32_bf16 v[32:35], v[156:159], v[176:179], v[32:35]
    v_mfma_f32_16x16x32_bf16 v[68:71], v[156:159], v[180:183], v[68:71]
    v_mfma_f32_16x16x32_bf16 v[36:39], v[160:163], v[176:179], v[36:39]
    v_mfma_f32_16x16x32_bf16 v[72:75], v[160:163], v[180:183], v[72:75]
    v_mfma_f32_16x16x32_bf16 v[40:43], v[164:167], v[176:179], v[40:43]
    v_mfma_f32_16x16x32_bf16 v[76:79], v[164:167], v[180:183], v[76:79]
    s_waitcnt lgkmcnt(0)
    ds_read_b128 v[176:179], v94 offset:49152
    ds_read_b128 v[180:183], v94 offset:51200
    v_mfma_f32_16x16x32_bf16 v[8:11], v[96:99], v[168:171], v[8:11]
    ds_read_b64_tr_b16 v[132:133], v88 offset:9216
    ds_read_b64_tr_b16 v[134:135], v88 offset:11520
    v_mfma_f32_16x16x32_bf16 v[44:47], v[96:99], v[172:175], v[44:47]
    ds_read_b64_tr_b16 v[136:137], v88 offset:9248
    ds_read_b64_tr_b16 v[138:139], v88 offset:11552
    v_mfma_f32_16x16x32_bf16 v[12:15], v[100:103], v[168:171], v[12:15]
    ds_read_b64_tr_b16 v[140:141], v88 offset:9280
    ds_read_b64_tr_b16 v[142:143], v88 offset:11584
    v_mfma_f32_16x16x32_bf16 v[48:51], v[100:103], v[172:175], v[48:51]
    ds_read_b64_tr_b16 v[144:145], v88 offset:9312
    ds_read_b64_tr_b16 v[146:147], v88 offset:11616
    v_mfma_f32_16x16x32_bf16 v[16:19], v[104:107], v[168:171], v[16:19]
    ds_read_b64_tr_b16 v[148:149], v88 offset:9344
    ds_read_b64_tr_b16 v[150:151], v88 offset:11648
    v_mfma_f32_16x16x32_bf16 v[52:55], v[104:107], v[172:175], v[52:55]
    ds_read_b64_tr_b16 v[152:153], v88 offset:9376
    ds_read_b64_tr_b16 v[154:155], v88 offset:11680
    v_mfma_f32_16x16x32_bf16 v[20:23], v[108:111], v[168:171], v[20:23]
    ds_read_b64_tr_b16 v[156:157], v88 offset:9408
    ds_read_b64_tr_b16 v[158:159], v88 offset:11712
    v_mfma_f32_16x16x32_bf16 v[56:59], v[108:111], v[172:175], v[56:59]
    ds_read_b64_tr_b16 v[160:161], v88 offset:9440
    ds_read_b64_tr_b16 v[162:163], v88 offset:11744
    v_mfma_f32_16x16x32_bf16 v[24:27], v[112:115], v[168:171], v[24:27]
    ds_read_b64_tr_b16 v[164:165], v88 offset:9472
    ds_read_b64_tr_b16 v[166:167], v88 offset:11776
    v_mfma_f32_16x16x32_bf16 v[60:63], v[112:115], v[172:175], v[60:63]
    v_mfma_f32_16x16x32_bf16 v[28:31], v[116:119], v[168:171], v[28:31]
    v_mfma_f32_16x16x32_bf16 v[64:67], v[116:119], v[172:175], v[64:67]
    v_mfma_f32_16x16x32_bf16 v[32:35], v[120:123], v[168:171], v[32:35]
    v_mfma_f32_16x16x32_bf16 v[68:71], v[120:123], v[172:175], v[68:71]
    v_mfma_f32_16x16x32_bf16 v[36:39], v[124:127], v[168:171], v[36:39]
    v_mfma_f32_16x16x32_bf16 v[72:75], v[124:127], v[172:175], v[72:75]
    v_mfma_f32_16x16x32_bf16 v[40:43], v[128:131], v[168:171], v[40:43]
    v_mfma_f32_16x16x32_bf16 v[76:79], v[128:131], v[172:175], v[76:79]
    s_waitcnt lgkmcnt(0)
    s_barrier
    ds_read_b128 v[168:171], v93 offset:0
    ds_read_b128 v[172:175], v93 offset:2048
    v_mfma_f32_16x16x32_bf16 v[8:11], v[132:135], v[176:179], v[8:11]
    ds_read_b64_tr_b16 v[96:97], v85 offset:0
    ds_read_b64_tr_b16 v[98:99], v85 offset:2304
    v_mfma_f32_16x16x32_bf16 v[44:47], v[132:135], v[180:183], v[44:47]
    ds_read_b64_tr_b16 v[100:101], v85 offset:32
    ds_read_b64_tr_b16 v[102:103], v85 offset:2336
    v_mfma_f32_16x16x32_bf16 v[12:15], v[136:139], v[176:179], v[12:15]
    ds_read_b64_tr_b16 v[104:105], v85 offset:64
    ds_read_b64_tr_b16 v[106:107], v85 offset:2368
    v_mfma_f32_16x16x32_bf16 v[48:51], v[136:139], v[180:183], v[48:51]
    ds_read_b64_tr_b16 v[108:109], v85 offset:96
    ds_read_b64_tr_b16 v[110:111], v85 offset:2400
    v_mfma_f32_16x16x32_bf16 v[16:19], v[140:143], v[176:179], v[16:19]
    ds_read_b64_tr_b16 v[112:113], v85 offset:128
    ds_read_b64_tr_b16 v[114:115], v85 offset:2432
    v_mfma_f32_16x16x32_bf16 v[52:55], v[140:143], v[180:183], v[52:55]
    ds_read_b64_tr_b16 v[116:117], v85 offset:160
    ds_read_b64_tr_b16 v[118:119], v85 offset:2464
    v_mfma_f32_16x16x32_bf16 v[20:23], v[144:147], v[176:179], v[20:23]
    ds_read_b64_tr_b16 v[120:121], v85 offset:192
    ds_read_b64_tr_b16 v[122:123], v85 offset:2496
    v_mfma_f32_16x16x32_bf16 v[56:59], v[144:147], v[180:183], v[56:59]
    ds_read_b64_tr_b16 v[124:125], v85 offset:224
    ds_read_b64_tr_b16 v[126:127], v85 offset:2528
    v_mfma_f32_16x16x32_bf16 v[24:27], v[148:151], v[176:179], v[24:27]
    ds_read_b64_tr_b16 v[128:129], v85 offset:256
    ds_read_b64_tr_b16 v[130:131], v85 offset:2560
    v_mfma_f32_16x16x32_bf16 v[60:63], v[148:151], v[180:183], v[60:63]
    v_mfma_f32_16x16x32_bf16 v[28:31], v[152:155], v[176:179], v[28:31]
    v_mfma_f32_16x16x32_bf16 v[64:67], v[152:155], v[180:183], v[64:67]
    v_mfma_f32_16x16x32_bf16 v[32:35], v[156:159], v[176:179], v[32:35]
    v_mfma_f32_16x16x32_bf16 v[68:71], v[156:159], v[180:183], v[68:71]
    v_mfma_f32_16x16x32_bf16 v[36:39], v[160:163], v[176:179], v[36:39]
    v_mfma_f32_16x16x32_bf16 v[72:75], v[160:163], v[180:183], v[72:75]
    v_mfma_f32_16x16x32_bf16 v[40:43], v[164:167], v[176:179], v[40:43]
    v_mfma_f32_16x16x32_bf16 v[76:79], v[164:167], v[180:183], v[76:79]
    s_waitcnt lgkmcnt(0)
    ds_read_b128 v[176:179], v94 offset:0
    ds_read_b128 v[180:183], v94 offset:2048
    v_mfma_f32_16x16x32_bf16 v[8:11], v[96:99], v[168:171], v[8:11]
    ds_read_b64_tr_b16 v[132:133], v85 offset:9216
    ds_read_b64_tr_b16 v[134:135], v85 offset:11520
    v_mfma_f32_16x16x32_bf16 v[44:47], v[96:99], v[172:175], v[44:47]
    ds_read_b64_tr_b16 v[136:137], v85 offset:9248
    ds_read_b64_tr_b16 v[138:139], v85 offset:11552
    v_mfma_f32_16x16x32_bf16 v[12:15], v[100:103], v[168:171], v[12:15]
    ds_read_b64_tr_b16 v[140:141], v85 offset:9280
    ds_read_b64_tr_b16 v[142:143], v85 offset:11584
    v_mfma_f32_16x16x32_bf16 v[48:51], v[100:103], v[172:175], v[48:51]
    ds_read_b64_tr_b16 v[144:145], v85 offset:9312
    ds_read_b64_tr_b16 v[146:147], v85 offset:11616
    v_mfma_f32_16x16x32_bf16 v[16:19], v[104:107], v[168:171], v[16:19]
    ds_read_b64_tr_b16 v[148:149], v85 offset:9344
    ds_read_b64_tr_b16 v[150:151], v85 offset:11648
    v_mfma_f32_16x16x32_bf16 v[52:55], v[104:107], v[172:175], v[52:55]
    ds_read_b64_tr_b16 v[152:153], v85 offset:9376
    ds_read_b64_tr_b16 v[154:155], v85 offset:11680
    v_mfma_f32_16x16x32_bf16 v[20:23], v[108:111], v[168:171], v[20:23]
    ds_read_b64_tr_b16 v[156:157], v85 offset:9408
    ds_read_b64_tr_b16 v[158:159], v85 offset:11712
    v_mfma_f32_16x16x32_bf16 v[56:59], v[108:111], v[172:175], v[56:59]
    ds_read_b64_tr_b16 v[160:161], v85 offset:9440
    ds_read_b64_tr_b16 v[162:163], v85 offset:11744
    v_mfma_f32_16x16x32_bf16 v[24:27], v[112:115], v[168:171], v[24:27]
    ds_read_b64_tr_b16 v[164:165], v85 offset:9472
    ds_read_b64_tr_b16 v[166:167], v85 offset:11776
    v_mfma_f32_16x16x32_bf16 v[60:63], v[112:115], v[172:175], v[60:63]
    v_mfma_f32_16x16x32_bf16 v[28:31], v[116:119], v[168:171], v[28:31]
    v_mfma_f32_16x16x32_bf16 v[64:67], v[116:119], v[172:175], v[64:67]
    v_mfma_f32_16x16x32_bf16 v[32:35], v[120:123], v[168:171], v[32:35]
    v_mfma_f32_16x16x32_bf16 v[68:71], v[120:123], v[172:175], v[68:71]
    v_mfma_f32_16x16x32_bf16 v[36:39], v[124:127], v[168:171], v[36:39]
    v_mfma_f32_16x16x32_bf16 v[72:75], v[124:127], v[172:175], v[72:75]
    v_mfma_f32_16x16x32_bf16 v[40:43], v[128:131], v[168:171], v[40:43]
    v_mfma_f32_16x16x32_bf16 v[76:79], v[128:131], v[172:175], v[76:79]
    s_waitcnt lgkmcnt(0)
    s_barrier
    ds_read_b128 v[168:171], v93 offset:16384
    ds_read_b128 v[172:175], v93 offset:18432
    v_mfma_f32_16x16x32_bf16 v[8:11], v[132:135], v[176:179], v[8:11]
    ds_read_b64_tr_b16 v[96:97], v86 offset:0
    ds_read_b64_tr_b16 v[98:99], v86 offset:2304
    v_mfma_f32_16x16x32_bf16 v[44:47], v[132:135], v[180:183], v[44:47]
    ds_read_b64_tr_b16 v[100:101], v86 offset:32
    ds_read_b64_tr_b16 v[102:103], v86 offset:2336
    v_mfma_f32_16x16x32_bf16 v[12:15], v[136:139], v[176:179], v[12:15]
    ds_read_b64_tr_b16 v[104:105], v86 offset:64
    ds_read_b64_tr_b16 v[106:107], v86 offset:2368
    v_mfma_f32_16x16x32_bf16 v[48:51], v[136:139], v[180:183], v[48:51]
    ds_read_b64_tr_b16 v[108:109], v86 offset:96
    ds_read_b64_tr_b16 v[110:111], v86 offset:2400
    v_mfma_f32_16x16x32_bf16 v[16:19], v[140:143], v[176:179], v[16:19]
    ds_read_b64_tr_b16 v[112:113], v86 offset:128
    ds_read_b64_tr_b16 v[114:115], v86 offset:2432
    v_mfma_f32_16x16x32_bf16 v[52:55], v[140:143], v[180:183], v[52:55]
    ds_read_b64_tr_b16 v[116:117], v86 offset:160
    ds_read_b64_tr_b16 v[118:119], v86 offset:2464
    v_mfma_f32_16x16x32_bf16 v[20:23], v[144:147], v[176:179], v[20:23]
    ds_read_b64_tr_b16 v[120:121], v86 offset:192
    ds_read_b64_tr_b16 v[122:123], v86 offset:2496
    v_mfma_f32_16x16x32_bf16 v[56:59], v[144:147], v[180:183], v[56:59]
    ds_read_b64_tr_b16 v[124:125], v86 offset:224
    ds_read_b64_tr_b16 v[126:127], v86 offset:2528
    v_mfma_f32_16x16x32_bf16 v[24:27], v[148:151], v[176:179], v[24:27]
    ds_read_b64_tr_b16 v[128:129], v86 offset:256
    ds_read_b64_tr_b16 v[130:131], v86 offset:2560
    v_mfma_f32_16x16x32_bf16 v[60:63], v[148:151], v[180:183], v[60:63]
    v_mfma_f32_16x16x32_bf16 v[28:31], v[152:155], v[176:179], v[28:31]
    v_mfma_f32_16x16x32_bf16 v[64:67], v[152:155], v[180:183], v[64:67]
    v_mfma_f32_16x16x32_bf16 v[32:35], v[156:159], v[176:179], v[32:35]
    v_mfma_f32_16x16x32_bf16 v[68:71], v[156:159], v[180:183], v[68:71]
    v_mfma_f32_16x16x32_bf16 v[36:39], v[160:163], v[176:179], v[36:39]
    v_mfma_f32_16x16x32_bf16 v[72:75], v[160:163], v[180:183], v[72:75]
    v_mfma_f32_16x16x32_bf16 v[40:43], v[164:167], v[176:179], v[40:43]
    v_mfma_f32_16x16x32_bf16 v[76:79], v[164:167], v[180:183], v[76:79]
    s_waitcnt lgkmcnt(0)
    ds_read_b128 v[176:179], v94 offset:16384
    ds_read_b128 v[180:183], v94 offset:18432
    v_mfma_f32_16x16x32_bf16 v[8:11], v[96:99], v[168:171], v[8:11]
    ds_read_b64_tr_b16 v[132:133], v86 offset:9216
    ds_read_b64_tr_b16 v[134:135], v86 offset:11520
    v_mfma_f32_16x16x32_bf16 v[44:47], v[96:99], v[172:175], v[44:47]
    ds_read_b64_tr_b16 v[136:137], v86 offset:9248
    ds_read_b64_tr_b16 v[138:139], v86 offset:11552
    v_mfma_f32_16x16x32_bf16 v[12:15], v[100:103], v[168:171], v[12:15]
    ds_read_b64_tr_b16 v[140:141], v86 offset:9280
    ds_read_b64_tr_b16 v[142:143], v86 offset:11584
    v_mfma_f32_16x16x32_bf16 v[48:51], v[100:103], v[172:175], v[48:51]
    ds_read_b64_tr_b16 v[144:145], v86 offset:9312
    ds_read_b64_tr_b16 v[146:147], v86 offset:11616
    v_mfma_f32_16x16x32_bf16 v[16:19], v[104:107], v[168:171], v[16:19]
    ds_read_b64_tr_b16 v[148:149], v86 offset:9344
    ds_read_b64_tr_b16 v[150:151], v86 offset:11648
    v_mfma_f32_16x16x32_bf16 v[52:55], v[104:107], v[172:175], v[52:55]
    ds_read_b64_tr_b16 v[152:153], v86 offset:9376
    ds_read_b64_tr_b16 v[154:155], v86 offset:11680
    v_mfma_f32_16x16x32_bf16 v[20:23], v[108:111], v[168:171], v[20:23]
    ds_read_b64_tr_b16 v[156:157], v86 offset:9408
    ds_read_b64_tr_b16 v[158:159], v86 offset:11712
    v_mfma_f32_16x16x32_bf16 v[56:59], v[108:111], v[172:175], v[56:59]
    ds_read_b64_tr_b16 v[160:161], v86 offset:9440
    ds_read_b64_tr_b16 v[162:163], v86 offset:11744
    v_mfma_f32_16x16x32_bf16 v[24:27], v[112:115], v[168:171], v[24:27]
    ds_read_b64_tr_b16 v[164:165], v86 offset:9472
    ds_read_b64_tr_b16 v[166:167], v86 offset:11776
    v_mfma_f32_16x16x32_bf16 v[60:63], v[112:115], v[172:175], v[60:63]
    v_mfma_f32_16x16x32_bf16 v[28:31], v[116:119], v[168:171], v[28:31]
    v_mfma_f32_16x16x32_bf16 v[64:67], v[116:119], v[172:175], v[64:67]
    v_mfma_f32_16x16x32_bf16 v[32:35], v[120:123], v[168:171], v[32:35]
    v_mfma_f32_16x16x32_bf16 v[68:71], v[120:123], v[172:175], v[68:71]
    v_mfma_f32_16x16x32_bf16 v[36:39], v[124:127], v[168:171], v[36:39]
    v_mfma_f32_16x16x32_bf16 v[72:75], v[124:127], v[172:175], v[72:75]
    v_mfma_f32_16x16x32_bf16 v[40:43], v[128:131], v[168:171], v[40:43]
    v_mfma_f32_16x16x32_bf16 v[76:79], v[128:131], v[172:175], v[76:79]
    s_waitcnt lgkmcnt(0)
    s_barrier
    ds_read_b128 v[168:171], v93 offset:32768
    ds_read_b128 v[172:175], v93 offset:34816
    v_mfma_f32_16x16x32_bf16 v[8:11], v[132:135], v[176:179], v[8:11]
    ds_read_b64_tr_b16 v[96:97], v87 offset:0
    ds_read_b64_tr_b16 v[98:99], v87 offset:2304
    v_mfma_f32_16x16x32_bf16 v[44:47], v[132:135], v[180:183], v[44:47]
    ds_read_b64_tr_b16 v[100:101], v87 offset:32
    ds_read_b64_tr_b16 v[102:103], v87 offset:2336
    v_mfma_f32_16x16x32_bf16 v[12:15], v[136:139], v[176:179], v[12:15]
    ds_read_b64_tr_b16 v[104:105], v87 offset:64
    ds_read_b64_tr_b16 v[106:107], v87 offset:2368
    v_mfma_f32_16x16x32_bf16 v[48:51], v[136:139], v[180:183], v[48:51]
    ds_read_b64_tr_b16 v[108:109], v87 offset:96
    ds_read_b64_tr_b16 v[110:111], v87 offset:2400
    v_mfma_f32_16x16x32_bf16 v[16:19], v[140:143], v[176:179], v[16:19]
    ds_read_b64_tr_b16 v[112:113], v87 offset:128
    ds_read_b64_tr_b16 v[114:115], v87 offset:2432
    v_mfma_f32_16x16x32_bf16 v[52:55], v[140:143], v[180:183], v[52:55]
    ds_read_b64_tr_b16 v[116:117], v87 offset:160
    ds_read_b64_tr_b16 v[118:119], v87 offset:2464
    v_mfma_f32_16x16x32_bf16 v[20:23], v[144:147], v[176:179], v[20:23]
    ds_read_b64_tr_b16 v[120:121], v87 offset:192
    ds_read_b64_tr_b16 v[122:123], v87 offset:2496
    v_mfma_f32_16x16x32_bf16 v[56:59], v[144:147], v[180:183], v[56:59]
    ds_read_b64_tr_b16 v[124:125], v87 offset:224
    ds_read_b64_tr_b16 v[126:127], v87 offset:2528
    v_mfma_f32_16x16x32_bf16 v[24:27], v[148:151], v[176:179], v[24:27]
    ds_read_b64_tr_b16 v[128:129], v87 offset:256
    ds_read_b64_tr_b16 v[130:131], v87 offset:2560
    v_mfma_f32_16x16x32_bf16 v[60:63], v[148:151], v[180:183], v[60:63]
    v_mfma_f32_16x16x32_bf16 v[28:31], v[152:155], v[176:179], v[28:31]
    v_mfma_f32_16x16x32_bf16 v[64:67], v[152:155], v[180:183], v[64:67]
    v_mfma_f32_16x16x32_bf16 v[32:35], v[156:159], v[176:179], v[32:35]
    v_mfma_f32_16x16x32_bf16 v[68:71], v[156:159], v[180:183], v[68:71]
    v_mfma_f32_16x16x32_bf16 v[36:39], v[160:163], v[176:179], v[36:39]
    v_mfma_f32_16x16x32_bf16 v[72:75], v[160:163], v[180:183], v[72:75]
    v_mfma_f32_16x16x32_bf16 v[40:43], v[164:167], v[176:179], v[40:43]
    v_mfma_f32_16x16x32_bf16 v[76:79], v[164:167], v[180:183], v[76:79]
    s_waitcnt lgkmcnt(0)
    ds_read_b128 v[176:179], v94 offset:32768
    ds_read_b128 v[180:183], v94 offset:34816
    v_mfma_f32_16x16x32_bf16 v[8:11], v[96:99], v[168:171], v[8:11]
    ds_read_b64_tr_b16 v[132:133], v87 offset:9216
    ds_read_b64_tr_b16 v[134:135], v87 offset:11520
    v_mfma_f32_16x16x32_bf16 v[44:47], v[96:99], v[172:175], v[44:47]
    ds_read_b64_tr_b16 v[136:137], v87 offset:9248
    ds_read_b64_tr_b16 v[138:139], v87 offset:11552
    v_mfma_f32_16x16x32_bf16 v[12:15], v[100:103], v[168:171], v[12:15]
    ds_read_b64_tr_b16 v[140:141], v87 offset:9280
    ds_read_b64_tr_b16 v[142:143], v87 offset:11584
    v_mfma_f32_16x16x32_bf16 v[48:51], v[100:103], v[172:175], v[48:51]
    ds_read_b64_tr_b16 v[144:145], v87 offset:9312
    ds_read_b64_tr_b16 v[146:147], v87 offset:11616
    v_mfma_f32_16x16x32_bf16 v[16:19], v[104:107], v[168:171], v[16:19]
    ds_read_b64_tr_b16 v[148:149], v87 offset:9344
    ds_read_b64_tr_b16 v[150:151], v87 offset:11648
    v_mfma_f32_16x16x32_bf16 v[52:55], v[104:107], v[172:175], v[52:55]
    ds_read_b64_tr_b16 v[152:153], v87 offset:9376
    ds_read_b64_tr_b16 v[154:155], v87 offset:11680
    v_mfma_f32_16x16x32_bf16 v[20:23], v[108:111], v[168:171], v[20:23]
    ds_read_b64_tr_b16 v[156:157], v87 offset:9408
    ds_read_b64_tr_b16 v[158:159], v87 offset:11712
    v_mfma_f32_16x16x32_bf16 v[56:59], v[108:111], v[172:175], v[56:59]
    ds_read_b64_tr_b16 v[160:161], v87 offset:9440
    ds_read_b64_tr_b16 v[162:163], v87 offset:11744
    v_mfma_f32_16x16x32_bf16 v[24:27], v[112:115], v[168:171], v[24:27]
    ds_read_b64_tr_b16 v[164:165], v87 offset:9472
    ds_read_b64_tr_b16 v[166:167], v87 offset:11776
    v_mfma_f32_16x16x32_bf16 v[60:63], v[112:115], v[172:175], v[60:63]
    v_mfma_f32_16x16x32_bf16 v[28:31], v[116:119], v[168:171], v[28:31]
    v_mfma_f32_16x16x32_bf16 v[64:67], v[116:119], v[172:175], v[64:67]
    v_mfma_f32_16x16x32_bf16 v[32:35], v[120:123], v[168:171], v[32:35]
    v_mfma_f32_16x16x32_bf16 v[68:71], v[120:123], v[172:175], v[68:71]
    v_mfma_f32_16x16x32_bf16 v[36:39], v[124:127], v[168:171], v[36:39]
    v_mfma_f32_16x16x32_bf16 v[72:75], v[124:127], v[172:175], v[72:75]
    v_mfma_f32_16x16x32_bf16 v[40:43], v[128:131], v[168:171], v[40:43]
    v_mfma_f32_16x16x32_bf16 v[76:79], v[128:131], v[172:175], v[76:79]
    s_waitcnt lgkmcnt(0)
    s_barrier
    ds_read_b128 v[168:171], v93 offset:49152
    ds_read_b128 v[172:175], v93 offset:51200
    v_mfma_f32_16x16x32_bf16 v[8:11], v[132:135], v[176:179], v[8:11]
    ds_read_b64_tr_b16 v[96:97], v88 offset:0
    ds_read_b64_tr_b16 v[98:99], v88 offset:2304
    v_mfma_f32_16x16x32_bf16 v[44:47], v[132:135], v[180:183], v[44:47]
    ds_read_b64_tr_b16 v[100:101], v88 offset:32
    ds_read_b64_tr_b16 v[102:103], v88 offset:2336
    v_mfma_f32_16x16x32_bf16 v[12:15], v[136:139], v[176:179], v[12:15]
    ds_read_b64_tr_b16 v[104:105], v88 offset:64
    ds_read_b64_tr_b16 v[106:107], v88 offset:2368
    v_mfma_f32_16x16x32_bf16 v[48:51], v[136:139], v[180:183], v[48:51]
    ds_read_b64_tr_b16 v[108:109], v88 offset:96
    ds_read_b64_tr_b16 v[110:111], v88 offset:2400
    v_mfma_f32_16x16x32_bf16 v[16:19], v[140:143], v[176:179], v[16:19]
    ds_read_b64_tr_b16 v[112:113], v88 offset:128
    ds_read_b64_tr_b16 v[114:115], v88 offset:2432
    v_mfma_f32_16x16x32_bf16 v[52:55], v[140:143], v[180:183], v[52:55]
    ds_read_b64_tr_b16 v[116:117], v88 offset:160
    ds_read_b64_tr_b16 v[118:119], v88 offset:2464
    v_mfma_f32_16x16x32_bf16 v[20:23], v[144:147], v[176:179], v[20:23]
    ds_read_b64_tr_b16 v[120:121], v88 offset:192
    ds_read_b64_tr_b16 v[122:123], v88 offset:2496
    v_mfma_f32_16x16x32_bf16 v[56:59], v[144:147], v[180:183], v[56:59]
    ds_read_b64_tr_b16 v[124:125], v88 offset:224
    ds_read_b64_tr_b16 v[126:127], v88 offset:2528
    v_mfma_f32_16x16x32_bf16 v[24:27], v[148:151], v[176:179], v[24:27]
    ds_read_b64_tr_b16 v[128:129], v88 offset:256
    ds_read_b64_tr_b16 v[130:131], v88 offset:2560
    v_mfma_f32_16x16x32_bf16 v[60:63], v[148:151], v[180:183], v[60:63]
    v_mfma_f32_16x16x32_bf16 v[28:31], v[152:155], v[176:179], v[28:31]
    v_mfma_f32_16x16x32_bf16 v[64:67], v[152:155], v[180:183], v[64:67]
    v_mfma_f32_16x16x32_bf16 v[32:35], v[156:159], v[176:179], v[32:35]
    v_mfma_f32_16x16x32_bf16 v[68:71], v[156:159], v[180:183], v[68:71]
    v_mfma_f32_16x16x32_bf16 v[36:39], v[160:163], v[176:179], v[36:39]
    v_mfma_f32_16x16x32_bf16 v[72:75], v[160:163], v[180:183], v[72:75]
    v_mfma_f32_16x16x32_bf16 v[40:43], v[164:167], v[176:179], v[40:43]
    v_mfma_f32_16x16x32_bf16 v[76:79], v[164:167], v[180:183], v[76:79]
    s_waitcnt lgkmcnt(0)
    ds_read_b128 v[176:179], v94 offset:49152
    ds_read_b128 v[180:183], v94 offset:51200
    v_mfma_f32_16x16x32_bf16 v[8:11], v[96:99], v[168:171], v[8:11]
    ds_read_b64_tr_b16 v[132:133], v88 offset:9216
    ds_read_b64_tr_b16 v[134:135], v88 offset:11520
    v_mfma_f32_16x16x32_bf16 v[44:47], v[96:99], v[172:175], v[44:47]
    ds_read_b64_tr_b16 v[136:137], v88 offset:9248
    ds_read_b64_tr_b16 v[138:139], v88 offset:11552
    v_mfma_f32_16x16x32_bf16 v[12:15], v[100:103], v[168:171], v[12:15]
    ds_read_b64_tr_b16 v[140:141], v88 offset:9280
    ds_read_b64_tr_b16 v[142:143], v88 offset:11584
    v_mfma_f32_16x16x32_bf16 v[48:51], v[100:103], v[172:175], v[48:51]
    ds_read_b64_tr_b16 v[144:145], v88 offset:9312
    ds_read_b64_tr_b16 v[146:147], v88 offset:11616
    v_mfma_f32_16x16x32_bf16 v[16:19], v[104:107], v[168:171], v[16:19]
    ds_read_b64_tr_b16 v[148:149], v88 offset:9344
    ds_read_b64_tr_b16 v[150:151], v88 offset:11648
    v_mfma_f32_16x16x32_bf16 v[52:55], v[104:107], v[172:175], v[52:55]
    ds_read_b64_tr_b16 v[152:153], v88 offset:9376
    ds_read_b64_tr_b16 v[154:155], v88 offset:11680
    v_mfma_f32_16x16x32_bf16 v[20:23], v[108:111], v[168:171], v[20:23]
    ds_read_b64_tr_b16 v[156:157], v88 offset:9408
    ds_read_b64_tr_b16 v[158:159], v88 offset:11712
    v_mfma_f32_16x16x32_bf16 v[56:59], v[108:111], v[172:175], v[56:59]
    ds_read_b64_tr_b16 v[160:161], v88 offset:9440
    ds_read_b64_tr_b16 v[162:163], v88 offset:11744
    v_mfma_f32_16x16x32_bf16 v[24:27], v[112:115], v[168:171], v[24:27]
    ds_read_b64_tr_b16 v[164:165], v88 offset:9472
    ds_read_b64_tr_b16 v[166:167], v88 offset:11776
    v_mfma_f32_16x16x32_bf16 v[60:63], v[112:115], v[172:175], v[60:63]
    v_mfma_f32_16x16x32_bf16 v[28:31], v[116:119], v[168:171], v[28:31]
    v_mfma_f32_16x16x32_bf16 v[64:67], v[116:119], v[172:175], v[64:67]
    v_mfma_f32_16x16x32_bf16 v[32:35], v[120:123], v[168:171], v[32:35]
    v_mfma_f32_16x16x32_bf16 v[68:71], v[120:123], v[172:175], v[68:71]
    v_mfma_f32_16x16x32_bf16 v[36:39], v[124:127], v[168:171], v[36:39]
    v_mfma_f32_16x16x32_bf16 v[72:75], v[124:127], v[172:175], v[72:75]
    v_mfma_f32_16x16x32_bf16 v[40:43], v[128:131], v[168:171], v[40:43]
    v_mfma_f32_16x16x32_bf16 v[76:79], v[128:131], v[172:175], v[76:79]
    s_waitcnt lgkmcnt(0)
    s_barrier
    ds_read_b128 v[168:171], v93 offset:0
    ds_read_b128 v[172:175], v93 offset:2048
    v_mfma_f32_16x16x32_bf16 v[8:11], v[132:135], v[176:179], v[8:11]
    ds_read_b64_tr_b16 v[96:97], v85 offset:0
    ds_read_b64_tr_b16 v[98:99], v85 offset:2304
    v_mfma_f32_16x16x32_bf16 v[44:47], v[132:135], v[180:183], v[44:47]
    ds_read_b64_tr_b16 v[100:101], v85 offset:32
    ds_read_b64_tr_b16 v[102:103], v85 offset:2336
    v_mfma_f32_16x16x32_bf16 v[12:15], v[136:139], v[176:179], v[12:15]
    ds_read_b64_tr_b16 v[104:105], v85 offset:64
    ds_read_b64_tr_b16 v[106:107], v85 offset:2368
    v_mfma_f32_16x16x32_bf16 v[48:51], v[136:139], v[180:183], v[48:51]
    ds_read_b64_tr_b16 v[108:109], v85 offset:96
    ds_read_b64_tr_b16 v[110:111], v85 offset:2400
    v_mfma_f32_16x16x32_bf16 v[16:19], v[140:143], v[176:179], v[16:19]
    ds_read_b64_tr_b16 v[112:113], v85 offset:128
    ds_read_b64_tr_b16 v[114:115], v85 offset:2432
    v_mfma_f32_16x16x32_bf16 v[52:55], v[140:143], v[180:183], v[52:55]
    ds_read_b64_tr_b16 v[116:117], v85 offset:160
    ds_read_b64_tr_b16 v[118:119], v85 offset:2464
    v_mfma_f32_16x16x32_bf16 v[20:23], v[144:147], v[176:179], v[20:23]
    ds_read_b64_tr_b16 v[120:121], v85 offset:192
    ds_read_b64_tr_b16 v[122:123], v85 offset:2496
    v_mfma_f32_16x16x32_bf16 v[56:59], v[144:147], v[180:183], v[56:59]
    ds_read_b64_tr_b16 v[124:125], v85 offset:224
    ds_read_b64_tr_b16 v[126:127], v85 offset:2528
    v_mfma_f32_16x16x32_bf16 v[24:27], v[148:151], v[176:179], v[24:27]
    ds_read_b64_tr_b16 v[128:129], v85 offset:256
    ds_read_b64_tr_b16 v[130:131], v85 offset:2560
    v_mfma_f32_16x16x32_bf16 v[60:63], v[148:151], v[180:183], v[60:63]
    v_mfma_f32_16x16x32_bf16 v[28:31], v[152:155], v[176:179], v[28:31]
    v_mfma_f32_16x16x32_bf16 v[64:67], v[152:155], v[180:183], v[64:67]
    v_mfma_f32_16x16x32_bf16 v[32:35], v[156:159], v[176:179], v[32:35]
    v_mfma_f32_16x16x32_bf16 v[68:71], v[156:159], v[180:183], v[68:71]
    v_mfma_f32_16x16x32_bf16 v[36:39], v[160:163], v[176:179], v[36:39]
    v_mfma_f32_16x16x32_bf16 v[72:75], v[160:163], v[180:183], v[72:75]
    v_mfma_f32_16x16x32_bf16 v[40:43], v[164:167], v[176:179], v[40:43]
    v_mfma_f32_16x16x32_bf16 v[76:79], v[164:167], v[180:183], v[76:79]
    s_waitcnt lgkmcnt(0)
    ds_read_b128 v[176:179], v94 offset:0
    ds_read_b128 v[180:183], v94 offset:2048
    v_mfma_f32_16x16x32_bf16 v[8:11], v[96:99], v[168:171], v[8:11]
    ds_read_b64_tr_b16 v[132:133], v85 offset:9216
    ds_read_b64_tr_b16 v[134:135], v85 offset:11520
    v_mfma_f32_16x16x32_bf16 v[44:47], v[96:99], v[172:175], v[44:47]
    ds_read_b64_tr_b16 v[136:137], v85 offset:9248
    ds_read_b64_tr_b16 v[138:139], v85 offset:11552
    v_mfma_f32_16x16x32_bf16 v[12:15], v[100:103], v[168:171], v[12:15]
    ds_read_b64_tr_b16 v[140:141], v85 offset:9280
    ds_read_b64_tr_b16 v[142:143], v85 offset:11584
    v_mfma_f32_16x16x32_bf16 v[48:51], v[100:103], v[172:175], v[48:51]
    ds_read_b64_tr_b16 v[144:145], v85 offset:9312
    ds_read_b64_tr_b16 v[146:147], v85 offset:11616
    v_mfma_f32_16x16x32_bf16 v[16:19], v[104:107], v[168:171], v[16:19]
    ds_read_b64_tr_b16 v[148:149], v85 offset:9344
    ds_read_b64_tr_b16 v[150:151], v85 offset:11648
    v_mfma_f32_16x16x32_bf16 v[52:55], v[104:107], v[172:175], v[52:55]
    ds_read_b64_tr_b16 v[152:153], v85 offset:9376
    ds_read_b64_tr_b16 v[154:155], v85 offset:11680
    v_mfma_f32_16x16x32_bf16 v[20:23], v[108:111], v[168:171], v[20:23]
    ds_read_b64_tr_b16 v[156:157], v85 offset:9408
    ds_read_b64_tr_b16 v[158:159], v85 offset:11712
    v_mfma_f32_16x16x32_bf16 v[56:59], v[108:111], v[172:175], v[56:59]
    ds_read_b64_tr_b16 v[160:161], v85 offset:9440
    ds_read_b64_tr_b16 v[162:163], v85 offset:11744
    v_mfma_f32_16x16x32_bf16 v[24:27], v[112:115], v[168:171], v[24:27]
    ds_read_b64_tr_b16 v[164:165], v85 offset:9472
    ds_read_b64_tr_b16 v[166:167], v85 offset:11776
    v_mfma_f32_16x16x32_bf16 v[60:63], v[112:115], v[172:175], v[60:63]
    v_mfma_f32_16x16x32_bf16 v[28:31], v[116:119], v[168:171], v[28:31]
    v_mfma_f32_16x16x32_bf16 v[64:67], v[116:119], v[172:175], v[64:67]
    v_mfma_f32_16x16x32_bf16 v[32:35], v[120:123], v[168:171], v[32:35]
    v_mfma_f32_16x16x32_bf16 v[68:71], v[120:123], v[172:175], v[68:71]
    v_mfma_f32_16x16x32_bf16 v[36:39], v[124:127], v[168:171], v[36:39]
    v_mfma_f32_16x16x32_bf16 v[72:75], v[124:127], v[172:175], v[72:75]
    v_mfma_f32_16x16x32_bf16 v[40:43], v[128:131], v[168:171], v[40:43]
    v_mfma_f32_16x16x32_bf16 v[76:79], v[128:131], v[172:175], v[76:79]
    s_waitcnt lgkmcnt(0)
    s_barrier
    ds_read_b128 v[168:171], v93 offset:16384
    ds_read_b128 v[172:175], v93 offset:18432
    v_mfma_f32_16x16x32_bf16 v[8:11], v[132:135], v[176:179], v[8:11]
    ds_read_b64_tr_b16 v[96:97], v86 offset:0
    ds_read_b64_tr_b16 v[98:99], v86 offset:2304
    v_mfma_f32_16x16x32_bf16 v[44:47], v[132:135], v[180:183], v[44:47]
    ds_read_b64_tr_b16 v[100:101], v86 offset:32
    ds_read_b64_tr_b16 v[102:103], v86 offset:2336
    v_mfma_f32_16x16x32_bf16 v[12:15], v[136:139], v[176:179], v[12:15]
    ds_read_b64_tr_b16 v[104:105], v86 offset:64
    ds_read_b64_tr_b16 v[106:107], v86 offset:2368
    v_mfma_f32_16x16x32_bf16 v[48:51], v[136:139], v[180:183], v[48:51]
    ds_read_b64_tr_b16 v[108:109], v86 offset:96
    ds_read_b64_tr_b16 v[110:111], v86 offset:2400
    v_mfma_f32_16x16x32_bf16 v[16:19], v[140:143], v[176:179], v[16:19]
    ds_read_b64_tr_b16 v[112:113], v86 offset:128
    ds_read_b64_tr_b16 v[114:115], v86 offset:2432
    v_mfma_f32_16x16x32_bf16 v[52:55], v[140:143], v[180:183], v[52:55]
    ds_read_b64_tr_b16 v[116:117], v86 offset:160
    ds_read_b64_tr_b16 v[118:119], v86 offset:2464
    v_mfma_f32_16x16x32_bf16 v[20:23], v[144:147], v[176:179], v[20:23]
    ds_read_b64_tr_b16 v[120:121], v86 offset:192
    ds_read_b64_tr_b16 v[122:123], v86 offset:2496
    v_mfma_f32_16x16x32_bf16 v[56:59], v[144:147], v[180:183], v[56:59]
    ds_read_b64_tr_b16 v[124:125], v86 offset:224
    ds_read_b64_tr_b16 v[126:127], v86 offset:2528
    v_mfma_f32_16x16x32_bf16 v[24:27], v[148:151], v[176:179], v[24:27]
    ds_read_b64_tr_b16 v[128:129], v86 offset:256
    ds_read_b64_tr_b16 v[130:131], v86 offset:2560
    v_mfma_f32_16x16x32_bf16 v[60:63], v[148:151], v[180:183], v[60:63]
    v_mfma_f32_16x16x32_bf16 v[28:31], v[152:155], v[176:179], v[28:31]
    v_mfma_f32_16x16x32_bf16 v[64:67], v[152:155], v[180:183], v[64:67]
    v_mfma_f32_16x16x32_bf16 v[32:35], v[156:159], v[176:179], v[32:35]
    v_mfma_f32_16x16x32_bf16 v[68:71], v[156:159], v[180:183], v[68:71]
    v_mfma_f32_16x16x32_bf16 v[36:39], v[160:163], v[176:179], v[36:39]
    v_mfma_f32_16x16x32_bf16 v[72:75], v[160:163], v[180:183], v[72:75]
    v_mfma_f32_16x16x32_bf16 v[40:43], v[164:167], v[176:179], v[40:43]
    v_mfma_f32_16x16x32_bf16 v[76:79], v[164:167], v[180:183], v[76:79]
    s_nop 7
    s_nop 1
    s_waitcnt vmcnt(0)
    v_mov_b32 v240, 0
    v_mov_b32 v241, 0
    v_mov_b32 v242, 0
    v_mov_b32 v243, 0
    v_mov_b32 v244, 0
    v_mov_b32 v245, 0
    v_mov_b32 v246, 0
    v_mov_b32 v247, 0
    v_pk_fma_f32 v[8:9], v[184:185], v[220:221], v[8:9] op_sel:[0,0,0] op_sel_hi:[1,0,1]
    v_pk_fma_f32 v[10:11], v[186:187], v[220:221], v[10:11] op_sel:[0,0,0] op_sel_hi:[1,0,1]
    v_pk_mul_f32 v[8:9], v[8:9], v[222:223] op_sel:[0,0] op_sel_hi:[1,0]
    v_pk_mul_f32 v[10:11], v[10:11], v[222:223] op_sel:[0,0] op_sel_hi:[1,0]
    v_cvt_pk_bf16_f32 v8, v8, v9
    v_cvt_pk_bf16_f32 v9, v10, v11
    v_lshlrev_b32 v252, 16, v8
    v_and_b32 v253, 0xffff0000, v8
    v_pk_mul_f32 v[248:249], v[252:253], v[252:253]
    v_pk_fma_f32 v[248:249], v[248:249], v[224:225], v[224:225] op_sel:[0,1,0] op_sel_hi:[1,1,0]
    v_pk_mul_f32 v[248:249], v[248:249], v[252:253]
    v_exp_f32 v248, v248
    v_exp_f32 v249, v249
    s_nop 0
    v_pk_add_f32 v[248:249], v[248:249], 1.0 op_sel_hi:[1,0]
    v_rcp_f32 v248, v248
    v_rcp_f32 v249, v249
    s_nop 0
    v_pk_mul_f32 v[252:253], v[252:253], v[248:249]
    v_cvt_pk_bf16_f32 v8, v252, v253
    v_lshlrev_b32 v252, 16, v8
    v_and_b32 v253, 0xffff0000, v8
    v_pk_add_f32 v[240:241], v[240:241], v[252:253]
    v_pk_fma_f32 v[242:243], v[252:253], v[252:253], v[242:243]
    v_lshlrev_b32 v252, 16, v9
    v_and_b32 v253, 0xffff0000, v9
    v_pk_mul_f32 v[248:249], v[252:253], v[252:253]
    v_pk_fma_f32 v[248:249], v[248:249], v[224:225], v[224:225] op_sel:[0,1,0] op_sel_hi:[1,1,0]
    v_pk_mul_f32 v[248:249], v[248:249], v[252:253]
    v_exp_f32 v248, v248
    v_exp_f32 v249, v249
    s_nop 0
    v_pk_add_f32 v[248:249], v[248:249], 1.0 op_sel_hi:[1,0]
    v_rcp_f32 v248, v248
    v_rcp_f32 v249, v249
    s_nop 0
    v_pk_mul_f32 v[252:253], v[252:253], v[248:249]
    v_cvt_pk_bf16_f32 v9, v252, v253
    v_lshlrev_b32 v252, 16, v9
    v_and_b32 v253, 0xffff0000, v9
    v_pk_add_f32 v[240:241], v[240:241], v[252:253]
    v_pk_fma_f32 v[242:243], v[252:253], v[252:253], v[242:243]
    ds_write_b64 v4, v[8:9] offset:0
    v_pk_fma_f32 v[12:13], v[188:189], v[220:221], v[12:13] op_sel:[0,0,0] op_sel_hi:[1,0,1]
    v_pk_fma_f32 v[14:15], v[190:191], v[220:221], v[14:15] op_sel:[0,0,0] op_sel_hi:[1,0,1]
    v_pk_mul_f32 v[12:13], v[12:13], v[222:223] op_sel:[0,0] op_sel_hi:[1,0]
    v_pk_mul_f32 v[14:15], v[14:15], v[222:223] op_sel:[0,0] op_sel_hi:[1,0]
    v_cvt_pk_bf16_f32 v12, v12, v13
    v_cvt_pk_bf16_f32 v13, v14, v15
    v_lshlrev_b32 v252, 16, v12
    v_and_b32 v253, 0xffff0000, v12
    v_pk_mul_f32 v[248:249], v[252:253], v[252:253]
    v_pk_fma_f32 v[248:249], v[248:249], v[224:225], v[224:225] op_sel:[0,1,0] op_sel_hi:[1,1,0]
    v_pk_mul_f32 v[248:249], v[248:249], v[252:253]
    v_exp_f32 v248, v248
    v_exp_f32 v249, v249
    s_nop 0
    v_pk_add_f32 v[248:249], v[248:249], 1.0 op_sel_hi:[1,0]
    v_rcp_f32 v248, v248
    v_rcp_f32 v249, v249
    s_nop 0
    v_pk_mul_f32 v[252:253], v[252:253], v[248:249]
    v_cvt_pk_bf16_f32 v12, v252, v253
    v_lshlrev_b32 v252, 16, v12
    v_and_b32 v253, 0xffff0000, v12
    v_pk_add_f32 v[240:241], v[240:241], v[252:253]
    v_pk_fma_f32 v[242:243], v[252:253], v[252:253], v[242:243]
    v_lshlrev_b32 v252, 16, v13
    v_and_b32 v253, 0xffff0000, v13
    v_pk_mul_f32 v[248:249], v[252:253], v[252:253]
    v_pk_fma_f32 v[248:249], v[248:249], v[224:225], v[224:225] op_sel:[0,1,0] op_sel_hi:[1,1,0]
    v_pk_mul_f32 v[248:249], v[248:249], v[252:253]
    v_exp_f32 v248, v248
    v_exp_f32 v249, v249
    s_nop 0
    v_pk_add_f32 v[248:249], v[248:249], 1.0 op_sel_hi:[1,0]
    v_rcp_f32 v248, v248
    v_rcp_f32 v249, v249
    s_nop 0
    v_pk_mul_f32 v[252:253], v[252:253], v[248:249]
    v_cvt_pk_bf16_f32 v13, v252, v253
    v_lshlrev_b32 v252, 16, v13
    v_and_b32 v253, 0xffff0000, v13
    v_pk_add_f32 v[240:241], v[240:241], v[252:253]
    v_pk_fma_f32 v[242:243], v[252:253], v[252:253], v[242:243]
    ds_write_b64 v4, v[12:13] offset:32
    v_pk_fma_f32 v[16:17], v[192:193], v[220:221], v[16:17] op_sel:[0,0,0] op_sel_hi:[1,0,1]
    v_pk_fma_f32 v[18:19], v[194:195], v[220:221], v[18:19] op_sel:[0,0,0] op_sel_hi:[1,0,1]
    v_pk_mul_f32 v[16:17], v[16:17], v[222:223] op_sel:[0,0] op_sel_hi:[1,0]
    v_pk_mul_f32 v[18:19], v[18:19], v[222:223] op_sel:[0,0] op_sel_hi:[1,0]
    v_cvt_pk_bf16_f32 v16, v16, v17
    v_cvt_pk_bf16_f32 v17, v18, v19
    v_lshlrev_b32 v252, 16, v16
    v_and_b32 v253, 0xffff0000, v16
    v_pk_mul_f32 v[248:249], v[252:253], v[252:253]
    v_pk_fma_f32 v[248:249], v[248:249], v[224:225], v[224:225] op_sel:[0,1,0] op_sel_hi:[1,1,0]
    v_pk_mul_f32 v[248:249], v[248:249], v[252:253]
    v_exp_f32 v248, v248
    v_exp_f32 v249, v249
    s_nop 0
    v_pk_add_f32 v[248:249], v[248:249], 1.0 op_sel_hi:[1,0]
    v_rcp_f32 v248, v248
    v_rcp_f32 v249, v249
    s_nop 0
    v_pk_mul_f32 v[252:253], v[252:253], v[248:249]
    v_cvt_pk_bf16_f32 v16, v252, v253
    v_lshlrev_b32 v252, 16, v16
    v_and_b32 v253, 0xffff0000, v16
    v_pk_add_f32 v[240:241], v[240:241], v[252:253]
    v_pk_fma_f32 v[242:243], v[252:253], v[252:253], v[242:243]
    v_lshlrev_b32 v252, 16, v17
    v_and_b32 v253, 0xffff0000, v17
    v_pk_mul_f32 v[248:249], v[252:253], v[252:253]
    v_pk_fma_f32 v[248:249], v[248:249], v[224:225], v[224:225] op_sel:[0,1,0] op_sel_hi:[1,1,0]
    v_pk_mul_f32 v[248:249], v[248:249], v[252:253]
    v_exp_f32 v248, v248
    v_exp_f32 v249, v249
    s_nop 0
    v_pk_add_f32 v[248:249], v[248:249], 1.0 op_sel_hi:[1,0]
    v_rcp_f32 v248, v248
    v_rcp_f32 v249, v249
    s_nop 0
    v_pk_mul_f32 v[252:253], v[252:253], v[248:249]
    v_cvt_pk_bf16_f32 v17, v252, v253
    v_lshlrev_b32 v252, 16, v17
    v_and_b32 v253, 0xffff0000, v17
    v_pk_add_f32 v[240:241], v[240:241], v[252:253]
    v_pk_fma_f32 v[242:243], v[252:253], v[252:253], v[242:243]
    ds_write_b64 v4, v[16:17] offset:64
    v_pk_fma_f32 v[20:21], v[196:197], v[220:221], v[20:21] op_sel:[0,0,0] op_sel_hi:[1,0,1]
    v_pk_fma_f32 v[22:23], v[198:199], v[220:221], v[22:23] op_sel:[0,0,0] op_sel_hi:[1,0,1]
    v_pk_mul_f32 v[20:21], v[20:21], v[222:223] op_sel:[0,0] op_sel_hi:[1,0]
    v_pk_mul_f32 v[22:23], v[22:23], v[222:223] op_sel:[0,0] op_sel_hi:[1,0]
    v_cvt_pk_bf16_f32 v20, v20, v21
    v_cvt_pk_bf16_f32 v21, v22, v23
    v_lshlrev_b32 v252, 16, v20
    v_and_b32 v253, 0xffff0000, v20
    v_pk_mul_f32 v[248:249], v[252:253], v[252:253]
    v_pk_fma_f32 v[248:249], v[248:249], v[224:225], v[224:225] op_sel:[0,1,0] op_sel_hi:[1,1,0]
    v_pk_mul_f32 v[248:249], v[248:249], v[252:253]
    v_exp_f32 v248, v248
    v_exp_f32 v249, v249
    s_nop 0
    v_pk_add_f32 v[248:249], v[248:249], 1.0 op_sel_hi:[1,0]
    v_rcp_f32 v248, v248
    v_rcp_f32 v249, v249
    s_nop 0
    v_pk_mul_f32 v[252:253], v[252:253], v[248:249]
    v_cvt_pk_bf16_f32 v20, v252, v253
    v_lshlrev_b32 v252, 16, v20
    v_and_b32 v253, 0xffff0000, v20
    v_pk_add_f32 v[240:241], v[240:241], v[252:253]
    v_pk_fma_f32 v[242:243], v[252:253], v[252:253], v[242:243]
    v_lshlrev_b32 v252, 16, v21
    v_and_b32 v253, 0xffff0000, v21
    v_pk_mul_f32 v[248:249], v[252:253], v[252:253]
    v_pk_fma_f32 v[248:249], v[248:249], v[224:225], v[224:225] op_sel:[0,1,0] op_sel_hi:[1,1,0]
    v_pk_mul_f32 v[248:249], v[248:249], v[252:253]
    v_exp_f32 v248, v248
    v_exp_f32 v249, v249
    s_nop 0
    v_pk_add_f32 v[248:249], v[248:249], 1.0 op_sel_hi:[1,0]
    v_rcp_f32 v248, v248
    v_rcp_f32 v249, v249
    s_nop 0
    v_pk_mul_f32 v[252:253], v[252:253], v[248:249]
    v_cvt_pk_bf16_f32 v21, v252, v253
    v_lshlrev_b32 v252, 16, v21
    v_and_b32 v253, 0xffff0000, v21
    v_pk_add_f32 v[240:241], v[240:241], v[252:253]
    v_pk_fma_f32 v[242:243], v[252:253], v[252:253], v[242:243]
    ds_write_b64 v4, v[20:21] offset:96
    v_pk_fma_f32 v[24:25], v[200:201], v[220:221], v[24:25] op_sel:[0,0,0] op_sel_hi:[1,0,1]
    v_pk_fma_f32 v[26:27], v[202:203], v[220:221], v[26:27] op_sel:[0,0,0] op_sel_hi:[1,0,1]
    v_pk_mul_f32 v[24:25], v[24:25], v[222:223] op_sel:[0,0] op_sel_hi:[1,0]
    v_pk_mul_f32 v[26:27], v[26:27], v[222:223] op_sel:[0,0] op_sel_hi:[1,0]
    v_cvt_pk_bf16_f32 v24, v24, v25
    v_cvt_pk_bf16_f32 v25, v26, v27
    v_lshlrev_b32 v252, 16, v24
    v_and_b32 v253, 0xffff0000, v24
    v_pk_mul_f32 v[248:249], v[252:253], v[252:253]
    v_pk_fma_f32 v[248:249], v[248:249], v[224:225], v[224:225] op_sel:[0,1,0] op_sel_hi:[1,1,0]
    v_pk_mul_f32 v[248:249], v[248:249], v[252:253]
    v_exp_f32 v248, v248
    v_exp_f32 v249, v249
    s_nop 0
    v_pk_add_f32 v[248:249], v[248:249], 1.0 op_sel_hi:[1,0]
    v_rcp_f32 v248, v248
    v_rcp_f32 v249, v249
    s_nop 0
    v_pk_mul_f32 v[252:253], v[252:253], v[248:249]
    v_cvt_pk_bf16_f32 v24, v252, v253
    v_lshlrev_b32 v252, 16, v24
    v_and_b32 v253, 0xffff0000, v24
    v_pk_add_f32 v[240:241], v[240:241], v[252:253]
    v_pk_fma_f32 v[242:243], v[252:253], v[252:253], v[242:243]
    v_lshlrev_b32 v252, 16, v25
    v_and_b32 v253, 0xffff0000, v25
    v_pk_mul_f32 v[248:249], v[252:253], v[252:253]
    v_pk_fma_f32 v[248:249], v[248:249], v[224:225], v[224:225] op_sel:[0,1,0] op_sel_hi:[1,1,0]
    v_pk_mul_f32 v[248:249], v[248:249], v[252:253]
    v_exp_f32 v248, v248
    v_exp_f32 v249, v249
    s_nop 0
    v_pk_add_f32 v[248:249], v[248:249], 1.0 op_sel_hi:[1,0]
    v_rcp_f32 v248, v248
    v_rcp_f32 v249, v249
    s_nop 0
    v_pk_mul_f32 v[252:253], v[252:253], v[248:249]
    v_cvt_pk_bf16_f32 v25, v252, v253
    v_lshlrev_b32 v252, 16, v25
    v_and_b32 v253, 0xffff0000, v25
    v_pk_add_f32 v[240:241], v[240:241], v[252:253]
    v_pk_fma_f32 v[242:243], v[252:253], v[252:253], v[242:243]
    ds_write_b64 v4, v[24:25] offset:128
    v_pk_fma_f32 v[28:29], v[204:205], v[220:221], v[28:29] op_sel:[0,0,0] op_sel_hi:[1,0,1]
    v_pk_fma_f32 v[30:31], v[206:207], v[220:221], v[30:31] op_sel:[0,0,0] op_sel_hi:[1,0,1]
    v_pk_mul_f32 v[28:29], v[28:29], v[222:223] op_sel:[0,0] op_sel_hi:[1,0]
    v_pk_mul_f32 v[30:31], v[30:31], v[222:223] op_sel:[0,0] op_sel_hi:[1,0]
    v_cvt_pk_bf16_f32 v28, v28, v29
    v_cvt_pk_bf16_f32 v29, v30, v31
    v_lshlrev_b32 v252, 16, v28
    v_and_b32 v253, 0xffff0000, v28
    v_pk_mul_f32 v[248:249], v[252:253], v[252:253]
    v_pk_fma_f32 v[248:249], v[248:249], v[224:225], v[224:225] op_sel:[0,1,0] op_sel_hi:[1,1,0]
    v_pk_mul_f32 v[248:249], v[248:249], v[252:253]
    v_exp_f32 v248, v248
    v_exp_f32 v249, v249
    s_nop 0
    v_pk_add_f32 v[248:249], v[248:249], 1.0 op_sel_hi:[1,0]
    v_rcp_f32 v248, v248
    v_rcp_f32 v249, v249
    s_nop 0
    v_pk_mul_f32 v[252:253], v[252:253], v[248:249]
    v_cvt_pk_bf16_f32 v28, v252, v253
    v_lshlrev_b32 v252, 16, v28
    v_and_b32 v253, 0xffff0000, v28
    v_pk_add_f32 v[240:241], v[240:241], v[252:253]
    v_pk_fma_f32 v[242:243], v[252:253], v[252:253], v[242:243]
    v_lshlrev_b32 v252, 16, v29
    v_and_b32 v253, 0xffff0000, v29
    v_pk_mul_f32 v[248:249], v[252:253], v[252:253]
    v_pk_fma_f32 v[248:249], v[248:249], v[224:225], v[224:225] op_sel:[0,1,0] op_sel_hi:[1,1,0]
    v_pk_mul_f32 v[248:249], v[248:249], v[252:253]
    v_exp_f32 v248, v248
    v_exp_f32 v249, v249
    s_nop 0
    v_pk_add_f32 v[248:249], v[248:249], 1.0 op_sel_hi:[1,0]
    v_rcp_f32 v248, v248
    v_rcp_f32 v249, v249
    s_nop 0
    v_pk_mul_f32 v[252:253], v[252:253], v[248:249]
    v_cvt_pk_bf16_f32 v29, v252, v253
    v_lshlrev_b32 v252, 16, v29
    v_and_b32 v253, 0xffff0000, v29
    v_pk_add_f32 v[240:241], v[240:241], v[252:253]
    v_pk_fma_f32 v[242:243], v[252:253], v[252:253], v[242:243]
    ds_write_b64 v4, v[28:29] offset:160
    v_pk_fma_f32 v[32:33], v[208:209], v[220:221], v[32:33] op_sel:[0,0,0] op_sel_hi:[1,0,1]
    v_pk_fma_f32 v[34:35], v[210:211], v[220:221], v[34:35] op_sel:[0,0,0] op_sel_hi:[1,0,1]
    v_pk_mul_f32 v[32:33], v[32:33], v[222:223] op_sel:[0,0] op_sel_hi:[1,0]
    v_pk_mul_f32 v[34:35], v[34:35], v[222:223] op_sel:[0,0] op_sel_hi:[1,0]
    v_cvt_pk_bf16_f32 v32, v32, v33
    v_cvt_pk_bf16_f32 v33, v34, v35
    v_lshlrev_b32 v252, 16, v32
    v_and_b32 v253, 0xffff0000, v32
    v_pk_mul_f32 v[248:249], v[252:253], v[252:253]
    v_pk_fma_f32 v[248:249], v[248:249], v[224:225], v[224:225] op_sel:[0,1,0] op_sel_hi:[1,1,0]
    v_pk_mul_f32 v[248:249], v[248:249], v[252:253]
    v_exp_f32 v248, v248
    v_exp_f32 v249, v249
    s_nop 0
    v_pk_add_f32 v[248:249], v[248:249], 1.0 op_sel_hi:[1,0]
    v_rcp_f32 v248, v248
    v_rcp_f32 v249, v249
    s_nop 0
    v_pk_mul_f32 v[252:253], v[252:253], v[248:249]
    v_cvt_pk_bf16_f32 v32, v252, v253
    v_lshlrev_b32 v252, 16, v32
    v_and_b32 v253, 0xffff0000, v32
    v_pk_add_f32 v[240:241], v[240:241], v[252:253]
    v_pk_fma_f32 v[242:243], v[252:253], v[252:253], v[242:243]
    v_lshlrev_b32 v252, 16, v33
    v_and_b32 v253, 0xffff0000, v33
    v_pk_mul_f32 v[248:249], v[252:253], v[252:253]
    v_pk_fma_f32 v[248:249], v[248:249], v[224:225], v[224:225] op_sel:[0,1,0] op_sel_hi:[1,1,0]
    v_pk_mul_f32 v[248:249], v[248:249], v[252:253]
    v_exp_f32 v248, v248
    v_exp_f32 v249, v249
    s_nop 0
    v_pk_add_f32 v[248:249], v[248:249], 1.0 op_sel_hi:[1,0]
    v_rcp_f32 v248, v248
    v_rcp_f32 v249, v249
    s_nop 0
    v_pk_mul_f32 v[252:253], v[252:253], v[248:249]
    v_cvt_pk_bf16_f32 v33, v252, v253
    v_lshlrev_b32 v252, 16, v33
    v_and_b32 v253, 0xffff0000, v33
    v_pk_add_f32 v[240:241], v[240:241], v[252:253]
    v_pk_fma_f32 v[242:243], v[252:253], v[252:253], v[242:243]
    ds_write_b64 v4, v[32:33] offset:192
    v_pk_fma_f32 v[36:37], v[212:213], v[220:221], v[36:37] op_sel:[0,0,0] op_sel_hi:[1,0,1]
    v_pk_fma_f32 v[38:39], v[214:215], v[220:221], v[38:39] op_sel:[0,0,0] op_sel_hi:[1,0,1]
    v_pk_mul_f32 v[36:37], v[36:37], v[222:223] op_sel:[0,0] op_sel_hi:[1,0]
    v_pk_mul_f32 v[38:39], v[38:39], v[222:223] op_sel:[0,0] op_sel_hi:[1,0]
    v_cvt_pk_bf16_f32 v36, v36, v37
    v_cvt_pk_bf16_f32 v37, v38, v39
    v_lshlrev_b32 v252, 16, v36
    v_and_b32 v253, 0xffff0000, v36
    v_pk_mul_f32 v[248:249], v[252:253], v[252:253]
    v_pk_fma_f32 v[248:249], v[248:249], v[224:225], v[224:225] op_sel:[0,1,0] op_sel_hi:[1,1,0]
    v_pk_mul_f32 v[248:249], v[248:249], v[252:253]
    v_exp_f32 v248, v248
    v_exp_f32 v249, v249
    s_nop 0
    v_pk_add_f32 v[248:249], v[248:249], 1.0 op_sel_hi:[1,0]
    v_rcp_f32 v248, v248
    v_rcp_f32 v249, v249
    s_nop 0
    v_pk_mul_f32 v[252:253], v[252:253], v[248:249]
    v_cvt_pk_bf16_f32 v36, v252, v253
    v_lshlrev_b32 v252, 16, v36
    v_and_b32 v253, 0xffff0000, v36
    v_pk_add_f32 v[240:241], v[240:241], v[252:253]
    v_pk_fma_f32 v[242:243], v[252:253], v[252:253], v[242:243]
    v_lshlrev_b32 v252, 16, v37
    v_and_b32 v253, 0xffff0000, v37
    v_pk_mul_f32 v[248:249], v[252:253], v[252:253]
    v_pk_fma_f32 v[248:249], v[248:249], v[224:225], v[224:225] op_sel:[0,1,0] op_sel_hi:[1,1,0]
    v_pk_mul_f32 v[248:249], v[248:249], v[252:253]
    v_exp_f32 v248, v248
    v_exp_f32 v249, v249
    s_nop 0
    v_pk_add_f32 v[248:249], v[248:249], 1.0 op_sel_hi:[1,0]
    v_rcp_f32 v248, v248
    v_rcp_f32 v249, v249
    s_nop 0
    v_pk_mul_f32 v[252:253], v[252:253], v[248:249]
    v_cvt_pk_bf16_f32 v37, v252, v253
    v_lshlrev_b32 v252, 16, v37
    v_and_b32 v253, 0xffff0000, v37
    v_pk_add_f32 v[240:241], v[240:241], v[252:253]
    v_pk_fma_f32 v[242:243], v[252:253], v[252:253], v[242:243]
    ds_write_b64 v4, v[36:37] offset:224
    v_pk_fma_f32 v[40:41], v[216:217], v[220:221], v[40:41] op_sel:[0,0,0] op_sel_hi:[1,0,1]
    v_pk_fma_f32 v[42:43], v[218:219], v[220:221], v[42:43] op_sel:[0,0,0] op_sel_hi:[1,0,1]
    v_pk_mul_f32 v[40:41], v[40:41], v[222:223] op_sel:[0,0] op_sel_hi:[1,0]
    v_pk_mul_f32 v[42:43], v[42:43], v[222:223] op_sel:[0,0] op_sel_hi:[1,0]
    v_cvt_pk_bf16_f32 v40, v40, v41
    v_cvt_pk_bf16_f32 v41, v42, v43
    v_lshlrev_b32 v252, 16, v40
    v_and_b32 v253, 0xffff0000, v40
    v_pk_mul_f32 v[248:249], v[252:253], v[252:253]
    v_pk_fma_f32 v[248:249], v[248:249], v[224:225], v[224:225] op_sel:[0,1,0] op_sel_hi:[1,1,0]
    v_pk_mul_f32 v[248:249], v[248:249], v[252:253]
    v_exp_f32 v248, v248
    v_exp_f32 v249, v249
    s_nop 0
    v_pk_add_f32 v[248:249], v[248:249], 1.0 op_sel_hi:[1,0]
    v_rcp_f32 v248, v248
    v_rcp_f32 v249, v249
    s_nop 0
    v_pk_mul_f32 v[252:253], v[252:253], v[248:249]
    v_cvt_pk_bf16_f32 v40, v252, v253
    v_lshlrev_b32 v252, 16, v40
    v_and_b32 v253, 0xffff0000, v40
    v_pk_add_f32 v[240:241], v[240:241], v[252:253]
    v_pk_fma_f32 v[242:243], v[252:253], v[252:253], v[242:243]
    v_lshlrev_b32 v252, 16, v41
    v_and_b32 v253, 0xffff0000, v41
    v_pk_mul_f32 v[248:249], v[252:253], v[252:253]
    v_pk_fma_f32 v[248:249], v[248:249], v[224:225], v[224:225] op_sel:[0,1,0] op_sel_hi:[1,1,0]
    v_pk_mul_f32 v[248:249], v[248:249], v[252:253]
    v_exp_f32 v248, v248
    v_exp_f32 v249, v249
    s_nop 0
    v_pk_add_f32 v[248:249], v[248:249], 1.0 op_sel_hi:[1,0]
    v_rcp_f32 v248, v248
    v_rcp_f32 v249, v249
    s_nop 0
    v_pk_mul_f32 v[252:253], v[252:253], v[248:249]
    v_cvt_pk_bf16_f32 v41, v252, v253
    v_lshlrev_b32 v252, 16, v41
    v_and_b32 v253, 0xffff0000, v41
    v_pk_add_f32 v[240:241], v[240:241], v[252:253]
    v_pk_fma_f32 v[242:243], v[252:253], v[252:253], v[242:243]
    ds_write_b64 v4, v[40:41] offset:256
    s_waitcnt lgkmcnt(0)
    ds_read_b128 v[8:11], v5 offset:0
    ds_read_b128 v[12:15], v5 offset:1024
    ds_read_b128 v[16:19], v5 offset:2048
    ds_read_b128 v[20:23], v5 offset:3072
    s_mov_b32 exec_hi, 0
    ds_read_b128 v[24:27], v5 offset:4096
    s_mov_b32 exec_hi, -1
    s_waitcnt lgkmcnt(4)
    buffer_store_dwordx4 v[8:11], v226, s[40:43], 0 offen sc1
    s_waitcnt lgkmcnt(3)
    buffer_store_dwordx4 v[12:15], v227, s[40:43], 0 offen sc1
    s_waitcnt lgkmcnt(2)
    buffer_store_dwordx4 v[16:19], v228, s[40:43], 0 offen sc1
    s_waitcnt lgkmcnt(1)
    buffer_store_dwordx4 v[20:23], v229, s[40:43], 0 offen sc1
    s_waitcnt lgkmcnt(0)
    s_mov_b32 exec_hi, 0
    buffer_store_dwordx4 v[24:27], v230, s[40:43], 0 offen sc1
    s_mov_b32 exec_hi, -1
    s_lshl_b32 s60, s68, 4
    v_add_u32 v226, s60, v226
    v_add_u32 v227, s60, v227
    v_add_u32 v228, s60, v228
    v_add_u32 v229, s60, v229
    v_add_u32 v230, s60, v230
    v_pk_fma_f32 v[44:45], v[184:185], v[220:221], v[44:45] op_sel:[0,1,0] op_sel_hi:[1,1,1]
    v_pk_fma_f32 v[46:47], v[186:187], v[220:221], v[46:47] op_sel:[0,1,0] op_sel_hi:[1,1,1]
    v_pk_mul_f32 v[44:45], v[44:45], v[222:223] op_sel:[0,1] op_sel_hi:[1,1]
    v_pk_mul_f32 v[46:47], v[46:47], v[222:223] op_sel:[0,1] op_sel_hi:[1,1]
    v_cvt_pk_bf16_f32 v44, v44, v45
    v_cvt_pk_bf16_f32 v45, v46, v47
    v_lshlrev_b32 v252, 16, v44
    v_and_b32 v253, 0xffff0000, v44
    v_pk_mul_f32 v[248:249], v[252:253], v[252:253]
    v_pk_fma_f32 v[248:249], v[248:249], v[224:225], v[224:225] op_sel:[0,1,0] op_sel_hi:[1,1,0]
    v_pk_mul_f32 v[248:249], v[248:249], v[252:253]
    v_exp_f32 v248, v248
    v_exp_f32 v249, v249
    s_nop 0
    v_pk_add_f32 v[248:249], v[248:249], 1.0 op_sel_hi:[1,0]
    v_rcp_f32 v248, v248
    v_rcp_f32 v249, v249
    s_nop 0
    v_pk_mul_f32 v[252:253], v[252:253], v[248:249]
    v_cvt_pk_bf16_f32 v44, v252, v253
    v_lshlrev_b32 v252, 16, v44
    v_and_b32 v253, 0xffff0000, v44
    v_pk_add_f32 v[244:245], v[244:245], v[252:253]
    v_pk_fma_f32 v[246:247], v[252:253], v[252:253], v[246:247]
    v_lshlrev_b32 v252, 16, v45
    v_and_b32 v253, 0xffff0000, v45
    v_pk_mul_f32 v[248:249], v[252:253], v[252:253]
    v_pk_fma_f32 v[248:249], v[248:249], v[224:225], v[224:225] op_sel:[0,1,0] op_sel_hi:[1,1,0]
    v_pk_mul_f32 v[248:249], v[248:249], v[252:253]
    v_exp_f32 v248, v248
    v_exp_f32 v249, v249
    s_nop 0
    v_pk_add_f32 v[248:249], v[248:249], 1.0 op_sel_hi:[1,0]
    v_rcp_f32 v248, v248
    v_rcp_f32 v249, v249
    s_nop 0
    v_pk_mul_f32 v[252:253], v[252:253], v[248:249]
    v_cvt_pk_bf16_f32 v45, v252, v253
    v_lshlrev_b32 v252, 16, v45
    v_and_b32 v253, 0xffff0000, v45
    v_pk_add_f32 v[244:245], v[244:245], v[252:253]
    v_pk_fma_f32 v[246:247], v[252:253], v[252:253], v[246:247]
    ds_write_b64 v4, v[44:45] offset:0
    v_pk_fma_f32 v[48:49], v[188:189], v[220:221], v[48:49] op_sel:[0,1,0] op_sel_hi:[1,1,1]
    v_pk_fma_f32 v[50:51], v[190:191], v[220:221], v[50:51] op_sel:[0,1,0] op_sel_hi:[1,1,1]
    v_pk_mul_f32 v[48:49], v[48:49], v[222:223] op_sel:[0,1] op_sel_hi:[1,1]
    v_pk_mul_f32 v[50:51], v[50:51], v[222:223] op_sel:[0,1] op_sel_hi:[1,1]
    v_cvt_pk_bf16_f32 v48, v48, v49
    v_cvt_pk_bf16_f32 v49, v50, v51
    v_lshlrev_b32 v252, 16, v48
    v_and_b32 v253, 0xffff0000, v48
    v_pk_mul_f32 v[248:249], v[252:253], v[252:253]
    v_pk_fma_f32 v[248:249], v[248:249], v[224:225], v[224:225] op_sel:[0,1,0] op_sel_hi:[1,1,0]
    v_pk_mul_f32 v[248:249], v[248:249], v[252:253]
    v_exp_f32 v248, v248
    v_exp_f32 v249, v249
    s_nop 0
    v_pk_add_f32 v[248:249], v[248:249], 1.0 op_sel_hi:[1,0]
    v_rcp_f32 v248, v248
    v_rcp_f32 v249, v249
    s_nop 0
    v_pk_mul_f32 v[252:253], v[252:253], v[248:249]
    v_cvt_pk_bf16_f32 v48, v252, v253
    v_lshlrev_b32 v252, 16, v48
    v_and_b32 v253, 0xffff0000, v48
    v_pk_add_f32 v[244:245], v[244:245], v[252:253]
    v_pk_fma_f32 v[246:247], v[252:253], v[252:253], v[246:247]
    v_lshlrev_b32 v252, 16, v49
    v_and_b32 v253, 0xffff0000, v49
    v_pk_mul_f32 v[248:249], v[252:253], v[252:253]
    v_pk_fma_f32 v[248:249], v[248:249], v[224:225], v[224:225] op_sel:[0,1,0] op_sel_hi:[1,1,0]
    v_pk_mul_f32 v[248:249], v[248:249], v[252:253]
    v_exp_f32 v248, v248
    v_exp_f32 v249, v249
    s_nop 0
    v_pk_add_f32 v[248:249], v[248:249], 1.0 op_sel_hi:[1,0]
    v_rcp_f32 v248, v248
    v_rcp_f32 v249, v249
    s_nop 0
    v_pk_mul_f32 v[252:253], v[252:253], v[248:249]
    v_cvt_pk_bf16_f32 v49, v252, v253
    v_lshlrev_b32 v252, 16, v49
    v_and_b32 v253, 0xffff0000, v49
    v_pk_add_f32 v[244:245], v[244:245], v[252:253]
    v_pk_fma_f32 v[246:247], v[252:253], v[252:253], v[246:247]
    ds_write_b64 v4, v[48:49] offset:32
    v_pk_fma_f32 v[52:53], v[192:193], v[220:221], v[52:53] op_sel:[0,1,0] op_sel_hi:[1,1,1]
    v_pk_fma_f32 v[54:55], v[194:195], v[220:221], v[54:55] op_sel:[0,1,0] op_sel_hi:[1,1,1]
    v_pk_mul_f32 v[52:53], v[52:53], v[222:223] op_sel:[0,1] op_sel_hi:[1,1]
    v_pk_mul_f32 v[54:55], v[54:55], v[222:223] op_sel:[0,1] op_sel_hi:[1,1]
    v_cvt_pk_bf16_f32 v52, v52, v53
    v_cvt_pk_bf16_f32 v53, v54, v55
    v_lshlrev_b32 v252, 16, v52
    v_and_b32 v253, 0xffff0000, v52
    v_pk_mul_f32 v[248:249], v[252:253], v[252:253]
    v_pk_fma_f32 v[248:249], v[248:249], v[224:225], v[224:225] op_sel:[0,1,0] op_sel_hi:[1,1,0]
    v_pk_mul_f32 v[248:249], v[248:249], v[252:253]
    v_exp_f32 v248, v248
    v_exp_f32 v249, v249
    s_nop 0
    v_pk_add_f32 v[248:249], v[248:249], 1.0 op_sel_hi:[1,0]
    v_rcp_f32 v248, v248
    v_rcp_f32 v249, v249
    s_nop 0
    v_pk_mul_f32 v[252:253], v[252:253], v[248:249]
    v_cvt_pk_bf16_f32 v52, v252, v253
    v_lshlrev_b32 v252, 16, v52
    v_and_b32 v253, 0xffff0000, v52
    v_pk_add_f32 v[244:245], v[244:245], v[252:253]
    v_pk_fma_f32 v[246:247], v[252:253], v[252:253], v[246:247]
    v_lshlrev_b32 v252, 16, v53
    v_and_b32 v253, 0xffff0000, v53
    v_pk_mul_f32 v[248:249], v[252:253], v[252:253]
    v_pk_fma_f32 v[248:249], v[248:249], v[224:225], v[224:225] op_sel:[0,1,0] op_sel_hi:[1,1,0]
    v_pk_mul_f32 v[248:249], v[248:249], v[252:253]
    v_exp_f32 v248, v248
    v_exp_f32 v249, v249
    s_nop 0
    v_pk_add_f32 v[248:249], v[248:249], 1.0 op_sel_hi:[1,0]
    v_rcp_f32 v248, v248
    v_rcp_f32 v249, v249
    s_nop 0
    v_pk_mul_f32 v[252:253], v[252:253], v[248:249]
    v_cvt_pk_bf16_f32 v53, v252, v253
    v_lshlrev_b32 v252, 16, v53
    v_and_b32 v253, 0xffff0000, v53
    v_pk_add_f32 v[244:245], v[244:245], v[252:253]
    v_pk_fma_f32 v[246:247], v[252:253], v[252:253], v[246:247]
    ds_write_b64 v4, v[52:53] offset:64
    v_pk_fma_f32 v[56:57], v[196:197], v[220:221], v[56:57] op_sel:[0,1,0] op_sel_hi:[1,1,1]
    v_pk_fma_f32 v[58:59], v[198:199], v[220:221], v[58:59] op_sel:[0,1,0] op_sel_hi:[1,1,1]
    v_pk_mul_f32 v[56:57], v[56:57], v[222:223] op_sel:[0,1] op_sel_hi:[1,1]
    v_pk_mul_f32 v[58:59], v[58:59], v[222:223] op_sel:[0,1] op_sel_hi:[1,1]
    v_cvt_pk_bf16_f32 v56, v56, v57
    v_cvt_pk_bf16_f32 v57, v58, v59
    v_lshlrev_b32 v252, 16, v56
    v_and_b32 v253, 0xffff0000, v56
    v_pk_mul_f32 v[248:249], v[252:253], v[252:253]
    v_pk_fma_f32 v[248:249], v[248:249], v[224:225], v[224:225] op_sel:[0,1,0] op_sel_hi:[1,1,0]
    v_pk_mul_f32 v[248:249], v[248:249], v[252:253]
    v_exp_f32 v248, v248
    v_exp_f32 v249, v249
    s_nop 0
    v_pk_add_f32 v[248:249], v[248:249], 1.0 op_sel_hi:[1,0]
    v_rcp_f32 v248, v248
    v_rcp_f32 v249, v249
    s_nop 0
    v_pk_mul_f32 v[252:253], v[252:253], v[248:249]
    v_cvt_pk_bf16_f32 v56, v252, v253
    v_lshlrev_b32 v252, 16, v56
    v_and_b32 v253, 0xffff0000, v56
    v_pk_add_f32 v[244:245], v[244:245], v[252:253]
    v_pk_fma_f32 v[246:247], v[252:253], v[252:253], v[246:247]
    v_lshlrev_b32 v252, 16, v57
    v_and_b32 v253, 0xffff0000, v57
    v_pk_mul_f32 v[248:249], v[252:253], v[252:253]
    v_pk_fma_f32 v[248:249], v[248:249], v[224:225], v[224:225] op_sel:[0,1,0] op_sel_hi:[1,1,0]
    v_pk_mul_f32 v[248:249], v[248:249], v[252:253]
    v_exp_f32 v248, v248
    v_exp_f32 v249, v249
    s_nop 0
    v_pk_add_f32 v[248:249], v[248:249], 1.0 op_sel_hi:[1,0]
    v_rcp_f32 v248, v248
    v_rcp_f32 v249, v249
    s_nop 0
    v_pk_mul_f32 v[252:253], v[252:253], v[248:249]
    v_cvt_pk_bf16_f32 v57, v252, v253
    v_lshlrev_b32 v252, 16, v57
    v_and_b32 v253, 0xffff0000, v57
    v_pk_add_f32 v[244:245], v[244:245], v[252:253]
    v_pk_fma_f32 v[246:247], v[252:253], v[252:253], v[246:247]
    ds_write_b64 v4, v[56:57] offset:96
    v_pk_fma_f32 v[60:61], v[200:201], v[220:221], v[60:61] op_sel:[0,1,0] op_sel_hi:[1,1,1]
    v_pk_fma_f32 v[62:63], v[202:203], v[220:221], v[62:63] op_sel:[0,1,0] op_sel_hi:[1,1,1]
    v_pk_mul_f32 v[60:61], v[60:61], v[222:223] op_sel:[0,1] op_sel_hi:[1,1]
    v_pk_mul_f32 v[62:63], v[62:63], v[222:223] op_sel:[0,1] op_sel_hi:[1,1]
    v_cvt_pk_bf16_f32 v60, v60, v61
    v_cvt_pk_bf16_f32 v61, v62, v63
    v_lshlrev_b32 v252, 16, v60
    v_and_b32 v253, 0xffff0000, v60
    v_pk_mul_f32 v[248:249], v[252:253], v[252:253]
    v_pk_fma_f32 v[248:249], v[248:249], v[224:225], v[224:225] op_sel:[0,1,0] op_sel_hi:[1,1,0]
    v_pk_mul_f32 v[248:249], v[248:249], v[252:253]
    v_exp_f32 v248, v248
    v_exp_f32 v249, v249
    s_nop 0
    v_pk_add_f32 v[248:249], v[248:249], 1.0 op_sel_hi:[1,0]
    v_rcp_f32 v248, v248
    v_rcp_f32 v249, v249
    s_nop 0
    v_pk_mul_f32 v[252:253], v[252:253], v[248:249]
    v_cvt_pk_bf16_f32 v60, v252, v253
    v_lshlrev_b32 v252, 16, v60
    v_and_b32 v253, 0xffff0000, v60
    v_pk_add_f32 v[244:245], v[244:245], v[252:253]
    v_pk_fma_f32 v[246:247], v[252:253], v[252:253], v[246:247]
    v_lshlrev_b32 v252, 16, v61
    v_and_b32 v253, 0xffff0000, v61
    v_pk_mul_f32 v[248:249], v[252:253], v[252:253]
    v_pk_fma_f32 v[248:249], v[248:249], v[224:225], v[224:225] op_sel:[0,1,0] op_sel_hi:[1,1,0]
    v_pk_mul_f32 v[248:249], v[248:249], v[252:253]
    v_exp_f32 v248, v248
    v_exp_f32 v249, v249
    s_nop 0
    v_pk_add_f32 v[248:249], v[248:249], 1.0 op_sel_hi:[1,0]
    v_rcp_f32 v248, v248
    v_rcp_f32 v249, v249
    s_nop 0
    v_pk_mul_f32 v[252:253], v[252:253], v[248:249]
    v_cvt_pk_bf16_f32 v61, v252, v253
    v_lshlrev_b32 v252, 16, v61
    v_and_b32 v253, 0xffff0000, v61
    v_pk_add_f32 v[244:245], v[244:245], v[252:253]
    v_pk_fma_f32 v[246:247], v[252:253], v[252:253], v[246:247]
    ds_write_b64 v4, v[60:61] offset:128
    v_pk_fma_f32 v[64:65], v[204:205], v[220:221], v[64:65] op_sel:[0,1,0] op_sel_hi:[1,1,1]
    v_pk_fma_f32 v[66:67], v[206:207], v[220:221], v[66:67] op_sel:[0,1,0] op_sel_hi:[1,1,1]
    v_pk_mul_f32 v[64:65], v[64:65], v[222:223] op_sel:[0,1] op_sel_hi:[1,1]
    v_pk_mul_f32 v[66:67], v[66:67], v[222:223] op_sel:[0,1] op_sel_hi:[1,1]
    v_cvt_pk_bf16_f32 v64, v64, v65
    v_cvt_pk_bf16_f32 v65, v66, v67
    v_lshlrev_b32 v252, 16, v64
    v_and_b32 v253, 0xffff0000, v64
    v_pk_mul_f32 v[248:249], v[252:253], v[252:253]
    v_pk_fma_f32 v[248:249], v[248:249], v[224:225], v[224:225] op_sel:[0,1,0] op_sel_hi:[1,1,0]
    v_pk_mul_f32 v[248:249], v[248:249], v[252:253]
    v_exp_f32 v248, v248
    v_exp_f32 v249, v249
    s_nop 0
    v_pk_add_f32 v[248:249], v[248:249], 1.0 op_sel_hi:[1,0]
    v_rcp_f32 v248, v248
    v_rcp_f32 v249, v249
    s_nop 0
    v_pk_mul_f32 v[252:253], v[252:253], v[248:249]
    v_cvt_pk_bf16_f32 v64, v252, v253
    v_lshlrev_b32 v252, 16, v64
    v_and_b32 v253, 0xffff0000, v64
    v_pk_add_f32 v[244:245], v[244:245], v[252:253]
    v_pk_fma_f32 v[246:247], v[252:253], v[252:253], v[246:247]
    v_lshlrev_b32 v252, 16, v65
    v_and_b32 v253, 0xffff0000, v65
    v_pk_mul_f32 v[248:249], v[252:253], v[252:253]
    v_pk_fma_f32 v[248:249], v[248:249], v[224:225], v[224:225] op_sel:[0,1,0] op_sel_hi:[1,1,0]
    v_pk_mul_f32 v[248:249], v[248:249], v[252:253]
    v_exp_f32 v248, v248
    v_exp_f32 v249, v249
    s_nop 0
    v_pk_add_f32 v[248:249], v[248:249], 1.0 op_sel_hi:[1,0]
    v_rcp_f32 v248, v248
    v_rcp_f32 v249, v249
    s_nop 0
    v_pk_mul_f32 v[252:253], v[252:253], v[248:249]
    v_cvt_pk_bf16_f32 v65, v252, v253
    v_lshlrev_b32 v252, 16, v65
    v_and_b32 v253, 0xffff0000, v65
    v_pk_add_f32 v[244:245], v[244:245], v[252:253]
    v_pk_fma_f32 v[246:247], v[252:253], v[252:253], v[246:247]
    ds_write_b64 v4, v[64:65] offset:160
    v_pk_fma_f32 v[68:69], v[208:209], v[220:221], v[68:69] op_sel:[0,1,0] op_sel_hi:[1,1,1]
    v_pk_fma_f32 v[70:71], v[210:211], v[220:221], v[70:71] op_sel:[0,1,0] op_sel_hi:[1,1,1]
    v_pk_mul_f32 v[68:69], v[68:69], v[222:223] op_sel:[0,1] op_sel_hi:[1,1]
    v_pk_mul_f32 v[70:71], v[70:71], v[222:223] op_sel:[0,1] op_sel_hi:[1,1]
    v_cvt_pk_bf16_f32 v68, v68, v69
    v_cvt_pk_bf16_f32 v69, v70, v71
    v_lshlrev_b32 v252, 16, v68
    v_and_b32 v253, 0xffff0000, v68
    v_pk_mul_f32 v[248:249], v[252:253], v[252:253]
    v_pk_fma_f32 v[248:249], v[248:249], v[224:225], v[224:225] op_sel:[0,1,0] op_sel_hi:[1,1,0]
    v_pk_mul_f32 v[248:249], v[248:249], v[252:253]
    v_exp_f32 v248, v248
    v_exp_f32 v249, v249
    s_nop 0
    v_pk_add_f32 v[248:249], v[248:249], 1.0 op_sel_hi:[1,0]
    v_rcp_f32 v248, v248
    v_rcp_f32 v249, v249
    s_nop 0
    v_pk_mul_f32 v[252:253], v[252:253], v[248:249]
    v_cvt_pk_bf16_f32 v68, v252, v253
    v_lshlrev_b32 v252, 16, v68
    v_and_b32 v253, 0xffff0000, v68
    v_pk_add_f32 v[244:245], v[244:245], v[252:253]
    v_pk_fma_f32 v[246:247], v[252:253], v[252:253], v[246:247]
    v_lshlrev_b32 v252, 16, v69
    v_and_b32 v253, 0xffff0000, v69
    v_pk_mul_f32 v[248:249], v[252:253], v[252:253]
    v_pk_fma_f32 v[248:249], v[248:249], v[224:225], v[224:225] op_sel:[0,1,0] op_sel_hi:[1,1,0]
    v_pk_mul_f32 v[248:249], v[248:249], v[252:253]
    v_exp_f32 v248, v248
    v_exp_f32 v249, v249
    s_nop 0
    v_pk_add_f32 v[248:249], v[248:249], 1.0 op_sel_hi:[1,0]
    v_rcp_f32 v248, v248
    v_rcp_f32 v249, v249
    s_nop 0
    v_pk_mul_f32 v[252:253], v[252:253], v[248:249]
    v_cvt_pk_bf16_f32 v69, v252, v253
    v_lshlrev_b32 v252, 16, v69
    v_and_b32 v253, 0xffff0000, v69
    v_pk_add_f32 v[244:245], v[244:245], v[252:253]
    v_pk_fma_f32 v[246:247], v[252:253], v[252:253], v[246:247]
    ds_write_b64 v4, v[68:69] offset:192
    v_pk_fma_f32 v[72:73], v[212:213], v[220:221], v[72:73] op_sel:[0,1,0] op_sel_hi:[1,1,1]
    v_pk_fma_f32 v[74:75], v[214:215], v[220:221], v[74:75] op_sel:[0,1,0] op_sel_hi:[1,1,1]
    v_pk_mul_f32 v[72:73], v[72:73], v[222:223] op_sel:[0,1] op_sel_hi:[1,1]
    v_pk_mul_f32 v[74:75], v[74:75], v[222:223] op_sel:[0,1] op_sel_hi:[1,1]
    v_cvt_pk_bf16_f32 v72, v72, v73
    v_cvt_pk_bf16_f32 v73, v74, v75
    v_lshlrev_b32 v252, 16, v72
    v_and_b32 v253, 0xffff0000, v72
    v_pk_mul_f32 v[248:249], v[252:253], v[252:253]
    v_pk_fma_f32 v[248:249], v[248:249], v[224:225], v[224:225] op_sel:[0,1,0] op_sel_hi:[1,1,0]
    v_pk_mul_f32 v[248:249], v[248:249], v[252:253]
    v_exp_f32 v248, v248
    v_exp_f32 v249, v249
    s_nop 0
    v_pk_add_f32 v[248:249], v[248:249], 1.0 op_sel_hi:[1,0]
    v_rcp_f32 v248, v248
    v_rcp_f32 v249, v249
    s_nop 0
    v_pk_mul_f32 v[252:253], v[252:253], v[248:249]
    v_cvt_pk_bf16_f32 v72, v252, v253
    v_lshlrev_b32 v252, 16, v72
    v_and_b32 v253, 0xffff0000, v72
    v_pk_add_f32 v[244:245], v[244:245], v[252:253]
    v_pk_fma_f32 v[246:247], v[252:253], v[252:253], v[246:247]
    v_lshlrev_b32 v252, 16, v73
    v_and_b32 v253, 0xffff0000, v73
    v_pk_mul_f32 v[248:249], v[252:253], v[252:253]
    v_pk_fma_f32 v[248:249], v[248:249], v[224:225], v[224:225] op_sel:[0,1,0] op_sel_hi:[1,1,0]
    v_pk_mul_f32 v[248:249], v[248:249], v[252:253]
    v_exp_f32 v248, v248
    v_exp_f32 v249, v249
    s_nop 0
    v_pk_add_f32 v[248:249], v[248:249], 1.0 op_sel_hi:[1,0]
    v_rcp_f32 v248, v248
    v_rcp_f32 v249, v249
    s_nop 0
    v_pk_mul_f32 v[252:253], v[252:253], v[248:249]
    v_cvt_pk_bf16_f32 v73, v252, v253
    v_lshlrev_b32 v252, 16, v73
    v_and_b32 v253, 0xffff0000, v73
    v_pk_add_f32 v[244:245], v[244:245], v[252:253]
    v_pk_fma_f32 v[246:247], v[252:253], v[252:253], v[246:247]
    ds_write_b64 v4, v[72:73] offset:224
    v_pk_fma_f32 v[76:77], v[216:217], v[220:221], v[76:77] op_sel:[0,1,0] op_sel_hi:[1,1,1]
    v_pk_fma_f32 v[78:79], v[218:219], v[220:221], v[78:79] op_sel:[0,1,0] op_sel_hi:[1,1,1]
    v_pk_mul_f32 v[76:77], v[76:77], v[222:223] op_sel:[0,1] op_sel_hi:[1,1]
    v_pk_mul_f32 v[78:79], v[78:79], v[222:223] op_sel:[0,1] op_sel_hi:[1,1]
    v_cvt_pk_bf16_f32 v76, v76, v77
    v_cvt_pk_bf16_f32 v77, v78, v79
    v_lshlrev_b32 v252, 16, v76
    v_and_b32 v253, 0xffff0000, v76
    v_pk_mul_f32 v[248:249], v[252:253], v[252:253]
    v_pk_fma_f32 v[248:249], v[248:249], v[224:225], v[224:225] op_sel:[0,1,0] op_sel_hi:[1,1,0]
    v_pk_mul_f32 v[248:249], v[248:249], v[252:253]
    v_exp_f32 v248, v248
    v_exp_f32 v249, v249
    s_nop 0
    v_pk_add_f32 v[248:249], v[248:249], 1.0 op_sel_hi:[1,0]
    v_rcp_f32 v248, v248
    v_rcp_f32 v249, v249
    s_nop 0
    v_pk_mul_f32 v[252:253], v[252:253], v[248:249]
    v_cvt_pk_bf16_f32 v76, v252, v253
    v_lshlrev_b32 v252, 16, v76
    v_and_b32 v253, 0xffff0000, v76
    v_pk_add_f32 v[244:245], v[244:245], v[252:253]
    v_pk_fma_f32 v[246:247], v[252:253], v[252:253], v[246:247]
    v_lshlrev_b32 v252, 16, v77
    v_and_b32 v253, 0xffff0000, v77
    v_pk_mul_f32 v[248:249], v[252:253], v[252:253]
    v_pk_fma_f32 v[248:249], v[248:249], v[224:225], v[224:225] op_sel:[0,1,0] op_sel_hi:[1,1,0]
    v_pk_mul_f32 v[248:249], v[248:249], v[252:253]
    v_exp_f32 v248, v248
    v_exp_f32 v249, v249
    s_nop 0
    v_pk_add_f32 v[248:249], v[248:249], 1.0 op_sel_hi:[1,0]
    v_rcp_f32 v248, v248
    v_rcp_f32 v249, v249
    s_nop 0
    v_pk_mul_f32 v[252:253], v[252:253], v[248:249]
    v_cvt_pk_bf16_f32 v77, v252, v253
    v_lshlrev_b32 v252, 16, v77
    v_and_b32 v253, 0xffff0000, v77
    v_pk_add_f32 v[244:245], v[244:245], v[252:253]
    v_pk_fma_f32 v[246:247], v[252:253], v[252:253], v[246:247]
    ds_write_b64 v4, v[76:77] offset:256
    s_waitcnt lgkmcnt(0)
    ds_read_b128 v[44:47], v5 offset:0
    ds_read_b128 v[48:51], v5 offset:1024
    ds_read_b128 v[52:55], v5 offset:2048
    ds_read_b128 v[56:59], v5 offset:3072
    s_mov_b32 exec_hi, 0
    ds_read_b128 v[60:63], v5 offset:4096
    s_mov_b32 exec_hi, -1
    s_waitcnt lgkmcnt(4)
    buffer_store_dwordx4 v[44:47], v226, s[40:43], 0 offen sc1
    s_waitcnt lgkmcnt(3)
    buffer_store_dwordx4 v[48:51], v227, s[40:43], 0 offen sc1
    s_waitcnt lgkmcnt(2)
    buffer_store_dwordx4 v[52:55], v228, s[40:43], 0 offen sc1
    s_waitcnt lgkmcnt(1)
    buffer_store_dwordx4 v[56:59], v229, s[40:43], 0 offen sc1
    s_waitcnt lgkmcnt(0)
    s_mov_b32 exec_hi, 0
    buffer_store_dwordx4 v[60:63], v230, s[40:43], 0 offen sc1
    s_mov_b32 exec_hi, -1
    v_subrev_u32 v226, s60, v226
    v_subrev_u32 v227, s60, v227
    v_subrev_u32 v228, s60, v228
    v_subrev_u32 v229, s60, v229
    v_subrev_u32 v230, s60, v230
    buffer_load_dwordx4 v[184:187], v6, s[36:39], 0 offen offset:576
    buffer_load_dwordx4 v[188:191], v6, s[36:39], 0 offen offset:640
    buffer_load_dwordx4 v[192:195], v6, s[36:39], 0 offen offset:704
    buffer_load_dwordx4 v[196:199], v6, s[36:39], 0 offen offset:768
    buffer_load_dwordx4 v[200:203], v6, s[36:39], 0 offen offset:832
    buffer_load_dwordx4 v[204:207], v6, s[36:39], 0 offen offset:896
    buffer_load_dwordx4 v[208:211], v6, s[36:39], 0 offen offset:960
    buffer_load_dwordx4 v[212:215], v6, s[36:39], 0 offen offset:1024
    buffer_load_dwordx4 v[216:219], v6, s[36:39], 0 offen offset:1088
    s_cmp_lt_u32 s65, 8
    s_cbranch_scc1 k3_kernel_fs0
    v_add_f32 v236, v240, v241
    v_add_f32 v237, v242, v243
    v_add_f32 v238, v244, v245
    v_add_f32 v239, v246, v247
    ds_bpermute_b32 v248, v2, v236
    ds_bpermute_b32 v249, v2, v237
    ds_bpermute_b32 v250, v2, v238
    ds_bpermute_b32 v251, v2, v239
    s_waitcnt lgkmcnt(0)
    v_add_f32 v236, v236, v248
    v_add_f32 v237, v237, v249
    v_add_f32 v238, v238, v250
    v_add_f32 v239, v239, v251
    ds_bpermute_b32 v248, v3, v236
    ds_bpermute_b32 v249, v3, v237
    ds_bpermute_b32 v250, v3, v238
    ds_bpermute_b32 v251, v3, v239
    s_waitcnt lgkmcnt(0)
    v_add_f32 v236, v236, v248
    v_add_f32 v237, v237, v249
    v_add_f32 v238, v238, v250
    v_add_f32 v239, v239, v251
    v_and_b32 v248, 15, v1
    v_add_u32 v248, s63, v248
    v_lshlrev_b32 v248, 3, v248
    s_mov_b64 exec, 0xffff
    buffer_atomic_add_f32 v236, v248, s[48:51], 0 offen offset:0
    buffer_atomic_add_f32 v237, v248, s[48:51], 0 offen offset:4
    buffer_atomic_add_f32 v238, v248, s[48:51], 0 offen offset:128
    buffer_atomic_add_f32 v239, v248, s[48:51], 0 offen offset:132
    s_mov_b64 exec, -1
k3_kernel_fs0:
    s_nop 1
    v_mov_b32 v8, 0
    v_mov_b32 v9, 0
    v_mov_b32 v10, 0
    v_mov_b32 v11, 0
    v_mov_b32 v12, 0
    v_mov_b32 v13, 0
    v_mov_b32 v14, 0
    v_mov_b32 v15, 0
    v_mov_b32 v16, 0
    v_mov_b32 v17, 0
    v_mov_b32 v18, 0
    v_mov_b32 v19, 0
    v_mov_b32 v20, 0
    v_mov_b32 v21, 0
    v_mov_b32 v22, 0
    v_mov_b32 v23, 0
    v_mov_b32 v24, 0
    v_mov_b32 v25, 0
    v_mov_b32 v26, 0
    v_mov_b32 v27, 0
    v_mov_b32 v28, 0
    v_mov_b32 v29, 0
    v_mov_b32 v30, 0
    v_mov_b32 v31, 0
    v_mov_b32 v32, 0
    v_mov_b32 v33, 0
    v_mov_b32 v34, 0
    v_mov_b32 v35, 0
    v_mov_b32 v36, 0
    v_mov_b32 v37, 0
    v_mov_b32 v38, 0
    v_mov_b32 v39, 0
    v_mov_b32 v40, 0
    v_mov_b32 v41, 0
    v_mov_b32 v42, 0
    v_mov_b32 v43, 0
    v_mov_b32 v44, 0
    v_mov_b32 v45, 0
    v_mov_b32 v46, 0
    v_mov_b32 v47, 0
    v_mov_b32 v48, 0
    v_mov_b32 v49, 0
    v_mov_b32 v50, 0
    v_mov_b32 v51, 0
    v_mov_b32 v52, 0
    v_mov_b32 v53, 0
    v_mov_b32 v54, 0
    v_mov_b32 v55, 0
    v_mov_b32 v56, 0
    v_mov_b32 v57, 0
    v_mov_b32 v58, 0
    v_mov_b32 v59, 0
    v_mov_b32 v60, 0
    v_mov_b32 v61, 0
    v_mov_b32 v62, 0
    v_mov_b32 v63, 0
    v_mov_b32 v64, 0
    v_mov_b32 v65, 0
    v_mov_b32 v66, 0
    v_mov_b32 v67, 0
    v_mov_b32 v68, 0
    v_mov_b32 v69, 0
    v_mov_b32 v70, 0
    v_mov_b32 v71, 0
    v_mov_b32 v72, 0
    v_mov_b32 v73, 0
    v_mov_b32 v74, 0
    v_mov_b32 v75, 0
    v_mov_b32 v76, 0
    v_mov_b32 v77, 0
    v_mov_b32 v78, 0
    v_mov_b32 v79, 0
    s_waitcnt lgkmcnt(0)
    ds_read_b128 v[176:179], v94 offset:16384
    ds_read_b128 v[180:183], v94 offset:18432
    v_mfma_f32_16x16x32_bf16 v[8:11], v[96:99], v[168:171], v[8:11]
    ds_read_b64_tr_b16 v[132:133], v86 offset:9216
    ds_read_b64_tr_b16 v[134:135], v86 offset:11520
    v_mfma_f32_16x16x32_bf16 v[44:47], v[96:99], v[172:175], v[44:47]
    ds_read_b64_tr_b16 v[136:137], v86 offset:9248
    ds_read_b64_tr_b16 v[138:139], v86 offset:11552
    v_mfma_f32_16x16x32_bf16 v[12:15], v[100:103], v[168:171], v[12:15]
    ds_read_b64_tr_b16 v[140:141], v86 offset:9280
    ds_read_b64_tr_b16 v[142:143], v86 offset:11584
    v_mfma_f32_16x16x32_bf16 v[48:51], v[100:103], v[172:175], v[48:51]
    ds_read_b64_tr_b16 v[144:145], v86 offset:9312
    ds_read_b64_tr_b16 v[146:147], v86 offset:11616
    v_mfma_f32_16x16x32_bf16 v[16:19], v[104:107], v[168:171], v[16:19]
    ds_read_b64_tr_b16 v[148:149], v86 offset:9344
    ds_read_b64_tr_b16 v[150:151], v86 offset:11648
    v_mfma_f32_16x16x32_bf16 v[52:55], v[104:107], v[172:175], v[52:55]
    ds_read_b64_tr_b16 v[152:153], v86 offset:9376
    ds_read_b64_tr_b16 v[154:155], v86 offset:11680
    v_mfma_f32_16x16x32_bf16 v[20:23], v[108:111], v[168:171], v[20:23]
    ds_read_b64_tr_b16 v[156:157], v86 offset:9408
    ds_read_b64_tr_b16 v[158:159], v86 offset:11712
    v_mfma_f32_16x16x32_bf16 v[56:59], v[108:111], v[172:175], v[56:59]
    ds_read_b64_tr_b16 v[160:161], v86 offset:9440
    ds_read_b64_tr_b16 v[162:163], v86 offset:11744
    v_mfma_f32_16x16x32_bf16 v[24:27], v[112:115], v[168:171], v[24:27]
    ds_read_b64_tr_b16 v[164:165], v86 offset:9472
    ds_read_b64_tr_b16 v[166:167], v86 offset:11776
    v_mfma_f32_16x16x32_bf16 v[60:63], v[112:115], v[172:175], v[60:63]
    v_mfma_f32_16x16x32_bf16 v[28:31], v[116:119], v[168:171], v[28:31]
    v_mfma_f32_16x16x32_bf16 v[64:67], v[116:119], v[172:175], v[64:67]
    v_mfma_f32_16x16x32_bf16 v[32:35], v[120:123], v[168:171], v[32:35]
    v_mfma_f32_16x16x32_bf16 v[68:71], v[120:123], v[172:175], v[68:71]
    v_mfma_f32_16x16x32_bf16 v[36:39], v[124:127], v[168:171], v[36:39]
    v_mfma_f32_16x16x32_bf16 v[72:75], v[124:127], v[172:175], v[72:75]
    v_mfma_f32_16x16x32_bf16 v[40:43], v[128:131], v[168:171], v[40:43]
    v_mfma_f32_16x16x32_bf16 v[76:79], v[128:131], v[172:175], v[76:79]
    s_waitcnt lgkmcnt(0)
    s_barrier
    ds_read_b128 v[168:171], v93 offset:32768
    ds_read_b128 v[172:175], v93 offset:34816
    v_mfma_f32_16x16x32_bf16 v[8:11], v[132:135], v[176:179], v[8:11]
    ds_read_b64_tr_b16 v[96:97], v87 offset:0
    ds_read_b64_tr_b16 v[98:99], v87 offset:2304
    v_mfma_f32_16x16x32_bf16 v[44:47], v[132:135], v[180:183], v[44:47]
    ds_read_b64_tr_b16 v[100:101], v87 offset:32
    ds_read_b64_tr_b16 v[102:103], v87 offset:2336
    v_mfma_f32_16x16x32_bf16 v[12:15], v[136:139], v[176:179], v[12:15]
    ds_read_b64_tr_b16 v[104:105], v87 offset:64
    ds_read_b64_tr_b16 v[106:107], v87 offset:2368
    v_mfma_f32_16x16x32_bf16 v[48:51], v[136:139], v[180:183], v[48:51]
    ds_read_b64_tr_b16 v[108:109], v87 offset:96
    ds_read_b64_tr_b16 v[110:111], v87 offset:2400
    v_mfma_f32_16x16x32_bf16 v[16:19], v[140:143], v[176:179], v[16:19]
    ds_read_b64_tr_b16 v[112:113], v87 offset:128
    ds_read_b64_tr_b16 v[114:115], v87 offset:2432
    v_mfma_f32_16x16x32_bf16 v[52:55], v[140:143], v[180:183], v[52:55]
    ds_read_b64_tr_b16 v[116:117], v87 offset:160
    ds_read_b64_tr_b16 v[118:119], v87 offset:2464
    v_mfma_f32_16x16x32_bf16 v[20:23], v[144:147], v[176:179], v[20:23]
    ds_read_b64_tr_b16 v[120:121], v87 offset:192
    ds_read_b64_tr_b16 v[122:123], v87 offset:2496
    v_mfma_f32_16x16x32_bf16 v[56:59], v[144:147], v[180:183], v[56:59]
    ds_read_b64_tr_b16 v[124:125], v87 offset:224
    ds_read_b64_tr_b16 v[126:127], v87 offset:2528
    v_mfma_f32_16x16x32_bf16 v[24:27], v[148:151], v[176:179], v[24:27]
    ds_read_b64_tr_b16 v[128:129], v87 offset:256
    ds_read_b64_tr_b16 v[130:131], v87 offset:2560
    v_mfma_f32_16x16x32_bf16 v[60:63], v[148:151], v[180:183], v[60:63]
    v_mfma_f32_16x16x32_bf16 v[28:31], v[152:155], v[176:179], v[28:31]
    v_mfma_f32_16x16x32_bf16 v[64:67], v[152:155], v[180:183], v[64:67]
    v_mfma_f32_16x16x32_bf16 v[32:35], v[156:159], v[176:179], v[32:35]
    v_mfma_f32_16x16x32_bf16 v[68:71], v[156:159], v[180:183], v[68:71]
    v_mfma_f32_16x16x32_bf16 v[36:39], v[160:163], v[176:179], v[36:39]
    v_mfma_f32_16x16x32_bf16 v[72:75], v[160:163], v[180:183], v[72:75]
    v_mfma_f32_16x16x32_bf16 v[40:43], v[164:167], v[176:179], v[40:43]
    v_mfma_f32_16x16x32_bf16 v[76:79], v[164:167], v[180:183], v[76:79]
    s_waitcnt lgkmcnt(0)
    ds_read_b128 v[176:179], v94 offset:32768
    ds_read_b128 v[180:183], v94 offset:34816
    v_mfma_f32_16x16x32_bf16 v[8:11], v[96:99], v[168:171], v[8:11]
    ds_read_b64_tr_b16 v[132:133], v87 offset:9216
    ds_read_b64_tr_b16 v[134:135], v87 offset:11520
    v_mfma_f32_16x16x32_bf16 v[44:47], v[96:99], v[172:175], v[44:47]
    ds_read_b64_tr_b16 v[136:137], v87 offset:9248
    ds_read_b64_tr_b16 v[138:139], v87 offset:11552
    v_mfma_f32_16x16x32_bf16 v[12:15], v[100:103], v[168:171], v[12:15]
    ds_read_b64_tr_b16 v[140:141], v87 offset:9280
    ds_read_b64_tr_b16 v[142:143], v87 offset:11584
    v_mfma_f32_16x16x32_bf16 v[48:51], v[100:103], v[172:175], v[48:51]
    ds_read_b64_tr_b16 v[144:145], v87 offset:9312
    ds_read_b64_tr_b16 v[146:147], v87 offset:11616
    v_mfma_f32_16x16x32_bf16 v[16:19], v[104:107], v[168:171], v[16:19]
    ds_read_b64_tr_b16 v[148:149], v87 offset:9344
    ds_read_b64_tr_b16 v[150:151], v87 offset:11648
    v_mfma_f32_16x16x32_bf16 v[52:55], v[104:107], v[172:175], v[52:55]
    ds_read_b64_tr_b16 v[152:153], v87 offset:9376
    ds_read_b64_tr_b16 v[154:155], v87 offset:11680
    v_mfma_f32_16x16x32_bf16 v[20:23], v[108:111], v[168:171], v[20:23]
    ds_read_b64_tr_b16 v[156:157], v87 offset:9408
    ds_read_b64_tr_b16 v[158:159], v87 offset:11712
    v_mfma_f32_16x16x32_bf16 v[56:59], v[108:111], v[172:175], v[56:59]
    ds_read_b64_tr_b16 v[160:161], v87 offset:9440
    ds_read_b64_tr_b16 v[162:163], v87 offset:11744
    v_mfma_f32_16x16x32_bf16 v[24:27], v[112:115], v[168:171], v[24:27]
    ds_read_b64_tr_b16 v[164:165], v87 offset:9472
    ds_read_b64_tr_b16 v[166:167], v87 offset:11776
    v_mfma_f32_16x16x32_bf16 v[60:63], v[112:115], v[172:175], v[60:63]
    v_mfma_f32_16x16x32_bf16 v[28:31], v[116:119], v[168:171], v[28:31]
    v_mfma_f32_16x16x32_bf16 v[64:67], v[116:119], v[172:175], v[64:67]
    v_mfma_f32_16x16x32_bf16 v[32:35], v[120:123], v[168:171], v[32:35]
    v_mfma_f32_16x16x32_bf16 v[68:71], v[120:123], v[172:175], v[68:71]
    v_mfma_f32_16x16x32_bf16 v[36:39], v[124:127], v[168:171], v[36:39]
    v_mfma_f32_16x16x32_bf16 v[72:75], v[124:127], v[172:175], v[72:75]
    v_mfma_f32_16x16x32_bf16 v[40:43], v[128:131], v[168:171], v[40:43]
    v_mfma_f32_16x16x32_bf16 v[76:79], v[128:131], v[172:175], v[76:79]
    s_waitcnt lgkmcnt(0)
    s_barrier
    ds_read_b128 v[168:171], v93 offset:49152
    ds_read_b128 v[172:175], v93 offset:51200
    v_mfma_f32_16x16x32_bf16 v[8:11], v[132:135], v[176:179], v[8:11]
    ds_read_b64_tr_b16 v[96:97], v88 offset:0
    ds_read_b64_tr_b16 v[98:99], v88 offset:2304
    v_mfma_f32_16x16x32_bf16 v[44:47], v[132:135], v[180:183], v[44:47]
    ds_read_b64_tr_b16 v[100:101], v88 offset:32
    ds_read_b64_tr_b16 v[102:103], v88 offset:2336
    v_mfma_f32_16x16x32_bf16 v[12:15], v[136:139], v[176:179], v[12:15]
    ds_read_b64_tr_b16 v[104:105], v88 offset:64
    ds_read_b64_tr_b16 v[106:107], v88 offset:2368
    v_mfma_f32_16x16x32_bf16 v[48:51], v[136:139], v[180:183], v[48:51]
    ds_read_b64_tr_b16 v[108:109], v88 offset:96
    ds_read_b64_tr_b16 v[110:111], v88 offset:2400
    v_mfma_f32_16x16x32_bf16 v[16:19], v[140:143], v[176:179], v[16:19]
    ds_read_b64_tr_b16 v[112:113], v88 offset:128
    ds_read_b64_tr_b16 v[114:115], v88 offset:2432
    v_mfma_f32_16x16x32_bf16 v[52:55], v[140:143], v[180:183], v[52:55]
    ds_read_b64_tr_b16 v[116:117], v88 offset:160
    ds_read_b64_tr_b16 v[118:119], v88 offset:2464
    v_mfma_f32_16x16x32_bf16 v[20:23], v[144:147], v[176:179], v[20:23]
    ds_read_b64_tr_b16 v[120:121], v88 offset:192
    ds_read_b64_tr_b16 v[122:123], v88 offset:2496
    v_mfma_f32_16x16x32_bf16 v[56:59], v[144:147], v[180:183], v[56:59]
    ds_read_b64_tr_b16 v[124:125], v88 offset:224
    ds_read_b64_tr_b16 v[126:127], v88 offset:2528
    v_mfma_f32_16x16x32_bf16 v[24:27], v[148:151], v[176:179], v[24:27]
    ds_read_b64_tr_b16 v[128:129], v88 offset:256
    ds_read_b64_tr_b16 v[130:131], v88 offset:2560
    v_mfma_f32_16x16x32_bf16 v[60:63], v[148:151], v[180:183], v[60:63]
    v_mfma_f32_16x16x32_bf16 v[28:31], v[152:155], v[176:179], v[28:31]
    v_mfma_f32_16x16x32_bf16 v[64:67], v[152:155], v[180:183], v[64:67]
    v_mfma_f32_16x16x32_bf16 v[32:35], v[156:159], v[176:179], v[32:35]
    v_mfma_f32_16x16x32_bf16 v[68:71], v[156:159], v[180:183], v[68:71]
    v_mfma_f32_16x16x32_bf16 v[36:39], v[160:163], v[176:179], v[36:39]
    v_mfma_f32_16x16x32_bf16 v[72:75], v[160:163], v[180:183], v[72:75]
    v_mfma_f32_16x16x32_bf16 v[40:43], v[164:167], v[176:179], v[40:43]
    v_mfma_f32_16x16x32_bf16 v[76:79], v[164:167], v[180:183], v[76:79]
    s_waitcnt lgkmcnt(0)
    ds_read_b128 v[176:179], v94 offset:49152
    ds_read_b128 v[180:183], v94 offset:51200
    v_mfma_f32_16x16x32_bf16 v[8:11], v[96:99], v[168:171], v[8:11]
    ds_read_b64_tr_b16 v[132:133], v88 offset:9216
    ds_read_b64_tr_b16 v[134:135], v88 offset:11520
    v_mfma_f32_16x16x32_bf16 v[44:47], v[96:99], v[172:175], v[44:47]
    ds_read_b64_tr_b16 v[136:137], v88 offset:9248
    ds_read_b64_tr_b16 v[138:139], v88 offset:11552
    v_mfma_f32_16x16x32_bf16 v[12:15], v[100:103], v[168:171], v[12:15]
    ds_read_b64_tr_b16 v[140:141], v88 offset:9280
    ds_read_b64_tr_b16 v[142:143], v88 offset:11584
    v_mfma_f32_16x16x32_bf16 v[48:51], v[100:103], v[172:175], v[48:51]
    ds_read_b64_tr_b16 v[144:145], v88 offset:9312
    ds_read_b64_tr_b16 v[146:147], v88 offset:11616
    v_mfma_f32_16x16x32_bf16 v[16:19], v[104:107], v[168:171], v[16:19]
    ds_read_b64_tr_b16 v[148:149], v88 offset:9344
    ds_read_b64_tr_b16 v[150:151], v88 offset:11648
    v_mfma_f32_16x16x32_bf16 v[52:55], v[104:107], v[172:175], v[52:55]
    ds_read_b64_tr_b16 v[152:153], v88 offset:9376
    ds_read_b64_tr_b16 v[154:155], v88 offset:11680
    v_mfma_f32_16x16x32_bf16 v[20:23], v[108:111], v[168:171], v[20:23]
    ds_read_b64_tr_b16 v[156:157], v88 offset:9408
    ds_read_b64_tr_b16 v[158:159], v88 offset:11712
    v_mfma_f32_16x16x32_bf16 v[56:59], v[108:111], v[172:175], v[56:59]
    ds_read_b64_tr_b16 v[160:161], v88 offset:9440
    ds_read_b64_tr_b16 v[162:163], v88 offset:11744
    v_mfma_f32_16x16x32_bf16 v[24:27], v[112:115], v[168:171], v[24:27]
    ds_read_b64_tr_b16 v[164:165], v88 offset:9472
    ds_read_b64_tr_b16 v[166:167], v88 offset:11776
    v_mfma_f32_16x16x32_bf16 v[60:63], v[112:115], v[172:175], v[60:63]
    v_mfma_f32_16x16x32_bf16 v[28:31], v[116:119], v[168:171], v[28:31]
    v_mfma_f32_16x16x32_bf16 v[64:67], v[116:119], v[172:175], v[64:67]
    v_mfma_f32_16x16x32_bf16 v[32:35], v[120:123], v[168:171], v[32:35]
    v_mfma_f32_16x16x32_bf16 v[68:71], v[120:123], v[172:175], v[68:71]
    v_mfma_f32_16x16x32_bf16 v[36:39], v[124:127], v[168:171], v[36:39]
    v_mfma_f32_16x16x32_bf16 v[72:75], v[124:127], v[172:175], v[72:75]
    v_mfma_f32_16x16x32_bf16 v[40:43], v[128:131], v[168:171], v[40:43]
    v_mfma_f32_16x16x32_bf16 v[76:79], v[128:131], v[172:175], v[76:79]
    s_waitcnt lgkmcnt(0)
    s_barrier
    ds_read_b128 v[168:171], v93 offset:0
    ds_read_b128 v[172:175], v93 offset:2048
    v_mfma_f32_16x16x32_bf16 v[8:11], v[132:135], v[176:179], v[8:11]
    ds_read_b64_tr_b16 v[96:97], v85 offset:0
    ds_read_b64_tr_b16 v[98:99], v85 offset:2304
    v_mfma_f32_16x16x32_bf16 v[44:47], v[132:135], v[180:183], v[44:47]
    ds_read_b64_tr_b16 v[100:101], v85 offset:32
    ds_read_b64_tr_b16 v[102:103], v85 offset:2336
    v_mfma_f32_16x16x32_bf16 v[12:15], v[136:139], v[176:179], v[12:15]
    ds_read_b64_tr_b16 v[104:105], v85 offset:64
    ds_read_b64_tr_b16 v[106:107], v85 offset:2368
    v_mfma_f32_16x16x32_bf16 v[48:51], v[136:139], v[180:183], v[48:51]
    ds_read_b64_tr_b16 v[108:109], v85 offset:96
    ds_read_b64_tr_b16 v[110:111], v85 offset:2400
    v_mfma_f32_16x16x32_bf16 v[16:19], v[140:143], v[176:179], v[16:19]
    ds_read_b64_tr_b16 v[112:113], v85 offset:128
    ds_read_b64_tr_b16 v[114:115], v85 offset:2432
    v_mfma_f32_16x16x32_bf16 v[52:55], v[140:143], v[180:183], v[52:55]
    ds_read_b64_tr_b16 v[116:117], v85 offset:160
    ds_read_b64_tr_b16 v[118:119], v85 offset:2464
    v_mfma_f32_16x16x32_bf16 v[20:23], v[144:147], v[176:179], v[20:23]
    ds_read_b64_tr_b16 v[120:121], v85 offset:192
    ds_read_b64_tr_b16 v[122:123], v85 offset:2496
    v_mfma_f32_16x16x32_bf16 v[56:59], v[144:147], v[180:183], v[56:59]
    ds_read_b64_tr_b16 v[124:125], v85 offset:224
    ds_read_b64_tr_b16 v[126:127], v85 offset:2528
    v_mfma_f32_16x16x32_bf16 v[24:27], v[148:151], v[176:179], v[24:27]
    ds_read_b64_tr_b16 v[128:129], v85 offset:256
    ds_read_b64_tr_b16 v[130:131], v85 offset:2560
    v_mfma_f32_16x16x32_bf16 v[60:63], v[148:151], v[180:183], v[60:63]
    v_mfma_f32_16x16x32_bf16 v[28:31], v[152:155], v[176:179], v[28:31]
    v_mfma_f32_16x16x32_bf16 v[64:67], v[152:155], v[180:183], v[64:67]
    v_mfma_f32_16x16x32_bf16 v[32:35], v[156:159], v[176:179], v[32:35]
    v_mfma_f32_16x16x32_bf16 v[68:71], v[156:159], v[180:183], v[68:71]
    v_mfma_f32_16x16x32_bf16 v[36:39], v[160:163], v[176:179], v[36:39]
    v_mfma_f32_16x16x32_bf16 v[72:75], v[160:163], v[180:183], v[72:75]
    v_mfma_f32_16x16x32_bf16 v[40:43], v[164:167], v[176:179], v[40:43]
    v_mfma_f32_16x16x32_bf16 v[76:79], v[164:167], v[180:183], v[76:79]
    s_waitcnt lgkmcnt(0)
    ds_read_b128 v[176:179], v94 offset:0
    ds_read_b128 v[180:183], v94 offset:2048
    v_mfma_f32_16x16x32_bf16 v[8:11], v[96:99], v[168:171], v[8:11]
    ds_read_b64_tr_b16 v[132:133], v85 offset:9216
    ds_read_b64_tr_b16 v[134:135], v85 offset:11520
    v_mfma_f32_16x16x32_bf16 v[44:47], v[96:99], v[172:175], v[44:47]
    ds_read_b64_tr_b16 v[136:137], v85 offset:9248
    ds_read_b64_tr_b16 v[138:139], v85 offset:11552
    v_mfma_f32_16x16x32_bf16 v[12:15], v[100:103], v[168:171], v[12:15]
    ds_read_b64_tr_b16 v[140:141], v85 offset:9280
    ds_read_b64_tr_b16 v[142:143], v85 offset:11584
    v_mfma_f32_16x16x32_bf16 v[48:51], v[100:103], v[172:175], v[48:51]
    ds_read_b64_tr_b16 v[144:145], v85 offset:9312
    ds_read_b64_tr_b16 v[146:147], v85 offset:11616
    v_mfma_f32_16x16x32_bf16 v[16:19], v[104:107], v[168:171], v[16:19]
    ds_read_b64_tr_b16 v[148:149], v85 offset:9344
    ds_read_b64_tr_b16 v[150:151], v85 offset:11648
    v_mfma_f32_16x16x32_bf16 v[52:55], v[104:107], v[172:175], v[52:55]
    ds_read_b64_tr_b16 v[152:153], v85 offset:9376
    ds_read_b64_tr_b16 v[154:155], v85 offset:11680
    v_mfma_f32_16x16x32_bf16 v[20:23], v[108:111], v[168:171], v[20:23]
    ds_read_b64_tr_b16 v[156:157], v85 offset:9408
    ds_read_b64_tr_b16 v[158:159], v85 offset:11712
    v_mfma_f32_16x16x32_bf16 v[56:59], v[108:111], v[172:175], v[56:59]
    ds_read_b64_tr_b16 v[160:161], v85 offset:9440
    ds_read_b64_tr_b16 v[162:163], v85 offset:11744
    v_mfma_f32_16x16x32_bf16 v[24:27], v[112:115], v[168:171], v[24:27]
    ds_read_b64_tr_b16 v[164:165], v85 offset:9472
    ds_read_b64_tr_b16 v[166:167], v85 offset:11776
    v_mfma_f32_16x16x32_bf16 v[60:63], v[112:115], v[172:175], v[60:63]
    v_mfma_f32_16x16x32_bf16 v[28:31], v[116:119], v[168:171], v[28:31]
    v_mfma_f32_16x16x32_bf16 v[64:67], v[116:119], v[172:175], v[64:67]
    v_mfma_f32_16x16x32_bf16 v[32:35], v[120:123], v[168:171], v[32:35]
    v_mfma_f32_16x16x32_bf16 v[68:71], v[120:123], v[172:175], v[68:71]
    v_mfma_f32_16x16x32_bf16 v[36:39], v[124:127], v[168:171], v[36:39]
    v_mfma_f32_16x16x32_bf16 v[72:75], v[124:127], v[172:175], v[72:75]
    v_mfma_f32_16x16x32_bf16 v[40:43], v[128:131], v[168:171], v[40:43]
    v_mfma_f32_16x16x32_bf16 v[76:79], v[128:131], v[172:175], v[76:79]
    s_waitcnt lgkmcnt(0)
    s_barrier
    ds_read_b128 v[168:171], v93 offset:16384
    ds_read_b128 v[172:175], v93 offset:18432
    v_mfma_f32_16x16x32_bf16 v[8:11], v[132:135], v[176:179], v[8:11]
    ds_read_b64_tr_b16 v[96:97], v86 offset:0
    ds_read_b64_tr_b16 v[98:99], v86 offset:2304
    v_mfma_f32_16x16x32_bf16 v[44:47], v[132:135], v[180:183], v[44:47]
    ds_read_b64_tr_b16 v[100:101], v86 offset:32
    ds_read_b64_tr_b16 v[102:103], v86 offset:2336
    v_mfma_f32_16x16x32_bf16 v[12:15], v[136:139], v[176:179], v[12:15]
    ds_read_b64_tr_b16 v[104:105], v86 offset:64
    ds_read_b64_tr_b16 v[106:107], v86 offset:2368
    v_mfma_f32_16x16x32_bf16 v[48:51], v[136:139], v[180:183], v[48:51]
    ds_read_b64_tr_b16 v[108:109], v86 offset:96
    ds_read_b64_tr_b16 v[110:111], v86 offset:2400
    v_mfma_f32_16x16x32_bf16 v[16:19], v[140:143], v[176:179], v[16:19]
    ds_read_b64_tr_b16 v[112:113], v86 offset:128
    ds_read_b64_tr_b16 v[114:115], v86 offset:2432
    v_mfma_f32_16x16x32_bf16 v[52:55], v[140:143], v[180:183], v[52:55]
    ds_read_b64_tr_b16 v[116:117], v86 offset:160
    ds_read_b64_tr_b16 v[118:119], v86 offset:2464
    v_mfma_f32_16x16x32_bf16 v[20:23], v[144:147], v[176:179], v[20:23]
    ds_read_b64_tr_b16 v[120:121], v86 offset:192
    ds_read_b64_tr_b16 v[122:123], v86 offset:2496
    v_mfma_f32_16x16x32_bf16 v[56:59], v[144:147], v[180:183], v[56:59]
    ds_read_b64_tr_b16 v[124:125], v86 offset:224
    ds_read_b64_tr_b16 v[126:127], v86 offset:2528
    v_mfma_f32_16x16x32_bf16 v[24:27], v[148:151], v[176:179], v[24:27]
    ds_read_b64_tr_b16 v[128:129], v86 offset:256
    ds_read_b64_tr_b16 v[130:131], v86 offset:2560
    v_mfma_f32_16x16x32_bf16 v[60:63], v[148:151], v[180:183], v[60:63]
    v_mfma_f32_16x16x32_bf16 v[28:31], v[152:155], v[176:179], v[28:31]
    v_mfma_f32_16x16x32_bf16 v[64:67], v[152:155], v[180:183], v[64:67]
    v_mfma_f32_16x16x32_bf16 v[32:35], v[156:159], v[176:179], v[32:35]
    v_mfma_f32_16x16x32_bf16 v[68:71], v[156:159], v[180:183], v[68:71]
    v_mfma_f32_16x16x32_bf16 v[36:39], v[160:163], v[176:179], v[36:39]
    v_mfma_f32_16x16x32_bf16 v[72:75], v[160:163], v[180:183], v[72:75]
    v_mfma_f32_16x16x32_bf16 v[40:43], v[164:167], v[176:179], v[40:43]
    v_mfma_f32_16x16x32_bf16 v[76:79], v[164:167], v[180:183], v[76:79]
    s_waitcnt lgkmcnt(0)
    ds_read_b128 v[176:179], v94 offset:16384
    ds_read_b128 v[180:183], v94 offset:18432
    v_mfma_f32_16x16x32_bf16 v[8:11], v[96:99], v[168:171], v[8:11]
    ds_read_b64_tr_b16 v[132:133], v86 offset:9216
    ds_read_b64_tr_b16 v[134:135], v86 offset:11520
    v_mfma_f32_16x16x32_bf16 v[44:47], v[96:99], v[172:175], v[44:47]
    ds_read_b64_tr_b16 v[136:137], v86 offset:9248
    ds_read_b64_tr_b16 v[138:139], v86 offset:11552
    v_mfma_f32_16x16x32_bf16 v[12:15], v[100:103], v[168:171], v[12:15]
    ds_read_b64_tr_b16 v[140:141], v86 offset:9280
    ds_read_b64_tr_b16 v[142:143], v86 offset:11584
    v_mfma_f32_16x16x32_bf16 v[48:51], v[100:103], v[172:175], v[48:51]
    ds_read_b64_tr_b16 v[144:145], v86 offset:9312
    ds_read_b64_tr_b16 v[146:147], v86 offset:11616
    v_mfma_f32_16x16x32_bf16 v[16:19], v[104:107], v[168:171], v[16:19]
    ds_read_b64_tr_b16 v[148:149], v86 offset:9344
    ds_read_b64_tr_b16 v[150:151], v86 offset:11648
    v_mfma_f32_16x16x32_bf16 v[52:55], v[104:107], v[172:175], v[52:55]
    ds_read_b64_tr_b16 v[152:153], v86 offset:9376
    ds_read_b64_tr_b16 v[154:155], v86 offset:11680
    v_mfma_f32_16x16x32_bf16 v[20:23], v[108:111], v[168:171], v[20:23]
    ds_read_b64_tr_b16 v[156:157], v86 offset:9408
    ds_read_b64_tr_b16 v[158:159], v86 offset:11712
    v_mfma_f32_16x16x32_bf16 v[56:59], v[108:111], v[172:175], v[56:59]
    ds_read_b64_tr_b16 v[160:161], v86 offset:9440
    ds_read_b64_tr_b16 v[162:163], v86 offset:11744
    v_mfma_f32_16x16x32_bf16 v[24:27], v[112:115], v[168:171], v[24:27]
    ds_read_b64_tr_b16 v[164:165], v86 offset:9472
    ds_read_b64_tr_b16 v[166:167], v86 offset:11776
    v_mfma_f32_16x16x32_bf16 v[60:63], v[112:115], v[172:175], v[60:63]
    v_mfma_f32_16x16x32_bf16 v[28:31], v[116:119], v[168:171], v[28:31]
    v_mfma_f32_16x16x32_bf16 v[64:67], v[116:119], v[172:175], v[64:67]
    v_mfma_f32_16x16x32_bf16 v[32:35], v[120:123], v[168:171], v[32:35]
    v_mfma_f32_16x16x32_bf16 v[68:71], v[120:123], v[172:175], v[68:71]
    v_mfma_f32_16x16x32_bf16 v[36:39], v[124:127], v[168:171], v[36:39]
    v_mfma_f32_16x16x32_bf16 v[72:75], v[124:127], v[172:175], v[72:75]
    v_mfma_f32_16x16x32_bf16 v[40:43], v[128:131], v[168:171], v[40:43]
    v_mfma_f32_16x16x32_bf16 v[76:79], v[128:131], v[172:175], v[76:79]
    s_waitcnt lgkmcnt(0)
    s_barrier
    ds_read_b128 v[168:171], v93 offset:32768
    ds_read_b128 v[172:175], v93 offset:34816
    v_mfma_f32_16x16x32_bf16 v[8:11], v[132:135], v[176:179], v[8:11]
    ds_read_b64_tr_b16 v[96:97], v87 offset:0
    ds_read_b64_tr_b16 v[98:99], v87 offset:2304
    v_mfma_f32_16x16x32_bf16 v[44:47], v[132:135], v[180:183], v[44:47]
    ds_read_b64_tr_b16 v[100:101], v87 offset:32
    ds_read_b64_tr_b16 v[102:103], v87 offset:2336
    v_mfma_f32_16x16x32_bf16 v[12:15], v[136:139], v[176:179], v[12:15]
    ds_read_b64_tr_b16 v[104:105], v87 offset:64
    ds_read_b64_tr_b16 v[106:107], v87 offset:2368
    v_mfma_f32_16x16x32_bf16 v[48:51], v[136:139], v[180:183], v[48:51]
    ds_read_b64_tr_b16 v[108:109], v87 offset:96
    ds_read_b64_tr_b16 v[110:111], v87 offset:2400
    v_mfma_f32_16x16x32_bf16 v[16:19], v[140:143], v[176:179], v[16:19]
    ds_read_b64_tr_b16 v[112:113], v87 offset:128
    ds_read_b64_tr_b16 v[114:115], v87 offset:2432
    v_mfma_f32_16x16x32_bf16 v[52:55], v[140:143], v[180:183], v[52:55]
    ds_read_b64_tr_b16 v[116:117], v87 offset:160
    ds_read_b64_tr_b16 v[118:119], v87 offset:2464
    v_mfma_f32_16x16x32_bf16 v[20:23], v[144:147], v[176:179], v[20:23]
    ds_read_b64_tr_b16 v[120:121], v87 offset:192
    ds_read_b64_tr_b16 v[122:123], v87 offset:2496
    v_mfma_f32_16x16x32_bf16 v[56:59], v[144:147], v[180:183], v[56:59]
    ds_read_b64_tr_b16 v[124:125], v87 offset:224
    ds_read_b64_tr_b16 v[126:127], v87 offset:2528
    v_mfma_f32_16x16x32_bf16 v[24:27], v[148:151], v[176:179], v[24:27]
    ds_read_b64_tr_b16 v[128:129], v87 offset:256
    ds_read_b64_tr_b16 v[130:131], v87 offset:2560
    v_mfma_f32_16x16x32_bf16 v[60:63], v[148:151], v[180:183], v[60:63]
    v_mfma_f32_16x16x32_bf16 v[28:31], v[152:155], v[176:179], v[28:31]
    v_mfma_f32_16x16x32_bf16 v[64:67], v[152:155], v[180:183], v[64:67]
    v_mfma_f32_16x16x32_bf16 v[32:35], v[156:159], v[176:179], v[32:35]
    v_mfma_f32_16x16x32_bf16 v[68:71], v[156:159], v[180:183], v[68:71]
    v_mfma_f32_16x16x32_bf16 v[36:39], v[160:163], v[176:179], v[36:39]
    v_mfma_f32_16x16x32_bf16 v[72:75], v[160:163], v[180:183], v[72:75]
    v_mfma_f32_16x16x32_bf16 v[40:43], v[164:167], v[176:179], v[40:43]
    v_mfma_f32_16x16x32_bf16 v[76:79], v[164:167], v[180:183], v[76:79]
    s_waitcnt lgkmcnt(0)
    ds_read_b128 v[176:179], v94 offset:32768
    ds_read_b128 v[180:183], v94 offset:34816
    v_mfma_f32_16x16x32_bf16 v[8:11], v[96:99], v[168:171], v[8:11]
    ds_read_b64_tr_b16 v[132:133], v87 offset:9216
    ds_read_b64_tr_b16 v[134:135], v87 offset:11520
    v_mfma_f32_16x16x32_bf16 v[44:47], v[96:99], v[172:175], v[44:47]
    ds_read_b64_tr_b16 v[136:137], v87 offset:9248
    ds_read_b64_tr_b16 v[138:139], v87 offset:11552
    v_mfma_f32_16x16x32_bf16 v[12:15], v[100:103], v[168:171], v[12:15]
    ds_read_b64_tr_b16 v[140:141], v87 offset:9280
    ds_read_b64_tr_b16 v[142:143], v87 offset:11584
    v_mfma_f32_16x16x32_bf16 v[48:51], v[100:103], v[172:175], v[48:51]
    ds_read_b64_tr_b16 v[144:145], v87 offset:9312
    ds_read_b64_tr_b16 v[146:147], v87 offset:11616
    v_mfma_f32_16x16x32_bf16 v[16:19], v[104:107], v[168:171], v[16:19]
    ds_read_b64_tr_b16 v[148:149], v87 offset:9344
    ds_read_b64_tr_b16 v[150:151], v87 offset:11648
    v_mfma_f32_16x16x32_bf16 v[52:55], v[104:107], v[172:175], v[52:55]
    ds_read_b64_tr_b16 v[152:153], v87 offset:9376
    ds_read_b64_tr_b16 v[154:155], v87 offset:11680
    v_mfma_f32_16x16x32_bf16 v[20:23], v[108:111], v[168:171], v[20:23]
    ds_read_b64_tr_b16 v[156:157], v87 offset:9408
    ds_read_b64_tr_b16 v[158:159], v87 offset:11712
    v_mfma_f32_16x16x32_bf16 v[56:59], v[108:111], v[172:175], v[56:59]
    ds_read_b64_tr_b16 v[160:161], v87 offset:9440
    ds_read_b64_tr_b16 v[162:163], v87 offset:11744
    v_mfma_f32_16x16x32_bf16 v[24:27], v[112:115], v[168:171], v[24:27]
    ds_read_b64_tr_b16 v[164:165], v87 offset:9472
    ds_read_b64_tr_b16 v[166:167], v87 offset:11776
    v_mfma_f32_16x16x32_bf16 v[60:63], v[112:115], v[172:175], v[60:63]
    v_mfma_f32_16x16x32_bf16 v[28:31], v[116:119], v[168:171], v[28:31]
    v_mfma_f32_16x16x32_bf16 v[64:67], v[116:119], v[172:175], v[64:67]
    v_mfma_f32_16x16x32_bf16 v[32:35], v[120:123], v[168:171], v[32:35]
    v_mfma_f32_16x16x32_bf16 v[68:71], v[120:123], v[172:175], v[68:71]
    v_mfma_f32_16x16x32_bf16 v[36:39], v[124:127], v[168:171], v[36:39]
    v_mfma_f32_16x16x32_bf16 v[72:75], v[124:127], v[172:175], v[72:75]
    v_mfma_f32_16x16x32_bf16 v[40:43], v[128:131], v[168:171], v[40:43]
    v_mfma_f32_16x16x32_bf16 v[76:79], v[128:131], v[172:175], v[76:79]
    s_waitcnt lgkmcnt(0)
    s_barrier
    ds_read_b128 v[168:171], v93 offset:49152
    ds_read_b128 v[172:175], v93 offset:51200
    v_mfma_f32_16x16x32_bf16 v[8:11], v[132:135], v[176:179], v[8:11]
    ds_read_b64_tr_b16 v[96:97], v88 offset:0
    ds_read_b64_tr_b16 v[98:99], v88 offset:2304
    v_mfma_f32_16x16x32_bf16 v[44:47], v[132:135], v[180:183], v[44:47]
    ds_read_b64_tr_b16 v[100:101], v88 offset:32
    ds_read_b64_tr_b16 v[102:103], v88 offset:2336
    v_mfma_f32_16x16x32_bf16 v[12:15], v[136:139], v[176:179], v[12:15]
    ds_read_b64_tr_b16 v[104:105], v88 offset:64
    ds_read_b64_tr_b16 v[106:107], v88 offset:2368
    v_mfma_f32_16x16x32_bf16 v[48:51], v[136:139], v[180:183], v[48:51]
    ds_read_b64_tr_b16 v[108:109], v88 offset:96
    ds_read_b64_tr_b16 v[110:111], v88 offset:2400
    v_mfma_f32_16x16x32_bf16 v[16:19], v[140:143], v[176:179], v[16:19]
    ds_read_b64_tr_b16 v[112:113], v88 offset:128
    ds_read_b64_tr_b16 v[114:115], v88 offset:2432
    v_mfma_f32_16x16x32_bf16 v[52:55], v[140:143], v[180:183], v[52:55]
    ds_read_b64_tr_b16 v[116:117], v88 offset:160
    ds_read_b64_tr_b16 v[118:119], v88 offset:2464
    v_mfma_f32_16x16x32_bf16 v[20:23], v[144:147], v[176:179], v[20:23]
    ds_read_b64_tr_b16 v[120:121], v88 offset:192
    ds_read_b64_tr_b16 v[122:123], v88 offset:2496
    v_mfma_f32_16x16x32_bf16 v[56:59], v[144:147], v[180:183], v[56:59]
    ds_read_b64_tr_b16 v[124:125], v88 offset:224
    ds_read_b64_tr_b16 v[126:127], v88 offset:2528
    v_mfma_f32_16x16x32_bf16 v[24:27], v[148:151], v[176:179], v[24:27]
    ds_read_b64_tr_b16 v[128:129], v88 offset:256
    ds_read_b64_tr_b16 v[130:131], v88 offset:2560
    v_mfma_f32_16x16x32_bf16 v[60:63], v[148:151], v[180:183], v[60:63]
    v_mfma_f32_16x16x32_bf16 v[28:31], v[152:155], v[176:179], v[28:31]
    v_mfma_f32_16x16x32_bf16 v[64:67], v[152:155], v[180:183], v[64:67]
    v_mfma_f32_16x16x32_bf16 v[32:35], v[156:159], v[176:179], v[32:35]
    v_mfma_f32_16x16x32_bf16 v[68:71], v[156:159], v[180:183], v[68:71]
    v_mfma_f32_16x16x32_bf16 v[36:39], v[160:163], v[176:179], v[36:39]
    v_mfma_f32_16x16x32_bf16 v[72:75], v[160:163], v[180:183], v[72:75]
    v_mfma_f32_16x16x32_bf16 v[40:43], v[164:167], v[176:179], v[40:43]
    v_mfma_f32_16x16x32_bf16 v[76:79], v[164:167], v[180:183], v[76:79]
    s_waitcnt lgkmcnt(0)
    ds_read_b128 v[176:179], v94 offset:49152
    ds_read_b128 v[180:183], v94 offset:51200
    v_mfma_f32_16x16x32_bf16 v[8:11], v[96:99], v[168:171], v[8:11]
    ds_read_b64_tr_b16 v[132:133], v88 offset:9216
    ds_read_b64_tr_b16 v[134:135], v88 offset:11520
    v_mfma_f32_16x16x32_bf16 v[44:47], v[96:99], v[172:175], v[44:47]
    ds_read_b64_tr_b16 v[136:137], v88 offset:9248
    ds_read_b64_tr_b16 v[138:139], v88 offset:11552
    v_mfma_f32_16x16x32_bf16 v[12:15], v[100:103], v[168:171], v[12:15]
    ds_read_b64_tr_b16 v[140:141], v88 offset:9280
    ds_read_b64_tr_b16 v[142:143], v88 offset:11584
    v_mfma_f32_16x16x32_bf16 v[48:51], v[100:103], v[172:175], v[48:51]
    ds_read_b64_tr_b16 v[144:145], v88 offset:9312
    ds_read_b64_tr_b16 v[146:147], v88 offset:11616
    v_mfma_f32_16x16x32_bf16 v[16:19], v[104:107], v[168:171], v[16:19]
    ds_read_b64_tr_b16 v[148:149], v88 offset:9344
    ds_read_b64_tr_b16 v[150:151], v88 offset:11648
    v_mfma_f32_16x16x32_bf16 v[52:55], v[104:107], v[172:175], v[52:55]
    ds_read_b64_tr_b16 v[152:153], v88 offset:9376
    ds_read_b64_tr_b16 v[154:155], v88 offset:11680
    v_mfma_f32_16x16x32_bf16 v[20:23], v[108:111], v[168:171], v[20:23]
    ds_read_b64_tr_b16 v[156:157], v88 offset:9408
    ds_read_b64_tr_b16 v[158:159], v88 offset:11712
    v_mfma_f32_16x16x32_bf16 v[56:59], v[108:111], v[172:175], v[56:59]
    ds_read_b64_tr_b16 v[160:161], v88 offset:9440
    ds_read_b64_tr_b16 v[162:163], v88 offset:11744
    v_mfma_f32_16x16x32_bf16 v[24:27], v[112:115], v[168:171], v[24:27]
    ds_read_b64_tr_b16 v[164:165], v88 offset:9472
    ds_read_b64_tr_b16 v[166:167], v88 offset:11776
    v_mfma_f32_16x16x32_bf16 v[60:63], v[112:115], v[172:175], v[60:63]
    v_mfma_f32_16x16x32_bf16 v[28:31], v[116:119], v[168:171], v[28:31]
    v_mfma_f32_16x16x32_bf16 v[64:67], v[116:119], v[172:175], v[64:67]
    v_mfma_f32_16x16x32_bf16 v[32:35], v[120:123], v[168:171], v[32:35]
    v_mfma_f32_16x16x32_bf16 v[68:71], v[120:123], v[172:175], v[68:71]
    v_mfma_f32_16x16x32_bf16 v[36:39], v[124:127], v[168:171], v[36:39]
    v_mfma_f32_16x16x32_bf16 v[72:75], v[124:127], v[172:175], v[72:75]
    v_mfma_f32_16x16x32_bf16 v[40:43], v[128:131], v[168:171], v[40:43]
    v_mfma_f32_16x16x32_bf16 v[76:79], v[128:131], v[172:175], v[76:79]
    s_waitcnt lgkmcnt(0)
    s_barrier
    ds_read_b128 v[168:171], v93 offset:0
    ds_read_b128 v[172:175], v93 offset:2048
    v_mfma_f32_16x16x32_bf16 v[8:11], v[132:135], v[176:179], v[8:11]
    ds_read_b64_tr_b16 v[96:97], v85 offset:0
    ds_read_b64_tr_b16 v[98:99], v85 offset:2304
    v_mfma_f32_16x16x32_bf16 v[44:47], v[132:135], v[180:183], v[44:47]
    ds_read_b64_tr_b16 v[100:101], v85 offset:32
    ds_read_b64_tr_b16 v[102:103], v85 offset:2336
    v_mfma_f32_16x16x32_bf16 v[12:15], v[136:139], v[176:179], v[12:15]
    ds_read_b64_tr_b16 v[104:105], v85 offset:64
    ds_read_b64_tr_b16 v[106:107], v85 offset:2368
    v_mfma_f32_16x16x32_bf16 v[48:51], v[136:139], v[180:183], v[48:51]
    ds_read_b64_tr_b16 v[108:109], v85 offset:96
    ds_read_b64_tr_b16 v[110:111], v85 offset:2400
    v_mfma_f32_16x16x32_bf16 v[16:19], v[140:143], v[176:179], v[16:19]
    ds_read_b64_tr_b16 v[112:113], v85 offset:128
    ds_read_b64_tr_b16 v[114:115], v85 offset:2432
    v_mfma_f32_16x16x32_bf16 v[52:55], v[140:143], v[180:183], v[52:55]
    ds_read_b64_tr_b16 v[116:117], v85 offset:160
    ds_read_b64_tr_b16 v[118:119], v85 offset:2464
    v_mfma_f32_16x16x32_bf16 v[20:23], v[144:147], v[176:179], v[20:23]
    ds_read_b64_tr_b16 v[120:121], v85 offset:192
    ds_read_b64_tr_b16 v[122:123], v85 offset:2496
    v_mfma_f32_16x16x32_bf16 v[56:59], v[144:147], v[180:183], v[56:59]
    ds_read_b64_tr_b16 v[124:125], v85 offset:224
    ds_read_b64_tr_b16 v[126:127], v85 offset:2528
    v_mfma_f32_16x16x32_bf16 v[24:27], v[148:151], v[176:179], v[24:27]
    ds_read_b64_tr_b16 v[128:129], v85 offset:256
    ds_read_b64_tr_b16 v[130:131], v85 offset:2560
    v_mfma_f32_16x16x32_bf16 v[60:63], v[148:151], v[180:183], v[60:63]
    v_mfma_f32_16x16x32_bf16 v[28:31], v[152:155], v[176:179], v[28:31]
    v_mfma_f32_16x16x32_bf16 v[64:67], v[152:155], v[180:183], v[64:67]
    v_mfma_f32_16x16x32_bf16 v[32:35], v[156:159], v[176:179], v[32:35]
    v_mfma_f32_16x16x32_bf16 v[68:71], v[156:159], v[180:183], v[68:71]
    v_mfma_f32_16x16x32_bf16 v[36:39], v[160:163], v[176:179], v[36:39]
    v_mfma_f32_16x16x32_bf16 v[72:75], v[160:163], v[180:183], v[72:75]
    v_mfma_f32_16x16x32_bf16 v[40:43], v[164:167], v[176:179], v[40:43]
    v_mfma_f32_16x16x32_bf16 v[76:79], v[164:167], v[180:183], v[76:79]
    s_waitcnt lgkmcnt(0)
    ds_read_b128 v[176:179], v94 offset:0
    ds_read_b128 v[180:183], v94 offset:2048
    v_mfma_f32_16x16x32_bf16 v[8:11], v[96:99], v[168:171], v[8:11]
    ds_read_b64_tr_b16 v[132:133], v85 offset:9216
    ds_read_b64_tr_b16 v[134:135], v85 offset:11520
    v_mfma_f32_16x16x32_bf16 v[44:47], v[96:99], v[172:175], v[44:47]
    ds_read_b64_tr_b16 v[136:137], v85 offset:9248
    ds_read_b64_tr_b16 v[138:139], v85 offset:11552
    v_mfma_f32_16x16x32_bf16 v[12:15], v[100:103], v[168:171], v[12:15]
    ds_read_b64_tr_b16 v[140:141], v85 offset:9280
    ds_read_b64_tr_b16 v[142:143], v85 offset:11584
    v_mfma_f32_16x16x32_bf16 v[48:51], v[100:103], v[172:175], v[48:51]
    ds_read_b64_tr_b16 v[144:145], v85 offset:9312
    ds_read_b64_tr_b16 v[146:147], v85 offset:11616
    v_mfma_f32_16x16x32_bf16 v[16:19], v[104:107], v[168:171], v[16:19]
    ds_read_b64_tr_b16 v[148:149], v85 offset:9344
    ds_read_b64_tr_b16 v[150:151], v85 offset:11648
    v_mfma_f32_16x16x32_bf16 v[52:55], v[104:107], v[172:175], v[52:55]
    ds_read_b64_tr_b16 v[152:153], v85 offset:9376
    ds_read_b64_tr_b16 v[154:155], v85 offset:11680
    v_mfma_f32_16x16x32_bf16 v[20:23], v[108:111], v[168:171], v[20:23]
    ds_read_b64_tr_b16 v[156:157], v85 offset:9408
    ds_read_b64_tr_b16 v[158:159], v85 offset:11712
    v_mfma_f32_16x16x32_bf16 v[56:59], v[108:111], v[172:175], v[56:59]
    ds_read_b64_tr_b16 v[160:161], v85 offset:9440
    ds_read_b64_tr_b16 v[162:163], v85 offset:11744
    v_mfma_f32_16x16x32_bf16 v[24:27], v[112:115], v[168:171], v[24:27]
    ds_read_b64_tr_b16 v[164:165], v85 offset:9472
    ds_read_b64_tr_b16 v[166:167], v85 offset:11776
    v_mfma_f32_16x16x32_bf16 v[60:63], v[112:115], v[172:175], v[60:63]
    v_mfma_f32_16x16x32_bf16 v[28:31], v[116:119], v[168:171], v[28:31]
    v_mfma_f32_16x16x32_bf16 v[64:67], v[116:119], v[172:175], v[64:67]
    v_mfma_f32_16x16x32_bf16 v[32:35], v[120:123], v[168:171], v[32:35]
    v_mfma_f32_16x16x32_bf16 v[68:71], v[120:123], v[172:175], v[68:71]
    v_mfma_f32_16x16x32_bf16 v[36:39], v[124:127], v[168:171], v[36:39]
    v_mfma_f32_16x16x32_bf16 v[72:75], v[124:127], v[172:175], v[72:75]
    v_mfma_f32_16x16x32_bf16 v[40:43], v[128:131], v[168:171], v[40:43]
    v_mfma_f32_16x16x32_bf16 v[76:79], v[128:131], v[172:175], v[76:79]
    s_waitcnt lgkmcnt(0)
    s_barrier
    ds_read_b128 v[168:171], v93 offset:16384
    ds_read_b128 v[172:175], v93 offset:18432
    v_mfma_f32_16x16x32_bf16 v[8:11], v[132:135], v[176:179], v[8:11]
    ds_read_b64_tr_b16 v[96:97], v86 offset:0
    ds_read_b64_tr_b16 v[98:99], v86 offset:2304
    v_mfma_f32_16x16x32_bf16 v[44:47], v[132:135], v[180:183], v[44:47]
    ds_read_b64_tr_b16 v[100:101], v86 offset:32
    ds_read_b64_tr_b16 v[102:103], v86 offset:2336
    v_mfma_f32_16x16x32_bf16 v[12:15], v[136:139], v[176:179], v[12:15]
    ds_read_b64_tr_b16 v[104:105], v86 offset:64
    ds_read_b64_tr_b16 v[106:107], v86 offset:2368
    v_mfma_f32_16x16x32_bf16 v[48:51], v[136:139], v[180:183], v[48:51]
    ds_read_b64_tr_b16 v[108:109], v86 offset:96
    ds_read_b64_tr_b16 v[110:111], v86 offset:2400
    v_mfma_f32_16x16x32_bf16 v[16:19], v[140:143], v[176:179], v[16:19]
    ds_read_b64_tr_b16 v[112:113], v86 offset:128
    ds_read_b64_tr_b16 v[114:115], v86 offset:2432
    v_mfma_f32_16x16x32_bf16 v[52:55], v[140:143], v[180:183], v[52:55]
    ds_read_b64_tr_b16 v[116:117], v86 offset:160
    ds_read_b64_tr_b16 v[118:119], v86 offset:2464
    v_mfma_f32_16x16x32_bf16 v[20:23], v[144:147], v[176:179], v[20:23]
    ds_read_b64_tr_b16 v[120:121], v86 offset:192
    ds_read_b64_tr_b16 v[122:123], v86 offset:2496
    v_mfma_f32_16x16x32_bf16 v[56:59], v[144:147], v[180:183], v[56:59]
    ds_read_b64_tr_b16 v[124:125], v86 offset:224
    ds_read_b64_tr_b16 v[126:127], v86 offset:2528
    v_mfma_f32_16x16x32_bf16 v[24:27], v[148:151], v[176:179], v[24:27]
    ds_read_b64_tr_b16 v[128:129], v86 offset:256
    ds_read_b64_tr_b16 v[130:131], v86 offset:2560
    v_mfma_f32_16x16x32_bf16 v[60:63], v[148:151], v[180:183], v[60:63]
    v_mfma_f32_16x16x32_bf16 v[28:31], v[152:155], v[176:179], v[28:31]
    v_mfma_f32_16x16x32_bf16 v[64:67], v[152:155], v[180:183], v[64:67]
    v_mfma_f32_16x16x32_bf16 v[32:35], v[156:159], v[176:179], v[32:35]
    v_mfma_f32_16x16x32_bf16 v[68:71], v[156:159], v[180:183], v[68:71]
    v_mfma_f32_16x16x32_bf16 v[36:39], v[160:163], v[176:179], v[36:39]
    v_mfma_f32_16x16x32_bf16 v[72:75], v[160:163], v[180:183], v[72:75]
    v_mfma_f32_16x16x32_bf16 v[40:43], v[164:167], v[176:179], v[40:43]
    v_mfma_f32_16x16x32_bf16 v[76:79], v[164:167], v[180:183], v[76:79]
    s_waitcnt lgkmcnt(0)
    ds_read_b128 v[176:179], v94 offset:16384
    ds_read_b128 v[180:183], v94 offset:18432
    v_mfma_f32_16x16x32_bf16 v[8:11], v[96:99], v[168:171], v[8:11]
    ds_read_b64_tr_b16 v[132:133], v86 offset:9216
    ds_read_b64_tr_b16 v[134:135], v86 offset:11520
    v_mfma_f32_16x16x32_bf16 v[44:47], v[96:99], v[172:175], v[44:47]
    ds_read_b64_tr_b16 v[136:137], v86 offset:9248
    ds_read_b64_tr_b16 v[138:139], v86 offset:11552
    v_mfma_f32_16x16x32_bf16 v[12:15], v[100:103], v[168:171], v[12:15]
    ds_read_b64_tr_b16 v[140:141], v86 offset:9280
    ds_read_b64_tr_b16 v[142:143], v86 offset:11584
    v_mfma_f32_16x16x32_bf16 v[48:51], v[100:103], v[172:175], v[48:51]
    ds_read_b64_tr_b16 v[144:145], v86 offset:9312
    ds_read_b64_tr_b16 v[146:147], v86 offset:11616
    v_mfma_f32_16x16x32_bf16 v[16:19], v[104:107], v[168:171], v[16:19]
    ds_read_b64_tr_b16 v[148:149], v86 offset:9344
    ds_read_b64_tr_b16 v[150:151], v86 offset:11648
    v_mfma_f32_16x16x32_bf16 v[52:55], v[104:107], v[172:175], v[52:55]
    ds_read_b64_tr_b16 v[152:153], v86 offset:9376
    ds_read_b64_tr_b16 v[154:155], v86 offset:11680
    v_mfma_f32_16x16x32_bf16 v[20:23], v[108:111], v[168:171], v[20:23]
    ds_read_b64_tr_b16 v[156:157], v86 offset:9408
    ds_read_b64_tr_b16 v[158:159], v86 offset:11712
    v_mfma_f32_16x16x32_bf16 v[56:59], v[108:111], v[172:175], v[56:59]
    ds_read_b64_tr_b16 v[160:161], v86 offset:9440
    ds_read_b64_tr_b16 v[162:163], v86 offset:11744
    v_mfma_f32_16x16x32_bf16 v[24:27], v[112:115], v[168:171], v[24:27]
    ds_read_b64_tr_b16 v[164:165], v86 offset:9472
    ds_read_b64_tr_b16 v[166:167], v86 offset:11776
    v_mfma_f32_16x16x32_bf16 v[60:63], v[112:115], v[172:175], v[60:63]
    v_mfma_f32_16x16x32_bf16 v[28:31], v[116:119], v[168:171], v[28:31]
    v_mfma_f32_16x16x32_bf16 v[64:67], v[116:119], v[172:175], v[64:67]
    v_mfma_f32_16x16x32_bf16 v[32:35], v[120:123], v[168:171], v[32:35]
    v_mfma_f32_16x16x32_bf16 v[68:71], v[120:123], v[172:175], v[68:71]
    v_mfma_f32_16x16x32_bf16 v[36:39], v[124:127], v[168:171], v[36:39]
    v_mfma_f32_16x16x32_bf16 v[72:75], v[124:127], v[172:175], v[72:75]
    v_mfma_f32_16x16x32_bf16 v[40:43], v[128:131], v[168:171], v[40:43]
    v_mfma_f32_16x16x32_bf16 v[76:79], v[128:131], v[172:175], v[76:79]
    s_waitcnt lgkmcnt(0)
    s_barrier
    v_mfma_f32_16x16x32_bf16 v[8:11], v[132:135], v[176:179], v[8:11]
    v_mfma_f32_16x16x32_bf16 v[44:47], v[132:135], v[180:183], v[44:47]
    v_mfma_f32_16x16x32_bf16 v[12:15], v[136:139], v[176:179], v[12:15]
    v_mfma_f32_16x16x32_bf16 v[48:51], v[136:139], v[180:183], v[48:51]
    v_mfma_f32_16x16x32_bf16 v[16:19], v[140:143], v[176:179], v[16:19]
    v_mfma_f32_16x16x32_bf16 v[52:55], v[140:143], v[180:183], v[52:55]
    v_mfma_f32_16x16x32_bf16 v[20:23], v[144:147], v[176:179], v[20:23]
    v_mfma_f32_16x16x32_bf16 v[56:59], v[144:147], v[180:183], v[56:59]
    v_mfma_f32_16x16x32_bf16 v[24:27], v[148:151], v[176:179], v[24:27]
    v_mfma_f32_16x16x32_bf16 v[60:63], v[148:151], v[180:183], v[60:63]
    v_mfma_f32_16x16x32_bf16 v[28:31], v[152:155], v[176:179], v[28:31]
    v_mfma_f32_16x16x32_bf16 v[64:67], v[152:155], v[180:183], v[64:67]
    v_mfma_f32_16x16x32_bf16 v[32:35], v[156:159], v[176:179], v[32:35]
    v_mfma_f32_16x16x32_bf16 v[68:71], v[156:159], v[180:183], v[68:71]
    v_mfma_f32_16x16x32_bf16 v[36:39], v[160:163], v[176:179], v[36:39]
    v_mfma_f32_16x16x32_bf16 v[72:75], v[160:163], v[180:183], v[72:75]
    v_mfma_f32_16x16x32_bf16 v[40:43], v[164:167], v[176:179], v[40:43]
    v_mfma_f32_16x16x32_bf16 v[76:79], v[164:167], v[180:183], v[76:79]
    s_nop 7
    s_nop 1
    s_waitcnt vmcnt(0)
    v_mov_b32 v240, 0
    v_mov_b32 v241, 0
    v_mov_b32 v242, 0
    v_mov_b32 v243, 0
    v_mov_b32 v244, 0
    v_mov_b32 v245, 0
    v_mov_b32 v246, 0
    v_mov_b32 v247, 0
    v_pk_fma_f32 v[8:9], v[184:185], v[220:221], v[8:9] op_sel:[0,0,0] op_sel_hi:[1,0,1]
    v_pk_fma_f32 v[10:11], v[186:187], v[220:221], v[10:11] op_sel:[0,0,0] op_sel_hi:[1,0,1]
    v_pk_mul_f32 v[8:9], v[8:9], v[222:223] op_sel:[0,0] op_sel_hi:[1,0]
    v_pk_mul_f32 v[10:11], v[10:11], v[222:223] op_sel:[0,0] op_sel_hi:[1,0]
    v_cvt_pk_bf16_f32 v8, v8, v9
    v_cvt_pk_bf16_f32 v9, v10, v11
    v_lshlrev_b32 v252, 16, v8
    v_and_b32 v253, 0xffff0000, v8
    v_pk_mul_f32 v[248:249], v[252:253], v[252:253]
    v_pk_fma_f32 v[248:249], v[248:249], v[224:225], v[224:225] op_sel:[0,1,0] op_sel_hi:[1,1,0]
    v_pk_mul_f32 v[248:249], v[248:249], v[252:253]
    v_exp_f32 v248, v248
    v_exp_f32 v249, v249
    s_nop 0
    v_pk_add_f32 v[248:249], v[248:249], 1.0 op_sel_hi:[1,0]
    v_rcp_f32 v248, v248
    v_rcp_f32 v249, v249
    s_nop 0
    v_pk_mul_f32 v[252:253], v[252:253], v[248:249]
    v_cvt_pk_bf16_f32 v8, v252, v253
    v_lshlrev_b32 v252, 16, v8
    v_and_b32 v253, 0xffff0000, v8
    v_pk_add_f32 v[240:241], v[240:241], v[252:253]
    v_pk_fma_f32 v[242:243], v[252:253], v[252:253], v[242:243]
    v_lshlrev_b32 v252, 16, v9
    v_and_b32 v253, 0xffff0000, v9
    v_pk_mul_f32 v[248:249], v[252:253], v[252:253]
    v_pk_fma_f32 v[248:249], v[248:249], v[224:225], v[224:225] op_sel:[0,1,0] op_sel_hi:[1,1,0]
    v_pk_mul_f32 v[248:249], v[248:249], v[252:253]
    v_exp_f32 v248, v248
    v_exp_f32 v249, v249
    s_nop 0
    v_pk_add_f32 v[248:249], v[248:249], 1.0 op_sel_hi:[1,0]
    v_rcp_f32 v248, v248
    v_rcp_f32 v249, v249
    s_nop 0
    v_pk_mul_f32 v[252:253], v[252:253], v[248:249]
    v_cvt_pk_bf16_f32 v9, v252, v253
    v_lshlrev_b32 v252, 16, v9
    v_and_b32 v253, 0xffff0000, v9
    v_pk_add_f32 v[240:241], v[240:241], v[252:253]
    v_pk_fma_f32 v[242:243], v[252:253], v[252:253], v[242:243]
    ds_write_b64 v4, v[8:9] offset:0
    v_pk_fma_f32 v[12:13], v[188:189], v[220:221], v[12:13] op_sel:[0,0,0] op_sel_hi:[1,0,1]
    v_pk_fma_f32 v[14:15], v[190:191], v[220:221], v[14:15] op_sel:[0,0,0] op_sel_hi:[1,0,1]
    v_pk_mul_f32 v[12:13], v[12:13], v[222:223] op_sel:[0,0] op_sel_hi:[1,0]
    v_pk_mul_f32 v[14:15], v[14:15], v[222:223] op_sel:[0,0] op_sel_hi:[1,0]
    v_cvt_pk_bf16_f32 v12, v12, v13
    v_cvt_pk_bf16_f32 v13, v14, v15
    v_lshlrev_b32 v252, 16, v12
    v_and_b32 v253, 0xffff0000, v12
    v_pk_mul_f32 v[248:249], v[252:253], v[252:253]
    v_pk_fma_f32 v[248:249], v[248:249], v[224:225], v[224:225] op_sel:[0,1,0] op_sel_hi:[1,1,0]
    v_pk_mul_f32 v[248:249], v[248:249], v[252:253]
    v_exp_f32 v248, v248
    v_exp_f32 v249, v249
    s_nop 0
    v_pk_add_f32 v[248:249], v[248:249], 1.0 op_sel_hi:[1,0]
    v_rcp_f32 v248, v248
    v_rcp_f32 v249, v249
    s_nop 0
    v_pk_mul_f32 v[252:253], v[252:253], v[248:249]
    v_cvt_pk_bf16_f32 v12, v252, v253
    v_lshlrev_b32 v252, 16, v12
    v_and_b32 v253, 0xffff0000, v12
    v_pk_add_f32 v[240:241], v[240:241], v[252:253]
    v_pk_fma_f32 v[242:243], v[252:253], v[252:253], v[242:243]
    v_lshlrev_b32 v252, 16, v13
    v_and_b32 v253, 0xffff0000, v13
    v_pk_mul_f32 v[248:249], v[252:253], v[252:253]
    v_pk_fma_f32 v[248:249], v[248:249], v[224:225], v[224:225] op_sel:[0,1,0] op_sel_hi:[1,1,0]
    v_pk_mul_f32 v[248:249], v[248:249], v[252:253]
    v_exp_f32 v248, v248
    v_exp_f32 v249, v249
    s_nop 0
    v_pk_add_f32 v[248:249], v[248:249], 1.0 op_sel_hi:[1,0]
    v_rcp_f32 v248, v248
    v_rcp_f32 v249, v249
    s_nop 0
    v_pk_mul_f32 v[252:253], v[252:253], v[248:249]
    v_cvt_pk_bf16_f32 v13, v252, v253
    v_lshlrev_b32 v252, 16, v13
    v_and_b32 v253, 0xffff0000, v13
    v_pk_add_f32 v[240:241], v[240:241], v[252:253]
    v_pk_fma_f32 v[242:243], v[252:253], v[252:253], v[242:243]
    ds_write_b64 v4, v[12:13] offset:32
    v_pk_fma_f32 v[16:17], v[192:193], v[220:221], v[16:17] op_sel:[0,0,0] op_sel_hi:[1,0,1]
    v_pk_fma_f32 v[18:19], v[194:195], v[220:221], v[18:19] op_sel:[0,0,0] op_sel_hi:[1,0,1]
    v_pk_mul_f32 v[16:17], v[16:17], v[222:223] op_sel:[0,0] op_sel_hi:[1,0]
    v_pk_mul_f32 v[18:19], v[18:19], v[222:223] op_sel:[0,0] op_sel_hi:[1,0]
    v_cvt_pk_bf16_f32 v16, v16, v17
    v_cvt_pk_bf16_f32 v17, v18, v19
    v_lshlrev_b32 v252, 16, v16
    v_and_b32 v253, 0xffff0000, v16
    v_pk_mul_f32 v[248:249], v[252:253], v[252:253]
    v_pk_fma_f32 v[248:249], v[248:249], v[224:225], v[224:225] op_sel:[0,1,0] op_sel_hi:[1,1,0]
    v_pk_mul_f32 v[248:249], v[248:249], v[252:253]
    v_exp_f32 v248, v248
    v_exp_f32 v249, v249
    s_nop 0
    v_pk_add_f32 v[248:249], v[248:249], 1.0 op_sel_hi:[1,0]
    v_rcp_f32 v248, v248
    v_rcp_f32 v249, v249
    s_nop 0
    v_pk_mul_f32 v[252:253], v[252:253], v[248:249]
    v_cvt_pk_bf16_f32 v16, v252, v253
    v_lshlrev_b32 v252, 16, v16
    v_and_b32 v253, 0xffff0000, v16
    v_pk_add_f32 v[240:241], v[240:241], v[252:253]
    v_pk_fma_f32 v[242:243], v[252:253], v[252:253], v[242:243]
    v_lshlrev_b32 v252, 16, v17
    v_and_b32 v253, 0xffff0000, v17
    v_pk_mul_f32 v[248:249], v[252:253], v[252:253]
    v_pk_fma_f32 v[248:249], v[248:249], v[224:225], v[224:225] op_sel:[0,1,0] op_sel_hi:[1,1,0]
    v_pk_mul_f32 v[248:249], v[248:249], v[252:253]
    v_exp_f32 v248, v248
    v_exp_f32 v249, v249
    s_nop 0
    v_pk_add_f32 v[248:249], v[248:249], 1.0 op_sel_hi:[1,0]
    v_rcp_f32 v248, v248
    v_rcp_f32 v249, v249
    s_nop 0
    v_pk_mul_f32 v[252:253], v[252:253], v[248:249]
    v_cvt_pk_bf16_f32 v17, v252, v253
    v_lshlrev_b32 v252, 16, v17
    v_and_b32 v253, 0xffff0000, v17
    v_pk_add_f32 v[240:241], v[240:241], v[252:253]
    v_pk_fma_f32 v[242:243], v[252:253], v[252:253], v[242:243]
    ds_write_b64 v4, v[16:17] offset:64
    v_pk_fma_f32 v[20:21], v[196:197], v[220:221], v[20:21] op_sel:[0,0,0] op_sel_hi:[1,0,1]
    v_pk_fma_f32 v[22:23], v[198:199], v[220:221], v[22:23] op_sel:[0,0,0] op_sel_hi:[1,0,1]
    v_pk_mul_f32 v[20:21], v[20:21], v[222:223] op_sel:[0,0] op_sel_hi:[1,0]
    v_pk_mul_f32 v[22:23], v[22:23], v[222:223] op_sel:[0,0] op_sel_hi:[1,0]
    v_cvt_pk_bf16_f32 v20, v20, v21
    v_cvt_pk_bf16_f32 v21, v22, v23
    v_lshlrev_b32 v252, 16, v20
    v_and_b32 v253, 0xffff0000, v20
    v_pk_mul_f32 v[248:249], v[252:253], v[252:253]
    v_pk_fma_f32 v[248:249], v[248:249], v[224:225], v[224:225] op_sel:[0,1,0] op_sel_hi:[1,1,0]
    v_pk_mul_f32 v[248:249], v[248:249], v[252:253]
    v_exp_f32 v248, v248
    v_exp_f32 v249, v249
    s_nop 0
    v_pk_add_f32 v[248:249], v[248:249], 1.0 op_sel_hi:[1,0]
    v_rcp_f32 v248, v248
    v_rcp_f32 v249, v249
    s_nop 0
    v_pk_mul_f32 v[252:253], v[252:253], v[248:249]
    v_cvt_pk_bf16_f32 v20, v252, v253
    v_lshlrev_b32 v252, 16, v20
    v_and_b32 v253, 0xffff0000, v20
    v_pk_add_f32 v[240:241], v[240:241], v[252:253]
    v_pk_fma_f32 v[242:243], v[252:253], v[252:253], v[242:243]
    v_lshlrev_b32 v252, 16, v21
    v_and_b32 v253, 0xffff0000, v21
    v_pk_mul_f32 v[248:249], v[252:253], v[252:253]
    v_pk_fma_f32 v[248:249], v[248:249], v[224:225], v[224:225] op_sel:[0,1,0] op_sel_hi:[1,1,0]
    v_pk_mul_f32 v[248:249], v[248:249], v[252:253]
    v_exp_f32 v248, v248
    v_exp_f32 v249, v249
    s_nop 0
    v_pk_add_f32 v[248:249], v[248:249], 1.0 op_sel_hi:[1,0]
    v_rcp_f32 v248, v248
    v_rcp_f32 v249, v249
    s_nop 0
    v_pk_mul_f32 v[252:253], v[252:253], v[248:249]
    v_cvt_pk_bf16_f32 v21, v252, v253
    v_lshlrev_b32 v252, 16, v21
    v_and_b32 v253, 0xffff0000, v21
    v_pk_add_f32 v[240:241], v[240:241], v[252:253]
    v_pk_fma_f32 v[242:243], v[252:253], v[252:253], v[242:243]
    ds_write_b64 v4, v[20:21] offset:96
    v_pk_fma_f32 v[24:25], v[200:201], v[220:221], v[24:25] op_sel:[0,0,0] op_sel_hi:[1,0,1]
    v_pk_fma_f32 v[26:27], v[202:203], v[220:221], v[26:27] op_sel:[0,0,0] op_sel_hi:[1,0,1]
    v_pk_mul_f32 v[24:25], v[24:25], v[222:223] op_sel:[0,0] op_sel_hi:[1,0]
    v_pk_mul_f32 v[26:27], v[26:27], v[222:223] op_sel:[0,0] op_sel_hi:[1,0]
    v_cvt_pk_bf16_f32 v24, v24, v25
    v_cvt_pk_bf16_f32 v25, v26, v27
    v_lshlrev_b32 v252, 16, v24
    v_and_b32 v253, 0xffff0000, v24
    v_pk_mul_f32 v[248:249], v[252:253], v[252:253]
    v_pk_fma_f32 v[248:249], v[248:249], v[224:225], v[224:225] op_sel:[0,1,0] op_sel_hi:[1,1,0]
    v_pk_mul_f32 v[248:249], v[248:249], v[252:253]
    v_exp_f32 v248, v248
    v_exp_f32 v249, v249
    s_nop 0
    v_pk_add_f32 v[248:249], v[248:249], 1.0 op_sel_hi:[1,0]
    v_rcp_f32 v248, v248
    v_rcp_f32 v249, v249
    s_nop 0
    v_pk_mul_f32 v[252:253], v[252:253], v[248:249]
    v_cvt_pk_bf16_f32 v24, v252, v253
    v_lshlrev_b32 v252, 16, v24
    v_and_b32 v253, 0xffff0000, v24
    v_pk_add_f32 v[240:241], v[240:241], v[252:253]
    v_pk_fma_f32 v[242:243], v[252:253], v[252:253], v[242:243]
    v_lshlrev_b32 v252, 16, v25
    v_and_b32 v253, 0xffff0000, v25
    v_pk_mul_f32 v[248:249], v[252:253], v[252:253]
    v_pk_fma_f32 v[248:249], v[248:249], v[224:225], v[224:225] op_sel:[0,1,0] op_sel_hi:[1,1,0]
    v_pk_mul_f32 v[248:249], v[248:249], v[252:253]
    v_exp_f32 v248, v248
    v_exp_f32 v249, v249
    s_nop 0
    v_pk_add_f32 v[248:249], v[248:249], 1.0 op_sel_hi:[1,0]
    v_rcp_f32 v248, v248
    v_rcp_f32 v249, v249
    s_nop 0
    v_pk_mul_f32 v[252:253], v[252:253], v[248:249]
    v_cvt_pk_bf16_f32 v25, v252, v253
    v_lshlrev_b32 v252, 16, v25
    v_and_b32 v253, 0xffff0000, v25
    v_pk_add_f32 v[240:241], v[240:241], v[252:253]
    v_pk_fma_f32 v[242:243], v[252:253], v[252:253], v[242:243]
    ds_write_b64 v4, v[24:25] offset:128
    v_pk_fma_f32 v[28:29], v[204:205], v[220:221], v[28:29] op_sel:[0,0,0] op_sel_hi:[1,0,1]
    v_pk_fma_f32 v[30:31], v[206:207], v[220:221], v[30:31] op_sel:[0,0,0] op_sel_hi:[1,0,1]
    v_pk_mul_f32 v[28:29], v[28:29], v[222:223] op_sel:[0,0] op_sel_hi:[1,0]
    v_pk_mul_f32 v[30:31], v[30:31], v[222:223] op_sel:[0,0] op_sel_hi:[1,0]
    v_cvt_pk_bf16_f32 v28, v28, v29
    v_cvt_pk_bf16_f32 v29, v30, v31
    v_lshlrev_b32 v252, 16, v28
    v_and_b32 v253, 0xffff0000, v28
    v_pk_mul_f32 v[248:249], v[252:253], v[252:253]
    v_pk_fma_f32 v[248:249], v[248:249], v[224:225], v[224:225] op_sel:[0,1,0] op_sel_hi:[1,1,0]
    v_pk_mul_f32 v[248:249], v[248:249], v[252:253]
    v_exp_f32 v248, v248
    v_exp_f32 v249, v249
    s_nop 0
    v_pk_add_f32 v[248:249], v[248:249], 1.0 op_sel_hi:[1,0]
    v_rcp_f32 v248, v248
    v_rcp_f32 v249, v249
    s_nop 0
    v_pk_mul_f32 v[252:253], v[252:253], v[248:249]
    v_cvt_pk_bf16_f32 v28, v252, v253
    v_lshlrev_b32 v252, 16, v28
    v_and_b32 v253, 0xffff0000, v28
    v_pk_add_f32 v[240:241], v[240:241], v[252:253]
    v_pk_fma_f32 v[242:243], v[252:253], v[252:253], v[242:243]
    v_lshlrev_b32 v252, 16, v29
    v_and_b32 v253, 0xffff0000, v29
    v_pk_mul_f32 v[248:249], v[252:253], v[252:253]
    v_pk_fma_f32 v[248:249], v[248:249], v[224:225], v[224:225] op_sel:[0,1,0] op_sel_hi:[1,1,0]
    v_pk_mul_f32 v[248:249], v[248:249], v[252:253]
    v_exp_f32 v248, v248
    v_exp_f32 v249, v249
    s_nop 0
    v_pk_add_f32 v[248:249], v[248:249], 1.0 op_sel_hi:[1,0]
    v_rcp_f32 v248, v248
    v_rcp_f32 v249, v249
    s_nop 0
    v_pk_mul_f32 v[252:253], v[252:253], v[248:249]
    v_cvt_pk_bf16_f32 v29, v252, v253
    v_lshlrev_b32 v252, 16, v29
    v_and_b32 v253, 0xffff0000, v29
    v_pk_add_f32 v[240:241], v[240:241], v[252:253]
    v_pk_fma_f32 v[242:243], v[252:253], v[252:253], v[242:243]
    ds_write_b64 v4, v[28:29] offset:160
    v_pk_fma_f32 v[32:33], v[208:209], v[220:221], v[32:33] op_sel:[0,0,0] op_sel_hi:[1,0,1]
    v_pk_fma_f32 v[34:35], v[210:211], v[220:221], v[34:35] op_sel:[0,0,0] op_sel_hi:[1,0,1]
    v_pk_mul_f32 v[32:33], v[32:33], v[222:223] op_sel:[0,0] op_sel_hi:[1,0]
    v_pk_mul_f32 v[34:35], v[34:35], v[222:223] op_sel:[0,0] op_sel_hi:[1,0]
    v_cvt_pk_bf16_f32 v32, v32, v33
    v_cvt_pk_bf16_f32 v33, v34, v35
    v_lshlrev_b32 v252, 16, v32
    v_and_b32 v253, 0xffff0000, v32
    v_pk_mul_f32 v[248:249], v[252:253], v[252:253]
    v_pk_fma_f32 v[248:249], v[248:249], v[224:225], v[224:225] op_sel:[0,1,0] op_sel_hi:[1,1,0]
    v_pk_mul_f32 v[248:249], v[248:249], v[252:253]
    v_exp_f32 v248, v248
    v_exp_f32 v249, v249
    s_nop 0
    v_pk_add_f32 v[248:249], v[248:249], 1.0 op_sel_hi:[1,0]
    v_rcp_f32 v248, v248
    v_rcp_f32 v249, v249
    s_nop 0
    v_pk_mul_f32 v[252:253], v[252:253], v[248:249]
    v_cvt_pk_bf16_f32 v32, v252, v253
    v_lshlrev_b32 v252, 16, v32
    v_and_b32 v253, 0xffff0000, v32
    v_pk_add_f32 v[240:241], v[240:241], v[252:253]
    v_pk_fma_f32 v[242:243], v[252:253], v[252:253], v[242:243]
    v_lshlrev_b32 v252, 16, v33
    v_and_b32 v253, 0xffff0000, v33
    v_pk_mul_f32 v[248:249], v[252:253], v[252:253]
    v_pk_fma_f32 v[248:249], v[248:249], v[224:225], v[224:225] op_sel:[0,1,0] op_sel_hi:[1,1,0]
    v_pk_mul_f32 v[248:249], v[248:249], v[252:253]
    v_exp_f32 v248, v248
    v_exp_f32 v249, v249
    s_nop 0
    v_pk_add_f32 v[248:249], v[248:249], 1.0 op_sel_hi:[1,0]
    v_rcp_f32 v248, v248
    v_rcp_f32 v249, v249
    s_nop 0
    v_pk_mul_f32 v[252:253], v[252:253], v[248:249]
    v_cvt_pk_bf16_f32 v33, v252, v253
    v_lshlrev_b32 v252, 16, v33
    v_and_b32 v253, 0xffff0000, v33
    v_pk_add_f32 v[240:241], v[240:241], v[252:253]
    v_pk_fma_f32 v[242:243], v[252:253], v[252:253], v[242:243]
    ds_write_b64 v4, v[32:33] offset:192
    v_pk_fma_f32 v[36:37], v[212:213], v[220:221], v[36:37] op_sel:[0,0,0] op_sel_hi:[1,0,1]
    v_pk_fma_f32 v[38:39], v[214:215], v[220:221], v[38:39] op_sel:[0,0,0] op_sel_hi:[1,0,1]
    v_pk_mul_f32 v[36:37], v[36:37], v[222:223] op_sel:[0,0] op_sel_hi:[1,0]
    v_pk_mul_f32 v[38:39], v[38:39], v[222:223] op_sel:[0,0] op_sel_hi:[1,0]
    v_cvt_pk_bf16_f32 v36, v36, v37
    v_cvt_pk_bf16_f32 v37, v38, v39
    v_lshlrev_b32 v252, 16, v36
    v_and_b32 v253, 0xffff0000, v36
    v_pk_mul_f32 v[248:249], v[252:253], v[252:253]
    v_pk_fma_f32 v[248:249], v[248:249], v[224:225], v[224:225] op_sel:[0,1,0] op_sel_hi:[1,1,0]
    v_pk_mul_f32 v[248:249], v[248:249], v[252:253]
    v_exp_f32 v248, v248
    v_exp_f32 v249, v249
    s_nop 0
    v_pk_add_f32 v[248:249], v[248:249], 1.0 op_sel_hi:[1,0]
    v_rcp_f32 v248, v248
    v_rcp_f32 v249, v249
    s_nop 0
    v_pk_mul_f32 v[252:253], v[252:253], v[248:249]
    v_cvt_pk_bf16_f32 v36, v252, v253
    v_lshlrev_b32 v252, 16, v36
    v_and_b32 v253, 0xffff0000, v36
    v_pk_add_f32 v[240:241], v[240:241], v[252:253]
    v_pk_fma_f32 v[242:243], v[252:253], v[252:253], v[242:243]
    v_lshlrev_b32 v252, 16, v37
    v_and_b32 v253, 0xffff0000, v37
    v_pk_mul_f32 v[248:249], v[252:253], v[252:253]
    v_pk_fma_f32 v[248:249], v[248:249], v[224:225], v[224:225] op_sel:[0,1,0] op_sel_hi:[1,1,0]
    v_pk_mul_f32 v[248:249], v[248:249], v[252:253]
    v_exp_f32 v248, v248
    v_exp_f32 v249, v249
    s_nop 0
    v_pk_add_f32 v[248:249], v[248:249], 1.0 op_sel_hi:[1,0]
    v_rcp_f32 v248, v248
    v_rcp_f32 v249, v249
    s_nop 0
    v_pk_mul_f32 v[252:253], v[252:253], v[248:249]
    v_cvt_pk_bf16_f32 v37, v252, v253
    v_lshlrev_b32 v252, 16, v37
    v_and_b32 v253, 0xffff0000, v37
    v_pk_add_f32 v[240:241], v[240:241], v[252:253]
    v_pk_fma_f32 v[242:243], v[252:253], v[252:253], v[242:243]
    ds_write_b64 v4, v[36:37] offset:224
    v_pk_fma_f32 v[40:41], v[216:217], v[220:221], v[40:41] op_sel:[0,0,0] op_sel_hi:[1,0,1]
    v_pk_fma_f32 v[42:43], v[218:219], v[220:221], v[42:43] op_sel:[0,0,0] op_sel_hi:[1,0,1]
    v_pk_mul_f32 v[40:41], v[40:41], v[222:223] op_sel:[0,0] op_sel_hi:[1,0]
    v_pk_mul_f32 v[42:43], v[42:43], v[222:223] op_sel:[0,0] op_sel_hi:[1,0]
    v_cvt_pk_bf16_f32 v40, v40, v41
    v_cvt_pk_bf16_f32 v41, v42, v43
    v_lshlrev_b32 v252, 16, v40
    v_and_b32 v253, 0xffff0000, v40
    v_pk_mul_f32 v[248:249], v[252:253], v[252:253]
    v_pk_fma_f32 v[248:249], v[248:249], v[224:225], v[224:225] op_sel:[0,1,0] op_sel_hi:[1,1,0]
    v_pk_mul_f32 v[248:249], v[248:249], v[252:253]
    v_exp_f32 v248, v248
    v_exp_f32 v249, v249
    s_nop 0
    v_pk_add_f32 v[248:249], v[248:249], 1.0 op_sel_hi:[1,0]
    v_rcp_f32 v248, v248
    v_rcp_f32 v249, v249
    s_nop 0
    v_pk_mul_f32 v[252:253], v[252:253], v[248:249]
    v_cvt_pk_bf16_f32 v40, v252, v253
    v_lshlrev_b32 v252, 16, v40
    v_and_b32 v253, 0xffff0000, v40
    v_pk_add_f32 v[240:241], v[240:241], v[252:253]
    v_pk_fma_f32 v[242:243], v[252:253], v[252:253], v[242:243]
    v_lshlrev_b32 v252, 16, v41
    v_and_b32 v253, 0xffff0000, v41
    v_pk_mul_f32 v[248:249], v[252:253], v[252:253]
    v_pk_fma_f32 v[248:249], v[248:249], v[224:225], v[224:225] op_sel:[0,1,0] op_sel_hi:[1,1,0]
    v_pk_mul_f32 v[248:249], v[248:249], v[252:253]
    v_exp_f32 v248, v248
    v_exp_f32 v249, v249
    s_nop 0
    v_pk_add_f32 v[248:249], v[248:249], 1.0 op_sel_hi:[1,0]
    v_rcp_f32 v248, v248
    v_rcp_f32 v249, v249
    s_nop 0
    v_pk_mul_f32 v[252:253], v[252:253], v[248:249]
    v_cvt_pk_bf16_f32 v41, v252, v253
    v_lshlrev_b32 v252, 16, v41
    v_and_b32 v253, 0xffff0000, v41
    v_pk_add_f32 v[240:241], v[240:241], v[252:253]
    v_pk_fma_f32 v[242:243], v[252:253], v[252:253], v[242:243]
    ds_write_b64 v4, v[40:41] offset:256
    s_waitcnt lgkmcnt(0)
    ds_read_b128 v[8:11], v5 offset:0
    ds_read_b128 v[12:15], v5 offset:1024
    ds_read_b128 v[16:19], v5 offset:2048
    ds_read_b128 v[20:23], v5 offset:3072
    s_mov_b32 exec_hi, 0
    ds_read_b128 v[24:27], v5 offset:4096
    s_mov_b32 exec_hi, -1
    s_waitcnt lgkmcnt(4)
    buffer_store_dwordx4 v[8:11], v226, s[40:43], s69 offen sc1
    s_waitcnt lgkmcnt(3)
    buffer_store_dwordx4 v[12:15], v227, s[40:43], s69 offen sc1
    s_waitcnt lgkmcnt(2)
    buffer_store_dwordx4 v[16:19], v228, s[40:43], s69 offen sc1
    s_waitcnt lgkmcnt(1)
    buffer_store_dwordx4 v[20:23], v229, s[40:43], s69 offen sc1
    s_waitcnt lgkmcnt(0)
    s_mov_b32 exec_hi, 0
    buffer_store_dwordx4 v[24:27], v230, s[40:43], s69 offen sc1
    s_mov_b32 exec_hi, -1
    s_lshl_b32 s60, s68, 4
    v_add_u32 v226, s60, v226
    v_add_u32 v227, s60, v227
    v_add_u32 v228, s60, v228
    v_add_u32 v229, s60, v229
    v_add_u32 v230, s60, v230
    v_pk_fma_f32 v[44:45], v[184:185], v[220:221], v[44:45] op_sel:[0,1,0] op_sel_hi:[1,1,1]
    v_pk_fma_f32 v[46:47], v[186:187], v[220:221], v[46:47] op_sel:[0,1,0] op_sel_hi:[1,1,1]
    v_pk_mul_f32 v[44:45], v[44:45], v[222:223] op_sel:[0,1] op_sel_hi:[1,1]
    v_pk_mul_f32 v[46:47], v[46:47], v[222:223] op_sel:[0,1] op_sel_hi:[1,1]
    v_cvt_pk_bf16_f32 v44, v44, v45
    v_cvt_pk_bf16_f32 v45, v46, v47
    v_lshlrev_b32 v252, 16, v44
    v_and_b32 v253, 0xffff0000, v44
    v_pk_mul_f32 v[248:249], v[252:253], v[252:253]
    v_pk_fma_f32 v[248:249], v[248:249], v[224:225], v[224:225] op_sel:[0,1,0] op_sel_hi:[1,1,0]
    v_pk_mul_f32 v[248:249], v[248:249], v[252:253]
    v_exp_f32 v248, v248
    v_exp_f32 v249, v249
    s_nop 0
    v_pk_add_f32 v[248:249], v[248:249], 1.0 op_sel_hi:[1,0]
    v_rcp_f32 v248, v248
    v_rcp_f32 v249, v249
    s_nop 0
    v_pk_mul_f32 v[252:253], v[252:253], v[248:249]
    v_cvt_pk_bf16_f32 v44, v252, v253
    v_lshlrev_b32 v252, 16, v44
    v_and_b32 v253, 0xffff0000, v44
    v_pk_add_f32 v[244:245], v[244:245], v[252:253]
    v_pk_fma_f32 v[246:247], v[252:253], v[252:253], v[246:247]
    v_lshlrev_b32 v252, 16, v45
    v_and_b32 v253, 0xffff0000, v45
    v_pk_mul_f32 v[248:249], v[252:253], v[252:253]
    v_pk_fma_f32 v[248:249], v[248:249], v[224:225], v[224:225] op_sel:[0,1,0] op_sel_hi:[1,1,0]
    v_pk_mul_f32 v[248:249], v[248:249], v[252:253]
    v_exp_f32 v248, v248
    v_exp_f32 v249, v249
    s_nop 0
    v_pk_add_f32 v[248:249], v[248:249], 1.0 op_sel_hi:[1,0]
    v_rcp_f32 v248, v248
    v_rcp_f32 v249, v249
    s_nop 0
    v_pk_mul_f32 v[252:253], v[252:253], v[248:249]
    v_cvt_pk_bf16_f32 v45, v252, v253
    v_lshlrev_b32 v252, 16, v45
    v_and_b32 v253, 0xffff0000, v45
    v_pk_add_f32 v[244:245], v[244:245], v[252:253]
    v_pk_fma_f32 v[246:247], v[252:253], v[252:253], v[246:247]
    ds_write_b64 v4, v[44:45] offset:0
    v_pk_fma_f32 v[48:49], v[188:189], v[220:221], v[48:49] op_sel:[0,1,0] op_sel_hi:[1,1,1]
    v_pk_fma_f32 v[50:51], v[190:191], v[220:221], v[50:51] op_sel:[0,1,0] op_sel_hi:[1,1,1]
    v_pk_mul_f32 v[48:49], v[48:49], v[222:223] op_sel:[0,1] op_sel_hi:[1,1]
    v_pk_mul_f32 v[50:51], v[50:51], v[222:223] op_sel:[0,1] op_sel_hi:[1,1]
    v_cvt_pk_bf16_f32 v48, v48, v49
    v_cvt_pk_bf16_f32 v49, v50, v51
    v_lshlrev_b32 v252, 16, v48
    v_and_b32 v253, 0xffff0000, v48
    v_pk_mul_f32 v[248:249], v[252:253], v[252:253]
    v_pk_fma_f32 v[248:249], v[248:249], v[224:225], v[224:225] op_sel:[0,1,0] op_sel_hi:[1,1,0]
    v_pk_mul_f32 v[248:249], v[248:249], v[252:253]
    v_exp_f32 v248, v248
    v_exp_f32 v249, v249
    s_nop 0
    v_pk_add_f32 v[248:249], v[248:249], 1.0 op_sel_hi:[1,0]
    v_rcp_f32 v248, v248
    v_rcp_f32 v249, v249
    s_nop 0
    v_pk_mul_f32 v[252:253], v[252:253], v[248:249]
    v_cvt_pk_bf16_f32 v48, v252, v253
    v_lshlrev_b32 v252, 16, v48
    v_and_b32 v253, 0xffff0000, v48
    v_pk_add_f32 v[244:245], v[244:245], v[252:253]
    v_pk_fma_f32 v[246:247], v[252:253], v[252:253], v[246:247]
    v_lshlrev_b32 v252, 16, v49
    v_and_b32 v253, 0xffff0000, v49
    v_pk_mul_f32 v[248:249], v[252:253], v[252:253]
    v_pk_fma_f32 v[248:249], v[248:249], v[224:225], v[224:225] op_sel:[0,1,0] op_sel_hi:[1,1,0]
    v_pk_mul_f32 v[248:249], v[248:249], v[252:253]
    v_exp_f32 v248, v248
    v_exp_f32 v249, v249
    s_nop 0
    v_pk_add_f32 v[248:249], v[248:249], 1.0 op_sel_hi:[1,0]
    v_rcp_f32 v248, v248
    v_rcp_f32 v249, v249
    s_nop 0
    v_pk_mul_f32 v[252:253], v[252:253], v[248:249]
    v_cvt_pk_bf16_f32 v49, v252, v253
    v_lshlrev_b32 v252, 16, v49
    v_and_b32 v253, 0xffff0000, v49
    v_pk_add_f32 v[244:245], v[244:245], v[252:253]
    v_pk_fma_f32 v[246:247], v[252:253], v[252:253], v[246:247]
    ds_write_b64 v4, v[48:49] offset:32
    v_pk_fma_f32 v[52:53], v[192:193], v[220:221], v[52:53] op_sel:[0,1,0] op_sel_hi:[1,1,1]
    v_pk_fma_f32 v[54:55], v[194:195], v[220:221], v[54:55] op_sel:[0,1,0] op_sel_hi:[1,1,1]
    v_pk_mul_f32 v[52:53], v[52:53], v[222:223] op_sel:[0,1] op_sel_hi:[1,1]
    v_pk_mul_f32 v[54:55], v[54:55], v[222:223] op_sel:[0,1] op_sel_hi:[1,1]
    v_cvt_pk_bf16_f32 v52, v52, v53
    v_cvt_pk_bf16_f32 v53, v54, v55
    v_lshlrev_b32 v252, 16, v52
    v_and_b32 v253, 0xffff0000, v52
    v_pk_mul_f32 v[248:249], v[252:253], v[252:253]
    v_pk_fma_f32 v[248:249], v[248:249], v[224:225], v[224:225] op_sel:[0,1,0] op_sel_hi:[1,1,0]
    v_pk_mul_f32 v[248:249], v[248:249], v[252:253]
    v_exp_f32 v248, v248
    v_exp_f32 v249, v249
    s_nop 0
    v_pk_add_f32 v[248:249], v[248:249], 1.0 op_sel_hi:[1,0]
    v_rcp_f32 v248, v248
    v_rcp_f32 v249, v249
    s_nop 0
    v_pk_mul_f32 v[252:253], v[252:253], v[248:249]
    v_cvt_pk_bf16_f32 v52, v252, v253
    v_lshlrev_b32 v252, 16, v52
    v_and_b32 v253, 0xffff0000, v52
    v_pk_add_f32 v[244:245], v[244:245], v[252:253]
    v_pk_fma_f32 v[246:247], v[252:253], v[252:253], v[246:247]
    v_lshlrev_b32 v252, 16, v53
    v_and_b32 v253, 0xffff0000, v53
    v_pk_mul_f32 v[248:249], v[252:253], v[252:253]
    v_pk_fma_f32 v[248:249], v[248:249], v[224:225], v[224:225] op_sel:[0,1,0] op_sel_hi:[1,1,0]
    v_pk_mul_f32 v[248:249], v[248:249], v[252:253]
    v_exp_f32 v248, v248
    v_exp_f32 v249, v249
    s_nop 0
    v_pk_add_f32 v[248:249], v[248:249], 1.0 op_sel_hi:[1,0]
    v_rcp_f32 v248, v248
    v_rcp_f32 v249, v249
    s_nop 0
    v_pk_mul_f32 v[252:253], v[252:253], v[248:249]
    v_cvt_pk_bf16_f32 v53, v252, v253
    v_lshlrev_b32 v252, 16, v53
    v_and_b32 v253, 0xffff0000, v53
    v_pk_add_f32 v[244:245], v[244:245], v[252:253]
    v_pk_fma_f32 v[246:247], v[252:253], v[252:253], v[246:247]
    ds_write_b64 v4, v[52:53] offset:64
    v_pk_fma_f32 v[56:57], v[196:197], v[220:221], v[56:57] op_sel:[0,1,0] op_sel_hi:[1,1,1]
    v_pk_fma_f32 v[58:59], v[198:199], v[220:221], v[58:59] op_sel:[0,1,0] op_sel_hi:[1,1,1]
    v_pk_mul_f32 v[56:57], v[56:57], v[222:223] op_sel:[0,1] op_sel_hi:[1,1]
    v_pk_mul_f32 v[58:59], v[58:59], v[222:223] op_sel:[0,1] op_sel_hi:[1,1]
    v_cvt_pk_bf16_f32 v56, v56, v57
    v_cvt_pk_bf16_f32 v57, v58, v59
    v_lshlrev_b32 v252, 16, v56
    v_and_b32 v253, 0xffff0000, v56
    v_pk_mul_f32 v[248:249], v[252:253], v[252:253]
    v_pk_fma_f32 v[248:249], v[248:249], v[224:225], v[224:225] op_sel:[0,1,0] op_sel_hi:[1,1,0]
    v_pk_mul_f32 v[248:249], v[248:249], v[252:253]
    v_exp_f32 v248, v248
    v_exp_f32 v249, v249
    s_nop 0
    v_pk_add_f32 v[248:249], v[248:249], 1.0 op_sel_hi:[1,0]
    v_rcp_f32 v248, v248
    v_rcp_f32 v249, v249
    s_nop 0
    v_pk_mul_f32 v[252:253], v[252:253], v[248:249]
    v_cvt_pk_bf16_f32 v56, v252, v253
    v_lshlrev_b32 v252, 16, v56
    v_and_b32 v253, 0xffff0000, v56
    v_pk_add_f32 v[244:245], v[244:245], v[252:253]
    v_pk_fma_f32 v[246:247], v[252:253], v[252:253], v[246:247]
    v_lshlrev_b32 v252, 16, v57
    v_and_b32 v253, 0xffff0000, v57
    v_pk_mul_f32 v[248:249], v[252:253], v[252:253]
    v_pk_fma_f32 v[248:249], v[248:249], v[224:225], v[224:225] op_sel:[0,1,0] op_sel_hi:[1,1,0]
    v_pk_mul_f32 v[248:249], v[248:249], v[252:253]
    v_exp_f32 v248, v248
    v_exp_f32 v249, v249
    s_nop 0
    v_pk_add_f32 v[248:249], v[248:249], 1.0 op_sel_hi:[1,0]
    v_rcp_f32 v248, v248
    v_rcp_f32 v249, v249
    s_nop 0
    v_pk_mul_f32 v[252:253], v[252:253], v[248:249]
    v_cvt_pk_bf16_f32 v57, v252, v253
    v_lshlrev_b32 v252, 16, v57
    v_and_b32 v253, 0xffff0000, v57
    v_pk_add_f32 v[244:245], v[244:245], v[252:253]
    v_pk_fma_f32 v[246:247], v[252:253], v[252:253], v[246:247]
    ds_write_b64 v4, v[56:57] offset:96
    v_pk_fma_f32 v[60:61], v[200:201], v[220:221], v[60:61] op_sel:[0,1,0] op_sel_hi:[1,1,1]
    v_pk_fma_f32 v[62:63], v[202:203], v[220:221], v[62:63] op_sel:[0,1,0] op_sel_hi:[1,1,1]
    v_pk_mul_f32 v[60:61], v[60:61], v[222:223] op_sel:[0,1] op_sel_hi:[1,1]
    v_pk_mul_f32 v[62:63], v[62:63], v[222:223] op_sel:[0,1] op_sel_hi:[1,1]
    v_cvt_pk_bf16_f32 v60, v60, v61
    v_cvt_pk_bf16_f32 v61, v62, v63
    v_lshlrev_b32 v252, 16, v60
    v_and_b32 v253, 0xffff0000, v60
    v_pk_mul_f32 v[248:249], v[252:253], v[252:253]
    v_pk_fma_f32 v[248:249], v[248:249], v[224:225], v[224:225] op_sel:[0,1,0] op_sel_hi:[1,1,0]
    v_pk_mul_f32 v[248:249], v[248:249], v[252:253]
    v_exp_f32 v248, v248
    v_exp_f32 v249, v249
    s_nop 0
    v_pk_add_f32 v[248:249], v[248:249], 1.0 op_sel_hi:[1,0]
    v_rcp_f32 v248, v248
    v_rcp_f32 v249, v249
    s_nop 0
    v_pk_mul_f32 v[252:253], v[252:253], v[248:249]
    v_cvt_pk_bf16_f32 v60, v252, v253
    v_lshlrev_b32 v252, 16, v60
    v_and_b32 v253, 0xffff0000, v60
    v_pk_add_f32 v[244:245], v[244:245], v[252:253]
    v_pk_fma_f32 v[246:247], v[252:253], v[252:253], v[246:247]
    v_lshlrev_b32 v252, 16, v61
    v_and_b32 v253, 0xffff0000, v61
    v_pk_mul_f32 v[248:249], v[252:253], v[252:253]
    v_pk_fma_f32 v[248:249], v[248:249], v[224:225], v[224:225] op_sel:[0,1,0] op_sel_hi:[1,1,0]
    v_pk_mul_f32 v[248:249], v[248:249], v[252:253]
    v_exp_f32 v248, v248
    v_exp_f32 v249, v249
    s_nop 0
    v_pk_add_f32 v[248:249], v[248:249], 1.0 op_sel_hi:[1,0]
    v_rcp_f32 v248, v248
    v_rcp_f32 v249, v249
    s_nop 0
    v_pk_mul_f32 v[252:253], v[252:253], v[248:249]
    v_cvt_pk_bf16_f32 v61, v252, v253
    v_lshlrev_b32 v252, 16, v61
    v_and_b32 v253, 0xffff0000, v61
    v_pk_add_f32 v[244:245], v[244:245], v[252:253]
    v_pk_fma_f32 v[246:247], v[252:253], v[252:253], v[246:247]
    ds_write_b64 v4, v[60:61] offset:128
    v_pk_fma_f32 v[64:65], v[204:205], v[220:221], v[64:65] op_sel:[0,1,0] op_sel_hi:[1,1,1]
    v_pk_fma_f32 v[66:67], v[206:207], v[220:221], v[66:67] op_sel:[0,1,0] op_sel_hi:[1,1,1]
    v_pk_mul_f32 v[64:65], v[64:65], v[222:223] op_sel:[0,1] op_sel_hi:[1,1]
    v_pk_mul_f32 v[66:67], v[66:67], v[222:223] op_sel:[0,1] op_sel_hi:[1,1]
    v_cvt_pk_bf16_f32 v64, v64, v65
    v_cvt_pk_bf16_f32 v65, v66, v67
    v_lshlrev_b32 v252, 16, v64
    v_and_b32 v253, 0xffff0000, v64
    v_pk_mul_f32 v[248:249], v[252:253], v[252:253]
    v_pk_fma_f32 v[248:249], v[248:249], v[224:225], v[224:225] op_sel:[0,1,0] op_sel_hi:[1,1,0]
    v_pk_mul_f32 v[248:249], v[248:249], v[252:253]
    v_exp_f32 v248, v248
    v_exp_f32 v249, v249
    s_nop 0
    v_pk_add_f32 v[248:249], v[248:249], 1.0 op_sel_hi:[1,0]
    v_rcp_f32 v248, v248
    v_rcp_f32 v249, v249
    s_nop 0
    v_pk_mul_f32 v[252:253], v[252:253], v[248:249]
    v_cvt_pk_bf16_f32 v64, v252, v253
    v_lshlrev_b32 v252, 16, v64
    v_and_b32 v253, 0xffff0000, v64
    v_pk_add_f32 v[244:245], v[244:245], v[252:253]
    v_pk_fma_f32 v[246:247], v[252:253], v[252:253], v[246:247]
    v_lshlrev_b32 v252, 16, v65
    v_and_b32 v253, 0xffff0000, v65
    v_pk_mul_f32 v[248:249], v[252:253], v[252:253]
    v_pk_fma_f32 v[248:249], v[248:249], v[224:225], v[224:225] op_sel:[0,1,0] op_sel_hi:[1,1,0]
    v_pk_mul_f32 v[248:249], v[248:249], v[252:253]
    v_exp_f32 v248, v248
    v_exp_f32 v249, v249
    s_nop 0
    v_pk_add_f32 v[248:249], v[248:249], 1.0 op_sel_hi:[1,0]
    v_rcp_f32 v248, v248
    v_rcp_f32 v249, v249
    s_nop 0
    v_pk_mul_f32 v[252:253], v[252:253], v[248:249]
    v_cvt_pk_bf16_f32 v65, v252, v253
    v_lshlrev_b32 v252, 16, v65
    v_and_b32 v253, 0xffff0000, v65
    v_pk_add_f32 v[244:245], v[244:245], v[252:253]
    v_pk_fma_f32 v[246:247], v[252:253], v[252:253], v[246:247]
    ds_write_b64 v4, v[64:65] offset:160
    v_pk_fma_f32 v[68:69], v[208:209], v[220:221], v[68:69] op_sel:[0,1,0] op_sel_hi:[1,1,1]
    v_pk_fma_f32 v[70:71], v[210:211], v[220:221], v[70:71] op_sel:[0,1,0] op_sel_hi:[1,1,1]
    v_pk_mul_f32 v[68:69], v[68:69], v[222:223] op_sel:[0,1] op_sel_hi:[1,1]
    v_pk_mul_f32 v[70:71], v[70:71], v[222:223] op_sel:[0,1] op_sel_hi:[1,1]
    v_cvt_pk_bf16_f32 v68, v68, v69
    v_cvt_pk_bf16_f32 v69, v70, v71
    v_lshlrev_b32 v252, 16, v68
    v_and_b32 v253, 0xffff0000, v68
    v_pk_mul_f32 v[248:249], v[252:253], v[252:253]
    v_pk_fma_f32 v[248:249], v[248:249], v[224:225], v[224:225] op_sel:[0,1,0] op_sel_hi:[1,1,0]
    v_pk_mul_f32 v[248:249], v[248:249], v[252:253]
    v_exp_f32 v248, v248
    v_exp_f32 v249, v249
    s_nop 0
    v_pk_add_f32 v[248:249], v[248:249], 1.0 op_sel_hi:[1,0]
    v_rcp_f32 v248, v248
    v_rcp_f32 v249, v249
    s_nop 0
    v_pk_mul_f32 v[252:253], v[252:253], v[248:249]
    v_cvt_pk_bf16_f32 v68, v252, v253
    v_lshlrev_b32 v252, 16, v68
    v_and_b32 v253, 0xffff0000, v68
    v_pk_add_f32 v[244:245], v[244:245], v[252:253]
    v_pk_fma_f32 v[246:247], v[252:253], v[252:253], v[246:247]
    v_lshlrev_b32 v252, 16, v69
    v_and_b32 v253, 0xffff0000, v69
    v_pk_mul_f32 v[248:249], v[252:253], v[252:253]
    v_pk_fma_f32 v[248:249], v[248:249], v[224:225], v[224:225] op_sel:[0,1,0] op_sel_hi:[1,1,0]
    v_pk_mul_f32 v[248:249], v[248:249], v[252:253]
    v_exp_f32 v248, v248
    v_exp_f32 v249, v249
    s_nop 0
    v_pk_add_f32 v[248:249], v[248:249], 1.0 op_sel_hi:[1,0]
    v_rcp_f32 v248, v248
    v_rcp_f32 v249, v249
    s_nop 0
    v_pk_mul_f32 v[252:253], v[252:253], v[248:249]
    v_cvt_pk_bf16_f32 v69, v252, v253
    v_lshlrev_b32 v252, 16, v69
    v_and_b32 v253, 0xffff0000, v69
    v_pk_add_f32 v[244:245], v[244:245], v[252:253]
    v_pk_fma_f32 v[246:247], v[252:253], v[252:253], v[246:247]
    ds_write_b64 v4, v[68:69] offset:192
    v_pk_fma_f32 v[72:73], v[212:213], v[220:221], v[72:73] op_sel:[0,1,0] op_sel_hi:[1,1,1]
    v_pk_fma_f32 v[74:75], v[214:215], v[220:221], v[74:75] op_sel:[0,1,0] op_sel_hi:[1,1,1]
    v_pk_mul_f32 v[72:73], v[72:73], v[222:223] op_sel:[0,1] op_sel_hi:[1,1]
    v_pk_mul_f32 v[74:75], v[74:75], v[222:223] op_sel:[0,1] op_sel_hi:[1,1]
    v_cvt_pk_bf16_f32 v72, v72, v73
    v_cvt_pk_bf16_f32 v73, v74, v75
    v_lshlrev_b32 v252, 16, v72
    v_and_b32 v253, 0xffff0000, v72
    v_pk_mul_f32 v[248:249], v[252:253], v[252:253]
    v_pk_fma_f32 v[248:249], v[248:249], v[224:225], v[224:225] op_sel:[0,1,0] op_sel_hi:[1,1,0]
    v_pk_mul_f32 v[248:249], v[248:249], v[252:253]
    v_exp_f32 v248, v248
    v_exp_f32 v249, v249
    s_nop 0
    v_pk_add_f32 v[248:249], v[248:249], 1.0 op_sel_hi:[1,0]
    v_rcp_f32 v248, v248
    v_rcp_f32 v249, v249
    s_nop 0
    v_pk_mul_f32 v[252:253], v[252:253], v[248:249]
    v_cvt_pk_bf16_f32 v72, v252, v253
    v_lshlrev_b32 v252, 16, v72
    v_and_b32 v253, 0xffff0000, v72
    v_pk_add_f32 v[244:245], v[244:245], v[252:253]
    v_pk_fma_f32 v[246:247], v[252:253], v[252:253], v[246:247]
    v_lshlrev_b32 v252, 16, v73
    v_and_b32 v253, 0xffff0000, v73
    v_pk_mul_f32 v[248:249], v[252:253], v[252:253]
    v_pk_fma_f32 v[248:249], v[248:249], v[224:225], v[224:225] op_sel:[0,1,0] op_sel_hi:[1,1,0]
    v_pk_mul_f32 v[248:249], v[248:249], v[252:253]
    v_exp_f32 v248, v248
    v_exp_f32 v249, v249
    s_nop 0
    v_pk_add_f32 v[248:249], v[248:249], 1.0 op_sel_hi:[1,0]
    v_rcp_f32 v248, v248
    v_rcp_f32 v249, v249
    s_nop 0
    v_pk_mul_f32 v[252:253], v[252:253], v[248:249]
    v_cvt_pk_bf16_f32 v73, v252, v253
    v_lshlrev_b32 v252, 16, v73
    v_and_b32 v253, 0xffff0000, v73
    v_pk_add_f32 v[244:245], v[244:245], v[252:253]
    v_pk_fma_f32 v[246:247], v[252:253], v[252:253], v[246:247]
    ds_write_b64 v4, v[72:73] offset:224
    v_pk_fma_f32 v[76:77], v[216:217], v[220:221], v[76:77] op_sel:[0,1,0] op_sel_hi:[1,1,1]
    v_pk_fma_f32 v[78:79], v[218:219], v[220:221], v[78:79] op_sel:[0,1,0] op_sel_hi:[1,1,1]
    v_pk_mul_f32 v[76:77], v[76:77], v[222:223] op_sel:[0,1] op_sel_hi:[1,1]
    v_pk_mul_f32 v[78:79], v[78:79], v[222:223] op_sel:[0,1] op_sel_hi:[1,1]
    v_cvt_pk_bf16_f32 v76, v76, v77
    v_cvt_pk_bf16_f32 v77, v78, v79
    v_lshlrev_b32 v252, 16, v76
    v_and_b32 v253, 0xffff0000, v76
    v_pk_mul_f32 v[248:249], v[252:253], v[252:253]
    v_pk_fma_f32 v[248:249], v[248:249], v[224:225], v[224:225] op_sel:[0,1,0] op_sel_hi:[1,1,0]
    v_pk_mul_f32 v[248:249], v[248:249], v[252:253]
    v_exp_f32 v248, v248
    v_exp_f32 v249, v249
    s_nop 0
    v_pk_add_f32 v[248:249], v[248:249], 1.0 op_sel_hi:[1,0]
    v_rcp_f32 v248, v248
    v_rcp_f32 v249, v249
    s_nop 0
    v_pk_mul_f32 v[252:253], v[252:253], v[248:249]
    v_cvt_pk_bf16_f32 v76, v252, v253
    v_lshlrev_b32 v252, 16, v76
    v_and_b32 v253, 0xffff0000, v76
    v_pk_add_f32 v[244:245], v[244:245], v[252:253]
    v_pk_fma_f32 v[246:247], v[252:253], v[252:253], v[246:247]
    v_lshlrev_b32 v252, 16, v77
    v_and_b32 v253, 0xffff0000, v77
    v_pk_mul_f32 v[248:249], v[252:253], v[252:253]
    v_pk_fma_f32 v[248:249], v[248:249], v[224:225], v[224:225] op_sel:[0,1,0] op_sel_hi:[1,1,0]
    v_pk_mul_f32 v[248:249], v[248:249], v[252:253]
    v_exp_f32 v248, v248
    v_exp_f32 v249, v249
    s_nop 0
    v_pk_add_f32 v[248:249], v[248:249], 1.0 op_sel_hi:[1,0]
    v_rcp_f32 v248, v248
    v_rcp_f32 v249, v249
    s_nop 0
    v_pk_mul_f32 v[252:253], v[252:253], v[248:249]
    v_cvt_pk_bf16_f32 v77, v252, v253
    v_lshlrev_b32 v252, 16, v77
    v_and_b32 v253, 0xffff0000, v77
    v_pk_add_f32 v[244:245], v[244:245], v[252:253]
    v_pk_fma_f32 v[246:247], v[252:253], v[252:253], v[246:247]
    ds_write_b64 v4, v[76:77] offset:256
    s_waitcnt lgkmcnt(0)
    ds_read_b128 v[44:47], v5 offset:0
    ds_read_b128 v[48:51], v5 offset:1024
    ds_read_b128 v[52:55], v5 offset:2048
    ds_read_b128 v[56:59], v5 offset:3072
    s_mov_b32 exec_hi, 0
    ds_read_b128 v[60:63], v5 offset:4096
    s_mov_b32 exec_hi, -1
    s_waitcnt lgkmcnt(4)
    buffer_store_dwordx4 v[44:47], v226, s[40:43], s69 offen sc1
    s_waitcnt lgkmcnt(3)
    buffer_store_dwordx4 v[48:51], v227, s[40:43], s69 offen sc1
    s_waitcnt lgkmcnt(2)
    buffer_store_dwordx4 v[52:55], v228, s[40:43], s69 offen sc1
    s_waitcnt lgkmcnt(1)
    buffer_store_dwordx4 v[56:59], v229, s[40:43], s69 offen sc1
    s_waitcnt lgkmcnt(0)
    s_mov_b32 exec_hi, 0
    buffer_store_dwordx4 v[60:63], v230, s[40:43], s69 offen sc1
    s_mov_b32 exec_hi, -1
    v_subrev_u32 v226, s60, v226
    v_subrev_u32 v227, s60, v227
    v_subrev_u32 v228, s60, v228
    v_subrev_u32 v229, s60, v229
    v_subrev_u32 v230, s60, v230
    s_cmp_lt_u32 s65, 8
    s_cbranch_scc1 k3_kernel_fs1
    v_add_f32 v236, v240, v241
    v_add_f32 v237, v242, v243
    v_add_f32 v238, v244, v245
    v_add_f32 v239, v246, v247
    ds_bpermute_b32 v248, v2, v236
    ds_bpermute_b32 v249, v2, v237
    ds_bpermute_b32 v250, v2, v238
    ds_bpermute_b32 v251, v2, v239
    s_waitcnt lgkmcnt(0)
    v_add_f32 v236, v236, v248
    v_add_f32 v237, v237, v249
    v_add_f32 v238, v238, v250
    v_add_f32 v239, v239, v251
    ds_bpermute_b32 v248, v3, v236
    ds_bpermute_b32 v249, v3, v237
    ds_bpermute_b32 v250, v3, v238
    ds_bpermute_b32 v251, v3, v239
    s_waitcnt lgkmcnt(0)
    v_add_f32 v236, v236, v248
    v_add_f32 v237, v237, v249
    v_add_f32 v238, v238, v250
    v_add_f32 v239, v239, v251
    v_and_b32 v248, 15, v1
    v_add_u32 v248, s63, v248
    v_lshlrev_b32 v248, 3, v248
    s_mov_b64 exec, 0xffff
    buffer_atomic_add_f32 v236, v248, s[48:51], 0 offen offset:0
    buffer_atomic_add_f32 v237, v248, s[48:51], 0 offen offset:4
    buffer_atomic_add_f32 v238, v248, s[48:51], 0 offen offset:128
    buffer_atomic_add_f32 v239, v248, s[48:51], 0 offen offset:132
    s_mov_b64 exec, -1
k3_kernel_fs1:
k3_kernel_end:
    s_endpgm
.globl kn_kernel
.p2align 8
.type kn_kernel,@function
kn_kernel:
    s_cmp_ge_u32 s2, 256
    s_cbranch_scc1 kn_kernel_end
    s_load_dwordx16 s[4:19], s[0:1], 0
    s_load_dwordx8 s[20:27], s[0:1], 64
    s_waitcnt lgkmcnt(0)
    s_add_u32 s28, s26, 27262976
    s_addc_u32 s29, s27, 0
    s_and_b32 s29, s29, 0xffff
    s_mov_b32 s30, 9437184
    s_mov_b32 s31, 0x00020000
    s_add_u32 s40, s26, 37748736
    s_addc_u32 s41, s27, 0
    s_and_b32 s41, s41, 0xffff
    s_mov_b32 s42, 9437184
    s_mov_b32 s43, 0x00020000
    s_add_u32 s48, s26, 48234496
    s_addc_u32 s49, s27, 0
    s_and_b32 s49, s49, 0xffff
    s_mov_b32 s50, 16384
    s_mov_b32 s51, 0x00020000
    s_mul_i32 s57, s2, 36864
    s_and_b32 s60, s2, 15
    s_lshl_b32 s60, s60, 10
    v_add_u32 v2, 0, v0
    v_lshlrev_b32 v10, 4, v2
    buffer_load_dwordx4 v[40:43], v10, s[28:31], s57 offen
    v_mul_u32_u24 v3, 3641, v2
    v_lshrrev_b32 v3, 16, v3
    v_lshlrev_b32 v3, 3, v3
    buffer_load_dwordx2 v[20:21], v3, s[48:51], s60 offen
    v_add_u32 v2, 256, v0
    v_lshlrev_b32 v11, 4, v2
    buffer_load_dwordx4 v[44:47], v11, s[28:31], s57 offen
    v_mul_u32_u24 v3, 3641, v2
    v_lshrrev_b32 v3, 16, v3
    v_lshlrev_b32 v3, 3, v3
    buffer_load_dwordx2 v[22:23], v3, s[48:51], s60 offen
    v_add_u32 v2, 512, v0
    v_lshlrev_b32 v12, 4, v2
    buffer_load_dwordx4 v[48:51], v12, s[28:31], s57 offen
    v_mul_u32_u24 v3, 3641, v2
    v_lshrrev_b32 v3, 16, v3
    v_lshlrev_b32 v3, 3, v3
    buffer_load_dwordx2 v[24:25], v3, s[48:51], s60 offen
    v_add_u32 v2, 768, v0
    v_lshlrev_b32 v13, 4, v2
    buffer_load_dwordx4 v[52:55], v13, s[28:31], s57 offen
    v_mul_u32_u24 v3, 3641, v2
    v_lshrrev_b32 v3, 16, v3
    v_lshlrev_b32 v3, 3, v3
    buffer_load_dwordx2 v[26:27], v3, s[48:51], s60 offen
    v_add_u32 v2, 1024, v0
    v_lshlrev_b32 v14, 4, v2
    buffer_load_dwordx4 v[56:59], v14, s[28:31], s57 offen
    v_mul_u32_u24 v3, 3641, v2
    v_lshrrev_b32 v3, 16, v3
    v_lshlrev_b32 v3, 3, v3
    buffer_load_dwordx2 v[28:29], v3, s[48:51], s60 offen
    v_add_u32 v2, 1280, v0
    v_lshlrev_b32 v15, 4, v2
    buffer_load_dwordx4 v[60:63], v15, s[28:31], s57 offen
    v_mul_u32_u24 v3, 3641, v2
    v_lshrrev_b32 v3, 16, v3
    v_lshlrev_b32 v3, 3, v3
    buffer_load_dwordx2 v[30:31], v3, s[48:51], s60 offen
    v_add_u32 v2, 1536, v0
    v_lshlrev_b32 v16, 4, v2
    buffer_load_dwordx4 v[64:67], v16, s[28:31], s57 offen
    v_mul_u32_u24 v3, 3641, v2
    v_lshrrev_b32 v3, 16, v3
    v_lshlrev_b32 v3, 3, v3
    buffer_load_dwordx2 v[32:33], v3, s[48:51], s60 offen
    v_add_u32 v2, 1792, v0
    v_lshlrev_b32 v17, 4, v2
    buffer_load_dwordx4 v[68:71], v17, s[28:31], s57 offen
    v_mul_u32_u24 v3, 3641, v2
    v_lshrrev_b32 v3, 16, v3
    v_lshlrev_b32 v3, 3, v3
    buffer_load_dwordx2 v[34:35], v3, s[48:51], s60 offen
    v_add_u32 v2, 2048, v0
    v_lshlrev_b32 v18, 4, v2
    buffer_load_dwordx4 v[72:75], v18, s[28:31], s57 offen
    v_mul_u32_u24 v3, 3641, v2
    v_lshrrev_b32 v3, 16, v3
    v_lshlrev_b32 v3, 3, v3
    buffer_load_dwordx2 v[36:37], v3, s[48:51], s60 offen
    s_waitcnt vmcnt(16)
    v_mul_f32 v6, 0.00043402777777777775, v20
    v_mul_f32 v7, 0.00043402777777777775, v21
    v_fma_f32 v7, -v6, v6, v7
    v_max_f32 v7, 0, v7
    v_cvt_pk_bf16_f32 v4, v6, v6
    v_lshlrev_b32 v6, 16, v4
    v_cvt_pk_bf16_f32 v4, v7, v7
    v_lshlrev_b32 v7, 16, v4
    v_add_f32 v7, 0x3727c5ac, v7
    v_cvt_pk_bf16_f32 v4, v7, v7
    v_lshlrev_b32 v7, 16, v4
    v_sqrt_f32 v7, v7
    s_nop 0
    v_cvt_pk_bf16_f32 v4, v7, v7
    v_lshlrev_b32 v7, 16, v4
    v_rcp_f32 v7, v7
    s_nop 0
    v_lshlrev_b32 v2, 16, v40
    v_and_b32 v3, 0xffff0000, v40
    v_sub_f32 v2, v2, v6
    v_sub_f32 v3, v3, v6
    v_cvt_pk_bf16_f32 v40, v2, v3
    v_lshlrev_b32 v2, 16, v40
    v_and_b32 v3, 0xffff0000, v40
    v_mul_f32 v2, v2, v7
    v_mul_f32 v3, v3, v7
    v_cvt_pk_bf16_f32 v40, v2, v3
    v_lshlrev_b32 v2, 16, v41
    v_and_b32 v3, 0xffff0000, v41
    v_sub_f32 v2, v2, v6
    v_sub_f32 v3, v3, v6
    v_cvt_pk_bf16_f32 v41, v2, v3
    v_lshlrev_b32 v2, 16, v41
    v_and_b32 v3, 0xffff0000, v41
    v_mul_f32 v2, v2, v7
    v_mul_f32 v3, v3, v7
    v_cvt_pk_bf16_f32 v41, v2, v3
    v_lshlrev_b32 v2, 16, v42
    v_and_b32 v3, 0xffff0000, v42
    v_sub_f32 v2, v2, v6
    v_sub_f32 v3, v3, v6
    v_cvt_pk_bf16_f32 v42, v2, v3
    v_lshlrev_b32 v2, 16, v42
    v_and_b32 v3, 0xffff0000, v42
    v_mul_f32 v2, v2, v7
    v_mul_f32 v3, v3, v7
    v_cvt_pk_bf16_f32 v42, v2, v3
    v_lshlrev_b32 v2, 16, v43
    v_and_b32 v3, 0xffff0000, v43
    v_sub_f32 v2, v2, v6
    v_sub_f32 v3, v3, v6
    v_cvt_pk_bf16_f32 v43, v2, v3
    v_lshlrev_b32 v2, 16, v43
    v_and_b32 v3, 0xffff0000, v43
    v_mul_f32 v2, v2, v7
    v_mul_f32 v3, v3, v7
    v_cvt_pk_bf16_f32 v43, v2, v3
    buffer_store_dwordx4 v[40:43], v10, s[40:43], s57 offen sc1
    s_waitcnt vmcnt(15)
    v_mul_f32 v6, 0.00043402777777777775, v22
    v_mul_f32 v7, 0.00043402777777777775, v23
    v_fma_f32 v7, -v6, v6, v7
    v_max_f32 v7, 0, v7
    v_cvt_pk_bf16_f32 v4, v6, v6
    v_lshlrev_b32 v6, 16, v4
    v_cvt_pk_bf16_f32 v4, v7, v7
    v_lshlrev_b32 v7, 16, v4
    v_add_f32 v7, 0x3727c5ac, v7
    v_cvt_pk_bf16_f32 v4, v7, v7
    v_lshlrev_b32 v7, 16, v4
    v_sqrt_f32 v7, v7
    s_nop 0
    v_cvt_pk_bf16_f32 v4, v7, v7
    v_lshlrev_b32 v7, 16, v4
    v_rcp_f32 v7, v7
    s_nop 0
    v_lshlrev_b32 v2, 16, v44
    v_and_b32 v3, 0xffff0000, v44
    v_sub_f32 v2, v2, v6
    v_sub_f32 v3, v3, v6
    v_cvt_pk_bf16_f32 v44, v2, v3
    v_lshlrev_b32 v2, 16, v44
    v_and_b32 v3, 0xffff0000, v44
    v_mul_f32 v2, v2, v7
    v_mul_f32 v3, v3, v7
    v_cvt_pk_bf16_f32 v44, v2, v3
    v_lshlrev_b32 v2, 16, v45
    v_and_b32 v3, 0xffff0000, v45
    v_sub_f32 v2, v2, v6
    v_sub_f32 v3, v3, v6
    v_cvt_pk_bf16_f32 v45, v2, v3
    v_lshlrev_b32 v2, 16, v45
    v_and_b32 v3, 0xffff0000, v45
    v_mul_f32 v2, v2, v7
    v_mul_f32 v3, v3, v7
    v_cvt_pk_bf16_f32 v45, v2, v3
    v_lshlrev_b32 v2, 16, v46
    v_and_b32 v3, 0xffff0000, v46
    v_sub_f32 v2, v2, v6
    v_sub_f32 v3, v3, v6
    v_cvt_pk_bf16_f32 v46, v2, v3
    v_lshlrev_b32 v2, 16, v46
    v_and_b32 v3, 0xffff0000, v46
    v_mul_f32 v2, v2, v7
    v_mul_f32 v3, v3, v7
    v_cvt_pk_bf16_f32 v46, v2, v3
    v_lshlrev_b32 v2, 16, v47
    v_and_b32 v3, 0xffff0000, v47
    v_sub_f32 v2, v2, v6
    v_sub_f32 v3, v3, v6
    v_cvt_pk_bf16_f32 v47, v2, v3
    v_lshlrev_b32 v2, 16, v47
    v_and_b32 v3, 0xffff0000, v47
    v_mul_f32 v2, v2, v7
    v_mul_f32 v3, v3, v7
    v_cvt_pk_bf16_f32 v47, v2, v3
    buffer_store_dwordx4 v[44:47], v11, s[40:43], s57 offen sc1
    s_waitcnt vmcnt(14)
    v_mul_f32 v6, 0.00043402777777777775, v24
    v_mul_f32 v7, 0.00043402777777777775, v25
    v_fma_f32 v7, -v6, v6, v7
    v_max_f32 v7, 0, v7
    v_cvt_pk_bf16_f32 v4, v6, v6
    v_lshlrev_b32 v6, 16, v4
    v_cvt_pk_bf16_f32 v4, v7, v7
    v_lshlrev_b32 v7, 16, v4
    v_add_f32 v7, 0x3727c5ac, v7
    v_cvt_pk_bf16_f32 v4, v7, v7
    v_lshlrev_b32 v7, 16, v4
    v_sqrt_f32 v7, v7
    s_nop 0
    v_cvt_pk_bf16_f32 v4, v7, v7
    v_lshlrev_b32 v7, 16, v4
    v_rcp_f32 v7, v7
    s_nop 0
    v_lshlrev_b32 v2, 16, v48
    v_and_b32 v3, 0xffff0000, v48
    v_sub_f32 v2, v2, v6
    v_sub_f32 v3, v3, v6
    v_cvt_pk_bf16_f32 v48, v2, v3
    v_lshlrev_b32 v2, 16, v48
    v_and_b32 v3, 0xffff0000, v48
    v_mul_f32 v2, v2, v7
    v_mul_f32 v3, v3, v7
    v_cvt_pk_bf16_f32 v48, v2, v3
    v_lshlrev_b32 v2, 16, v49
    v_and_b32 v3, 0xffff0000, v49
    v_sub_f32 v2, v2, v6
    v_sub_f32 v3, v3, v6
    v_cvt_pk_bf16_f32 v49, v2, v3
    v_lshlrev_b32 v2, 16, v49
    v_and_b32 v3, 0xffff0000, v49
    v_mul_f32 v2, v2, v7
    v_mul_f32 v3, v3, v7
    v_cvt_pk_bf16_f32 v49, v2, v3
    v_lshlrev_b32 v2, 16, v50
    v_and_b32 v3, 0xffff0000, v50
    v_sub_f32 v2, v2, v6
    v_sub_f32 v3, v3, v6
    v_cvt_pk_bf16_f32 v50, v2, v3
    v_lshlrev_b32 v2, 16, v50
    v_and_b32 v3, 0xffff0000, v50
    v_mul_f32 v2, v2, v7
    v_mul_f32 v3, v3, v7
    v_cvt_pk_bf16_f32 v50, v2, v3
    v_lshlrev_b32 v2, 16, v51
    v_and_b32 v3, 0xffff0000, v51
    v_sub_f32 v2, v2, v6
    v_sub_f32 v3, v3, v6
    v_cvt_pk_bf16_f32 v51, v2, v3
    v_lshlrev_b32 v2, 16, v51
    v_and_b32 v3, 0xffff0000, v51
    v_mul_f32 v2, v2, v7
    v_mul_f32 v3, v3, v7
    v_cvt_pk_bf16_f32 v51, v2, v3
    buffer_store_dwordx4 v[48:51], v12, s[40:43], s57 offen sc1
    s_waitcnt vmcnt(13)
    v_mul_f32 v6, 0.00043402777777777775, v26
    v_mul_f32 v7, 0.00043402777777777775, v27
    v_fma_f32 v7, -v6, v6, v7
    v_max_f32 v7, 0, v7
    v_cvt_pk_bf16_f32 v4, v6, v6
    v_lshlrev_b32 v6, 16, v4
    v_cvt_pk_bf16_f32 v4, v7, v7
    v_lshlrev_b32 v7, 16, v4
    v_add_f32 v7, 0x3727c5ac, v7
    v_cvt_pk_bf16_f32 v4, v7, v7
    v_lshlrev_b32 v7, 16, v4
    v_sqrt_f32 v7, v7
    s_nop 0
    v_cvt_pk_bf16_f32 v4, v7, v7
    v_lshlrev_b32 v7, 16, v4
    v_rcp_f32 v7, v7
    s_nop 0
    v_lshlrev_b32 v2, 16, v52
    v_and_b32 v3, 0xffff0000, v52
    v_sub_f32 v2, v2, v6
    v_sub_f32 v3, v3, v6
    v_cvt_pk_bf16_f32 v52, v2, v3
    v_lshlrev_b32 v2, 16, v52
    v_and_b32 v3, 0xffff0000, v52
    v_mul_f32 v2, v2, v7
    v_mul_f32 v3, v3, v7
    v_cvt_pk_bf16_f32 v52, v2, v3
    v_lshlrev_b32 v2, 16, v53
    v_and_b32 v3, 0xffff0000, v53
    v_sub_f32 v2, v2, v6
    v_sub_f32 v3, v3, v6
    v_cvt_pk_bf16_f32 v53, v2, v3
    v_lshlrev_b32 v2, 16, v53
    v_and_b32 v3, 0xffff0000, v53
    v_mul_f32 v2, v2, v7
    v_mul_f32 v3, v3, v7
    v_cvt_pk_bf16_f32 v53, v2, v3
    v_lshlrev_b32 v2, 16, v54
    v_and_b32 v3, 0xffff0000, v54
    v_sub_f32 v2, v2, v6
    v_sub_f32 v3, v3, v6
    v_cvt_pk_bf16_f32 v54, v2, v3
    v_lshlrev_b32 v2, 16, v54
    v_and_b32 v3, 0xffff0000, v54
    v_mul_f32 v2, v2, v7
    v_mul_f32 v3, v3, v7
    v_cvt_pk_bf16_f32 v54, v2, v3
    v_lshlrev_b32 v2, 16, v55
    v_and_b32 v3, 0xffff0000, v55
    v_sub_f32 v2, v2, v6
    v_sub_f32 v3, v3, v6
    v_cvt_pk_bf16_f32 v55, v2, v3
    v_lshlrev_b32 v2, 16, v55
    v_and_b32 v3, 0xffff0000, v55
    v_mul_f32 v2, v2, v7
    v_mul_f32 v3, v3, v7
    v_cvt_pk_bf16_f32 v55, v2, v3
    buffer_store_dwordx4 v[52:55], v13, s[40:43], s57 offen sc1
    s_waitcnt vmcnt(12)
    v_mul_f32 v6, 0.00043402777777777775, v28
    v_mul_f32 v7, 0.00043402777777777775, v29
    v_fma_f32 v7, -v6, v6, v7
    v_max_f32 v7, 0, v7
    v_cvt_pk_bf16_f32 v4, v6, v6
    v_lshlrev_b32 v6, 16, v4
    v_cvt_pk_bf16_f32 v4, v7, v7
    v_lshlrev_b32 v7, 16, v4
    v_add_f32 v7, 0x3727c5ac, v7
    v_cvt_pk_bf16_f32 v4, v7, v7
    v_lshlrev_b32 v7, 16, v4
    v_sqrt_f32 v7, v7
    s_nop 0
    v_cvt_pk_bf16_f32 v4, v7, v7
    v_lshlrev_b32 v7, 16, v4
    v_rcp_f32 v7, v7
    s_nop 0
    v_lshlrev_b32 v2, 16, v56
    v_and_b32 v3, 0xffff0000, v56
    v_sub_f32 v2, v2, v6
    v_sub_f32 v3, v3, v6
    v_cvt_pk_bf16_f32 v56, v2, v3
    v_lshlrev_b32 v2, 16, v56
    v_and_b32 v3, 0xffff0000, v56
    v_mul_f32 v2, v2, v7
    v_mul_f32 v3, v3, v7
    v_cvt_pk_bf16_f32 v56, v2, v3
    v_lshlrev_b32 v2, 16, v57
    v_and_b32 v3, 0xffff0000, v57
    v_sub_f32 v2, v2, v6
    v_sub_f32 v3, v3, v6
    v_cvt_pk_bf16_f32 v57, v2, v3
    v_lshlrev_b32 v2, 16, v57
    v_and_b32 v3, 0xffff0000, v57
    v_mul_f32 v2, v2, v7
    v_mul_f32 v3, v3, v7
    v_cvt_pk_bf16_f32 v57, v2, v3
    v_lshlrev_b32 v2, 16, v58
    v_and_b32 v3, 0xffff0000, v58
    v_sub_f32 v2, v2, v6
    v_sub_f32 v3, v3, v6
    v_cvt_pk_bf16_f32 v58, v2, v3
    v_lshlrev_b32 v2, 16, v58
    v_and_b32 v3, 0xffff0000, v58
    v_mul_f32 v2, v2, v7
    v_mul_f32 v3, v3, v7
    v_cvt_pk_bf16_f32 v58, v2, v3
    v_lshlrev_b32 v2, 16, v59
    v_and_b32 v3, 0xffff0000, v59
    v_sub_f32 v2, v2, v6
    v_sub_f32 v3, v3, v6
    v_cvt_pk_bf16_f32 v59, v2, v3
    v_lshlrev_b32 v2, 16, v59
    v_and_b32 v3, 0xffff0000, v59
    v_mul_f32 v2, v2, v7
    v_mul_f32 v3, v3, v7
    v_cvt_pk_bf16_f32 v59, v2, v3
    buffer_store_dwordx4 v[56:59], v14, s[40:43], s57 offen sc1
    s_waitcnt vmcnt(11)
    v_mul_f32 v6, 0.00043402777777777775, v30
    v_mul_f32 v7, 0.00043402777777777775, v31
    v_fma_f32 v7, -v6, v6, v7
    v_max_f32 v7, 0, v7
    v_cvt_pk_bf16_f32 v4, v6, v6
    v_lshlrev_b32 v6, 16, v4
    v_cvt_pk_bf16_f32 v4, v7, v7
    v_lshlrev_b32 v7, 16, v4
    v_add_f32 v7, 0x3727c5ac, v7
    v_cvt_pk_bf16_f32 v4, v7, v7
    v_lshlrev_b32 v7, 16, v4
    v_sqrt_f32 v7, v7
    s_nop 0
    v_cvt_pk_bf16_f32 v4, v7, v7
    v_lshlrev_b32 v7, 16, v4
    v_rcp_f32 v7, v7
    s_nop 0
    v_lshlrev_b32 v2, 16, v60
    v_and_b32 v3, 0xffff0000, v60
    v_sub_f32 v2, v2, v6
    v_sub_f32 v3, v3, v6
    v_cvt_pk_bf16_f32 v60, v2, v3
    v_lshlrev_b32 v2, 16, v60
    v_and_b32 v3, 0xffff0000, v60
    v_mul_f32 v2, v2, v7
    v_mul_f32 v3, v3, v7
    v_cvt_pk_bf16_f32 v60, v2, v3
    v_lshlrev_b32 v2, 16, v61
    v_and_b32 v3, 0xffff0000, v61
    v_sub_f32 v2, v2, v6
    v_sub_f32 v3, v3, v6
    v_cvt_pk_bf16_f32 v61, v2, v3
    v_lshlrev_b32 v2, 16, v61
    v_and_b32 v3, 0xffff0000, v61
    v_mul_f32 v2, v2, v7
    v_mul_f32 v3, v3, v7
    v_cvt_pk_bf16_f32 v61, v2, v3
    v_lshlrev_b32 v2, 16, v62
    v_and_b32 v3, 0xffff0000, v62
    v_sub_f32 v2, v2, v6
    v_sub_f32 v3, v3, v6
    v_cvt_pk_bf16_f32 v62, v2, v3
    v_lshlrev_b32 v2, 16, v62
    v_and_b32 v3, 0xffff0000, v62
    v_mul_f32 v2, v2, v7
    v_mul_f32 v3, v3, v7
    v_cvt_pk_bf16_f32 v62, v2, v3
    v_lshlrev_b32 v2, 16, v63
    v_and_b32 v3, 0xffff0000, v63
    v_sub_f32 v2, v2, v6
    v_sub_f32 v3, v3, v6
    v_cvt_pk_bf16_f32 v63, v2, v3
    v_lshlrev_b32 v2, 16, v63
    v_and_b32 v3, 0xffff0000, v63
    v_mul_f32 v2, v2, v7
    v_mul_f32 v3, v3, v7
    v_cvt_pk_bf16_f32 v63, v2, v3
    buffer_store_dwordx4 v[60:63], v15, s[40:43], s57 offen sc1
    s_waitcnt vmcnt(10)
    v_mul_f32 v6, 0.00043402777777777775, v32
    v_mul_f32 v7, 0.00043402777777777775, v33
    v_fma_f32 v7, -v6, v6, v7
    v_max_f32 v7, 0, v7
    v_cvt_pk_bf16_f32 v4, v6, v6
    v_lshlrev_b32 v6, 16, v4
    v_cvt_pk_bf16_f32 v4, v7, v7
    v_lshlrev_b32 v7, 16, v4
    v_add_f32 v7, 0x3727c5ac, v7
    v_cvt_pk_bf16_f32 v4, v7, v7
    v_lshlrev_b32 v7, 16, v4
    v_sqrt_f32 v7, v7
    s_nop 0
    v_cvt_pk_bf16_f32 v4, v7, v7
    v_lshlrev_b32 v7, 16, v4
    v_rcp_f32 v7, v7
    s_nop 0
    v_lshlrev_b32 v2, 16, v64
    v_and_b32 v3, 0xffff0000, v64
    v_sub_f32 v2, v2, v6
    v_sub_f32 v3, v3, v6
    v_cvt_pk_bf16_f32 v64, v2, v3
    v_lshlrev_b32 v2, 16, v64
    v_and_b32 v3, 0xffff0000, v64
    v_mul_f32 v2, v2, v7
    v_mul_f32 v3, v3, v7
    v_cvt_pk_bf16_f32 v64, v2, v3
    v_lshlrev_b32 v2, 16, v65
    v_and_b32 v3, 0xffff0000, v65
    v_sub_f32 v2, v2, v6
    v_sub_f32 v3, v3, v6
    v_cvt_pk_bf16_f32 v65, v2, v3
    v_lshlrev_b32 v2, 16, v65
    v_and_b32 v3, 0xffff0000, v65
    v_mul_f32 v2, v2, v7
    v_mul_f32 v3, v3, v7
    v_cvt_pk_bf16_f32 v65, v2, v3
    v_lshlrev_b32 v2, 16, v66
    v_and_b32 v3, 0xffff0000, v66
    v_sub_f32 v2, v2, v6
    v_sub_f32 v3, v3, v6
    v_cvt_pk_bf16_f32 v66, v2, v3
    v_lshlrev_b32 v2, 16, v66
    v_and_b32 v3, 0xffff0000, v66
    v_mul_f32 v2, v2, v7
    v_mul_f32 v3, v3, v7
    v_cvt_pk_bf16_f32 v66, v2, v3
    v_lshlrev_b32 v2, 16, v67
    v_and_b32 v3, 0xffff0000, v67
    v_sub_f32 v2, v2, v6
    v_sub_f32 v3, v3, v6
    v_cvt_pk_bf16_f32 v67, v2, v3
    v_lshlrev_b32 v2, 16, v67
    v_and_b32 v3, 0xffff0000, v67
    v_mul_f32 v2, v2, v7
    v_mul_f32 v3, v3, v7
    v_cvt_pk_bf16_f32 v67, v2, v3
    buffer_store_dwordx4 v[64:67], v16, s[40:43], s57 offen sc1
    s_waitcnt vmcnt(9)
    v_mul_f32 v6, 0.00043402777777777775, v34
    v_mul_f32 v7, 0.00043402777777777775, v35
    v_fma_f32 v7, -v6, v6, v7
    v_max_f32 v7, 0, v7
    v_cvt_pk_bf16_f32 v4, v6, v6
    v_lshlrev_b32 v6, 16, v4
    v_cvt_pk_bf16_f32 v4, v7, v7
    v_lshlrev_b32 v7, 16, v4
    v_add_f32 v7, 0x3727c5ac, v7
    v_cvt_pk_bf16_f32 v4, v7, v7
    v_lshlrev_b32 v7, 16, v4
    v_sqrt_f32 v7, v7
    s_nop 0
    v_cvt_pk_bf16_f32 v4, v7, v7
    v_lshlrev_b32 v7, 16, v4
    v_rcp_f32 v7, v7
    s_nop 0
    v_lshlrev_b32 v2, 16, v68
    v_and_b32 v3, 0xffff0000, v68
    v_sub_f32 v2, v2, v6
    v_sub_f32 v3, v3, v6
    v_cvt_pk_bf16_f32 v68, v2, v3
    v_lshlrev_b32 v2, 16, v68
    v_and_b32 v3, 0xffff0000, v68
    v_mul_f32 v2, v2, v7
    v_mul_f32 v3, v3, v7
    v_cvt_pk_bf16_f32 v68, v2, v3
    v_lshlrev_b32 v2, 16, v69
    v_and_b32 v3, 0xffff0000, v69
    v_sub_f32 v2, v2, v6
    v_sub_f32 v3, v3, v6
    v_cvt_pk_bf16_f32 v69, v2, v3
    v_lshlrev_b32 v2, 16, v69
    v_and_b32 v3, 0xffff0000, v69
    v_mul_f32 v2, v2, v7
    v_mul_f32 v3, v3, v7
    v_cvt_pk_bf16_f32 v69, v2, v3
    v_lshlrev_b32 v2, 16, v70
    v_and_b32 v3, 0xffff0000, v70
    v_sub_f32 v2, v2, v6
    v_sub_f32 v3, v3, v6
    v_cvt_pk_bf16_f32 v70, v2, v3
    v_lshlrev_b32 v2, 16, v70
    v_and_b32 v3, 0xffff0000, v70
    v_mul_f32 v2, v2, v7
    v_mul_f32 v3, v3, v7
    v_cvt_pk_bf16_f32 v70, v2, v3
    v_lshlrev_b32 v2, 16, v71
    v_and_b32 v3, 0xffff0000, v71
    v_sub_f32 v2, v2, v6
    v_sub_f32 v3, v3, v6
    v_cvt_pk_bf16_f32 v71, v2, v3
    v_lshlrev_b32 v2, 16, v71
    v_and_b32 v3, 0xffff0000, v71
    v_mul_f32 v2, v2, v7
    v_mul_f32 v3, v3, v7
    v_cvt_pk_bf16_f32 v71, v2, v3
    buffer_store_dwordx4 v[68:71], v17, s[40:43], s57 offen sc1
    s_waitcnt vmcnt(8)
    v_mul_f32 v6, 0.00043402777777777775, v36
    v_mul_f32 v7, 0.00043402777777777775, v37
    v_fma_f32 v7, -v6, v6, v7
    v_max_f32 v7, 0, v7
    v_cvt_pk_bf16_f32 v4, v6, v6
    v_lshlrev_b32 v6, 16, v4
    v_cvt_pk_bf16_f32 v4, v7, v7
    v_lshlrev_b32 v7, 16, v4
    v_add_f32 v7, 0x3727c5ac, v7
    v_cvt_pk_bf16_f32 v4, v7, v7
    v_lshlrev_b32 v7, 16, v4
    v_sqrt_f32 v7, v7
    s_nop 0
    v_cvt_pk_bf16_f32 v4, v7, v7
    v_lshlrev_b32 v7, 16, v4
    v_rcp_f32 v7, v7
    s_nop 0
    v_lshlrev_b32 v2, 16, v72
    v_and_b32 v3, 0xffff0000, v72
    v_sub_f32 v2, v2, v6
    v_sub_f32 v3, v3, v6
    v_cvt_pk_bf16_f32 v72, v2, v3
    v_lshlrev_b32 v2, 16, v72
    v_and_b32 v3, 0xffff0000, v72
    v_mul_f32 v2, v2, v7
    v_mul_f32 v3, v3, v7
    v_cvt_pk_bf16_f32 v72, v2, v3
    v_lshlrev_b32 v2, 16, v73
    v_and_b32 v3, 0xffff0000, v73
    v_sub_f32 v2, v2, v6
    v_sub_f32 v3, v3, v6
    v_cvt_pk_bf16_f32 v73, v2, v3
    v_lshlrev_b32 v2, 16, v73
    v_and_b32 v3, 0xffff0000, v73
    v_mul_f32 v2, v2, v7
    v_mul_f32 v3, v3, v7
    v_cvt_pk_bf16_f32 v73, v2, v3
    v_lshlrev_b32 v2, 16, v74
    v_and_b32 v3, 0xffff0000, v74
    v_sub_f32 v2, v2, v6
    v_sub_f32 v3, v3, v6
    v_cvt_pk_bf16_f32 v74, v2, v3
    v_lshlrev_b32 v2, 16, v74
    v_and_b32 v3, 0xffff0000, v74
    v_mul_f32 v2, v2, v7
    v_mul_f32 v3, v3, v7
    v_cvt_pk_bf16_f32 v74, v2, v3
    v_lshlrev_b32 v2, 16, v75
    v_and_b32 v3, 0xffff0000, v75
    v_sub_f32 v2, v2, v6
    v_sub_f32 v3, v3, v6
    v_cvt_pk_bf16_f32 v75, v2, v3
    v_lshlrev_b32 v2, 16, v75
    v_and_b32 v3, 0xffff0000, v75
    v_mul_f32 v2, v2, v7
    v_mul_f32 v3, v3, v7
    v_cvt_pk_bf16_f32 v75, v2, v3
    buffer_store_dwordx4 v[72:75], v18, s[40:43], s57 offen sc1
kn_kernel_end:
    s_endpgm
.globl k4_kernel
.p2align 8
.type k4_kernel,@function
k4_kernel:
    s_cmp_ge_u32 s2, 256
    s_cbranch_scc1 k4_kernel_end
    s_load_dwordx16 s[4:19], s[0:1], 0
    s_load_dwordx8 s[20:27], s[0:1], 64
    v_and_b32 v1, 63, v0
    v_lshrrev_b32 v2, 6, v0
    s_nop 0
    v_readfirstlane_b32 s72, v2
    s_and_b32 s52, s72, 3
    s_lshr_b32 s72, s72, 2
    s_and_b32 s60, s2, 7
    s_lshr_b32 s61, s2, 3
    s_and_b32 s57, s60, 3
    s_lshl_b32 s57, s57, 2
    s_and_b32 s71, s61, 3
    s_add_u32 s57, s57, s71
    s_lshl_b32 s57, s57, 7
    s_lshr_b32 s58, s60, 2
    s_lshl_b32 s58, s58, 3
    s_lshr_b32 s62, s61, 2
    s_add_u32 s58, s58, s62
    s_mul_i32 s58, s58, 144
    s_mul_i32 s71, s71, 2
    s_mul_i32 s62, s62, 1
    s_add_u32 s71, s71, s62
    s_waitcnt lgkmcnt(0)
    s_mov_b32 s28, s16
    s_and_b32 s29, s17, 0xffff
    s_mov_b32 s30, 8388608
    s_mov_b32 s31, 0x00020000
    s_add_u32 s32, s26, 37748736
    s_addc_u32 s33, s27, 0
    s_and_b32 s33, s33, 0xffff
    s_mov_b32 s34, 9437184
    s_mov_b32 s35, 0x00020000
    s_add_u32 s48, s26, 48234496
    s_addc_u32 s49, s27, 0
    s_and_b32 s49, s49, 0xffff
    s_mov_b32 s50, 16384
    s_mov_b32 s51, 0x00020000
    s_add_u32 s36, s26, 16777216
    s_addc_u32 s37, s27, 0
    s_and_b32 s37, s37, 0xffff
    s_mov_b32 s38, 9437184
    s_mov_b32 s39, 0x00020000
    s_add_u32 s40, s26, 50331648
    s_addc_u32 s41, s27, 0
    s_and_b32 s41, s41, 0xffff
    s_mov_b32 s42, 9437184
    s_mov_b32 s43, 0x00020000
    s_mov_b32 s44, s18
    s_and_b32 s45, s19, 0xffff
    s_mov_b32 s46, 4096
    s_mov_b32 s47, 0x00020000
    s_mul_i32 s63, s52, 32
    s_add_u32 s63, s63, s57
    s_lshl_b32 s64, s58, 1
    s_mul_i32 s65, s58, 4096
    s_mul_i32 s53, s52, 4608
    s_add_u32 s53, s53, 65536
    s_lshl_b32 s60, s52, 4
    v_add_u32 v2, 0, v1
    v_mul_u32_u24 v3, 3641, v2
    v_lshrrev_b32 v3, 16, v3
    v_mul_u32_u24 v4, 18, v3
    v_sub_u32 v2, v2, v4
    v_and_b32 v4, 3, v3
    v_and_b32 v5, 4, v3
    v_lshl_or_b32 v4, v5, 1, v4
    v_and_b32 v5, 8, v3
    v_lshrrev_b32 v5, 1, v5
    v_or_b32 v4, v4, v5
    v_add_u32 v4, s60, v4
    s_mov_b32 s61, 288
    v_mul_lo_u32 v4, v4, s61
    v_lshlrev_b32 v2, 4, v2
    v_add_u32 v80, v4, v2
    v_add_u32 v80, s65, v80
    v_add_u32 v2, 64, v1
    v_mul_u32_u24 v3, 3641, v2
    v_lshrrev_b32 v3, 16, v3
    v_mul_u32_u24 v4, 18, v3
    v_sub_u32 v2, v2, v4
    v_and_b32 v4, 3, v3
    v_and_b32 v5, 4, v3
    v_lshl_or_b32 v4, v5, 1, v4
    v_and_b32 v5, 8, v3
    v_lshrrev_b32 v5, 1, v5
    v_or_b32 v4, v4, v5
    v_add_u32 v4, s60, v4
    s_mov_b32 s61, 288
    v_mul_lo_u32 v4, v4, s61
    v_lshlrev_b32 v2, 4, v2
    v_add_u32 v81, v4, v2
    v_add_u32 v81, s65, v81
    v_add_u32 v2, 128, v1
    v_mul_u32_u24 v3, 3641, v2
    v_lshrrev_b32 v3, 16, v3
    v_mul_u32_u24 v4, 18, v3
    v_sub_u32 v2, v2, v4
    v_and_b32 v4, 3, v3
    v_and_b32 v5, 4, v3
    v_lshl_or_b32 v4, v5, 1, v4
    v_and_b32 v5, 8, v3
    v_lshrrev_b32 v5, 1, v5
    v_or_b32 v4, v4, v5
    v_add_u32 v4, s60, v4
    s_mov_b32 s61, 288
    v_mul_lo_u32 v4, v4, s61
    v_lshlrev_b32 v2, 4, v2
    v_add_u32 v82, v4, v2
    v_add_u32 v82, s65, v82
    v_add_u32 v2, 192, v1
    v_mul_u32_u24 v3, 3641, v2
    v_lshrrev_b32 v3, 16, v3
    v_mul_u32_u24 v4, 18, v3
    v_sub_u32 v2, v2, v4
    v_and_b32 v4, 3, v3
    v_and_b32 v5, 4, v3
    v_lshl_or_b32 v4, v5, 1, v4
    v_and_b32 v5, 8, v3
    v_lshrrev_b32 v5, 1, v5
    v_or_b32 v4, v4, v5
    v_add_u32 v4, s60, v4
    s_mov_b32 s61, 288
    v_mul_lo_u32 v4, v4, s61
    v_lshlrev_b32 v2, 4, v2
    v_add_u32 v83, v4, v2
    v_add_u32 v83, s65, v83
    v_add_u32 v2, 256, v1
    v_mul_u32_u24 v3, 3641, v2
    v_lshrrev_b32 v3, 16, v3
    v_mul_u32_u24 v4, 18, v3
    v_sub_u32 v2, v2, v4
    v_and_b32 v4, 3, v3
    v_and_b32 v5, 4, v3
    v_lshl_or_b32 v4, v5, 1, v4
    v_and_b32 v5, 8, v3
    v_lshrrev_b32 v5, 1, v5
    v_or_b32 v4, v4, v5
    v_add_u32 v4, s60, v4
    s_mov_b32 s61, 288
    v_mul_lo_u32 v4, v4, s61
    v_lshlrev_b32 v2, 4, v2
    v_add_u32 v84, v4, v2
    v_add_u32 v84, s65, v84
    v_lshrrev_b32 v2, 5, v1
    v_lshlrev_b32 v2, 4, v2
    v_bfe_u32 v3, v1, 4, 1
    v_lshl_or_b32 v2, v3, 2, v2
    v_bfe_u32 v3, v1, 2, 2
    v_add_u32 v2, v2, v3
    v_mul_u32_u24 v2, 288, v2
    v_and_b32 v3, 3, v1
    v_lshl_add_u32 v2, v3, 3, v2
    v_add_u32 v85, 65536, v2
    v_add_u32 v86, 83968, v2
    v_add_u32 v87, 102400, v2
    v_add_u32 v88, 120832, v2
    s_mul_i32 s59, s52, 4096
    v_lshrrev_b32 v2, 3, v1
    v_and_b32 v3, 7, v1
    v_xor_b32 v3, v3, v2
    v_add_u32 v2, s63, v2
    s_mov_b32 s60, 4096
    v_mul_lo_u32 v2, v2, s60
    v_lshl_add_u32 v2, v3, 4, v2
    v_add_u32 v89, 0, v2
    v_add_u32 v90, 32768, v2
    v_add_u32 v91, 65536, v2
    v_add_u32 v92, 98304, v2
    v_and_b32 v2, 15, v1
    v_lshrrev_b32 v3, 4, v1
    v_and_b32 v4, 7, v1
    v_xor_b32 v3, v3, v4
    v_lshlrev_b32 v3, 4, v3
    v_lshl_add_u32 v2, v2, 7, v3
    v_add_u32 v93, s59, v2
    v_xor_b32 v94, 64, v93
    s_mov_b32 s70, 0
    s_and_b32 s55, s71, 7
    s_mul_i32 s54, s55, 18432
    s_lshl_b32 s55, s55, 7
    s_cmp_eq_u32 s72, 0
    s_cbranch_scc1 k4_kernel_comp
    s_add_u32 m0, s59, 0
    s_nop 0
    buffer_load_dwordx4 v89, s[28:31], s55 offen lds
    s_add_u32 m0, s59, 1024
    s_nop 0
    buffer_load_dwordx4 v90, s[28:31], s55 offen lds
    s_add_u32 m0, s59, 2048
    s_nop 0
    buffer_load_dwordx4 v91, s[28:31], s55 offen lds
    s_add_u32 m0, s59, 3072
    s_nop 0
    buffer_load_dwordx4 v92, s[28:31], s55 offen lds
    s_add_u32 m0, s53, 0
    s_nop 0
    buffer_load_dwordx4 v80, s[32:35], s54 offen lds
    s_add_u32 m0, s53, 1024
    s_nop 0
    buffer_load_dwordx4 v81, s[32:35], s54 offen lds
    s_add_u32 m0, s53, 2048
    s_nop 0
    buffer_load_dwordx4 v82, s[32:35], s54 offen lds
    s_add_u32 m0, s53, 3072
    s_nop 0
    buffer_load_dwordx4 v83, s[32:35], s54 offen lds
    s_add_u32 m0, s53, 4096
    s_nop 0
    s_mov_b32 exec_hi, 0
    buffer_load_dwordx4 v84, s[32:35], s54 offen lds
    s_mov_b32 exec_hi, -1
    s_add_u32 s70, s70, 1
    s_add_u32 s55, s70, s71
    s_and_b32 s55, s55, 7
    s_and_b32 s54, s70, 65528
    s_or_b32 s55, s55, s54
    s_mul_i32 s54, s55, 18432
    s_lshl_b32 s55, s55, 7
    s_add_u32 m0, s59, 16384
    s_nop 0
    buffer_load_dwordx4 v89, s[28:31], s55 offen lds
    s_add_u32 m0, s59, 17408
    s_nop 0
    buffer_load_dwordx4 v90, s[28:31], s55 offen lds
    s_add_u32 m0, s59, 18432
    s_nop 0
    buffer_load_dwordx4 v91, s[28:31], s55 offen lds
    s_add_u32 m0, s59, 19456
    s_nop 0
    buffer_load_dwordx4 v92, s[28:31], s55 offen lds
    s_add_u32 m0, s53, 18432
    s_nop 0
    buffer_load_dwordx4 v80, s[32:35], s54 offen lds
    s_add_u32 m0, s53, 19456
    s_nop 0
    buffer_load_dwordx4 v81, s[32:35], s54 offen lds
    s_add_u32 m0, s53, 20480
    s_nop 0
    buffer_load_dwordx4 v82, s[32:35], s54 offen lds
    s_add_u32 m0, s53, 21504
    s_nop 0
    buffer_load_dwordx4 v83, s[32:35], s54 offen lds
    s_add_u32 m0, s53, 22528
    s_nop 0
    s_mov_b32 exec_hi, 0
    buffer_load_dwordx4 v84, s[32:35], s54 offen lds
    s_mov_b32 exec_hi, -1
    s_add_u32 s70, s70, 1
    s_add_u32 s55, s70, s71
    s_and_b32 s55, s55, 7
    s_and_b32 s54, s70, 65528
    s_or_b32 s55, s55, s54
    s_mul_i32 s54, s55, 18432
    s_lshl_b32 s55, s55, 7
    s_add_u32 m0, s59, 32768
    s_nop 0
    buffer_load_dwordx4 v89, s[28:31], s55 offen lds
    s_add_u32 m0, s59, 33792
    s_nop 0
    buffer_load_dwordx4 v90, s[28:31], s55 offen lds
    s_add_u32 m0, s59, 34816
    s_nop 0
    buffer_load_dwordx4 v91, s[28:31], s55 offen lds
    s_add_u32 m0, s59, 35840
    s_nop 0
    buffer_load_dwordx4 v92, s[28:31], s55 offen lds
    s_add_u32 m0, s53, 36864
    s_nop 0
    buffer_load_dwordx4 v80, s[32:35], s54 offen lds
    s_add_u32 m0, s53, 37888
    s_nop 0
    buffer_load_dwordx4 v81, s[32:35], s54 offen lds
    s_add_u32 m0, s53, 38912
    s_nop 0
    buffer_load_dwordx4 v82, s[32:35], s54 offen lds
    s_add_u32 m0, s53, 39936
    s_nop 0
    buffer_load_dwordx4 v83, s[32:35], s54 offen lds
    s_add_u32 m0, s53, 40960
    s_nop 0
    s_mov_b32 exec_hi, 0
    buffer_load_dwordx4 v84, s[32:35], s54 offen lds
    s_mov_b32 exec_hi, -1
    s_add_u32 s70, s70, 1
    s_add_u32 s55, s70, s71
    s_and_b32 s55, s55, 7
    s_and_b32 s54, s70, 65528
    s_or_b32 s55, s55, s54
    s_mul_i32 s54, s55, 18432
    s_lshl_b32 s55, s55, 7
    s_add_u32 m0, s59, 49152
    s_nop 0
    buffer_load_dwordx4 v89, s[28:31], s55 offen lds
    s_add_u32 m0, s59, 50176
    s_nop 0
    buffer_load_dwordx4 v90, s[28:31], s55 offen lds
    s_add_u32 m0, s59, 51200
    s_nop 0
    buffer_load_dwordx4 v91, s[28:31], s55 offen lds
    s_add_u32 m0, s59, 52224
    s_nop 0
    buffer_load_dwordx4 v92, s[28:31], s55 offen lds
    s_add_u32 m0, s53, 55296
    s_nop 0
    buffer_load_dwordx4 v80, s[32:35], s54 offen lds
    s_add_u32 m0, s53, 56320
    s_nop 0
    buffer_load_dwordx4 v81, s[32:35], s54 offen lds
    s_add_u32 m0, s53, 57344
    s_nop 0
    buffer_load_dwordx4 v82, s[32:35], s54 offen lds
    s_add_u32 m0, s53, 58368
    s_nop 0
    buffer_load_dwordx4 v83, s[32:35], s54 offen lds
    s_add_u32 m0, s53, 59392
    s_nop 0
    s_mov_b32 exec_hi, 0
    buffer_load_dwordx4 v84, s[32:35], s54 offen lds
    s_mov_b32 exec_hi, -1
    s_add_u32 s70, s70, 1
    s_add_u32 s55, s70, s71
    s_and_b32 s55, s55, 7
    s_and_b32 s54, s70, 65528
    s_or_b32 s55, s55, s54
    s_mul_i32 s54, s55, 18432
    s_lshl_b32 s55, s55, 7
    s_waitcnt vmcnt(27)
    s_barrier
    s_mov_b32 s56, 8
k4_kernel_lloop:
    s_waitcnt vmcnt(18)
    s_barrier
    s_add_u32 m0, s59, 0
    s_nop 0
    buffer_load_dwordx4 v89, s[28:31], s55 offen lds
    s_add_u32 m0, s59, 1024
    s_nop 0
    buffer_load_dwordx4 v90, s[28:31], s55 offen lds
    s_add_u32 m0, s59, 2048
    s_nop 0
    buffer_load_dwordx4 v91, s[28:31], s55 offen lds
    s_add_u32 m0, s59, 3072
    s_nop 0
    buffer_load_dwordx4 v92, s[28:31], s55 offen lds
    s_add_u32 m0, s53, 0
    s_nop 0
    buffer_load_dwordx4 v80, s[32:35], s54 offen lds
    s_add_u32 m0, s53, 1024
    s_nop 0
    buffer_load_dwordx4 v81, s[32:35], s54 offen lds
    s_add_u32 m0, s53, 2048
    s_nop 0
    buffer_load_dwordx4 v82, s[32:35], s54 offen lds
    s_add_u32 m0, s53, 3072
    s_nop 0
    buffer_load_dwordx4 v83, s[32:35], s54 offen lds
    s_add_u32 m0, s53, 4096
    s_nop 0
    s_mov_b32 exec_hi, 0
    buffer_load_dwordx4 v84, s[32:35], s54 offen lds
    s_mov_b32 exec_hi, -1
    s_add_u32 s70, s70, 1
    s_add_u32 s55, s70, s71
    s_and_b32 s55, s55, 7
    s_and_b32 s54, s70, 65528
    s_or_b32 s55, s55, s54
    s_mul_i32 s54, s55, 18432
    s_lshl_b32 s55, s55, 7
    s_waitcnt vmcnt(18)
    s_barrier
    s_add_u32 m0, s59, 16384
    s_nop 0
    buffer_load_dwordx4 v89, s[28:31], s55 offen lds
    s_add_u32 m0, s59, 17408
    s_nop 0
    buffer_load_dwordx4 v90, s[28:31], s55 offen lds
    s_add_u32 m0, s59, 18432
    s_nop 0
    buffer_load_dwordx4 v91, s[28:31], s55 offen lds
    s_add_u32 m0, s59, 19456
    s_nop 0
    buffer_load_dwordx4 v92, s[28:31], s55 offen lds
    s_add_u32 m0, s53, 18432
    s_nop 0
    buffer_load_dwordx4 v80, s[32:35], s54 offen lds
    s_add_u32 m0, s53, 19456
    s_nop 0
    buffer_load_dwordx4 v81, s[32:35], s54 offen lds
    s_add_u32 m0, s53, 20480
    s_nop 0
    buffer_load_dwordx4 v82, s[32:35], s54 offen lds
    s_add_u32 m0, s53, 21504
    s_nop 0
    buffer_load_dwordx4 v83, s[32:35], s54 offen lds
    s_add_u32 m0, s53, 22528
    s_nop 0
    s_mov_b32 exec_hi, 0
    buffer_load_dwordx4 v84, s[32:35], s54 offen lds
    s_mov_b32 exec_hi, -1
    s_add_u32 s70, s70, 1
    s_add_u32 s55, s70, s71
    s_and_b32 s55, s55, 7
    s_and_b32 s54, s70, 65528
    s_or_b32 s55, s55, s54
    s_mul_i32 s54, s55, 18432
    s_lshl_b32 s55, s55, 7
    s_waitcnt vmcnt(18)
    s_barrier
    s_add_u32 m0, s59, 32768
    s_nop 0
    buffer_load_dwordx4 v89, s[28:31], s55 offen lds
    s_add_u32 m0, s59, 33792
    s_nop 0
    buffer_load_dwordx4 v90, s[28:31], s55 offen lds
    s_add_u32 m0, s59, 34816
    s_nop 0
    buffer_load_dwordx4 v91, s[28:31], s55 offen lds
    s_add_u32 m0, s59, 35840
    s_nop 0
    buffer_load_dwordx4 v92, s[28:31], s55 offen lds
    s_add_u32 m0, s53, 36864
    s_nop 0
    buffer_load_dwordx4 v80, s[32:35], s54 offen lds
    s_add_u32 m0, s53, 37888
    s_nop 0
    buffer_load_dwordx4 v81, s[32:35], s54 offen lds
    s_add_u32 m0, s53, 38912
    s_nop 0
    buffer_load_dwordx4 v82, s[32:35], s54 offen lds
    s_add_u32 m0, s53, 39936
    s_nop 0
    buffer_load_dwordx4 v83, s[32:35], s54 offen lds
    s_add_u32 m0, s53, 40960
    s_nop 0
    s_mov_b32 exec_hi, 0
    buffer_load_dwordx4 v84, s[32:35], s54 offen lds
    s_mov_b32 exec_hi, -1
    s_add_u32 s70, s70, 1
    s_add_u32 s55, s70, s71
    s_and_b32 s55, s55, 7
    s_and_b32 s54, s70, 65528
    s_or_b32 s55, s55, s54
    s_mul_i32 s54, s55, 18432
    s_lshl_b32 s55, s55, 7
    s_waitcnt vmcnt(18)
    s_barrier
    s_add_u32 m0, s59, 49152
    s_nop 0
    buffer_load_dwordx4 v89, s[28:31], s55 offen lds
    s_add_u32 m0, s59, 50176
    s_nop 0
    buffer_load_dwordx4 v90, s[28:31], s55 offen lds
    s_add_u32 m0, s59, 51200
    s_nop 0
    buffer_load_dwordx4 v91, s[28:31], s55 offen lds
    s_add_u32 m0, s59, 52224
    s_nop 0
    buffer_load_dwordx4 v92, s[28:31], s55 offen lds
    s_add_u32 m0, s53, 55296
    s_nop 0
    buffer_load_dwordx4 v80, s[32:35], s54 offen lds
    s_add_u32 m0, s53, 56320
    s_nop 0
    buffer_load_dwordx4 v81, s[32:35], s54 offen lds
    s_add_u32 m0, s53, 57344
    s_nop 0
    buffer_load_dwordx4 v82, s[32:35], s54 offen lds
    s_add_u32 m0, s53, 58368
    s_nop 0
    buffer_load_dwordx4 v83, s[32:35], s54 offen lds
    s_add_u32 m0, s53, 59392
    s_nop 0
    s_mov_b32 exec_hi, 0
    buffer_load_dwordx4 v84, s[32:35], s54 offen lds
    s_mov_b32 exec_hi, -1
    s_add_u32 s70, s70, 1
    s_add_u32 s55, s70, s71
    s_and_b32 s55, s55, 7
    s_and_b32 s54, s70, 65528
    s_or_b32 s55, s55, s54
    s_mul_i32 s54, s55, 18432
    s_lshl_b32 s55, s55, 7
    s_sub_u32 s56, s56, 1
    s_cmp_lg_u32 s56, 0
    s_cbranch_scc1 k4_kernel_lloop
    s_waitcnt vmcnt(0)
    s_barrier
    s_branch k4_kernel_end
k4_kernel_comp:
    v_and_b32 v236, 15, v1
    v_add_u32 v236, s63, v236
    v_add_u32 v235, 0, v236
    v_lshlrev_b32 v235, 1, v235
    buffer_load_ushort v184, v235, s[44:47], 0 offen
    v_add_u32 v235, 16, v236
    v_lshlrev_b32 v235, 1, v235
    buffer_load_ushort v185, v235, s[44:47], 0 offen
    s_mul_i32 s60, s63, 4608
    s_add_u32 s60, s60, s64
    v_add_u32 v232, 0, v1
    v_mul_u32_u24 v233, 3641, v232
    v_lshrrev_b32 v233, 16, v233
    v_mul_u32_u24 v234, 18, v233
    v_sub_u32 v232, v232, v234
    v_mul_u32_u24 v233, 4608, v233
    v_lshl_add_u32 v232, v232, 4, v233
    v_add_u32 v186, s60, v232
    v_add_u32 v232, 64, v1
    v_mul_u32_u24 v233, 3641, v232
    v_lshrrev_b32 v233, 16, v233
    v_mul_u32_u24 v234, 18, v233
    v_sub_u32 v232, v232, v234
    v_mul_u32_u24 v233, 4608, v233
    v_lshl_add_u32 v232, v232, 4, v233
    v_add_u32 v187, s60, v232
    v_add_u32 v232, 128, v1
    v_mul_u32_u24 v233, 3641, v232
    v_lshrrev_b32 v233, 16, v233
    v_mul_u32_u24 v234, 18, v233
    v_sub_u32 v232, v232, v234
    v_mul_u32_u24 v233, 4608, v233
    v_lshl_add_u32 v232, v232, 4, v233
    v_add_u32 v188, s60, v232
    v_add_u32 v232, 192, v1
    v_mul_u32_u24 v233, 3641, v232
    v_lshrrev_b32 v233, 16, v233
    v_mul_u32_u24 v234, 18, v233
    v_sub_u32 v232, v232, v234
    v_mul_u32_u24 v233, 4608, v233
    v_lshl_add_u32 v232, v232, 4, v233
    v_add_u32 v189, s60, v232
    v_add_u32 v232, 256, v1
    v_mul_u32_u24 v233, 3641, v232
    v_lshrrev_b32 v233, 16, v233
    v_mul_u32_u24 v234, 18, v233
    v_sub_u32 v232, v232, v234
    v_mul_u32_u24 v233, 4608, v233
    v_lshl_add_u32 v232, v232, 4, v233
    v_add_u32 v190, s60, v232
    v_add_u32 v232, 320, v1
    v_mul_u32_u24 v233, 3641, v232
    v_lshrrev_b32 v233, 16, v233
    v_mul_u32_u24 v234, 18, v233
    v_sub_u32 v232, v232, v234
    v_mul_u32_u24 v233, 4608, v233
    v_lshl_add_u32 v232, v232, 4, v233
    v_add_u32 v191, s60, v232
    v_add_u32 v232, 384, v1
    v_mul_u32_u24 v233, 3641, v232
    v_lshrrev_b32 v233, 16, v233
    v_mul_u32_u24 v234, 18, v233
    v_sub_u32 v232, v232, v234
    v_mul_u32_u24 v233, 4608, v233
    v_lshl_add_u32 v232, v232, 4, v233
    v_add_u32 v192, s60, v232
    v_add_u32 v232, 448, v1
    v_mul_u32_u24 v233, 3641, v232
    v_lshrrev_b32 v233, 16, v233
    v_mul_u32_u24 v234, 18, v233
    v_sub_u32 v232, v232, v234
    v_mul_u32_u24 v233, 4608, v233
    v_lshl_add_u32 v232, v232, 4, v233
    v_add_u32 v193, s60, v232
    v_add_u32 v232, 512, v1
    v_mul_u32_u24 v233, 3641, v232
    v_lshrrev_b32 v233, 16, v233
    v_mul_u32_u24 v234, 18, v233
    v_sub_u32 v232, v232, v234
    v_mul_u32_u24 v233, 4608, v233
    v_lshl_add_u32 v232, v232, 4, v233
    v_add_u32 v194, s60, v232
    v_mov_b32 v8, 0
    v_mov_b32 v9, 0
    v_mov_b32 v10, 0
    v_mov_b32 v11, 0
    v_mov_b32 v12, 0
    v_mov_b32 v13, 0
    v_mov_b32 v14, 0
    v_mov_b32 v15, 0
    v_mov_b32 v16, 0
    v_mov_b32 v17, 0
    v_mov_b32 v18, 0
    v_mov_b32 v19, 0
    v_mov_b32 v20, 0
    v_mov_b32 v21, 0
    v_mov_b32 v22, 0
    v_mov_b32 v23, 0
    v_mov_b32 v24, 0
    v_mov_b32 v25, 0
    v_mov_b32 v26, 0
    v_mov_b32 v27, 0
    v_mov_b32 v28, 0
    v_mov_b32 v29, 0
    v_mov_b32 v30, 0
    v_mov_b32 v31, 0
    v_mov_b32 v32, 0
    v_mov_b32 v33, 0
    v_mov_b32 v34, 0
    v_mov_b32 v35, 0
    v_mov_b32 v36, 0
    v_mov_b32 v37, 0
    v_mov_b32 v38, 0
    v_mov_b32 v39, 0
    v_mov_b32 v40, 0
    v_mov_b32 v41, 0
    v_mov_b32 v42, 0
    v_mov_b32 v43, 0
    v_mov_b32 v44, 0
    v_mov_b32 v45, 0
    v_mov_b32 v46, 0
    v_mov_b32 v47, 0
    v_mov_b32 v48, 0
    v_mov_b32 v49, 0
    v_mov_b32 v50, 0
    v_mov_b32 v51, 0
    v_mov_b32 v52, 0
    v_mov_b32 v53, 0
    v_mov_b32 v54, 0
    v_mov_b32 v55, 0
    v_mov_b32 v56, 0
    v_mov_b32 v57, 0
    v_mov_b32 v58, 0
    v_mov_b32 v59, 0
    v_mov_b32 v60, 0
    v_mov_b32 v61, 0
    v_mov_b32 v62, 0
    v_mov_b32 v63, 0
    v_mov_b32 v64, 0
    v_mov_b32 v65, 0
    v_mov_b32 v66, 0
    v_mov_b32 v67, 0
    v_mov_b32 v68, 0
    v_mov_b32 v69, 0
    v_mov_b32 v70, 0
    v_mov_b32 v71, 0
    v_mov_b32 v72, 0
    v_mov_b32 v73, 0
    v_mov_b32 v74, 0
    v_mov_b32 v75, 0
    v_mov_b32 v76, 0
    v_mov_b32 v77, 0
    v_mov_b32 v78, 0
    v_mov_b32 v79, 0
    s_barrier
    ds_read_b128 v[168:171], v93 offset:0
    ds_read_b128 v[172:175], v93 offset:2048
    ds_read_b64_tr_b16 v[96:97], v85 offset:0
    ds_read_b64_tr_b16 v[98:99], v85 offset:2304
    ds_read_b64_tr_b16 v[100:101], v85 offset:32
    ds_read_b64_tr_b16 v[102:103], v85 offset:2336
    ds_read_b64_tr_b16 v[104:105], v85 offset:64
    ds_read_b64_tr_b16 v[106:107], v85 offset:2368
    ds_read_b64_tr_b16 v[108:109], v85 offset:96
    ds_read_b64_tr_b16 v[110:111], v85 offset:2400
    ds_read_b64_tr_b16 v[112:113], v85 offset:128
    ds_read_b64_tr_b16 v[114:115], v85 offset:2432
    ds_read_b64_tr_b16 v[116:117], v85 offset:160
    ds_read_b64_tr_b16 v[118:119], v85 offset:2464
    ds_read_b64_tr_b16 v[120:121], v85 offset:192
    ds_read_b64_tr_b16 v[122:123], v85 offset:2496
    ds_read_b64_tr_b16 v[124:125], v85 offset:224
    ds_read_b64_tr_b16 v[126:127], v85 offset:2528
    ds_read_b64_tr_b16 v[128:129], v85 offset:256
    ds_read_b64_tr_b16 v[130:131], v85 offset:2560
    s_mov_b32 s56, 8
k4_kernel_loop:
    s_cmp_lg_u32 s56, 2
    s_cbranch_scc1 k4_kernel_noz
    buffer_load_dwordx4 v[196:199], v186, s[36:39], 0 offen
    buffer_load_dwordx4 v[200:203], v187, s[36:39], 0 offen
    buffer_load_dwordx4 v[204:207], v188, s[36:39], 0 offen
    buffer_load_dwordx4 v[208:211], v189, s[36:39], 0 offen
    buffer_load_dwordx4 v[212:215], v190, s[36:39], 0 offen
    buffer_load_dwordx4 v[216:219], v191, s[36:39], 0 offen
    buffer_load_dwordx4 v[220:223], v192, s[36:39], 0 offen
    buffer_load_dwordx4 v[224:227], v193, s[36:39], 0 offen
    buffer_load_dwordx4 v[228:231], v194, s[36:39], 0 offen
k4_kernel_noz:
    s_waitcnt lgkmcnt(0)
    ds_read_b128 v[176:179], v94 offset:0
    ds_read_b128 v[180:183], v94 offset:2048
    v_mfma_f32_16x16x32_bf16 v[8:11], v[96:99], v[168:171], v[8:11]
    ds_read_b64_tr_b16 v[132:133], v85 offset:9216
    ds_read_b64_tr_b16 v[134:135], v85 offset:11520
    v_mfma_f32_16x16x32_bf16 v[44:47], v[96:99], v[172:175], v[44:47]
    ds_read_b64_tr_b16 v[136:137], v85 offset:9248
    ds_read_b64_tr_b16 v[138:139], v85 offset:11552
    v_mfma_f32_16x16x32_bf16 v[12:15], v[100:103], v[168:171], v[12:15]
    ds_read_b64_tr_b16 v[140:141], v85 offset:9280
    ds_read_b64_tr_b16 v[142:143], v85 offset:11584
    v_mfma_f32_16x16x32_bf16 v[48:51], v[100:103], v[172:175], v[48:51]
    ds_read_b64_tr_b16 v[144:145], v85 offset:9312
    ds_read_b64_tr_b16 v[146:147], v85 offset:11616
    v_mfma_f32_16x16x32_bf16 v[16:19], v[104:107], v[168:171], v[16:19]
    ds_read_b64_tr_b16 v[148:149], v85 offset:9344
    ds_read_b64_tr_b16 v[150:151], v85 offset:11648
    v_mfma_f32_16x16x32_bf16 v[52:55], v[104:107], v[172:175], v[52:55]
    ds_read_b64_tr_b16 v[152:153], v85 offset:9376
    ds_read_b64_tr_b16 v[154:155], v85 offset:11680
    v_mfma_f32_16x16x32_bf16 v[20:23], v[108:111], v[168:171], v[20:23]
    ds_read_b64_tr_b16 v[156:157], v85 offset:9408
    ds_read_b64_tr_b16 v[158:159], v85 offset:11712
    v_mfma_f32_16x16x32_bf16 v[56:59], v[108:111], v[172:175], v[56:59]
    ds_read_b64_tr_b16 v[160:161], v85 offset:9440
    ds_read_b64_tr_b16 v[162:163], v85 offset:11744
    v_mfma_f32_16x16x32_bf16 v[24:27], v[112:115], v[168:171], v[24:27]
    ds_read_b64_tr_b16 v[164:165], v85 offset:9472
    ds_read_b64_tr_b16 v[166:167], v85 offset:11776
    v_mfma_f32_16x16x32_bf16 v[60:63], v[112:115], v[172:175], v[60:63]
    v_mfma_f32_16x16x32_bf16 v[28:31], v[116:119], v[168:171], v[28:31]
    v_mfma_f32_16x16x32_bf16 v[64:67], v[116:119], v[172:175], v[64:67]
    v_mfma_f32_16x16x32_bf16 v[32:35], v[120:123], v[168:171], v[32:35]
    v_mfma_f32_16x16x32_bf16 v[68:71], v[120:123], v[172:175], v[68:71]
    v_mfma_f32_16x16x32_bf16 v[36:39], v[124:127], v[168:171], v[36:39]
    v_mfma_f32_16x16x32_bf16 v[72:75], v[124:127], v[172:175], v[72:75]
    v_mfma_f32_16x16x32_bf16 v[40:43], v[128:131], v[168:171], v[40:43]
    v_mfma_f32_16x16x32_bf16 v[76:79], v[128:131], v[172:175], v[76:79]
    s_waitcnt lgkmcnt(0)
    s_barrier
    ds_read_b128 v[168:171], v93 offset:16384
    ds_read_b128 v[172:175], v93 offset:18432
    v_mfma_f32_16x16x32_bf16 v[8:11], v[132:135], v[176:179], v[8:11]
    ds_read_b64_tr_b16 v[96:97], v86 offset:0
    ds_read_b64_tr_b16 v[98:99], v86 offset:2304
    v_mfma_f32_16x16x32_bf16 v[44:47], v[132:135], v[180:183], v[44:47]
    ds_read_b64_tr_b16 v[100:101], v86 offset:32
    ds_read_b64_tr_b16 v[102:103], v86 offset:2336
    v_mfma_f32_16x16x32_bf16 v[12:15], v[136:139], v[176:179], v[12:15]
    ds_read_b64_tr_b16 v[104:105], v86 offset:64
    ds_read_b64_tr_b16 v[106:107], v86 offset:2368
    v_mfma_f32_16x16x32_bf16 v[48:51], v[136:139], v[180:183], v[48:51]
    ds_read_b64_tr_b16 v[108:109], v86 offset:96
    ds_read_b64_tr_b16 v[110:111], v86 offset:2400
    v_mfma_f32_16x16x32_bf16 v[16:19], v[140:143], v[176:179], v[16:19]
    ds_read_b64_tr_b16 v[112:113], v86 offset:128
    ds_read_b64_tr_b16 v[114:115], v86 offset:2432
    v_mfma_f32_16x16x32_bf16 v[52:55], v[140:143], v[180:183], v[52:55]
    ds_read_b64_tr_b16 v[116:117], v86 offset:160
    ds_read_b64_tr_b16 v[118:119], v86 offset:2464
    v_mfma_f32_16x16x32_bf16 v[20:23], v[144:147], v[176:179], v[20:23]
    ds_read_b64_tr_b16 v[120:121], v86 offset:192
    ds_read_b64_tr_b16 v[122:123], v86 offset:2496
    v_mfma_f32_16x16x32_bf16 v[56:59], v[144:147], v[180:183], v[56:59]
    ds_read_b64_tr_b16 v[124:125], v86 offset:224
    ds_read_b64_tr_b16 v[126:127], v86 offset:2528
    v_mfma_f32_16x16x32_bf16 v[24:27], v[148:151], v[176:179], v[24:27]
    ds_read_b64_tr_b16 v[128:129], v86 offset:256
    ds_read_b64_tr_b16 v[130:131], v86 offset:2560
    v_mfma_f32_16x16x32_bf16 v[60:63], v[148:151], v[180:183], v[60:63]
    v_mfma_f32_16x16x32_bf16 v[28:31], v[152:155], v[176:179], v[28:31]
    v_mfma_f32_16x16x32_bf16 v[64:67], v[152:155], v[180:183], v[64:67]
    v_mfma_f32_16x16x32_bf16 v[32:35], v[156:159], v[176:179], v[32:35]
    v_mfma_f32_16x16x32_bf16 v[68:71], v[156:159], v[180:183], v[68:71]
    v_mfma_f32_16x16x32_bf16 v[36:39], v[160:163], v[176:179], v[36:39]
    v_mfma_f32_16x16x32_bf16 v[72:75], v[160:163], v[180:183], v[72:75]
    v_mfma_f32_16x16x32_bf16 v[40:43], v[164:167], v[176:179], v[40:43]
    v_mfma_f32_16x16x32_bf16 v[76:79], v[164:167], v[180:183], v[76:79]
    s_waitcnt lgkmcnt(0)
    ds_read_b128 v[176:179], v94 offset:16384
    ds_read_b128 v[180:183], v94 offset:18432
    v_mfma_f32_16x16x32_bf16 v[8:11], v[96:99], v[168:171], v[8:11]
    ds_read_b64_tr_b16 v[132:133], v86 offset:9216
    ds_read_b64_tr_b16 v[134:135], v86 offset:11520
    v_mfma_f32_16x16x32_bf16 v[44:47], v[96:99], v[172:175], v[44:47]
    ds_read_b64_tr_b16 v[136:137], v86 offset:9248
    ds_read_b64_tr_b16 v[138:139], v86 offset:11552
    v_mfma_f32_16x16x32_bf16 v[12:15], v[100:103], v[168:171], v[12:15]
    ds_read_b64_tr_b16 v[140:141], v86 offset:9280
    ds_read_b64_tr_b16 v[142:143], v86 offset:11584
    v_mfma_f32_16x16x32_bf16 v[48:51], v[100:103], v[172:175], v[48:51]
    ds_read_b64_tr_b16 v[144:145], v86 offset:9312
    ds_read_b64_tr_b16 v[146:147], v86 offset:11616
    v_mfma_f32_16x16x32_bf16 v[16:19], v[104:107], v[168:171], v[16:19]
    ds_read_b64_tr_b16 v[148:149], v86 offset:9344
    ds_read_b64_tr_b16 v[150:151], v86 offset:11648
    v_mfma_f32_16x16x32_bf16 v[52:55], v[104:107], v[172:175], v[52:55]
    ds_read_b64_tr_b16 v[152:153], v86 offset:9376
    ds_read_b64_tr_b16 v[154:155], v86 offset:11680
    v_mfma_f32_16x16x32_bf16 v[20:23], v[108:111], v[168:171], v[20:23]
    ds_read_b64_tr_b16 v[156:157], v86 offset:9408
    ds_read_b64_tr_b16 v[158:159], v86 offset:11712
    v_mfma_f32_16x16x32_bf16 v[56:59], v[108:111], v[172:175], v[56:59]
    ds_read_b64_tr_b16 v[160:161], v86 offset:9440
    ds_read_b64_tr_b16 v[162:163], v86 offset:11744
    v_mfma_f32_16x16x32_bf16 v[24:27], v[112:115], v[168:171], v[24:27]
    ds_read_b64_tr_b16 v[164:165], v86 offset:9472
    ds_read_b64_tr_b16 v[166:167], v86 offset:11776
    v_mfma_f32_16x16x32_bf16 v[60:63], v[112:115], v[172:175], v[60:63]
    v_mfma_f32_16x16x32_bf16 v[28:31], v[116:119], v[168:171], v[28:31]
    v_mfma_f32_16x16x32_bf16 v[64:67], v[116:119], v[172:175], v[64:67]
    v_mfma_f32_16x16x32_bf16 v[32:35], v[120:123], v[168:171], v[32:35]
    v_mfma_f32_16x16x32_bf16 v[68:71], v[120:123], v[172:175], v[68:71]
    v_mfma_f32_16x16x32_bf16 v[36:39], v[124:127], v[168:171], v[36:39]
    v_mfma_f32_16x16x32_bf16 v[72:75], v[124:127], v[172:175], v[72:75]
    v_mfma_f32_16x16x32_bf16 v[40:43], v[128:131], v[168:171], v[40:43]
    v_mfma_f32_16x16x32_bf16 v[76:79], v[128:131], v[172:175], v[76:79]
    s_waitcnt lgkmcnt(0)
    s_barrier
    ds_read_b128 v[168:171], v93 offset:32768
    ds_read_b128 v[172:175], v93 offset:34816
    v_mfma_f32_16x16x32_bf16 v[8:11], v[132:135], v[176:179], v[8:11]
    ds_read_b64_tr_b16 v[96:97], v87 offset:0
    ds_read_b64_tr_b16 v[98:99], v87 offset:2304
    v_mfma_f32_16x16x32_bf16 v[44:47], v[132:135], v[180:183], v[44:47]
    ds_read_b64_tr_b16 v[100:101], v87 offset:32
    ds_read_b64_tr_b16 v[102:103], v87 offset:2336
    v_mfma_f32_16x16x32_bf16 v[12:15], v[136:139], v[176:179], v[12:15]
    ds_read_b64_tr_b16 v[104:105], v87 offset:64
    ds_read_b64_tr_b16 v[106:107], v87 offset:2368
    v_mfma_f32_16x16x32_bf16 v[48:51], v[136:139], v[180:183], v[48:51]
    ds_read_b64_tr_b16 v[108:109], v87 offset:96
    ds_read_b64_tr_b16 v[110:111], v87 offset:2400
    v_mfma_f32_16x16x32_bf16 v[16:19], v[140:143], v[176:179], v[16:19]
    ds_read_b64_tr_b16 v[112:113], v87 offset:128
    ds_read_b64_tr_b16 v[114:115], v87 offset:2432
    v_mfma_f32_16x16x32_bf16 v[52:55], v[140:143], v[180:183], v[52:55]
    ds_read_b64_tr_b16 v[116:117], v87 offset:160
    ds_read_b64_tr_b16 v[118:119], v87 offset:2464
    v_mfma_f32_16x16x32_bf16 v[20:23], v[144:147], v[176:179], v[20:23]
    ds_read_b64_tr_b16 v[120:121], v87 offset:192
    ds_read_b64_tr_b16 v[122:123], v87 offset:2496
    v_mfma_f32_16x16x32_bf16 v[56:59], v[144:147], v[180:183], v[56:59]
    ds_read_b64_tr_b16 v[124:125], v87 offset:224
    ds_read_b64_tr_b16 v[126:127], v87 offset:2528
    v_mfma_f32_16x16x32_bf16 v[24:27], v[148:151], v[176:179], v[24:27]
    ds_read_b64_tr_b16 v[128:129], v87 offset:256
    ds_read_b64_tr_b16 v[130:131], v87 offset:2560
    v_mfma_f32_16x16x32_bf16 v[60:63], v[148:151], v[180:183], v[60:63]
    v_mfma_f32_16x16x32_bf16 v[28:31], v[152:155], v[176:179], v[28:31]
    v_mfma_f32_16x16x32_bf16 v[64:67], v[152:155], v[180:183], v[64:67]
    v_mfma_f32_16x16x32_bf16 v[32:35], v[156:159], v[176:179], v[32:35]
    v_mfma_f32_16x16x32_bf16 v[68:71], v[156:159], v[180:183], v[68:71]
    v_mfma_f32_16x16x32_bf16 v[36:39], v[160:163], v[176:179], v[36:39]
    v_mfma_f32_16x16x32_bf16 v[72:75], v[160:163], v[180:183], v[72:75]
    v_mfma_f32_16x16x32_bf16 v[40:43], v[164:167], v[176:179], v[40:43]
    v_mfma_f32_16x16x32_bf16 v[76:79], v[164:167], v[180:183], v[76:79]
    s_waitcnt lgkmcnt(0)
    ds_read_b128 v[176:179], v94 offset:32768
    ds_read_b128 v[180:183], v94 offset:34816
    v_mfma_f32_16x16x32_bf16 v[8:11], v[96:99], v[168:171], v[8:11]
    ds_read_b64_tr_b16 v[132:133], v87 offset:9216
    ds_read_b64_tr_b16 v[134:135], v87 offset:11520
    v_mfma_f32_16x16x32_bf16 v[44:47], v[96:99], v[172:175], v[44:47]
    ds_read_b64_tr_b16 v[136:137], v87 offset:9248
    ds_read_b64_tr_b16 v[138:139], v87 offset:11552
    v_mfma_f32_16x16x32_bf16 v[12:15], v[100:103], v[168:171], v[12:15]
    ds_read_b64_tr_b16 v[140:141], v87 offset:9280
    ds_read_b64_tr_b16 v[142:143], v87 offset:11584
    v_mfma_f32_16x16x32_bf16 v[48:51], v[100:103], v[172:175], v[48:51]
    ds_read_b64_tr_b16 v[144:145], v87 offset:9312
    ds_read_b64_tr_b16 v[146:147], v87 offset:11616
    v_mfma_f32_16x16x32_bf16 v[16:19], v[104:107], v[168:171], v[16:19]
    ds_read_b64_tr_b16 v[148:149], v87 offset:9344
    ds_read_b64_tr_b16 v[150:151], v87 offset:11648
    v_mfma_f32_16x16x32_bf16 v[52:55], v[104:107], v[172:175], v[52:55]
    ds_read_b64_tr_b16 v[152:153], v87 offset:9376
    ds_read_b64_tr_b16 v[154:155], v87 offset:11680
    v_mfma_f32_16x16x32_bf16 v[20:23], v[108:111], v[168:171], v[20:23]
    ds_read_b64_tr_b16 v[156:157], v87 offset:9408
    ds_read_b64_tr_b16 v[158:159], v87 offset:11712
    v_mfma_f32_16x16x32_bf16 v[56:59], v[108:111], v[172:175], v[56:59]
    ds_read_b64_tr_b16 v[160:161], v87 offset:9440
    ds_read_b64_tr_b16 v[162:163], v87 offset:11744
    v_mfma_f32_16x16x32_bf16 v[24:27], v[112:115], v[168:171], v[24:27]
    ds_read_b64_tr_b16 v[164:165], v87 offset:9472
    ds_read_b64_tr_b16 v[166:167], v87 offset:11776
    v_mfma_f32_16x16x32_bf16 v[60:63], v[112:115], v[172:175], v[60:63]
    v_mfma_f32_16x16x32_bf16 v[28:31], v[116:119], v[168:171], v[28:31]
    v_mfma_f32_16x16x32_bf16 v[64:67], v[116:119], v[172:175], v[64:67]
    v_mfma_f32_16x16x32_bf16 v[32:35], v[120:123], v[168:171], v[32:35]
    v_mfma_f32_16x16x32_bf16 v[68:71], v[120:123], v[172:175], v[68:71]
    v_mfma_f32_16x16x32_bf16 v[36:39], v[124:127], v[168:171], v[36:39]
    v_mfma_f32_16x16x32_bf16 v[72:75], v[124:127], v[172:175], v[72:75]
    v_mfma_f32_16x16x32_bf16 v[40:43], v[128:131], v[168:171], v[40:43]
    v_mfma_f32_16x16x32_bf16 v[76:79], v[128:131], v[172:175], v[76:79]
    s_waitcnt lgkmcnt(0)
    s_barrier
    ds_read_b128 v[168:171], v93 offset:49152
    ds_read_b128 v[172:175], v93 offset:51200
    v_mfma_f32_16x16x32_bf16 v[8:11], v[132:135], v[176:179], v[8:11]
    ds_read_b64_tr_b16 v[96:97], v88 offset:0
    ds_read_b64_tr_b16 v[98:99], v88 offset:2304
    v_mfma_f32_16x16x32_bf16 v[44:47], v[132:135], v[180:183], v[44:47]
    ds_read_b64_tr_b16 v[100:101], v88 offset:32
    ds_read_b64_tr_b16 v[102:103], v88 offset:2336
    v_mfma_f32_16x16x32_bf16 v[12:15], v[136:139], v[176:179], v[12:15]
    ds_read_b64_tr_b16 v[104:105], v88 offset:64
    ds_read_b64_tr_b16 v[106:107], v88 offset:2368
    v_mfma_f32_16x16x32_bf16 v[48:51], v[136:139], v[180:183], v[48:51]
    ds_read_b64_tr_b16 v[108:109], v88 offset:96
    ds_read_b64_tr_b16 v[110:111], v88 offset:2400
    v_mfma_f32_16x16x32_bf16 v[16:19], v[140:143], v[176:179], v[16:19]
    ds_read_b64_tr_b16 v[112:113], v88 offset:128
    ds_read_b64_tr_b16 v[114:115], v88 offset:2432
    v_mfma_f32_16x16x32_bf16 v[52:55], v[140:143], v[180:183], v[52:55]
    ds_read_b64_tr_b16 v[116:117], v88 offset:160
    ds_read_b64_tr_b16 v[118:119], v88 offset:2464
    v_mfma_f32_16x16x32_bf16 v[20:23], v[144:147], v[176:179], v[20:23]
    ds_read_b64_tr_b16 v[120:121], v88 offset:192
    ds_read_b64_tr_b16 v[122:123], v88 offset:2496
    v_mfma_f32_16x16x32_bf16 v[56:59], v[144:147], v[180:183], v[56:59]
    ds_read_b64_tr_b16 v[124:125], v88 offset:224
    ds_read_b64_tr_b16 v[126:127], v88 offset:2528
    v_mfma_f32_16x16x32_bf16 v[24:27], v[148:151], v[176:179], v[24:27]
    ds_read_b64_tr_b16 v[128:129], v88 offset:256
    ds_read_b64_tr_b16 v[130:131], v88 offset:2560
    v_mfma_f32_16x16x32_bf16 v[60:63], v[148:151], v[180:183], v[60:63]
    v_mfma_f32_16x16x32_bf16 v[28:31], v[152:155], v[176:179], v[28:31]
    v_mfma_f32_16x16x32_bf16 v[64:67], v[152:155], v[180:183], v[64:67]
    v_mfma_f32_16x16x32_bf16 v[32:35], v[156:159], v[176:179], v[32:35]
    v_mfma_f32_16x16x32_bf16 v[68:71], v[156:159], v[180:183], v[68:71]
    v_mfma_f32_16x16x32_bf16 v[36:39], v[160:163], v[176:179], v[36:39]
    v_mfma_f32_16x16x32_bf16 v[72:75], v[160:163], v[180:183], v[72:75]
    v_mfma_f32_16x16x32_bf16 v[40:43], v[164:167], v[176:179], v[40:43]
    v_mfma_f32_16x16x32_bf16 v[76:79], v[164:167], v[180:183], v[76:79]
    s_waitcnt lgkmcnt(0)
    ds_read_b128 v[176:179], v94 offset:49152
    ds_read_b128 v[180:183], v94 offset:51200
    v_mfma_f32_16x16x32_bf16 v[8:11], v[96:99], v[168:171], v[8:11]
    ds_read_b64_tr_b16 v[132:133], v88 offset:9216
    ds_read_b64_tr_b16 v[134:135], v88 offset:11520
    v_mfma_f32_16x16x32_bf16 v[44:47], v[96:99], v[172:175], v[44:47]
    ds_read_b64_tr_b16 v[136:137], v88 offset:9248
    ds_read_b64_tr_b16 v[138:139], v88 offset:11552
    v_mfma_f32_16x16x32_bf16 v[12:15], v[100:103], v[168:171], v[12:15]
    ds_read_b64_tr_b16 v[140:141], v88 offset:9280
    ds_read_b64_tr_b16 v[142:143], v88 offset:11584
    v_mfma_f32_16x16x32_bf16 v[48:51], v[100:103], v[172:175], v[48:51]
    ds_read_b64_tr_b16 v[144:145], v88 offset:9312
    ds_read_b64_tr_b16 v[146:147], v88 offset:11616
    v_mfma_f32_16x16x32_bf16 v[16:19], v[104:107], v[168:171], v[16:19]
    ds_read_b64_tr_b16 v[148:149], v88 offset:9344
    ds_read_b64_tr_b16 v[150:151], v88 offset:11648
    v_mfma_f32_16x16x32_bf16 v[52:55], v[104:107], v[172:175], v[52:55]
    ds_read_b64_tr_b16 v[152:153], v88 offset:9376
    ds_read_b64_tr_b16 v[154:155], v88 offset:11680
    v_mfma_f32_16x16x32_bf16 v[20:23], v[108:111], v[168:171], v[20:23]
    ds_read_b64_tr_b16 v[156:157], v88 offset:9408
    ds_read_b64_tr_b16 v[158:159], v88 offset:11712
    v_mfma_f32_16x16x32_bf16 v[56:59], v[108:111], v[172:175], v[56:59]
    ds_read_b64_tr_b16 v[160:161], v88 offset:9440
    ds_read_b64_tr_b16 v[162:163], v88 offset:11744
    v_mfma_f32_16x16x32_bf16 v[24:27], v[112:115], v[168:171], v[24:27]
    ds_read_b64_tr_b16 v[164:165], v88 offset:9472
    ds_read_b64_tr_b16 v[166:167], v88 offset:11776
    v_mfma_f32_16x16x32_bf16 v[60:63], v[112:115], v[172:175], v[60:63]
    v_mfma_f32_16x16x32_bf16 v[28:31], v[116:119], v[168:171], v[28:31]
    v_mfma_f32_16x16x32_bf16 v[64:67], v[116:119], v[172:175], v[64:67]
    v_mfma_f32_16x16x32_bf16 v[32:35], v[120:123], v[168:171], v[32:35]
    v_mfma_f32_16x16x32_bf16 v[68:71], v[120:123], v[172:175], v[68:71]
    v_mfma_f32_16x16x32_bf16 v[36:39], v[124:127], v[168:171], v[36:39]
    v_mfma_f32_16x16x32_bf16 v[72:75], v[124:127], v[172:175], v[72:75]
    v_mfma_f32_16x16x32_bf16 v[40:43], v[128:131], v[168:171], v[40:43]
    v_mfma_f32_16x16x32_bf16 v[76:79], v[128:131], v[172:175], v[76:79]
    s_waitcnt lgkmcnt(0)
    s_barrier
    ds_read_b128 v[168:171], v93 offset:0
    ds_read_b128 v[172:175], v93 offset:2048
    v_mfma_f32_16x16x32_bf16 v[8:11], v[132:135], v[176:179], v[8:11]
    ds_read_b64_tr_b16 v[96:97], v85 offset:0
    ds_read_b64_tr_b16 v[98:99], v85 offset:2304
    v_mfma_f32_16x16x32_bf16 v[44:47], v[132:135], v[180:183], v[44:47]
    ds_read_b64_tr_b16 v[100:101], v85 offset:32
    ds_read_b64_tr_b16 v[102:103], v85 offset:2336
    v_mfma_f32_16x16x32_bf16 v[12:15], v[136:139], v[176:179], v[12:15]
    ds_read_b64_tr_b16 v[104:105], v85 offset:64
    ds_read_b64_tr_b16 v[106:107], v85 offset:2368
    v_mfma_f32_16x16x32_bf16 v[48:51], v[136:139], v[180:183], v[48:51]
    ds_read_b64_tr_b16 v[108:109], v85 offset:96
    ds_read_b64_tr_b16 v[110:111], v85 offset:2400
    v_mfma_f32_16x16x32_bf16 v[16:19], v[140:143], v[176:179], v[16:19]
    ds_read_b64_tr_b16 v[112:113], v85 offset:128
    ds_read_b64_tr_b16 v[114:115], v85 offset:2432
    v_mfma_f32_16x16x32_bf16 v[52:55], v[140:143], v[180:183], v[52:55]
    ds_read_b64_tr_b16 v[116:117], v85 offset:160
    ds_read_b64_tr_b16 v[118:119], v85 offset:2464
    v_mfma_f32_16x16x32_bf16 v[20:23], v[144:147], v[176:179], v[20:23]
    ds_read_b64_tr_b16 v[120:121], v85 offset:192
    ds_read_b64_tr_b16 v[122:123], v85 offset:2496
    v_mfma_f32_16x16x32_bf16 v[56:59], v[144:147], v[180:183], v[56:59]
    ds_read_b64_tr_b16 v[124:125], v85 offset:224
    ds_read_b64_tr_b16 v[126:127], v85 offset:2528
    v_mfma_f32_16x16x32_bf16 v[24:27], v[148:151], v[176:179], v[24:27]
    ds_read_b64_tr_b16 v[128:129], v85 offset:256
    ds_read_b64_tr_b16 v[130:131], v85 offset:2560
    v_mfma_f32_16x16x32_bf16 v[60:63], v[148:151], v[180:183], v[60:63]
    v_mfma_f32_16x16x32_bf16 v[28:31], v[152:155], v[176:179], v[28:31]
    v_mfma_f32_16x16x32_bf16 v[64:67], v[152:155], v[180:183], v[64:67]
    v_mfma_f32_16x16x32_bf16 v[32:35], v[156:159], v[176:179], v[32:35]
    v_mfma_f32_16x16x32_bf16 v[68:71], v[156:159], v[180:183], v[68:71]
    v_mfma_f32_16x16x32_bf16 v[36:39], v[160:163], v[176:179], v[36:39]
    v_mfma_f32_16x16x32_bf16 v[72:75], v[160:163], v[180:183], v[72:75]
    v_mfma_f32_16x16x32_bf16 v[40:43], v[164:167], v[176:179], v[40:43]
    v_mfma_f32_16x16x32_bf16 v[76:79], v[164:167], v[180:183], v[76:79]
    s_sub_u32 s56, s56, 1
    s_cmp_lg_u32 s56, 0
    s_cbranch_scc1 k4_kernel_loop
    s_waitcnt vmcnt(0) lgkmcnt(0)
    v_and_b32 v100, 15, v1
    v_add_u32 v100, s63, v100
    s_mov_b32 s60, 4608
    v_mul_lo_u32 v101, v100, s60
    v_lshrrev_b32 v102, 4, v1
    v_lshl_add_u32 v101, v102, 3, v101
    v_add_u32 v101, s64, v101
    v_add_u32 v96, 0, v101
    v_add_u32 v97, 73728, v101
    s_barrier
    s_mul_i32 s61, s52, 9216
    v_and_b32 v232, 15, v1
    v_mul_u32_u24 v232, 288, v232
    v_lshrrev_b32 v233, 4, v1
    v_lshl_add_u32 v232, v233, 3, v232
    v_add_u32 v96, s61, v232
    v_lshlrev_b32 v232, 4, v1
    v_add_u32 v97, s61, v232
    v_lshlrev_b32 v184, 16, v184
    v_lshlrev_b32 v185, 16, v185
    v_cvt_pk_bf16_f32 v232, v8, v9
    v_lshlrev_b32 v234, 16, v232
    v_and_b32 v235, 0xffff0000, v232
    v_pk_add_f32 v[234:235], v[234:235], v[184:185] op_sel:[0,0] op_sel_hi:[1,0]
    v_cvt_pk_bf16_f32 v8, v234, v235
    v_cvt_pk_bf16_f32 v232, v10, v11
    v_lshlrev_b32 v234, 16, v232
    v_and_b32 v235, 0xffff0000, v232
    v_pk_add_f32 v[234:235], v[234:235], v[184:185] op_sel:[0,0] op_sel_hi:[1,0]
    v_cvt_pk_bf16_f32 v9, v234, v235
    ds_write_b64 v96, v[8:9] offset:0
    v_cvt_pk_bf16_f32 v232, v12, v13
    v_lshlrev_b32 v234, 16, v232
    v_and_b32 v235, 0xffff0000, v232
    v_pk_add_f32 v[234:235], v[234:235], v[184:185] op_sel:[0,0] op_sel_hi:[1,0]
    v_cvt_pk_bf16_f32 v12, v234, v235
    v_cvt_pk_bf16_f32 v232, v14, v15
    v_lshlrev_b32 v234, 16, v232
    v_and_b32 v235, 0xffff0000, v232
    v_pk_add_f32 v[234:235], v[234:235], v[184:185] op_sel:[0,0] op_sel_hi:[1,0]
    v_cvt_pk_bf16_f32 v13, v234, v235
    ds_write_b64 v96, v[12:13] offset:32
    v_cvt_pk_bf16_f32 v232, v16, v17
    v_lshlrev_b32 v234, 16, v232
    v_and_b32 v235, 0xffff0000, v232
    v_pk_add_f32 v[234:235], v[234:235], v[184:185] op_sel:[0,0] op_sel_hi:[1,0]
    v_cvt_pk_bf16_f32 v16, v234, v235
    v_cvt_pk_bf16_f32 v232, v18, v19
    v_lshlrev_b32 v234, 16, v232
    v_and_b32 v235, 0xffff0000, v232
    v_pk_add_f32 v[234:235], v[234:235], v[184:185] op_sel:[0,0] op_sel_hi:[1,0]
    v_cvt_pk_bf16_f32 v17, v234, v235
    ds_write_b64 v96, v[16:17] offset:64
    v_cvt_pk_bf16_f32 v232, v20, v21
    v_lshlrev_b32 v234, 16, v232
    v_and_b32 v235, 0xffff0000, v232
    v_pk_add_f32 v[234:235], v[234:235], v[184:185] op_sel:[0,0] op_sel_hi:[1,0]
    v_cvt_pk_bf16_f32 v20, v234, v235
    v_cvt_pk_bf16_f32 v232, v22, v23
    v_lshlrev_b32 v234, 16, v232
    v_and_b32 v235, 0xffff0000, v232
    v_pk_add_f32 v[234:235], v[234:235], v[184:185] op_sel:[0,0] op_sel_hi:[1,0]
    v_cvt_pk_bf16_f32 v21, v234, v235
    ds_write_b64 v96, v[20:21] offset:96
    v_cvt_pk_bf16_f32 v232, v24, v25
    v_lshlrev_b32 v234, 16, v232
    v_and_b32 v235, 0xffff0000, v232
    v_pk_add_f32 v[234:235], v[234:235], v[184:185] op_sel:[0,0] op_sel_hi:[1,0]
    v_cvt_pk_bf16_f32 v24, v234, v235
    v_cvt_pk_bf16_f32 v232, v26, v27
    v_lshlrev_b32 v234, 16, v232
    v_and_b32 v235, 0xffff0000, v232
    v_pk_add_f32 v[234:235], v[234:235], v[184:185] op_sel:[0,0] op_sel_hi:[1,0]
    v_cvt_pk_bf16_f32 v25, v234, v235
    ds_write_b64 v96, v[24:25] offset:128
    v_cvt_pk_bf16_f32 v232, v28, v29
    v_lshlrev_b32 v234, 16, v232
    v_and_b32 v235, 0xffff0000, v232
    v_pk_add_f32 v[234:235], v[234:235], v[184:185] op_sel:[0,0] op_sel_hi:[1,0]
    v_cvt_pk_bf16_f32 v28, v234, v235
    v_cvt_pk_bf16_f32 v232, v30, v31
    v_lshlrev_b32 v234, 16, v232
    v_and_b32 v235, 0xffff0000, v232
    v_pk_add_f32 v[234:235], v[234:235], v[184:185] op_sel:[0,0] op_sel_hi:[1,0]
    v_cvt_pk_bf16_f32 v29, v234, v235
    ds_write_b64 v96, v[28:29] offset:160
    v_cvt_pk_bf16_f32 v232, v32, v33
    v_lshlrev_b32 v234, 16, v232
    v_and_b32 v235, 0xffff0000, v232
    v_pk_add_f32 v[234:235], v[234:235], v[184:185] op_sel:[0,0] op_sel_hi:[1,0]
    v_cvt_pk_bf16_f32 v32, v234, v235
    v_cvt_pk_bf16_f32 v232, v34, v35
    v_lshlrev_b32 v234, 16, v232
    v_and_b32 v235, 0xffff0000, v232
    v_pk_add_f32 v[234:235], v[234:235], v[184:185] op_sel:[0,0] op_sel_hi:[1,0]
    v_cvt_pk_bf16_f32 v33, v234, v235
    ds_write_b64 v96, v[32:33] offset:192
    v_cvt_pk_bf16_f32 v232, v36, v37
    v_lshlrev_b32 v234, 16, v232
    v_and_b32 v235, 0xffff0000, v232
    v_pk_add_f32 v[234:235], v[234:235], v[184:185] op_sel:[0,0] op_sel_hi:[1,0]
    v_cvt_pk_bf16_f32 v36, v234, v235
    v_cvt_pk_bf16_f32 v232, v38, v39
    v_lshlrev_b32 v234, 16, v232
    v_and_b32 v235, 0xffff0000, v232
    v_pk_add_f32 v[234:235], v[234:235], v[184:185] op_sel:[0,0] op_sel_hi:[1,0]
    v_cvt_pk_bf16_f32 v37, v234, v235
    ds_write_b64 v96, v[36:37] offset:224
    v_cvt_pk_bf16_f32 v232, v40, v41
    v_lshlrev_b32 v234, 16, v232
    v_and_b32 v235, 0xffff0000, v232
    v_pk_add_f32 v[234:235], v[234:235], v[184:185] op_sel:[0,0] op_sel_hi:[1,0]
    v_cvt_pk_bf16_f32 v40, v234, v235
    v_cvt_pk_bf16_f32 v232, v42, v43
    v_lshlrev_b32 v234, 16, v232
    v_and_b32 v235, 0xffff0000, v232
    v_pk_add_f32 v[234:235], v[234:235], v[184:185] op_sel:[0,0] op_sel_hi:[1,0]
    v_cvt_pk_bf16_f32 v41, v234, v235
    ds_write_b64 v96, v[40:41] offset:256
    v_cvt_pk_bf16_f32 v232, v44, v45
    v_lshlrev_b32 v234, 16, v232
    v_and_b32 v235, 0xffff0000, v232
    v_pk_add_f32 v[234:235], v[234:235], v[184:185] op_sel:[0,1] op_sel_hi:[1,1]
    v_cvt_pk_bf16_f32 v44, v234, v235
    v_cvt_pk_bf16_f32 v232, v46, v47
    v_lshlrev_b32 v234, 16, v232
    v_and_b32 v235, 0xffff0000, v232
    v_pk_add_f32 v[234:235], v[234:235], v[184:185] op_sel:[0,1] op_sel_hi:[1,1]
    v_cvt_pk_bf16_f32 v45, v234, v235
    ds_write_b64 v96, v[44:45] offset:4608
    v_cvt_pk_bf16_f32 v232, v48, v49
    v_lshlrev_b32 v234, 16, v232
    v_and_b32 v235, 0xffff0000, v232
    v_pk_add_f32 v[234:235], v[234:235], v[184:185] op_sel:[0,1] op_sel_hi:[1,1]
    v_cvt_pk_bf16_f32 v48, v234, v235
    v_cvt_pk_bf16_f32 v232, v50, v51
    v_lshlrev_b32 v234, 16, v232
    v_and_b32 v235, 0xffff0000, v232
    v_pk_add_f32 v[234:235], v[234:235], v[184:185] op_sel:[0,1] op_sel_hi:[1,1]
    v_cvt_pk_bf16_f32 v49, v234, v235
    ds_write_b64 v96, v[48:49] offset:4640
    v_cvt_pk_bf16_f32 v232, v52, v53
    v_lshlrev_b32 v234, 16, v232
    v_and_b32 v235, 0xffff0000, v232
    v_pk_add_f32 v[234:235], v[234:235], v[184:185] op_sel:[0,1] op_sel_hi:[1,1]
    v_cvt_pk_bf16_f32 v52, v234, v235
    v_cvt_pk_bf16_f32 v232, v54, v55
    v_lshlrev_b32 v234, 16, v232
    v_and_b32 v235, 0xffff0000, v232
    v_pk_add_f32 v[234:235], v[234:235], v[184:185] op_sel:[0,1] op_sel_hi:[1,1]
    v_cvt_pk_bf16_f32 v53, v234, v235
    ds_write_b64 v96, v[52:53] offset:4672
    v_cvt_pk_bf16_f32 v232, v56, v57
    v_lshlrev_b32 v234, 16, v232
    v_and_b32 v235, 0xffff0000, v232
    v_pk_add_f32 v[234:235], v[234:235], v[184:185] op_sel:[0,1] op_sel_hi:[1,1]
    v_cvt_pk_bf16_f32 v56, v234, v235
    v_cvt_pk_bf16_f32 v232, v58, v59
    v_lshlrev_b32 v234, 16, v232
    v_and_b32 v235, 0xffff0000, v232
    v_pk_add_f32 v[234:235], v[234:235], v[184:185] op_sel:[0,1] op_sel_hi:[1,1]
    v_cvt_pk_bf16_f32 v57, v234, v235
    ds_write_b64 v96, v[56:57] offset:4704
    v_cvt_pk_bf16_f32 v232, v60, v61
    v_lshlrev_b32 v234, 16, v232
    v_and_b32 v235, 0xffff0000, v232
    v_pk_add_f32 v[234:235], v[234:235], v[184:185] op_sel:[0,1] op_sel_hi:[1,1]
    v_cvt_pk_bf16_f32 v60, v234, v235
    v_cvt_pk_bf16_f32 v232, v62, v63
    v_lshlrev_b32 v234, 16, v232
    v_and_b32 v235, 0xffff0000, v232
    v_pk_add_f32 v[234:235], v[234:235], v[184:185] op_sel:[0,1] op_sel_hi:[1,1]
    v_cvt_pk_bf16_f32 v61, v234, v235
    ds_write_b64 v96, v[60:61] offset:4736
    v_cvt_pk_bf16_f32 v232, v64, v65
    v_lshlrev_b32 v234, 16, v232
    v_and_b32 v235, 0xffff0000, v232
    v_pk_add_f32 v[234:235], v[234:235], v[184:185] op_sel:[0,1] op_sel_hi:[1,1]
    v_cvt_pk_bf16_f32 v64, v234, v235
    v_cvt_pk_bf16_f32 v232, v66, v67
    v_lshlrev_b32 v234, 16, v232
    v_and_b32 v235, 0xffff0000, v232
    v_pk_add_f32 v[234:235], v[234:235], v[184:185] op_sel:[0,1] op_sel_hi:[1,1]
    v_cvt_pk_bf16_f32 v65, v234, v235
    ds_write_b64 v96, v[64:65] offset:4768
    v_cvt_pk_bf16_f32 v232, v68, v69
    v_lshlrev_b32 v234, 16, v232
    v_and_b32 v235, 0xffff0000, v232
    v_pk_add_f32 v[234:235], v[234:235], v[184:185] op_sel:[0,1] op_sel_hi:[1,1]
    v_cvt_pk_bf16_f32 v68, v234, v235
    v_cvt_pk_bf16_f32 v232, v70, v71
    v_lshlrev_b32 v234, 16, v232
    v_and_b32 v235, 0xffff0000, v232
    v_pk_add_f32 v[234:235], v[234:235], v[184:185] op_sel:[0,1] op_sel_hi:[1,1]
    v_cvt_pk_bf16_f32 v69, v234, v235
    ds_write_b64 v96, v[68:69] offset:4800
    v_cvt_pk_bf16_f32 v232, v72, v73
    v_lshlrev_b32 v234, 16, v232
    v_and_b32 v235, 0xffff0000, v232
    v_pk_add_f32 v[234:235], v[234:235], v[184:185] op_sel:[0,1] op_sel_hi:[1,1]
    v_cvt_pk_bf16_f32 v72, v234, v235
    v_cvt_pk_bf16_f32 v232, v74, v75
    v_lshlrev_b32 v234, 16, v232
    v_and_b32 v235, 0xffff0000, v232
    v_pk_add_f32 v[234:235], v[234:235], v[184:185] op_sel:[0,1] op_sel_hi:[1,1]
    v_cvt_pk_bf16_f32 v73, v234, v235
    ds_write_b64 v96, v[72:73] offset:4832
    v_cvt_pk_bf16_f32 v232, v76, v77
    v_lshlrev_b32 v234, 16, v232
    v_and_b32 v235, 0xffff0000, v232
    v_pk_add_f32 v[234:235], v[234:235], v[184:185] op_sel:[0,1] op_sel_hi:[1,1]
    v_cvt_pk_bf16_f32 v76, v234, v235
    v_cvt_pk_bf16_f32 v232, v78, v79
    v_lshlrev_b32 v234, 16, v232
    v_and_b32 v235, 0xffff0000, v232
    v_pk_add_f32 v[234:235], v[234:235], v[184:185] op_sel:[0,1] op_sel_hi:[1,1]
    v_cvt_pk_bf16_f32 v77, v234, v235
    ds_write_b64 v96, v[76:77] offset:4864
    s_waitcnt lgkmcnt(0)
    ds_read_b128 v[8:11], v97 offset:0
    ds_read_b128 v[12:15], v97 offset:1024
    ds_read_b128 v[16:19], v97 offset:2048
    ds_read_b128 v[20:23], v97 offset:3072
    ds_read_b128 v[24:27], v97 offset:4096
    ds_read_b128 v[28:31], v97 offset:5120
    ds_read_b128 v[32:35], v97 offset:6144
    ds_read_b128 v[36:39], v97 offset:7168
    ds_read_b128 v[40:43], v97 offset:8192
    s_waitcnt lgkmcnt(8)
    v_lshlrev_b32 v234, 16, v8
    v_and_b32 v235, 0xffff0000, v8
    v_lshlrev_b32 v236, 16, v196
    v_and_b32 v237, 0xffff0000, v196
    v_pk_mul_f32 v[234:235], v[234:235], v[236:237]
    v_cvt_pk_bf16_f32 v196, v234, v235
    v_lshlrev_b32 v234, 16, v9
    v_and_b32 v235, 0xffff0000, v9
    v_lshlrev_b32 v236, 16, v197
    v_and_b32 v237, 0xffff0000, v197
    v_pk_mul_f32 v[234:235], v[234:235], v[236:237]
    v_cvt_pk_bf16_f32 v197, v234, v235
    v_lshlrev_b32 v234, 16, v10
    v_and_b32 v235, 0xffff0000, v10
    v_lshlrev_b32 v236, 16, v198
    v_and_b32 v237, 0xffff0000, v198
    v_pk_mul_f32 v[234:235], v[234:235], v[236:237]
    v_cvt_pk_bf16_f32 v198, v234, v235
    v_lshlrev_b32 v234, 16, v11
    v_and_b32 v235, 0xffff0000, v11
    v_lshlrev_b32 v236, 16, v199
    v_and_b32 v237, 0xffff0000, v199
    v_pk_mul_f32 v[234:235], v[234:235], v[236:237]
    v_cvt_pk_bf16_f32 v199, v234, v235
    buffer_store_dwordx4 v[196:199], v186, s[40:43], 0 offen sc1
    s_waitcnt lgkmcnt(7)
    v_lshlrev_b32 v234, 16, v12
    v_and_b32 v235, 0xffff0000, v12
    v_lshlrev_b32 v236, 16, v200
    v_and_b32 v237, 0xffff0000, v200
    v_pk_mul_f32 v[234:235], v[234:235], v[236:237]
    v_cvt_pk_bf16_f32 v200, v234, v235
    v_lshlrev_b32 v234, 16, v13
    v_and_b32 v235, 0xffff0000, v13
    v_lshlrev_b32 v236, 16, v201
    v_and_b32 v237, 0xffff0000, v201
    v_pk_mul_f32 v[234:235], v[234:235], v[236:237]
    v_cvt_pk_bf16_f32 v201, v234, v235
    v_lshlrev_b32 v234, 16, v14
    v_and_b32 v235, 0xffff0000, v14
    v_lshlrev_b32 v236, 16, v202
    v_and_b32 v237, 0xffff0000, v202
    v_pk_mul_f32 v[234:235], v[234:235], v[236:237]
    v_cvt_pk_bf16_f32 v202, v234, v235
    v_lshlrev_b32 v234, 16, v15
    v_and_b32 v235, 0xffff0000, v15
    v_lshlrev_b32 v236, 16, v203
    v_and_b32 v237, 0xffff0000, v203
    v_pk_mul_f32 v[234:235], v[234:235], v[236:237]
    v_cvt_pk_bf16_f32 v203, v234, v235
    buffer_store_dwordx4 v[200:203], v187, s[40:43], 0 offen sc1
    s_waitcnt lgkmcnt(6)
    v_lshlrev_b32 v234, 16, v16
    v_and_b32 v235, 0xffff0000, v16
    v_lshlrev_b32 v236, 16, v204
    v_and_b32 v237, 0xffff0000, v204
    v_pk_mul_f32 v[234:235], v[234:235], v[236:237]
    v_cvt_pk_bf16_f32 v204, v234, v235
    v_lshlrev_b32 v234, 16, v17
    v_and_b32 v235, 0xffff0000, v17
    v_lshlrev_b32 v236, 16, v205
    v_and_b32 v237, 0xffff0000, v205
    v_pk_mul_f32 v[234:235], v[234:235], v[236:237]
    v_cvt_pk_bf16_f32 v205, v234, v235
    v_lshlrev_b32 v234, 16, v18
    v_and_b32 v235, 0xffff0000, v18
    v_lshlrev_b32 v236, 16, v206
    v_and_b32 v237, 0xffff0000, v206
    v_pk_mul_f32 v[234:235], v[234:235], v[236:237]
    v_cvt_pk_bf16_f32 v206, v234, v235
    v_lshlrev_b32 v234, 16, v19
    v_and_b32 v235, 0xffff0000, v19
    v_lshlrev_b32 v236, 16, v207
    v_and_b32 v237, 0xffff0000, v207
    v_pk_mul_f32 v[234:235], v[234:235], v[236:237]
    v_cvt_pk_bf16_f32 v207, v234, v235
    buffer_store_dwordx4 v[204:207], v188, s[40:43], 0 offen sc1
    s_waitcnt lgkmcnt(5)
    v_lshlrev_b32 v234, 16, v20
    v_and_b32 v235, 0xffff0000, v20
    v_lshlrev_b32 v236, 16, v208
    v_and_b32 v237, 0xffff0000, v208
    v_pk_mul_f32 v[234:235], v[234:235], v[236:237]
    v_cvt_pk_bf16_f32 v208, v234, v235
    v_lshlrev_b32 v234, 16, v21
    v_and_b32 v235, 0xffff0000, v21
    v_lshlrev_b32 v236, 16, v209
    v_and_b32 v237, 0xffff0000, v209
    v_pk_mul_f32 v[234:235], v[234:235], v[236:237]
    v_cvt_pk_bf16_f32 v209, v234, v235
    v_lshlrev_b32 v234, 16, v22
    v_and_b32 v235, 0xffff0000, v22
    v_lshlrev_b32 v236, 16, v210
    v_and_b32 v237, 0xffff0000, v210
    v_pk_mul_f32 v[234:235], v[234:235], v[236:237]
    v_cvt_pk_bf16_f32 v210, v234, v235
    v_lshlrev_b32 v234, 16, v23
    v_and_b32 v235, 0xffff0000, v23
    v_lshlrev_b32 v236, 16, v211
    v_and_b32 v237, 0xffff0000, v211
    v_pk_mul_f32 v[234:235], v[234:235], v[236:237]
    v_cvt_pk_bf16_f32 v211, v234, v235
    buffer_store_dwordx4 v[208:211], v189, s[40:43], 0 offen sc1
    s_waitcnt lgkmcnt(4)
    v_lshlrev_b32 v234, 16, v24
    v_and_b32 v235, 0xffff0000, v24
    v_lshlrev_b32 v236, 16, v212
    v_and_b32 v237, 0xffff0000, v212
    v_pk_mul_f32 v[234:235], v[234:235], v[236:237]
    v_cvt_pk_bf16_f32 v212, v234, v235
    v_lshlrev_b32 v234, 16, v25
    v_and_b32 v235, 0xffff0000, v25
    v_lshlrev_b32 v236, 16, v213
    v_and_b32 v237, 0xffff0000, v213
    v_pk_mul_f32 v[234:235], v[234:235], v[236:237]
    v_cvt_pk_bf16_f32 v213, v234, v235
    v_lshlrev_b32 v234, 16, v26
    v_and_b32 v235, 0xffff0000, v26
    v_lshlrev_b32 v236, 16, v214
    v_and_b32 v237, 0xffff0000, v214
    v_pk_mul_f32 v[234:235], v[234:235], v[236:237]
    v_cvt_pk_bf16_f32 v214, v234, v235
    v_lshlrev_b32 v234, 16, v27
    v_and_b32 v235, 0xffff0000, v27
    v_lshlrev_b32 v236, 16, v215
    v_and_b32 v237, 0xffff0000, v215
    v_pk_mul_f32 v[234:235], v[234:235], v[236:237]
    v_cvt_pk_bf16_f32 v215, v234, v235
    buffer_store_dwordx4 v[212:215], v190, s[40:43], 0 offen sc1
    s_waitcnt lgkmcnt(3)
    v_lshlrev_b32 v234, 16, v28
    v_and_b32 v235, 0xffff0000, v28
    v_lshlrev_b32 v236, 16, v216
    v_and_b32 v237, 0xffff0000, v216
    v_pk_mul_f32 v[234:235], v[234:235], v[236:237]
    v_cvt_pk_bf16_f32 v216, v234, v235
    v_lshlrev_b32 v234, 16, v29
    v_and_b32 v235, 0xffff0000, v29
    v_lshlrev_b32 v236, 16, v217
    v_and_b32 v237, 0xffff0000, v217
    v_pk_mul_f32 v[234:235], v[234:235], v[236:237]
    v_cvt_pk_bf16_f32 v217, v234, v235
    v_lshlrev_b32 v234, 16, v30
    v_and_b32 v235, 0xffff0000, v30
    v_lshlrev_b32 v236, 16, v218
    v_and_b32 v237, 0xffff0000, v218
    v_pk_mul_f32 v[234:235], v[234:235], v[236:237]
    v_cvt_pk_bf16_f32 v218, v234, v235
    v_lshlrev_b32 v234, 16, v31
    v_and_b32 v235, 0xffff0000, v31
    v_lshlrev_b32 v236, 16, v219
    v_and_b32 v237, 0xffff0000, v219
    v_pk_mul_f32 v[234:235], v[234:235], v[236:237]
    v_cvt_pk_bf16_f32 v219, v234, v235
    buffer_store_dwordx4 v[216:219], v191, s[40:43], 0 offen sc1
    s_waitcnt lgkmcnt(2)
    v_lshlrev_b32 v234, 16, v32
    v_and_b32 v235, 0xffff0000, v32
    v_lshlrev_b32 v236, 16, v220
    v_and_b32 v237, 0xffff0000, v220
    v_pk_mul_f32 v[234:235], v[234:235], v[236:237]
    v_cvt_pk_bf16_f32 v220, v234, v235
    v_lshlrev_b32 v234, 16, v33
    v_and_b32 v235, 0xffff0000, v33
    v_lshlrev_b32 v236, 16, v221
    v_and_b32 v237, 0xffff0000, v221
    v_pk_mul_f32 v[234:235], v[234:235], v[236:237]
    v_cvt_pk_bf16_f32 v221, v234, v235
    v_lshlrev_b32 v234, 16, v34
    v_and_b32 v235, 0xffff0000, v34
    v_lshlrev_b32 v236, 16, v222
    v_and_b32 v237, 0xffff0000, v222
    v_pk_mul_f32 v[234:235], v[234:235], v[236:237]
    v_cvt_pk_bf16_f32 v222, v234, v235
    v_lshlrev_b32 v234, 16, v35
    v_and_b32 v235, 0xffff0000, v35
    v_lshlrev_b32 v236, 16, v223
    v_and_b32 v237, 0xffff0000, v223
    v_pk_mul_f32 v[234:235], v[234:235], v[236:237]
    v_cvt_pk_bf16_f32 v223, v234, v235
    buffer_store_dwordx4 v[220:223], v192, s[40:43], 0 offen sc1
    s_waitcnt lgkmcnt(1)
    v_lshlrev_b32 v234, 16, v36
    v_and_b32 v235, 0xffff0000, v36
    v_lshlrev_b32 v236, 16, v224
    v_and_b32 v237, 0xffff0000, v224
    v_pk_mul_f32 v[234:235], v[234:235], v[236:237]
    v_cvt_pk_bf16_f32 v224, v234, v235
    v_lshlrev_b32 v234, 16, v37
    v_and_b32 v235, 0xffff0000, v37
    v_lshlrev_b32 v236, 16, v225
    v_and_b32 v237, 0xffff0000, v225
    v_pk_mul_f32 v[234:235], v[234:235], v[236:237]
    v_cvt_pk_bf16_f32 v225, v234, v235
    v_lshlrev_b32 v234, 16, v38
    v_and_b32 v235, 0xffff0000, v38
    v_lshlrev_b32 v236, 16, v226
    v_and_b32 v237, 0xffff0000, v226
    v_pk_mul_f32 v[234:235], v[234:235], v[236:237]
    v_cvt_pk_bf16_f32 v226, v234, v235
    v_lshlrev_b32 v234, 16, v39
    v_and_b32 v235, 0xffff0000, v39
    v_lshlrev_b32 v236, 16, v227
    v_and_b32 v237, 0xffff0000, v227
    v_pk_mul_f32 v[234:235], v[234:235], v[236:237]
    v_cvt_pk_bf16_f32 v227, v234, v235
    buffer_store_dwordx4 v[224:227], v193, s[40:43], 0 offen sc1
    s_waitcnt lgkmcnt(0)
    v_lshlrev_b32 v234, 16, v40
    v_and_b32 v235, 0xffff0000, v40
    v_lshlrev_b32 v236, 16, v228
    v_and_b32 v237, 0xffff0000, v228
    v_pk_mul_f32 v[234:235], v[234:235], v[236:237]
    v_cvt_pk_bf16_f32 v228, v234, v235
    v_lshlrev_b32 v234, 16, v41
    v_and_b32 v235, 0xffff0000, v41
    v_lshlrev_b32 v236, 16, v229
    v_and_b32 v237, 0xffff0000, v229
    v_pk_mul_f32 v[234:235], v[234:235], v[236:237]
    v_cvt_pk_bf16_f32 v229, v234, v235
    v_lshlrev_b32 v234, 16, v42
    v_and_b32 v235, 0xffff0000, v42
    v_lshlrev_b32 v236, 16, v230
    v_and_b32 v237, 0xffff0000, v230
    v_pk_mul_f32 v[234:235], v[234:235], v[236:237]
    v_cvt_pk_bf16_f32 v230, v234, v235
    v_lshlrev_b32 v234, 16, v43
    v_and_b32 v235, 0xffff0000, v43
    v_lshlrev_b32 v236, 16, v231
    v_and_b32 v237, 0xffff0000, v231
    v_pk_mul_f32 v[234:235], v[234:235], v[236:237]
    v_cvt_pk_bf16_f32 v231, v234, v235
    buffer_store_dwordx4 v[228:231], v194, s[40:43], 0 offen sc1
k4_kernel_end:
    s_endpgm
.globl k5_kernel
.p2align 8
.type k5_kernel,@function
k5_kernel:
    s_cmp_ge_u32 s2, 256
    s_cbranch_scc1 k5_kernel_end
    s_load_dwordx16 s[4:19], s[0:1], 0
    s_load_dwordx8 s[20:27], s[0:1], 64
    v_and_b32 v1, 63, v0
    v_lshrrev_b32 v2, 6, v0
    s_nop 0
    v_readfirstlane_b32 s72, v2
    s_and_b32 s52, s72, 3
    s_lshr_b32 s72, s72, 2
    s_and_b32 s60, s2, 7
    s_lshr_b32 s61, s2, 3
    s_lshl_b32 s57, s60, 2
    s_lshr_b32 s62, s61, 3
    s_add_u32 s57, s57, s62
    s_lshl_b32 s57, s57, 6
    s_and_b32 s58, s61, 7
    s_mul_i32 s58, s58, 72
    s_lshr_b32 s71, s61, 1
    s_add_u32 s71, s71, s62
    s_waitcnt lgkmcnt(0)
    s_add_u32 s28, s26, 50331648
    s_addc_u32 s29, s27, 0
    s_and_b32 s29, s29, 0xffff
    s_mov_b32 s30, 9437184
    s_mov_b32 s31, 0x00020000
    s_add_u32 s32, s26, 77594624
    s_addc_u32 s33, s27, 0
    s_and_b32 s33, s33, 0xffff
    s_mov_b32 s34, 2949120
    s_mov_b32 s35, 0x00020000
    s_add_u32 s36, s26, 13631488
    s_addc_u32 s37, s27, 0
    s_and_b32 s37, s37, 0xffff
    s_mov_b32 s38, 2359296
    s_mov_b32 s39, 0x00020000
    s_mov_b32 s40, s22
    s_and_b32 s41, s23, 0xffff
    s_mov_b32 s42, 2359296
    s_mov_b32 s43, 0x00020000
    s_mul_i32 s63, s52, 16
    s_add_u32 s63, s63, s57
    s_lshl_b32 s64, s58, 1
    s_mul_i32 s65, s58, 5120
    s_mul_i32 s53, s52, 2560
    s_add_u32 s53, s53, 32768
    s_lshl_b32 s60, s52, 4
    v_add_u32 v2, 0, v1
    v_mul_u32_u24 v3, 6554, v2
    v_lshrrev_b32 v3, 16, v3
    v_mul_u32_u24 v4, 10, v3
    v_sub_u32 v2, v2, v4
    v_and_b32 v4, 3, v3
    v_and_b32 v5, 4, v3
    v_lshl_or_b32 v4, v5, 1, v4
    v_and_b32 v5, 8, v3
    v_lshrrev_b32 v5, 1, v5
    v_or_b32 v4, v4, v5
    v_add_u32 v4, s60, v4
    s_mov_b32 s61, 160
    v_mul_lo_u32 v4, v4, s61
    v_lshlrev_b32 v2, 4, v2
    v_add_u32 v28, v4, v2
    v_add_u32 v28, s65, v28
    v_add_u32 v2, 64, v1
    v_mul_u32_u24 v3, 6554, v2
    v_lshrrev_b32 v3, 16, v3
    v_mul_u32_u24 v4, 10, v3
    v_sub_u32 v2, v2, v4
    v_and_b32 v4, 3, v3
    v_and_b32 v5, 4, v3
    v_lshl_or_b32 v4, v5, 1, v4
    v_and_b32 v5, 8, v3
    v_lshrrev_b32 v5, 1, v5
    v_or_b32 v4, v4, v5
    v_add_u32 v4, s60, v4
    s_mov_b32 s61, 160
    v_mul_lo_u32 v4, v4, s61
    v_lshlrev_b32 v2, 4, v2
    v_add_u32 v29, v4, v2
    v_add_u32 v29, s65, v29
    v_add_u32 v2, 128, v1
    v_mul_u32_u24 v3, 6554, v2
    v_lshrrev_b32 v3, 16, v3
    v_mul_u32_u24 v4, 10, v3
    v_sub_u32 v2, v2, v4
    v_and_b32 v4, 3, v3
    v_and_b32 v5, 4, v3
    v_lshl_or_b32 v4, v5, 1, v4
    v_and_b32 v5, 8, v3
    v_lshrrev_b32 v5, 1, v5
    v_or_b32 v4, v4, v5
    v_add_u32 v4, s60, v4
    s_mov_b32 s61, 160
    v_mul_lo_u32 v4, v4, s61
    v_lshlrev_b32 v2, 4, v2
    v_add_u32 v30, v4, v2
    v_add_u32 v30, s65, v30
    v_lshrrev_b32 v2, 5, v1
    v_lshlrev_b32 v2, 4, v2
    v_bfe_u32 v3, v1, 4, 1
    v_lshl_or_b32 v2, v3, 2, v2
    v_bfe_u32 v3, v1, 2, 2
    v_add_u32 v2, v2, v3
    v_mul_u32_u24 v2, 160, v2
    v_and_b32 v3, 3, v1
    v_lshl_add_u32 v2, v3, 3, v2
    v_add_u32 v31, 32768, v2
    v_add_u32 v32, 43008, v2
    v_add_u32 v33, 53248, v2
    v_add_u32 v34, 63488, v2
    s_mul_i32 s59, s52, 2048
    v_lshrrev_b32 v2, 3, v1
    v_and_b32 v3, 7, v1
    v_xor_b32 v3, v3, v2
    v_add_u32 v2, s63, v2
    s_mov_b32 s60, 4608
    v_mul_lo_u32 v2, v2, s60
    v_lshl_add_u32 v2, v3, 4, v2
    v_add_u32 v35, 0, v2
    v_add_u32 v36, 36864, v2
    v_and_b32 v2, 15, v1
    v_lshrrev_b32 v3, 4, v1
    v_and_b32 v4, 7, v1
    v_xor_b32 v3, v3, v4
    v_lshlrev_b32 v3, 4, v3
    v_lshl_add_u32 v2, v2, 7, v3
    v_add_u32 v37, s59, v2
    v_xor_b32 v38, 64, v37
    s_mov_b32 s70, 0
    s_and_b32 s55, s71, 3
    s_mul_i32 s54, s55, 10240
    s_lshl_b32 s55, s55, 7
    s_cmp_eq_u32 s72, 0
    s_cbranch_scc1 k5_kernel_comp
    s_add_u32 m0, s59, 0
    s_nop 0
    buffer_load_dwordx4 v35, s[28:31], s55 offen lds
    s_add_u32 m0, s59, 1024
    s_nop 0
    buffer_load_dwordx4 v36, s[28:31], s55 offen lds
    s_add_u32 m0, s53, 0
    s_nop 0
    buffer_load_dwordx4 v28, s[32:35], s54 offen lds
    s_add_u32 m0, s53, 1024
    s_nop 0
    buffer_load_dwordx4 v29, s[32:35], s54 offen lds
    s_add_u32 m0, s53, 2048
    s_nop 0
    s_mov_b32 exec_hi, 0
    buffer_load_dwordx4 v30, s[32:35], s54 offen lds
    s_mov_b32 exec_hi, -1
    s_add_u32 s70, s70, 1
    s_add_u32 s55, s70, s71
    s_and_b32 s55, s55, 3
    s_and_b32 s54, s70, 65532
    s_or_b32 s55, s55, s54
    s_mul_i32 s54, s55, 10240
    s_lshl_b32 s55, s55, 7
    s_add_u32 m0, s59, 8192
    s_nop 0
    buffer_load_dwordx4 v35, s[28:31], s55 offen lds
    s_add_u32 m0, s59, 9216
    s_nop 0
    buffer_load_dwordx4 v36, s[28:31], s55 offen lds
    s_add_u32 m0, s53, 10240
    s_nop 0
    buffer_load_dwordx4 v28, s[32:35], s54 offen lds
    s_add_u32 m0, s53, 11264
    s_nop 0
    buffer_load_dwordx4 v29, s[32:35], s54 offen lds
    s_add_u32 m0, s53, 12288
    s_nop 0
    s_mov_b32 exec_hi, 0
    buffer_load_dwordx4 v30, s[32:35], s54 offen lds
    s_mov_b32 exec_hi, -1
    s_add_u32 s70, s70, 1
    s_add_u32 s55, s70, s71
    s_and_b32 s55, s55, 3
    s_and_b32 s54, s70, 65532
    s_or_b32 s55, s55, s54
    s_mul_i32 s54, s55, 10240
    s_lshl_b32 s55, s55, 7
    s_add_u32 m0, s59, 16384
    s_nop 0
    buffer_load_dwordx4 v35, s[28:31], s55 offen lds
    s_add_u32 m0, s59, 17408
    s_nop 0
    buffer_load_dwordx4 v36, s[28:31], s55 offen lds
    s_add_u32 m0, s53, 20480
    s_nop 0
    buffer_load_dwordx4 v28, s[32:35], s54 offen lds
    s_add_u32 m0, s53, 21504
    s_nop 0
    buffer_load_dwordx4 v29, s[32:35], s54 offen lds
    s_add_u32 m0, s53, 22528
    s_nop 0
    s_mov_b32 exec_hi, 0
    buffer_load_dwordx4 v30, s[32:35], s54 offen lds
    s_mov_b32 exec_hi, -1
    s_add_u32 s70, s70, 1
    s_add_u32 s55, s70, s71
    s_and_b32 s55, s55, 3
    s_and_b32 s54, s70, 65532
    s_or_b32 s55, s55, s54
    s_mul_i32 s54, s55, 10240
    s_lshl_b32 s55, s55, 7
    s_add_u32 m0, s59, 24576
    s_nop 0
    buffer_load_dwordx4 v35, s[28:31], s55 offen lds
    s_add_u32 m0, s59, 25600
    s_nop 0
    buffer_load_dwordx4 v36, s[28:31], s55 offen lds
    s_add_u32 m0, s53, 30720
    s_nop 0
    buffer_load_dwordx4 v28, s[32:35], s54 offen lds
    s_add_u32 m0, s53, 31744
    s_nop 0
    buffer_load_dwordx4 v29, s[32:35], s54 offen lds
    s_add_u32 m0, s53, 32768
    s_nop 0
    s_mov_b32 exec_hi, 0
    buffer_load_dwordx4 v30, s[32:35], s54 offen lds
    s_mov_b32 exec_hi, -1
    s_add_u32 s70, s70, 1
    s_add_u32 s55, s70, s71
    s_and_b32 s55, s55, 3
    s_and_b32 s54, s70, 65532
    s_or_b32 s55, s55, s54
    s_mul_i32 s54, s55, 10240
    s_lshl_b32 s55, s55, 7
    s_waitcnt vmcnt(15)
    s_barrier
    s_mov_b32 s56, 9
k5_kernel_lloop:
    s_waitcnt vmcnt(10)
    s_barrier
    s_add_u32 m0, s59, 0
    s_nop 0
    buffer_load_dwordx4 v35, s[28:31], s55 offen lds
    s_add_u32 m0, s59, 1024
    s_nop 0
    buffer_load_dwordx4 v36, s[28:31], s55 offen lds
    s_add_u32 m0, s53, 0
    s_nop 0
    buffer_load_dwordx4 v28, s[32:35], s54 offen lds
    s_add_u32 m0, s53, 1024
    s_nop 0
    buffer_load_dwordx4 v29, s[32:35], s54 offen lds
    s_add_u32 m0, s53, 2048
    s_nop 0
    s_mov_b32 exec_hi, 0
    buffer_load_dwordx4 v30, s[32:35], s54 offen lds
    s_mov_b32 exec_hi, -1
    s_add_u32 s70, s70, 1
    s_add_u32 s55, s70, s71
    s_and_b32 s55, s55, 3
    s_and_b32 s54, s70, 65532
    s_or_b32 s55, s55, s54
    s_mul_i32 s54, s55, 10240
    s_lshl_b32 s55, s55, 7
    s_waitcnt vmcnt(10)
    s_barrier
    s_add_u32 m0, s59, 8192
    s_nop 0
    buffer_load_dwordx4 v35, s[28:31], s55 offen lds
    s_add_u32 m0, s59, 9216
    s_nop 0
    buffer_load_dwordx4 v36, s[28:31], s55 offen lds
    s_add_u32 m0, s53, 10240
    s_nop 0
    buffer_load_dwordx4 v28, s[32:35], s54 offen lds
    s_add_u32 m0, s53, 11264
    s_nop 0
    buffer_load_dwordx4 v29, s[32:35], s54 offen lds
    s_add_u32 m0, s53, 12288
    s_nop 0
    s_mov_b32 exec_hi, 0
    buffer_load_dwordx4 v30, s[32:35], s54 offen lds
    s_mov_b32 exec_hi, -1
    s_add_u32 s70, s70, 1
    s_add_u32 s55, s70, s71
    s_and_b32 s55, s55, 3
    s_and_b32 s54, s70, 65532
    s_or_b32 s55, s55, s54
    s_mul_i32 s54, s55, 10240
    s_lshl_b32 s55, s55, 7
    s_waitcnt vmcnt(10)
    s_barrier
    s_add_u32 m0, s59, 16384
    s_nop 0
    buffer_load_dwordx4 v35, s[28:31], s55 offen lds
    s_add_u32 m0, s59, 17408
    s_nop 0
    buffer_load_dwordx4 v36, s[28:31], s55 offen lds
    s_add_u32 m0, s53, 20480
    s_nop 0
    buffer_load_dwordx4 v28, s[32:35], s54 offen lds
    s_add_u32 m0, s53, 21504
    s_nop 0
    buffer_load_dwordx4 v29, s[32:35], s54 offen lds
    s_add_u32 m0, s53, 22528
    s_nop 0
    s_mov_b32 exec_hi, 0
    buffer_load_dwordx4 v30, s[32:35], s54 offen lds
    s_mov_b32 exec_hi, -1
    s_add_u32 s70, s70, 1
    s_add_u32 s55, s70, s71
    s_and_b32 s55, s55, 3
    s_and_b32 s54, s70, 65532
    s_or_b32 s55, s55, s54
    s_mul_i32 s54, s55, 10240
    s_lshl_b32 s55, s55, 7
    s_waitcnt vmcnt(10)
    s_barrier
    s_add_u32 m0, s59, 24576
    s_nop 0
    buffer_load_dwordx4 v35, s[28:31], s55 offen lds
    s_add_u32 m0, s59, 25600
    s_nop 0
    buffer_load_dwordx4 v36, s[28:31], s55 offen lds
    s_add_u32 m0, s53, 30720
    s_nop 0
    buffer_load_dwordx4 v28, s[32:35], s54 offen lds
    s_add_u32 m0, s53, 31744
    s_nop 0
    buffer_load_dwordx4 v29, s[32:35], s54 offen lds
    s_add_u32 m0, s53, 32768
    s_nop 0
    s_mov_b32 exec_hi, 0
    buffer_load_dwordx4 v30, s[32:35], s54 offen lds
    s_mov_b32 exec_hi, -1
    s_add_u32 s70, s70, 1
    s_add_u32 s55, s70, s71
    s_and_b32 s55, s55, 3
    s_and_b32 s54, s70, 65532
    s_or_b32 s55, s55, s54
    s_mul_i32 s54, s55, 10240
    s_lshl_b32 s55, s55, 7
    s_sub_u32 s56, s56, 1
    s_cmp_lg_u32 s56, 0
    s_cbranch_scc1 k5_kernel_lloop
    s_waitcnt vmcnt(0)
    s_branch k5_kernel_end
k5_kernel_comp:
    v_mov_b32 v8, 0
    v_mov_b32 v9, 0
    v_mov_b32 v10, 0
    v_mov_b32 v11, 0
    v_mov_b32 v12, 0
    v_mov_b32 v13, 0
    v_mov_b32 v14, 0
    v_mov_b32 v15, 0
    v_mov_b32 v16, 0
    v_mov_b32 v17, 0
    v_mov_b32 v18, 0
    v_mov_b32 v19, 0
    v_mov_b32 v20, 0
    v_mov_b32 v21, 0
    v_mov_b32 v22, 0
    v_mov_b32 v23, 0
    v_mov_b32 v24, 0
    v_mov_b32 v25, 0
    v_mov_b32 v26, 0
    v_mov_b32 v27, 0
    s_barrier
    ds_read_b128 v[80:83], v37 offset:0
    ds_read_b64_tr_b16 v[40:41], v31 offset:0
    ds_read_b64_tr_b16 v[42:43], v31 offset:1280
    ds_read_b64_tr_b16 v[44:45], v31 offset:32
    ds_read_b64_tr_b16 v[46:47], v31 offset:1312
    ds_read_b64_tr_b16 v[48:49], v31 offset:64
    ds_read_b64_tr_b16 v[50:51], v31 offset:1344
    ds_read_b64_tr_b16 v[52:53], v31 offset:96
    ds_read_b64_tr_b16 v[54:55], v31 offset:1376
    ds_read_b64_tr_b16 v[56:57], v31 offset:128
    ds_read_b64_tr_b16 v[58:59], v31 offset:1408
    s_mov_b32 s56, 9
k5_kernel_loop:
    s_waitcnt lgkmcnt(0)
    ds_read_b128 v[84:87], v38 offset:0
    ds_read_b64_tr_b16 v[60:61], v31 offset:5120
    v_mfma_f32_16x16x32_bf16 v[8:11], v[40:43], v[80:83], v[8:11]
    ds_read_b64_tr_b16 v[62:63], v31 offset:6400
    ds_read_b64_tr_b16 v[64:65], v31 offset:5152
    v_mfma_f32_16x16x32_bf16 v[12:15], v[44:47], v[80:83], v[12:15]
    ds_read_b64_tr_b16 v[66:67], v31 offset:6432
    ds_read_b64_tr_b16 v[68:69], v31 offset:5184
    v_mfma_f32_16x16x32_bf16 v[16:19], v[48:51], v[80:83], v[16:19]
    ds_read_b64_tr_b16 v[70:71], v31 offset:6464
    ds_read_b64_tr_b16 v[72:73], v31 offset:5216
    v_mfma_f32_16x16x32_bf16 v[20:23], v[52:55], v[80:83], v[20:23]
    ds_read_b64_tr_b16 v[74:75], v31 offset:6496
    ds_read_b64_tr_b16 v[76:77], v31 offset:5248
    v_mfma_f32_16x16x32_bf16 v[24:27], v[56:59], v[80:83], v[24:27]
    ds_read_b64_tr_b16 v[78:79], v31 offset:6528
    s_waitcnt lgkmcnt(0)
    s_barrier
    ds_read_b128 v[80:83], v37 offset:8192
    ds_read_b64_tr_b16 v[40:41], v32 offset:0
    v_mfma_f32_16x16x32_bf16 v[8:11], v[60:63], v[84:87], v[8:11]
    ds_read_b64_tr_b16 v[42:43], v32 offset:1280
    ds_read_b64_tr_b16 v[44:45], v32 offset:32
    v_mfma_f32_16x16x32_bf16 v[12:15], v[64:67], v[84:87], v[12:15]
    ds_read_b64_tr_b16 v[46:47], v32 offset:1312
    ds_read_b64_tr_b16 v[48:49], v32 offset:64
    v_mfma_f32_16x16x32_bf16 v[16:19], v[68:71], v[84:87], v[16:19]
    ds_read_b64_tr_b16 v[50:51], v32 offset:1344
    ds_read_b64_tr_b16 v[52:53], v32 offset:96
    v_mfma_f32_16x16x32_bf16 v[20:23], v[72:75], v[84:87], v[20:23]
    ds_read_b64_tr_b16 v[54:55], v32 offset:1376
    ds_read_b64_tr_b16 v[56:57], v32 offset:128
    v_mfma_f32_16x16x32_bf16 v[24:27], v[76:79], v[84:87], v[24:27]
    ds_read_b64_tr_b16 v[58:59], v32 offset:1408
    s_waitcnt lgkmcnt(0)
    ds_read_b128 v[84:87], v38 offset:8192
    ds_read_b64_tr_b16 v[60:61], v32 offset:5120
    v_mfma_f32_16x16x32_bf16 v[8:11], v[40:43], v[80:83], v[8:11]
    ds_read_b64_tr_b16 v[62:63], v32 offset:6400
    ds_read_b64_tr_b16 v[64:65], v32 offset:5152
    v_mfma_f32_16x16x32_bf16 v[12:15], v[44:47], v[80:83], v[12:15]
    ds_read_b64_tr_b16 v[66:67], v32 offset:6432
    ds_read_b64_tr_b16 v[68:69], v32 offset:5184
    v_mfma_f32_16x16x32_bf16 v[16:19], v[48:51], v[80:83], v[16:19]
    ds_read_b64_tr_b16 v[70:71], v32 offset:6464
    ds_read_b64_tr_b16 v[72:73], v32 offset:5216
    v_mfma_f32_16x16x32_bf16 v[20:23], v[52:55], v[80:83], v[20:23]
    ds_read_b64_tr_b16 v[74:75], v32 offset:6496
    ds_read_b64_tr_b16 v[76:77], v32 offset:5248
    v_mfma_f32_16x16x32_bf16 v[24:27], v[56:59], v[80:83], v[24:27]
    ds_read_b64_tr_b16 v[78:79], v32 offset:6528
    s_waitcnt lgkmcnt(0)
    s_barrier
    ds_read_b128 v[80:83], v37 offset:16384
    ds_read_b64_tr_b16 v[40:41], v33 offset:0
    v_mfma_f32_16x16x32_bf16 v[8:11], v[60:63], v[84:87], v[8:11]
    ds_read_b64_tr_b16 v[42:43], v33 offset:1280
    ds_read_b64_tr_b16 v[44:45], v33 offset:32
    v_mfma_f32_16x16x32_bf16 v[12:15], v[64:67], v[84:87], v[12:15]
    ds_read_b64_tr_b16 v[46:47], v33 offset:1312
    ds_read_b64_tr_b16 v[48:49], v33 offset:64
    v_mfma_f32_16x16x32_bf16 v[16:19], v[68:71], v[84:87], v[16:19]
    ds_read_b64_tr_b16 v[50:51], v33 offset:1344
    ds_read_b64_tr_b16 v[52:53], v33 offset:96
    v_mfma_f32_16x16x32_bf16 v[20:23], v[72:75], v[84:87], v[20:23]
    ds_read_b64_tr_b16 v[54:55], v33 offset:1376
    ds_read_b64_tr_b16 v[56:57], v33 offset:128
    v_mfma_f32_16x16x32_bf16 v[24:27], v[76:79], v[84:87], v[24:27]
    ds_read_b64_tr_b16 v[58:59], v33 offset:1408
    s_waitcnt lgkmcnt(0)
    ds_read_b128 v[84:87], v38 offset:16384
    ds_read_b64_tr_b16 v[60:61], v33 offset:5120
    v_mfma_f32_16x16x32_bf16 v[8:11], v[40:43], v[80:83], v[8:11]
    ds_read_b64_tr_b16 v[62:63], v33 offset:6400
    ds_read_b64_tr_b16 v[64:65], v33 offset:5152
    v_mfma_f32_16x16x32_bf16 v[12:15], v[44:47], v[80:83], v[12:15]
    ds_read_b64_tr_b16 v[66:67], v33 offset:6432
    ds_read_b64_tr_b16 v[68:69], v33 offset:5184
    v_mfma_f32_16x16x32_bf16 v[16:19], v[48:51], v[80:83], v[16:19]
    ds_read_b64_tr_b16 v[70:71], v33 offset:6464
    ds_read_b64_tr_b16 v[72:73], v33 offset:5216
    v_mfma_f32_16x16x32_bf16 v[20:23], v[52:55], v[80:83], v[20:23]
    ds_read_b64_tr_b16 v[74:75], v33 offset:6496
    ds_read_b64_tr_b16 v[76:77], v33 offset:5248
    v_mfma_f32_16x16x32_bf16 v[24:27], v[56:59], v[80:83], v[24:27]
    ds_read_b64_tr_b16 v[78:79], v33 offset:6528
    s_waitcnt lgkmcnt(0)
    s_barrier
    ds_read_b128 v[80:83], v37 offset:24576
    ds_read_b64_tr_b16 v[40:41], v34 offset:0
    v_mfma_f32_16x16x32_bf16 v[8:11], v[60:63], v[84:87], v[8:11]
    ds_read_b64_tr_b16 v[42:43], v34 offset:1280
    ds_read_b64_tr_b16 v[44:45], v34 offset:32
    v_mfma_f32_16x16x32_bf16 v[12:15], v[64:67], v[84:87], v[12:15]
    ds_read_b64_tr_b16 v[46:47], v34 offset:1312
    ds_read_b64_tr_b16 v[48:49], v34 offset:64
    v_mfma_f32_16x16x32_bf16 v[16:19], v[68:71], v[84:87], v[16:19]
    ds_read_b64_tr_b16 v[50:51], v34 offset:1344
    ds_read_b64_tr_b16 v[52:53], v34 offset:96
    v_mfma_f32_16x16x32_bf16 v[20:23], v[72:75], v[84:87], v[20:23]
    ds_read_b64_tr_b16 v[54:55], v34 offset:1376
    ds_read_b64_tr_b16 v[56:57], v34 offset:128
    v_mfma_f32_16x16x32_bf16 v[24:27], v[76:79], v[84:87], v[24:27]
    ds_read_b64_tr_b16 v[58:59], v34 offset:1408
    s_waitcnt lgkmcnt(0)
    ds_read_b128 v[84:87], v38 offset:24576
    ds_read_b64_tr_b16 v[60:61], v34 offset:5120
    v_mfma_f32_16x16x32_bf16 v[8:11], v[40:43], v[80:83], v[8:11]
    ds_read_b64_tr_b16 v[62:63], v34 offset:6400
    ds_read_b64_tr_b16 v[64:65], v34 offset:5152
    v_mfma_f32_16x16x32_bf16 v[12:15], v[44:47], v[80:83], v[12:15]
    ds_read_b64_tr_b16 v[66:67], v34 offset:6432
    ds_read_b64_tr_b16 v[68:69], v34 offset:5184
    v_mfma_f32_16x16x32_bf16 v[16:19], v[48:51], v[80:83], v[16:19]
    ds_read_b64_tr_b16 v[70:71], v34 offset:6464
    ds_read_b64_tr_b16 v[72:73], v34 offset:5216
    v_mfma_f32_16x16x32_bf16 v[20:23], v[52:55], v[80:83], v[20:23]
    ds_read_b64_tr_b16 v[74:75], v34 offset:6496
    ds_read_b64_tr_b16 v[76:77], v34 offset:5248
    v_mfma_f32_16x16x32_bf16 v[24:27], v[56:59], v[80:83], v[24:27]
    ds_read_b64_tr_b16 v[78:79], v34 offset:6528
    s_waitcnt lgkmcnt(0)
    s_barrier
    ds_read_b128 v[80:83], v37 offset:0
    ds_read_b64_tr_b16 v[40:41], v31 offset:0
    v_mfma_f32_16x16x32_bf16 v[8:11], v[60:63], v[84:87], v[8:11]
    ds_read_b64_tr_b16 v[42:43], v31 offset:1280
    ds_read_b64_tr_b16 v[44:45], v31 offset:32
    v_mfma_f32_16x16x32_bf16 v[12:15], v[64:67], v[84:87], v[12:15]
    ds_read_b64_tr_b16 v[46:47], v31 offset:1312
    ds_read_b64_tr_b16 v[48:49], v31 offset:64
    v_mfma_f32_16x16x32_bf16 v[16:19], v[68:71], v[84:87], v[16:19]
    ds_read_b64_tr_b16 v[50:51], v31 offset:1344
    ds_read_b64_tr_b16 v[52:53], v31 offset:96
    v_mfma_f32_16x16x32_bf16 v[20:23], v[72:75], v[84:87], v[20:23]
    ds_read_b64_tr_b16 v[54:55], v31 offset:1376
    ds_read_b64_tr_b16 v[56:57], v31 offset:128
    v_mfma_f32_16x16x32_bf16 v[24:27], v[76:79], v[84:87], v[24:27]
    ds_read_b64_tr_b16 v[58:59], v31 offset:1408
    s_sub_u32 s56, s56, 1
    s_cmp_lg_u32 s56, 0
    s_cbranch_scc1 k5_kernel_loop
    s_waitcnt vmcnt(0) lgkmcnt(0)
    v_and_b32 v44, 15, v1
    v_add_u32 v44, s63, v44
    s_mov_b32 s60, 1152
    v_mul_lo_u32 v45, v44, s60
    v_lshrrev_b32 v46, 4, v1
    v_lshl_add_u32 v45, v46, 3, v45
    v_add_u32 v45, s64, v45
    v_add_u32 v40, 0, v45
    buffer_load_dwordx2 v[50:51], v40, s[36:39], 0 offen offset:0
    buffer_load_dwordx2 v[52:53], v40, s[36:39], 0 offen offset:32
    buffer_load_dwordx2 v[54:55], v40, s[36:39], 0 offen offset:64
    buffer_load_dwordx2 v[56:57], v40, s[36:39], 0 offen offset:96
    buffer_load_dwordx2 v[58:59], v40, s[36:39], 0 offen offset:128
    v_cmp_gt_u32 vcc, 32, v1
    v_mov_b32 v47, 0x40000000
    s_nop 0
    v_cndmask_b32 v48, v47, v40, vcc
    s_waitcnt vmcnt(0)
    v_cvt_pk_bf16_f32 v60, v8, v9
    v_lshlrev_b32 v61, 16, v60
    v_and_b32 v62, 0xffff0000, v60
    v_lshlrev_b32 v63, 16, v50
    v_and_b32 v64, 0xffff0000, v50
    v_add_f32 v61, v61, v63
    v_add_f32 v62, v62, v64
    v_cvt_pk_bf16_f32 v50, v61, v62
    v_cvt_pk_bf16_f32 v60, v10, v11
    v_lshlrev_b32 v61, 16, v60
    v_and_b32 v62, 0xffff0000, v60
    v_lshlrev_b32 v63, 16, v51
    v_and_b32 v64, 0xffff0000, v51
    v_add_f32 v61, v61, v63
    v_add_f32 v62, v62, v64
    v_cvt_pk_bf16_f32 v51, v61, v62
    buffer_store_dwordx2 v[50:51], v40, s[40:43], 0 offen offset:0
    v_cvt_pk_bf16_f32 v60, v12, v13
    v_lshlrev_b32 v61, 16, v60
    v_and_b32 v62, 0xffff0000, v60
    v_lshlrev_b32 v63, 16, v52
    v_and_b32 v64, 0xffff0000, v52
    v_add_f32 v61, v61, v63
    v_add_f32 v62, v62, v64
    v_cvt_pk_bf16_f32 v52, v61, v62
    v_cvt_pk_bf16_f32 v60, v14, v15
    v_lshlrev_b32 v61, 16, v60
    v_and_b32 v62, 0xffff0000, v60
    v_lshlrev_b32 v63, 16, v53
    v_and_b32 v64, 0xffff0000, v53
    v_add_f32 v61, v61, v63
    v_add_f32 v62, v62, v64
    v_cvt_pk_bf16_f32 v53, v61, v62
    buffer_store_dwordx2 v[52:53], v40, s[40:43], 0 offen offset:32
    v_cvt_pk_bf16_f32 v60, v16, v17
    v_lshlrev_b32 v61, 16, v60
    v_and_b32 v62, 0xffff0000, v60
    v_lshlrev_b32 v63, 16, v54
    v_and_b32 v64, 0xffff0000, v54
    v_add_f32 v61, v61, v63
    v_add_f32 v62, v62, v64
    v_cvt_pk_bf16_f32 v54, v61, v62
    v_cvt_pk_bf16_f32 v60, v18, v19
    v_lshlrev_b32 v61, 16, v60
    v_and_b32 v62, 0xffff0000, v60
    v_lshlrev_b32 v63, 16, v55
    v_and_b32 v64, 0xffff0000, v55
    v_add_f32 v61, v61, v63
    v_add_f32 v62, v62, v64
    v_cvt_pk_bf16_f32 v55, v61, v62
    buffer_store_dwordx2 v[54:55], v40, s[40:43], 0 offen offset:64
    v_cvt_pk_bf16_f32 v60, v20, v21
    v_lshlrev_b32 v61, 16, v60
    v_and_b32 v62, 0xffff0000, v60
    v_lshlrev_b32 v63, 16, v56
    v_and_b32 v64, 0xffff0000, v56
    v_add_f32 v61, v61, v63
    v_add_f32 v62, v62, v64
    v_cvt_pk_bf16_f32 v56, v61, v62
    v_cvt_pk_bf16_f32 v60, v22, v23
    v_lshlrev_b32 v61, 16, v60
    v_and_b32 v62, 0xffff0000, v60
    v_lshlrev_b32 v63, 16, v57
    v_and_b32 v64, 0xffff0000, v57
    v_add_f32 v61, v61, v63
    v_add_f32 v62, v62, v64
    v_cvt_pk_bf16_f32 v57, v61, v62
    buffer_store_dwordx2 v[56:57], v40, s[40:43], 0 offen offset:96
    v_cvt_pk_bf16_f32 v60, v24, v25
    v_lshlrev_b32 v61, 16, v60
    v_and_b32 v62, 0xffff0000, v60
    v_lshlrev_b32 v63, 16, v58
    v_and_b32 v64, 0xffff0000, v58
    v_add_f32 v61, v61, v63
    v_add_f32 v62, v62, v64
    v_cvt_pk_bf16_f32 v58, v61, v62
    v_cvt_pk_bf16_f32 v60, v26, v27
    v_lshlrev_b32 v61, 16, v60
    v_and_b32 v62, 0xffff0000, v60
    v_lshlrev_b32 v63, 16, v59
    v_and_b32 v64, 0xffff0000, v59
    v_add_f32 v61, v61, v63
    v_add_f32 v62, v62, v64
    v_cvt_pk_bf16_f32 v59, v61, v62
    buffer_store_dwordx2 v[58:59], v48, s[40:43], 0 offen offset:128
k5_kernel_end:
    s_endpgm
.section .rodata,"a"
.p2align 6
.amdhsa_kernel k1_kernel
  .amdhsa_next_free_vgpr 256
  .amdhsa_next_free_sgpr 100
  .amdhsa_accum_offset 256
  .amdhsa_group_segment_fixed_size 0
  .amdhsa_kernarg_size 96
  .amdhsa_user_sgpr_count 2
  .amdhsa_user_sgpr_kernarg_segment_ptr 1
  .amdhsa_system_sgpr_workgroup_id_x 1
.end_amdhsa_kernel
.p2align 6
.amdhsa_kernel k2_kernel
  .amdhsa_next_free_vgpr 256
  .amdhsa_next_free_sgpr 100
  .amdhsa_accum_offset 256
  .amdhsa_group_segment_fixed_size 0
  .amdhsa_kernarg_size 96
  .amdhsa_user_sgpr_count 2
  .amdhsa_user_sgpr_kernarg_segment_ptr 1
  .amdhsa_system_sgpr_workgroup_id_x 1
.end_amdhsa_kernel
.p2align 6
.amdhsa_kernel k3_kernel
  .amdhsa_next_free_vgpr 256
  .amdhsa_next_free_sgpr 100
  .amdhsa_accum_offset 256
  .amdhsa_group_segment_fixed_size 0
  .amdhsa_kernarg_size 96
  .amdhsa_user_sgpr_count 2
  .amdhsa_user_sgpr_kernarg_segment_ptr 1
  .amdhsa_system_sgpr_workgroup_id_x 1
.end_amdhsa_kernel
.p2align 6
.amdhsa_kernel kn_kernel
  .amdhsa_next_free_vgpr 80
  .amdhsa_next_free_sgpr 100
  .amdhsa_accum_offset 80
  .amdhsa_group_segment_fixed_size 0
  .amdhsa_kernarg_size 96
  .amdhsa_user_sgpr_count 2
  .amdhsa_user_sgpr_kernarg_segment_ptr 1
  .amdhsa_system_sgpr_workgroup_id_x 1
.end_amdhsa_kernel
.p2align 6
.amdhsa_kernel k4_kernel
  .amdhsa_next_free_vgpr 256
  .amdhsa_next_free_sgpr 100
  .amdhsa_accum_offset 256
  .amdhsa_group_segment_fixed_size 0
  .amdhsa_kernarg_size 96
  .amdhsa_user_sgpr_count 2
  .amdhsa_user_sgpr_kernarg_segment_ptr 1
  .amdhsa_system_sgpr_workgroup_id_x 1
.end_amdhsa_kernel
.p2align 6
.amdhsa_kernel k5_kernel
  .amdhsa_next_free_vgpr 216
  .amdhsa_next_free_sgpr 100
  .amdhsa_accum_offset 216
  .amdhsa_group_segment_fixed_size 0
  .amdhsa_kernarg_size 96
  .amdhsa_user_sgpr_count 2
  .amdhsa_user_sgpr_kernarg_segment_ptr 1
  .amdhsa_system_sgpr_workgroup_id_x 1
.end_amdhsa_kernel
```
